```python
import torch

def _softmax(x, axis=-1):
    return torch.softmax(x, dim=axis)
def _gelu(x):
    return torch.nn.functional.gelu(x, approximate="tanh")
def _silu(x):
    return torch.nn.functional.silu(x)
def _sigmoid(x):
    return torch.sigmoid(x)
def _layernorm(x, axis=-1, eps=1e-5):
    m = x.mean(dim=axis, keepdim=True)
    v = x.var(dim=axis, keepdim=True, unbiased=False)
    return (x - m) / torch.sqrt(v + eps)
def _scatter_add(tgt, idx, src, axis=0):
    return tgt.clone().index_add_(axis, idx, src)
def _segment_sum(src, seg, n):
    out = torch.zeros((n,) + src.shape[1:], dtype=src.dtype)
    return out.index_add_(0, seg, src)
def _pad(x, pw):
    flat = tuple(v for pair in reversed(pw) for v in pair)
    return torch.nn.functional.pad(x, flat)

kernel_name = 'gated_mix__compressed_kv_cla__swiglu_ffn__prompt'

def setup_inputs():

    _w = (lambda a: (lambda t: t.to(torch.bfloat16) if t.is_floating_point() else t)(torch.as_tensor(a)))
    def _A_setup():
        B, H, Sq, Sk, D, M = 1, 32, 2048, 2048, 128, 640
        Dc = 4 * D
        return {
            "x": _w((lambda *s: torch.randn(*s, dtype=torch.bfloat16) * 0.05)(B, Sq, M)),
            "c_kv": _w((lambda *s: torch.randn(*s, dtype=torch.bfloat16) * 0.4)(B, Sk, Dc)),
            "w_q": _w((lambda *s: torch.randn(*s, dtype=torch.bfloat16) * 6.4)(M, H, D) * (M ** -0.5)),
            "w_uk": _w((lambda *s: torch.randn(*s, dtype=torch.bfloat16) * 6.4)(Dc, H, D) * (Dc ** -0.5)),
            "w_uv": _w((lambda *s: torch.randn(*s, dtype=torch.bfloat16) * 0.4)(Dc, H, D) * (Dc ** -0.5)),
            "w_o": _w((lambda *s: torch.randn(*s, dtype=torch.bfloat16) * 0.4)(H, D, M) * ((H * D) ** -0.5)),
        }
    _A_in = _A_setup()

    def _B_setup():
        B, S, D, F = 1, 2048, 640, 1728
        return {
            "x": _w((lambda *s: torch.randn(*s, dtype=torch.bfloat16) * 0.05)(B, S, D)),
            "w_gate": _w((lambda *s: torch.randn(*s, dtype=torch.bfloat16) * 0.05)(D, F)),
            "w_up": _w((lambda *s: torch.randn(*s, dtype=torch.bfloat16) * 0.05)(D, F)),
            "w_down": _w((lambda *s: torch.randn(*s, dtype=torch.bfloat16) * 0.05)(F, D)),
        }
    _B_in = _B_setup()

    return {
        "A_x": _A_in["x"],
        "A_c_kv": _A_in["c_kv"],
        "A_w_q": _A_in["w_q"],
        "A_w_uk": _A_in["w_uk"],
        "A_w_uv": _A_in["w_uv"],
        "A_w_o": _A_in["w_o"],
        "B_x": _B_in["x"],
        "B_w_gate": _B_in["w_gate"],
        "B_w_up": _B_in["w_up"],
        "B_w_down": _B_in["w_down"],
        "gate_w": _w((lambda *s: torch.randn(*s, dtype=torch.bfloat16) * 0.05)(640) * 16.0),
    }

def reference(A_x, A_c_kv, A_w_q, A_w_uk, A_w_uv, A_w_o, B_x, B_w_gate, B_w_up, B_w_down, gate_w):
    def _A_ref(x, c_kv, w_q, w_uk, w_uv, w_o):
        B, Sq, M = x.shape[0], x.shape[1], x.shape[2]
        Sk = c_kv.shape[1]
        H, D = w_q.shape[1], w_q.shape[2]
        q = torch.einsum("bqm,mhd->bhqd", x, w_q)
        k = torch.einsum("bkc,chd->bhkd", c_kv, w_uk)
        v = torch.einsum("bkc,chd->bhkd", c_kv, w_uv)
        scores = torch.einsum("bhqd,bhkd->bhqk", q, k) * (D ** -0.5)
        off = Sk - Sq
        qi = torch.arange(Sq)[:, None]
        kj = torch.arange(Sk)[None, :]
        cmask = kj <= (qi + off)
        scores = torch.where(cmask[None, None], scores, -1e9)
        p = _softmax(scores, axis=-1)
        ctx = torch.einsum("bhqk,bhkd->bhqd", p, v)
        return torch.einsum("bhqd,hdm->bqm", ctx, w_o)

    def _B_ref(x, w_gate, w_up, w_down):
        g = _silu(x @ w_gate)
        u = x @ w_up
        return (g * u) @ w_down

    x = A_x
    g = _sigmoid((x * gate_w).sum(-1, keepdims=True))
    a = _A_ref(x, A_c_kv, A_w_q, A_w_uk, A_w_uv, A_w_o)
    b = _B_ref(x, B_w_gate, B_w_up, B_w_down)
    return g * a + (1 - g) * b
```

```asm
; @launch grid=(256,1,1) block=(256,1,1) lds=163840
.amdgcn_target "amdgcn-amd-amdhsa--gfx950"
.text
.macro rqa d, a, o
 ds_read_b128 a[\d:\d+3], v\a offset:\o
.endm
.macro rta d, a, o
 ds_read_b64_tr_b16 a[\d:\d+1], v\a offset:\o
.endm
.macro mvaaz d, a, b, c=0
 v_mfma_f32_16x16x32_bf16 v[\d:\d+3], a[\a:\a+3], a[\b:\b+3], 0
.endm
.macro mvaas d, a, b, c=0
 v_mfma_f32_16x16x32_bf16 v[\d:\d+3], a[\a:\a+3], a[\b:\b+3], v[\d:\d+3]
.endm
.macro maaaz d, a, b, c=0
 v_mfma_f32_16x16x32_bf16 a[\d:\d+3], a[\a:\a+3], a[\b:\b+3], 0
.endm
.macro maaas d, a, b, c=0
 v_mfma_f32_16x16x32_bf16 a[\d:\d+3], a[\a:\a+3], a[\b:\b+3], a[\d:\d+3]
.endm
.macro mvavz d, a, b, c=0
 v_mfma_f32_16x16x32_bf16 v[\d:\d+3], a[\a:\a+3], v[\b:\b+3], 0
.endm
.macro mvavs d, a, b, c=0
 v_mfma_f32_16x16x32_bf16 v[\d:\d+3], a[\a:\a+3], v[\b:\b+3], v[\d:\d+3]
.endm
.macro rqv d, a, o
 ds_read_b128 v[\d:\d+3], v\a offset:\o
.endm
.macro mvvvs d, a, b, c=0
 v_mfma_f32_16x16x32_bf16 v[\d:\d+3], v[\a:\a+3], v[\b:\b+3], v[\d:\d+3]
.endm
.macro rtv d, a, o
 ds_read_b64_tr_b16 v[\d:\d+1], v\a offset:\o
.endm
.macro mvvaz d, a, b, c=0
 v_mfma_f32_16x16x32_bf16 v[\d:\d+3], v[\a:\a+3], a[\b:\b+3], 0
.endm
.macro mvvas d, a, b, c=0
 v_mfma_f32_16x16x32_bf16 v[\d:\d+3], v[\a:\a+3], a[\b:\b+3], v[\d:\d+3]
.endm
.macro mvvvz d, a, b, c=0
 v_mfma_f32_16x16x32_bf16 v[\d:\d+3], v[\a:\a+3], v[\b:\b+3], 0
.endm
.globl gated_mix__compressed_kv_cla__swiglu_ffn__prompt_kernel
.p2align 8
.type gated_mix__compressed_kv_cla__swiglu_ffn__prompt_kernel,@function
gated_mix__compressed_kv_cla__swiglu_ffn__prompt_kernel:
s_cmp_ge_u32 s2, 256
s_cbranch_scc1 K_end
s_load_dwordx16 s[8:23], s[0:1], 0
s_load_dwordx8 s[24:31], s[0:1], 64
s_load_dwordx4 s[32:35], s[0:1], 96
v_lshrrev_b32 v27, 6, v0
v_and_b32 v24, 63, v0
v_readfirstlane_b32 s80, v27
v_lshrrev_b32 v25, 3, v24
v_lshrrev_b32 v26, 4, v24
s_and_b32 s94, s2, 7
s_lshr_b32 s95, s2, 3
s_lshr_b32 s3, s95, 4
s_getpc_b64 s[4:5]
K_first:
s_lshl2_add_u32 s6, s95, s80
s_mul_i32 s6, s6, (K_last-K_first)/128
s_add_u32 s4, s4, s6
s_addc_u32 s5, s5, 0
s_and_b32 s4, s4, -4
v_min_u32 v28, 17, v24
v_lshlrev_b32 v28, 6, v28
v_mov_b32 v31, s5
v_add_co_u32 v30, vcc, s4, v28
s_nop 1
v_addc_co_u32 v31, vcc, 0, v31, vcc
global_load_dword a222, v[30:31], off
s_and_b32 s4, s95, 1
s_bfe_u32 s97, s95, 0x30001
s_lshl_b32 s96, s94, 1
s_add_u32 s96, s96, s4
s_lshl_b32 s84, s80, 13
s_lshl_b32 s85, s80, 12
s_lshl_b32 s5, s97, 8
s_lshl_b32 s6, s80, 6
s_add_u32 s5, s5, s6
v_add_u32 v27, s5, v25
v_mul_u32_u24 v27, 1024, v27
v_and_b32 v28, 7, v24
v_xor_b32 v28, v28, v26
v_lshlrev_b32 v28, 4, v28
v_xor_b32 v29, 64, v28
v_add_u32 v0, v27, v28
v_add_u32 v1, v27, v29
v_add_u32 v1, 7168, v1
v_add_u32 v2, v27, v28
v_add_u32 v2, 14336, v2
v_add_u32 v3, v27, v29
v_add_u32 v3, 21504, v3
s_mov_b32 s5, 0
s_lshl_b32 s87, s80, 4
v_add_u32 v27, s87, v26
v_mul_u32_u24 v27, 8192, v27
v_add_u32 v27, s5, v27
v_and_b32 v28, 15, v24
v_lshlrev_b32 v29, 1, v26
v_xor_b32 v28, v28, v29
v_lshlrev_b32 v28, 4, v28
v_xor_b32 v29, 128, v28
v_add_u32 v12, v27, v28
v_add_u32 v13, v27, v28
v_add_u32 v13, 31744, v13
v_add_u32 v14, v27, v29
v_add_u32 v14, 63488, v14
v_add_u32 v15, v27, v29
v_add_u32 v15, 95232, v15
s_lshl_b32 s5, s96, 8
s_lshr_b32 s6, s95, 1
s_lshl_b32 s6, s6, 4
s_add_u32 s5, s5, s6
s_lshl_b32 s6, s80, 2
s_add_u32 s5, s5, s6
s_add_u32 s100, s5, 79691776
s_waitcnt lgkmcnt(0)
s_mov_b32 s36, s10
s_mov_b32 s37, s11
s_mov_b32 s38, 2097152
s_mov_b32 s39, 0x20000
s_mov_b32 s64, s34
s_mov_b32 s65, s35
s_mov_b32 s66, 268435456
s_mov_b32 s67, 0x20000
s_cmp_eq_u32 s3, 1
s_cselect_b32 s20, s16, s14
s_cselect_b32 s21, s17, s15
s_lshl_b32 s5, s96, 9
s_add_u32 s44, s20, s5
s_addc_u32 s45, s21, 0
s_sub_u32 s46, 4194304, s5
s_mov_b32 s47, 0x20000
s_add_u32 s5, s5, 256
s_add_u32 s48, s20, s5
s_addc_u32 s49, s21, 0
s_sub_u32 s50, 4194304, s5
s_mov_b32 s51, 0x20000
s_add_u32 m0, s85, 98304
s_mov_b32 s82, 0
buffer_load_dwordx4 v12, s[44:47], s82 offen offset:0 lds
buffer_load_dwordx4 v13, s[44:47], s82 offen offset:1024 lds
buffer_load_dwordx4 v14, s[44:47], s82 offen offset:2048 lds
buffer_load_dwordx4 v15, s[44:47], s82 offen offset:3072 lds
s_add_u32 m0, s85, 131072
s_mov_b32 s83, 0
buffer_load_dwordx4 v12, s[48:51], s83 offen offset:0 lds
buffer_load_dwordx4 v13, s[48:51], s83 offen offset:1024 lds
buffer_load_dwordx4 v14, s[48:51], s83 offen offset:2048 lds
buffer_load_dwordx4 v15, s[48:51], s83 offen offset:3072 lds
s_add_u32 m0, s84, 0
s_mov_b32 s81, 0
buffer_load_dwordx4 v0, s[36:39], s81 offen offset:0 lds
buffer_load_dwordx4 v1, s[36:39], s81 offen offset:1024 lds
buffer_load_dwordx4 v2, s[36:39], s81 offen offset:2048 lds
buffer_load_dwordx4 v3, s[36:39], s81 offen offset:3072 lds
s_lshr_b32 s5, s80, 1
s_lshl_b32 s5, s5, 14
s_add_u32 s5, s5, 0
v_and_b32 v27, 15, v24
v_lshlrev_b32 v28, 7, v27
v_add_u32 v28, s5, v28
v_lshrrev_b32 v27, 1, v27
v_xor_b32 v27, v27, v26
v_lshlrev_b32 v27, 4, v27
v_add_u32 v16, v28, v27
v_xor_b32 v27, 64, v27
v_add_u32 v17, v28, v27
v_add_u32 v18, 0x10000, v16
v_add_u32 v19, 0x10000, v17
v_bfe_u32 v27, v24, 2, 2
v_lshlrev_b32 v28, 3, v26
v_add_u32 v28, v28, v27
v_lshlrev_b32 v28, 8, v28
v_and_b32 v29, 3, v24
v_lshlrev_b32 v29, 3, v29
v_add_u32 v28, v28, v29
v_add_u32 v28, 98304, v28
v_and_b32 v29, 1, v26
v_lshlrev_b32 v29, 2, v29
v_or_b32 v27, v27, v29
s_and_b32 s5, s80, 1
s_lshl_b32 s5, s5, 2
v_xor_b32 v27, s5, v27
v_xor_b32 v29, 0, v27
v_lshlrev_b32 v29, 5, v29
v_add_u32 v20, v28, v29
v_xor_b32 v29, 1, v27
v_lshlrev_b32 v29, 5, v29
v_add_u32 v21, v28, v29
v_xor_b32 v29, 2, v27
v_lshlrev_b32 v29, 5, v29
v_add_u32 v22, v28, v29
v_xor_b32 v29, 3, v27
v_lshlrev_b32 v29, 5, v29
v_add_u32 v23, v28, v29
v_bfe_u32 v27, v24, 2, 2
v_lshlrev_b32 v28, 3, v26
v_add_u32 v28, v28, v27
v_lshlrev_b32 v28, 7, v28
v_and_b32 v29, 3, v24
v_lshlrev_b32 v29, 3, v29
v_add_u32 v28, v28, v29
v_add_u32 v28, 98304, v28
v_lshrrev_b32 v27, 1, v27
v_and_b32 v29, 1, v26
v_lshlrev_b32 v29, 1, v29
v_or_b32 v27, v27, v29
s_and_b32 s5, s80, 1
s_lshl_b32 s5, s5, 1
v_xor_b32 v27, s5, v27
v_xor_b32 v29, 0, v27
v_lshlrev_b32 v29, 5, v29
v_add_u32 v30, v28, v29
v_xor_b32 v29, 1, v27
v_lshlrev_b32 v29, 5, v29
v_add_u32 v31, v28, v29
s_mov_b32 s40, s8
s_mov_b32 s41, s9
s_mov_b32 s42, 2621440
s_mov_b32 s43, 0x20000
s_mov_b32 s76, s32
s_mov_b32 s77, s33
s_mov_b32 s78, 256
s_mov_b32 s79, 0x20000
s_and_b32 s4, s95, 3
s_lshr_b32 s7, s95, 2
s_lshl_b32 s5, s94, 2
s_add_u32 s5, s5, s4
s_lshl_b32 s6, s5, 8
s_add_u32 s52, s12, s6
s_addc_u32 s53, s13, 0
s_sub_u32 s54, 5242880, s6
s_mov_b32 s55, 0x20000
s_lshl_b32 s6, s5, 19
s_add_u32 s87, s6, 0
s_add_u32 s68, s34, s87
s_addc_u32 s69, s35, 0
s_mov_b32 s70, 0x80000
s_mov_b32 s71, 0x20000
s_add_u32 s87, s6, 16777216
s_add_u32 s72, s34, s87
s_addc_u32 s73, s35, 0
s_mov_b32 s74, 0x80000
s_mov_b32 s75, 0x20000
s_sub_u32 s6, s94, s7
s_and_b32 s6, s6, 7
s_mul_i32 s101, s94, 5
s_add_u32 s101, s101, s6
s_cmp_ge_u32 s6, 5
s_cselect_b32 s101, -1, s101
s_add_u32 s6, s6, 19
s_mul_i32 s98, s94, 3
s_add_u32 s98, s98, s4
s_cmp_eq_u32 s4, 3
s_cselect_b32 s98, s6, s98
s_cselect_b32 s101, s101, -1
s_lshl_b32 s6, s98, 7
s_add_u32 s56, s22, s6
s_addc_u32 s57, s23, 0
s_sub_u32 s58, 2211840, s6
s_mov_b32 s59, 0x20000
s_add_u32 s60, s24, s6
s_addc_u32 s61, s25, 0
s_sub_u32 s62, 2211840, s6
s_mov_b32 s63, 0x20000
s_mov_b32 s30, s5
s_mov_b32 s31, s7
s_lshr_b32 s32, s80, 1
s_and_b32 s33, s80, 1
s_mov_b32 s88, 0xbfb8aa3b
s_mov_b32 s89, 0xbfb8aa3b
s_cmp_eq_u32 s3, 1
s_cselect_b32 s90, 1.0, 0x3e0293ee
s_mov_b32 s91, s90
s_lshl_b32 s86, s80, 11
s_sub_u32 s4, 15, s31
s_cmp_ge_u32 s80, 2
s_cselect_b32 s4, s31, s4
s_lshl_b32 s5, s4, 7
s_lshl_b32 s6, s33, 6
s_add_u32 s5, s5, s6
v_add_u32 v27, s5, v25
v_mul_u32_u24 v27, 1280, v27
v_and_b32 v28, 7, v24
v_xor_b32 v28, v28, v26
v_lshlrev_b32 v28, 4, v28
v_xor_b32 v29, 64, v28
v_add_u32 v8, v27, v28
v_add_u32 v9, v27, v29
v_add_u32 v9, 9216, v9
v_add_u32 v10, v27, v28
v_add_u32 v10, 18432, v10
v_add_u32 v11, v27, v29
v_add_u32 v11, 27648, v11
s_mov_b32 s5, 0
s_lshl_b32 s87, s80, 4
v_add_u32 v27, s87, v25
v_mul_u32_u24 v27, 3456, v27
v_add_u32 v27, s5, v27
v_and_b32 v28, 7, v24
v_and_b32 v29, 2, v25
v_xor_b32 v28, v28, v29
v_lshlrev_b32 v28, 4, v28
v_xor_b32 v29, 64, v28
v_add_u32 v4, v27, v28
v_add_u32 v5, v27, v29
v_add_u32 v5, 26624, v5
s_lshl_b32 s5, s96, 20
s_lshl_b32 s6, s97, 16
s_add_u32 s5, s5, s6
s_lshl_b32 s6, s32, 15
s_add_u32 s5, s5, s6
s_lshl_b32 s6, s33, 12
s_add_u32 s5, s5, s6
s_lshl_b32 s6, s3, 24
s_add_u32 s5, s5, s6
v_lshlrev_b32 v27, 4, v24
v_add_u32 v6, s5, v27
s_mul_i32 s5, s4, 364
s_lshl_b32 s6, s98, 1
s_add_u32 s5, s5, s6
s_add_u32 s5, s5, s33
s_add_u32 s5, s5, 128
s_lshl_b32 s5, s5, 12
s_add_u32 s5, s5, 50331648
v_add_u32 v7, s5, v27
s_lshl_b32 s5, s96, 2
s_lshl_b32 s6, s80, 12
s_add_u32 s5, s5, s6
v_lshlrev_b32 v28, 12, v24
v_add_u32 v28, s5, v28
v_mov_b32 v27, 1
s_lshl_b32 s34, s2, 2
s_add_u32 s34, s34, s80
s_add_u32 m0, s84, 4096
s_mov_b32 s81, 32768
buffer_load_dwordx4 v0, s[36:39], s81 offen offset:0 lds
buffer_load_dwordx4 v1, s[36:39], s81 offen offset:1024 lds
buffer_load_dwordx4 v2, s[36:39], s81 offen offset:2048 lds
buffer_load_dwordx4 v3, s[36:39], s81 offen offset:3072 lds
v_mov_b32 v34, 0
buffer_store_dword v34, off, s[64:67], s100 sc1
s_lshr_b32 s5, s95, 2
s_lshl3_add_u32 s5, s5, s94
s_and_b32 s6, s95, 3
s_lshl2_add_u32 s5, s5, s6
s_lshl2_add_u32 s5, s5, s80
s_lshl2_add_u32 s5, s5, 79695872
buffer_store_dword v34, off, s[64:67], s5 sc1
s_add_u32 m0, s85, 147456
s_mov_b32 s83, 524288
buffer_load_dwordx4 v12, s[48:51], s83 offen offset:0 lds
buffer_load_dwordx4 v13, s[48:51], s83 offen offset:1024 lds
buffer_load_dwordx4 v14, s[48:51], s83 offen offset:2048 lds
buffer_load_dwordx4 v15, s[48:51], s83 offen offset:3072 lds
v_min_u32 v25, 15, v24
v_lshlrev_b32 v25, 7, v25
s_mul_i32 s35, s34, 2048
s_add_u32 s35, s35, 0
v_add_u32 v25, s35, v25
v_min_u32 v25, 2097148, v25
global_load_dword a223, v25, s[10:11]
s_mov_b32 s7, 1920
v_med3_u32 v33, v24, 16, 23
v_lshrrev_b32 v32, 3, v33
v_lshlrev_b32 v32, 19, v32
v_and_b32 v33, 7, v33
v_lshl_add_u32 v32, v33, 7, v32
v_and_b32 v33, 4, v33
v_mad_u32_u24 v32, v33, s7, v32
s_lshl2_add_u32 s6, s97, s80
s_lshl_b32 s6, s6, 14
buffer_load_dword a223, v32, s[44:47], s6 offen
s_add_u32 m0, s84, 32768
s_mov_b32 s81, 128
buffer_load_dwordx4 v0, s[36:39], s81 offen offset:0 lds
buffer_load_dwordx4 v1, s[36:39], s81 offen offset:1024 lds
buffer_load_dwordx4 v2, s[36:39], s81 offen offset:2048 lds
buffer_load_dwordx4 v3, s[36:39], s81 offen offset:3072 lds
s_waitcnt vmcnt(12)
s_barrier
rqa 96,16,0
rqa 100,17,0
rta 0,20,0
rta 2,20,1024
rta 4,20,8192
rta 6,20,9216
rta 8,21,0
rta 10,21,1024
rta 12,21,8192
rta 14,21,9216
rta 16,22,0
rta 18,22,1024
rta 20,22,8192
rta 22,22,9216
rta 24,23,0
rta 26,23,1024
rta 28,23,8192
rta 30,23,9216
rta 32,20,32768
rta 34,20,33792
rta 36,20,40960
rta 38,20,41984
rta 40,21,32768
rta 42,21,33792
rta 44,21,40960
rta 46,21,41984
rta 48,22,32768
rta 50,22,33792
rta 52,22,40960
rta 54,22,41984
rta 56,23,32768
rta 58,23,33792
rta 60,23,40960
rta 62,23,41984
rqa 104,16,2048
rqa 108,17,2048
s_cmp_eq_u32 s3, 1
s_cbranch_scc1 K_progV
s_waitcnt lgkmcnt(0)
mvaaz 128,0,96
s_add_u32 m0, s84, 36864
rqa 112,16,4096
s_mov_b32 s81, 32896
mvaas 128,4,100
buffer_load_dwordx4 v0, s[36:39], s81 offen offset:0 lds
mvaaz 160,8,96
rqa 116,17,4096
mvaas 160,12,100
buffer_load_dwordx4 v1, s[36:39], s81 offen offset:1024 lds
mvaaz 132,16,96
s_mov_b32 s82, 524288
mvaas 132,20,100
buffer_load_dwordx4 v2, s[36:39], s81 offen offset:2048 lds
mvaaz 164,24,96
mvaas 164,28,100
buffer_load_dwordx4 v3, s[36:39], s81 offen offset:3072 lds
mvaaz 144,32,96
s_add_u32 m0, s85, 114688
mvaas 144,36,100
mvaaz 176,40,96
mvaas 176,44,100
buffer_load_dwordx4 v12, s[44:47], s82 offen offset:0 lds
mvaaz 148,48,96
mvaas 148,52,100
mvaaz 180,56,96
rqa 120,16,6144
mvaas 180,60,100
buffer_load_dwordx4 v13, s[44:47], s82 offen offset:1024 lds
mvaaz 136,0,104
mvaas 136,4,108
mvaaz 168,8,104
buffer_load_dwordx4 v14, s[44:47], s82 offen offset:2048 lds
mvaas 168,12,108
rqa 124,17,6144
mvaaz 140,16,104
mvaas 140,20,108
mvaaz 172,24,104
buffer_load_dwordx4 v15, s[44:47], s82 offen offset:3072 lds
mvaas 172,28,108
mvaaz 152,32,104
mvaas 152,36,108
mvaaz 184,40,104
mvaas 184,44,108
mvaaz 156,48,104
mvaas 156,52,108
s_waitcnt vmcnt(14) lgkmcnt(0)
mvaaz 188,56,104
mvaas 188,60,108
s_barrier
mvaaz 32,0,112
s_add_u32 m0, s85, 131072
rta 64,20,49152
s_mov_b32 s83, 1048576
mvaas 32,4,116
buffer_load_dwordx4 v12, s[48:51], s83 offen offset:0 lds
mvaaz 192,8,112
rqa 96,16,8192
mvaas 192,12,116
rta 66,20,50176
mvaaz 36,16,112
rqa 100,17,8192
mvaas 36,20,116
buffer_load_dwordx4 v13, s[48:51], s83 offen offset:1024 lds
mvaaz 196,24,112
rta 68,20,57344
mvaas 196,28,116
rta 70,20,58368
mvaaz 48,32,112
mvaas 48,36,116
mvaaz 208,40,112
mvaas 208,44,116
rta 72,21,49152
mvaaz 52,48,112
mvaas 52,52,116
buffer_load_dwordx4 v14, s[48:51], s83 offen offset:2048 lds
mvaaz 212,56,112
rqa 104,16,10240
mvaas 212,60,116
rta 74,21,50176
mvaaz 40,0,120
mvaas 40,4,124
mvaaz 200,8,120
rqa 108,17,10240
mvaas 200,12,124
rta 76,21,57344
mvaaz 44,16,120
mvaas 44,20,124
buffer_load_dwordx4 v15, s[48:51], s83 offen offset:3072 lds
mvaaz 204,24,120
rta 78,21,58368
mvaas 204,28,124
mvaaz 56,32,120
mvaas 56,36,124
mvaaz 216,40,120
s_add_u32 m0, s84, 65536
rta 80,22,49152
s_mov_b32 s81, 256
mvaas 216,44,124
mvaaz 60,48,120
mvaas 60,52,124
rta 82,22,50176
mvaaz 220,56,120
rqa 112,16,12288
mvaas 220,60,124
s_waitcnt lgkmcnt(4)
mvaaz 64,0,96
mvaas 64,4,100
buffer_load_dwordx4 v0, s[36:39], s81 offen offset:0 lds
mvaaz 224,8,96
rta 84,22,57344
mvaas 224,12,100
rqa 116,17,12288
mvaaz 68,16,96
rta 86,22,58368
mvaas 68,20,100
mvaaz 228,24,96
mvaas 228,28,100
mvaaz 80,32,96
rta 88,23,49152
mvaas 80,36,100
buffer_load_dwordx4 v1, s[36:39], s81 offen offset:1024 lds
mvaaz 240,40,96
mvaas 240,44,100
mvaaz 84,48,96
rta 90,23,50176
mvaas 84,52,100
v_med3_u32 v26, v24, 24, 39
v_lshrrev_b32 v25, 3, v26
mvaaz 244,56,96
rqa 120,16,14336
v_lshlrev_b32 v25, 19, v25
mvaas 244,60,100
rta 92,23,57344
v_and_b32 v26, 7, v26
mvaaz 72,0,104
v_lshl_add_u32 v25, v26, 7, v25
v_and_b32 v26, 4, v26
mvaas 72,4,108
buffer_load_dwordx4 v2, s[36:39], s81 offen offset:2048 lds
mvaaz 232,8,104
rqa 124,17,14336
mvaas 232,12,108
s_mov_b32 s7, 1920
rta 94,23,58368
v_mad_u32_u24 v25, v26, s7, v25
mvaaz 76,16,104
s_lshl2_add_u32 s6, s97, s80
mvaas 76,20,108
mvaaz 236,24,104
mvaas 236,28,108
mvaaz 88,32,104
mvaas 88,36,108
buffer_load_dwordx4 v3, s[36:39], s81 offen offset:3072 lds
mvaaz 248,40,104
s_add_u32 m0, s84, 69632
s_mov_b32 s81, 33024
s_lshl_b32 s6, s6, 14
mvaas 248,44,108
buffer_load_dwordx4 v0, s[36:39], s81 offen offset:0 lds
mvaaz 92,48,104
mvaas 92,52,108
buffer_load_dwordx4 v1, s[36:39], s81 offen offset:1024 lds
mvaaz 252,56,104
buffer_load_dwordx4 v2, s[36:39], s81 offen offset:2048 lds
buffer_load_dwordx4 v3, s[36:39], s81 offen offset:3072 lds
buffer_load_dword a223, v25, s[44:47], s6 offen
s_waitcnt vmcnt(9) lgkmcnt(0)
mvaas 252,60,108
s_barrier
mvaaz 96,0,112
s_add_u32 m0, s85, 147456
rqa 96,16,32768
s_mov_b32 s83, 1572864
mvaas 96,4,116
buffer_load_dwordx4 v12, s[48:51], s83 offen offset:0 lds
maaaz 224,8,112
rqa 100,17,32768
maaas 224,12,116
mvaaz 100,16,112
buffer_load_dwordx4 v13, s[48:51], s83 offen offset:1024 lds
mvaas 100,20,116
maaaz 228,24,112
rqa 104,16,34816
maaas 228,28,116
mvaaz 112,32,112
mvaas 112,36,116
rqa 108,17,34816
maaaz 240,40,112
maaas 240,44,116
buffer_load_dwordx4 v14, s[48:51], s83 offen offset:2048 lds
mvaaz 116,48,112
mvaas 116,52,116
maaaz 244,56,112
maaas 244,60,116
mvaaz 104,0,120
rta 0,20,16384
mvaas 104,4,124
rta 2,20,17408
maaaz 232,8,120
buffer_load_dwordx4 v15, s[48:51], s83 offen offset:3072 lds
maaas 232,12,124
s_add_u32 m0, s85, 98304
rta 4,20,24576
s_mov_b32 s82, 1048576
mvaaz 108,16,120
rta 6,20,25600
mvaas 108,20,124
rta 8,21,16384
maaaz 236,24,120
rta 10,21,17408
maaas 236,28,124
rta 12,21,24576
mvaaz 120,32,120
rta 14,21,25600
mvaas 120,36,124
rta 16,22,16384
maaaz 248,40,120
rta 18,22,17408
maaas 248,44,124
rta 20,22,24576
mvaaz 124,48,120
rta 22,22,25600
mvaas 124,52,124
rta 24,23,16384
rta 26,23,17408
maaaz 252,56,120
buffer_load_dwordx4 v12, s[44:47], s82 offen offset:0 lds
maaas 252,60,124
s_waitcnt lgkmcnt(10)
rta 28,23,24576
rta 30,23,25600
mvaas 128,0,96
buffer_load_dwordx4 v13, s[44:47], s82 offen offset:1024 lds
mvaas 128,4,100
rta 32,20,32768
s_waitcnt lgkmcnt(11)
mvaas 160,8,96
rqa 112,16,36864
s_waitcnt lgkmcnt(10)
mvaas 160,12,100
s_waitcnt lgkmcnt(8)
mvaas 132,16,96
rqa 116,17,36864
s_waitcnt lgkmcnt(7)
mvaas 132,20,100
rta 34,20,33792
s_waitcnt lgkmcnt(6)
mvaas 164,24,96
s_waitcnt lgkmcnt(4)
mvaas 164,28,100
buffer_load_dwordx4 v14, s[44:47], s82 offen offset:2048 lds
mvaas 144,64,96
mvaas 144,68,100
mvaas 176,72,96
rta 36,20,40960
mvaas 176,76,100
v_med3_u32 v26, v24, 40, 63
v_lshrrev_b32 v25, 3, v26
mvaas 148,80,96
v_lshlrev_b32 v25, 19, v25
v_and_b32 v26, 7, v26
mvaas 148,84,100
v_lshl_add_u32 v25, v26, 7, v25
v_and_b32 v26, 4, v26
mvaas 180,88,96
buffer_load_dwordx4 v15, s[44:47], s82 offen offset:3072 lds
mvaas 180,92,100
s_add_u32 m0, s84, 0
rqa 120,16,38912
s_mov_b32 s81, 384
mvaas 136,0,104
rta 38,20,41984
mvaas 136,4,108
s_mov_b32 s7, 1920
v_mad_u32_u24 v25, v26, s7, v25
s_lshl2_add_u32 s6, s97, s80
mvaas 168,8,104
rqa 124,17,38912
s_lshl_b32 s6, s6, 14
mvaas 168,12,108
mvaas 140,16,104
mvaas 140,20,108
buffer_load_dwordx4 v0, s[36:39], s81 offen offset:0 lds
mvaas 172,24,104
rta 40,21,32768
mvaas 172,28,108
mvaas 152,64,104
buffer_load_dword a223, v25, s[44:47], s6 offen
mvaas 152,68,108
mvaas 184,72,104
rta 42,21,33792
mvaas 184,76,108
mvaas 156,80,104
buffer_load_dwordx4 v1, s[36:39], s81 offen offset:1024 lds
mvaas 156,84,108
mvaas 188,88,104
rqa 96,16,40960
mvaas 188,92,108
s_waitcnt lgkmcnt(3)
mvaas 32,0,112
rta 44,21,40960
mvaas 32,4,116
mvaas 192,8,112
rqa 100,17,40960
mvaas 192,12,116
buffer_load_dwordx4 v2, s[36:39], s81 offen offset:2048 lds
mvaas 36,16,112
mvaas 36,20,116
rta 46,21,41984
mvaas 196,24,112
mvaas 196,28,116
mvaas 48,64,112
mvaas 48,68,116
mvaas 208,72,112
buffer_load_dwordx4 v3, s[36:39], s81 offen offset:3072 lds
mvaas 208,76,116
s_add_u32 m0, s84, 4096
rta 48,22,32768
s_mov_b32 s81, 33152
mvaas 52,80,112
mvaas 52,84,116
mvaas 212,88,112
rqa 104,16,43008
mvaas 212,92,116
mvaas 40,0,120
rta 50,22,33792
mvaas 40,4,124
buffer_load_dwordx4 v0, s[36:39], s81 offen offset:0 lds
mvaas 200,8,120
rqa 108,17,43008
mvaas 200,12,124
mvaas 44,16,120
mvaas 44,20,124
mvaas 204,24,120
rta 52,22,40960
mvaas 204,28,124
mvaas 56,64,120
buffer_load_dwordx4 v1, s[36:39], s81 offen offset:1024 lds
mvaas 56,68,124
mvaas 216,72,120
mvaas 216,76,124
rta 54,22,41984
mvaas 60,80,120
mvaas 60,84,124
mvaas 220,88,120
rqa 112,16,45056
s_waitcnt lgkmcnt(3)
mvaas 220,92,124
buffer_load_dwordx4 v2, s[36:39], s81 offen offset:2048 lds
mvaas 64,0,96
mvaas 64,4,100
rta 56,23,32768
mvaas 224,8,96
rqa 116,17,45056
mvaas 224,12,100
mvaas 68,16,96
mvaas 68,20,100
mvaas 228,24,96
buffer_load_dwordx4 v3, s[36:39], s81 offen offset:3072 lds
mvaas 228,28,100
rta 58,23,33792
mvaas 80,64,96
mvaas 80,68,100
mvaas 240,72,96
mvaas 240,76,100
mvaas 84,80,96
rta 60,23,40960
mvaas 84,84,100
mvaas 244,88,96
rqa 120,16,47104
mvaas 244,92,100
mvaas 72,0,104
mvaas 72,4,108
rta 62,23,41984
mvaas 232,8,104
rqa 124,17,47104
mvaas 232,12,108
mvaas 76,16,104
mvaas 76,20,108
mvaas 236,24,104
mvaas 236,28,108
mvaas 88,64,104
mvaas 88,68,108
mvaas 248,72,104
mvaas 248,76,108
mvaas 92,80,104
mvaas 92,84,108
s_waitcnt vmcnt(9) lgkmcnt(0)
mvaas 252,88,104
mvaas 252,92,108
s_barrier
mvaas 96,0,112
s_add_u32 m0, s85, 131072
rqa 96,18,0
s_mov_b32 s83, 2097152
mvaas 96,4,116
buffer_load_dwordx4 v12, s[48:51], s83 offen offset:0 lds
maaas 224,8,112
rqa 100,19,0
maaas 224,12,116
mvaas 100,16,112
buffer_load_dwordx4 v13, s[48:51], s83 offen offset:1024 lds
mvaas 100,20,116
maaas 228,24,112
rqa 104,18,2048
maaas 228,28,116
mvaas 112,64,112
mvaas 112,68,116
rqa 108,19,2048
maaas 240,72,112
maaas 240,76,116
buffer_load_dwordx4 v14, s[48:51], s83 offen offset:2048 lds
mvaas 116,80,112
mvaas 116,84,116
maaas 244,88,112
maaas 244,92,116
mvaas 104,0,120
rta 0,20,0
mvaas 104,4,124
rta 2,20,1024
maaas 232,8,120
buffer_load_dwordx4 v15, s[48:51], s83 offen offset:3072 lds
maaas 232,12,124
s_add_u32 m0, s85, 114688
rta 4,20,8192
s_mov_b32 s82, 1572864
mvaas 108,16,120
rta 6,20,9216
mvaas 108,20,124
rta 8,21,0
maaas 236,24,120
rta 10,21,1024
maaas 236,28,124
rta 12,21,8192
mvaas 120,64,120
rta 14,21,9216
mvaas 120,68,124
rta 16,22,0
maaas 248,72,120
rta 18,22,1024
maaas 248,76,124
rta 20,22,8192
mvaas 124,80,120
rta 22,22,9216
mvaas 124,84,124
rta 24,23,0
rta 26,23,1024
maaas 252,88,120
buffer_load_dwordx4 v12, s[44:47], s82 offen offset:0 lds
maaas 252,92,124
s_waitcnt lgkmcnt(10)
rta 28,23,8192
rta 30,23,9216
mvaas 128,0,96
buffer_load_dwordx4 v13, s[44:47], s82 offen offset:1024 lds
mvaas 128,4,100
rta 64,20,49152
s_waitcnt lgkmcnt(11)
mvaas 160,8,96
rqa 112,18,4096
s_waitcnt lgkmcnt(10)
mvaas 160,12,100
s_waitcnt lgkmcnt(8)
mvaas 132,16,96
rqa 116,19,4096
s_waitcnt lgkmcnt(7)
mvaas 132,20,100
rta 66,20,50176
s_waitcnt lgkmcnt(6)
mvaas 164,24,96
s_waitcnt lgkmcnt(4)
mvaas 164,28,100
buffer_load_dwordx4 v14, s[44:47], s82 offen offset:2048 lds
mvaas 144,32,96
mvaas 144,36,100
mvaas 176,40,96
rta 68,20,57344
mvaas 176,44,100
v_min_u32 v25, 19, v24
v_lshlrev_b32 v25, 7, v25
mvaas 148,48,96
mvaas 148,52,100
mvaas 180,56,96
buffer_load_dwordx4 v15, s[44:47], s82 offen offset:3072 lds
mvaas 180,60,100
s_add_u32 m0, s84, 32768
rqa 120,18,6144
s_mov_b32 s81, 512
mvaas 136,0,104
rta 70,20,58368
mvaas 136,4,108
s_mul_i32 s35, s34, 2560
s_add_u32 s35, s35, 0
v_add_u32 v25, s35, v25
mvaas 168,8,104
rqa 124,19,6144
v_min_u32 v25, 2621436, v25
mvaas 168,12,108
mvaas 140,16,104
mvaas 140,20,108
buffer_load_dwordx4 v0, s[36:39], s81 offen offset:0 lds
mvaas 172,24,104
rta 72,21,49152
mvaas 172,28,108
mvaas 152,32,104
global_load_dword a223, v25, s[8:9]
mvaas 152,36,108
mvaas 184,40,104
rta 74,21,50176
mvaas 184,44,108
mvaas 156,48,104
buffer_load_dwordx4 v1, s[36:39], s81 offen offset:1024 lds
mvaas 156,52,108
mvaas 188,56,104
rqa 96,18,8192
mvaas 188,60,108
s_waitcnt lgkmcnt(3)
mvaas 32,0,112
rta 76,21,57344
mvaas 32,4,116
mvaas 192,8,112
rqa 100,19,8192
mvaas 192,12,116
buffer_load_dwordx4 v2, s[36:39], s81 offen offset:2048 lds
mvaas 36,16,112
mvaas 36,20,116
rta 78,21,58368
mvaas 196,24,112
mvaas 196,28,116
mvaas 48,32,112
mvaas 48,36,116
mvaas 208,40,112
buffer_load_dwordx4 v3, s[36:39], s81 offen offset:3072 lds
mvaas 208,44,116
s_add_u32 m0, s84, 36864
rta 80,22,49152
s_mov_b32 s81, 33280
mvaas 52,48,112
mvaas 52,52,116
s_and_b32 s6, s97, 3
s_cmp_eq_u32 s6, 0
s_cselect_b32 s6, 0, 4096
mvaas 212,56,112
rqa 104,18,10240
mvaas 212,60,116
mvaas 40,0,120
rta 82,22,50176
mvaas 40,4,124
buffer_load_dwordx4 v0, s[36:39], s81 offen offset:0 lds
mvaas 200,8,120
rqa 108,19,10240
mvaas 200,12,124
mvaas 44,16,120
buffer_atomic_add v27, v28, s[76:79], s6 offen sc1
mvaas 44,20,124
mvaas 204,24,120
rta 84,22,57344
mvaas 204,28,124
mvaas 56,32,120
buffer_load_dwordx4 v1, s[36:39], s81 offen offset:1024 lds
mvaas 56,36,124
mvaas 216,40,120
mvaas 216,44,124
rta 86,22,58368
mvaas 60,48,120
mvaas 60,52,124
mvaas 220,56,120
rqa 112,18,12288
s_waitcnt lgkmcnt(3)
mvaas 220,60,124
buffer_load_dwordx4 v2, s[36:39], s81 offen offset:2048 lds
mvaas 64,0,96
mvaas 64,4,100
rta 88,23,49152
mvaas 224,8,96
rqa 116,19,12288
mvaas 224,12,100
mvaas 68,16,96
mvaas 68,20,100
mvaas 228,24,96
buffer_load_dwordx4 v3, s[36:39], s81 offen offset:3072 lds
mvaas 228,28,100
rta 90,23,50176
mvaas 80,32,96
mvaas 80,36,100
mvaas 240,40,96
mvaas 240,44,100
mvaas 84,48,96
rta 92,23,57344
mvaas 84,52,100
mvaas 244,56,96
rqa 120,18,14336
mvaas 244,60,100
mvaas 72,0,104
mvaas 72,4,108
rta 94,23,58368
mvaas 232,8,104
rqa 124,19,14336
mvaas 232,12,108
mvaas 76,16,104
mvaas 76,20,108
mvaas 236,24,104
mvaas 236,28,108
mvaas 88,32,104
mvaas 88,36,108
mvaas 248,40,104
mvaas 248,44,108
mvaas 92,48,104
mvaas 92,52,108
s_waitcnt vmcnt(10) lgkmcnt(0)
mvaas 252,56,104
mvaas 252,60,108
s_barrier
mvaas 96,0,112
s_add_u32 m0, s85, 147456
rqa 96,16,0
s_mov_b32 s83, 2621440
mvaas 96,4,116
buffer_load_dwordx4 v12, s[48:51], s83 offen offset:0 lds
maaas 224,8,112
rqa 100,17,0
maaas 224,12,116
mvaas 100,16,112
buffer_load_dwordx4 v13, s[48:51], s83 offen offset:1024 lds
mvaas 100,20,116
maaas 228,24,112
rqa 104,16,2048
maaas 228,28,116
mvaas 112,32,112
mvaas 112,36,116
rqa 108,17,2048
maaas 240,40,112
maaas 240,44,116
buffer_load_dwordx4 v14, s[48:51], s83 offen offset:2048 lds
mvaas 116,48,112
mvaas 116,52,116
maaas 244,56,112
maaas 244,60,116
mvaas 104,0,120
rta 0,20,16384
mvaas 104,4,124
rta 2,20,17408
maaas 232,8,120
buffer_load_dwordx4 v15, s[48:51], s83 offen offset:3072 lds
maaas 232,12,124
s_add_u32 m0, s85, 98304
rta 4,20,24576
s_mov_b32 s82, 2097152
mvaas 108,16,120
rta 6,20,25600
mvaas 108,20,124
rta 8,21,16384
maaas 236,24,120
rta 10,21,17408
maaas 236,28,124
rta 12,21,24576
mvaas 120,32,120
rta 14,21,25600
mvaas 120,36,124
rta 16,22,16384
maaas 248,40,120
rta 18,22,17408
maaas 248,44,124
rta 20,22,24576
mvaas 124,48,120
rta 22,22,25600
mvaas 124,52,124
rta 24,23,16384
rta 26,23,17408
maaas 252,56,120
buffer_load_dwordx4 v12, s[44:47], s82 offen offset:0 lds
maaas 252,60,124
s_waitcnt lgkmcnt(10)
rta 28,23,24576
rta 30,23,25600
mvaas 128,0,96
buffer_load_dwordx4 v13, s[44:47], s82 offen offset:1024 lds
mvaas 128,4,100
rta 32,20,32768
s_waitcnt lgkmcnt(11)
mvaas 160,8,96
rqa 112,16,4096
s_waitcnt lgkmcnt(10)
mvaas 160,12,100
s_waitcnt lgkmcnt(8)
mvaas 132,16,96
rqa 116,17,4096
s_waitcnt lgkmcnt(7)
mvaas 132,20,100
rta 34,20,33792
s_waitcnt lgkmcnt(6)
mvaas 164,24,96
s_waitcnt lgkmcnt(4)
mvaas 164,28,100
buffer_load_dwordx4 v14, s[44:47], s82 offen offset:2048 lds
mvaas 144,64,96
mvaas 144,68,100
mvaas 176,72,96
rta 36,20,40960
mvaas 176,76,100
v_min_u32 v25, 19, v24
v_lshlrev_b32 v25, 7, v25
mvaas 148,80,96
mvaas 148,84,100
mvaas 180,88,96
buffer_load_dwordx4 v15, s[44:47], s82 offen offset:3072 lds
mvaas 180,92,100
s_add_u32 m0, s84, 65536
rqa 120,16,6144
s_mov_b32 s81, 640
mvaas 136,0,104
rta 38,20,41984
mvaas 136,4,108
s_mul_i32 s35, s34, 5120
s_add_u32 s35, s35, 0
v_add_u32 v25, s35, v25
mvaas 168,8,104
rqa 124,17,6144
v_min_u32 v25, 5242876, v25
mvaas 168,12,108
mvaas 140,16,104
mvaas 140,20,108
buffer_load_dwordx4 v0, s[36:39], s81 offen offset:0 lds
mvaas 172,24,104
rta 40,21,32768
mvaas 172,28,108
mvaas 152,64,104
global_load_dword a223, v25, s[12:13]
mvaas 152,68,108
mvaas 184,72,104
rta 42,21,33792
mvaas 184,76,108
mvaas 156,80,104
buffer_load_dwordx4 v1, s[36:39], s81 offen offset:1024 lds
mvaas 156,84,108
mvaas 188,88,104
rqa 96,16,8192
mvaas 188,92,108
s_waitcnt lgkmcnt(3)
mvaas 32,0,112
rta 44,21,40960
mvaas 32,4,116
mvaas 192,8,112
rqa 100,17,8192
mvaas 192,12,116
buffer_load_dwordx4 v2, s[36:39], s81 offen offset:2048 lds
mvaas 36,16,112
mvaas 36,20,116
rta 46,21,41984
mvaas 196,24,112
mvaas 196,28,116
mvaas 48,64,112
mvaas 48,68,116
mvaas 208,72,112
buffer_load_dwordx4 v3, s[36:39], s81 offen offset:3072 lds
mvaas 208,76,116
s_add_u32 m0, s84, 69632
rta 48,22,32768
s_mov_b32 s81, 33408
mvaas 52,80,112
mvaas 52,84,116
s_and_b32 s6, s97, 3
s_cmp_eq_u32 s6, 1
s_cselect_b32 s6, 0, 4096
mvaas 212,88,112
rqa 104,16,10240
mvaas 212,92,116
mvaas 40,0,120
rta 50,22,33792
mvaas 40,4,124
buffer_load_dwordx4 v0, s[36:39], s81 offen offset:0 lds
mvaas 200,8,120
rqa 108,17,10240
mvaas 200,12,124
mvaas 44,16,120
buffer_atomic_add v27, v28, s[76:79], s6 offen sc1
mvaas 44,20,124
mvaas 204,24,120
rta 52,22,40960
mvaas 204,28,124
mvaas 56,64,120
buffer_load_dwordx4 v1, s[36:39], s81 offen offset:1024 lds
mvaas 56,68,124
mvaas 216,72,120
mvaas 216,76,124
rta 54,22,41984
mvaas 60,80,120
mvaas 60,84,124
mvaas 220,88,120
rqa 112,16,12288
s_waitcnt lgkmcnt(3)
mvaas 220,92,124
buffer_load_dwordx4 v2, s[36:39], s81 offen offset:2048 lds
mvaas 64,0,96
mvaas 64,4,100
rta 56,23,32768
mvaas 224,8,96
rqa 116,17,12288
mvaas 224,12,100
mvaas 68,16,96
mvaas 68,20,100
mvaas 228,24,96
buffer_load_dwordx4 v3, s[36:39], s81 offen offset:3072 lds
mvaas 228,28,100
rta 58,23,33792
mvaas 80,64,96
mvaas 80,68,100
mvaas 240,72,96
mvaas 240,76,100
mvaas 84,80,96
rta 60,23,40960
mvaas 84,84,100
mvaas 244,88,96
rqa 120,16,14336
mvaas 244,92,100
mvaas 72,0,104
mvaas 72,4,108
rta 62,23,41984
mvaas 232,8,104
rqa 124,17,14336
mvaas 232,12,108
mvaas 76,16,104
mvaas 76,20,108
mvaas 236,24,104
mvaas 236,28,108
mvaas 88,64,104
mvaas 88,68,108
mvaas 248,72,104
mvaas 248,76,108
mvaas 92,80,104
mvaas 92,84,108
s_waitcnt vmcnt(10) lgkmcnt(0)
mvaas 252,88,104
mvaas 252,92,108
s_barrier
mvaas 96,0,112
s_add_u32 m0, s85, 131072
rqa 96,16,32768
s_mov_b32 s83, 3145728
mvaas 96,4,116
buffer_load_dwordx4 v12, s[48:51], s83 offen offset:0 lds
maaas 224,8,112
rqa 100,17,32768
maaas 224,12,116
mvaas 100,16,112
buffer_load_dwordx4 v13, s[48:51], s83 offen offset:1024 lds
mvaas 100,20,116
maaas 228,24,112
rqa 104,16,34816
maaas 228,28,116
mvaas 112,64,112
mvaas 112,68,116
rqa 108,17,34816
maaas 240,72,112
maaas 240,76,116
buffer_load_dwordx4 v14, s[48:51], s83 offen offset:2048 lds
mvaas 116,80,112
mvaas 116,84,116
maaas 244,88,112
maaas 244,92,116
mvaas 104,0,120
rta 0,20,0
mvaas 104,4,124
rta 2,20,1024
maaas 232,8,120
buffer_load_dwordx4 v15, s[48:51], s83 offen offset:3072 lds
maaas 232,12,124
s_add_u32 m0, s85, 114688
rta 4,20,8192
s_mov_b32 s82, 2621440
mvaas 108,16,120
rta 6,20,9216
mvaas 108,20,124
rta 8,21,0
maaas 236,24,120
rta 10,21,1024
maaas 236,28,124
rta 12,21,8192
mvaas 120,64,120
rta 14,21,9216
mvaas 120,68,124
rta 16,22,0
maaas 248,72,120
rta 18,22,1024
maaas 248,76,124
rta 20,22,8192
mvaas 124,80,120
rta 22,22,9216
mvaas 124,84,124
rta 24,23,0
rta 26,23,1024
maaas 252,88,120
buffer_load_dwordx4 v12, s[44:47], s82 offen offset:0 lds
maaas 252,92,124
s_waitcnt lgkmcnt(10)
rta 28,23,8192
rta 30,23,9216
mvaas 128,0,96
buffer_load_dwordx4 v13, s[44:47], s82 offen offset:1024 lds
mvaas 128,4,100
rta 64,20,49152
s_waitcnt lgkmcnt(11)
mvaas 160,8,96
rqa 112,16,36864
s_waitcnt lgkmcnt(10)
mvaas 160,12,100
s_waitcnt lgkmcnt(8)
mvaas 132,16,96
rqa 116,17,36864
s_waitcnt lgkmcnt(7)
mvaas 132,20,100
rta 66,20,50176
s_waitcnt lgkmcnt(6)
mvaas 164,24,96
s_waitcnt lgkmcnt(4)
mvaas 164,28,100
buffer_load_dwordx4 v14, s[44:47], s82 offen offset:2048 lds
mvaas 144,32,96
mvaas 144,36,100
mvaas 176,40,96
rta 68,20,57344
mvaas 176,44,100
v_min_u32 v25, 19, v24
v_lshlrev_b32 v25, 7, v25
mvaas 148,48,96
mvaas 148,52,100
mvaas 180,56,96
buffer_load_dwordx4 v15, s[44:47], s82 offen offset:3072 lds
mvaas 180,60,100
s_add_u32 m0, s84, 0
rqa 120,16,38912
s_mov_b32 s81, 768
mvaas 136,0,104
rta 70,20,58368
mvaas 136,4,108
s_mul_i32 s35, s34, 5120
s_add_u32 s35, s35, 2560
v_add_u32 v25, s35, v25
mvaas 168,8,104
rqa 124,17,38912
v_min_u32 v25, 5242876, v25
mvaas 168,12,108
mvaas 140,16,104
mvaas 140,20,108
buffer_load_dwordx4 v0, s[36:39], s81 offen offset:0 lds
mvaas 172,24,104
rta 72,21,49152
mvaas 172,28,108
mvaas 152,32,104
global_load_dword a223, v25, s[12:13]
mvaas 152,36,108
mvaas 184,40,104
rta 74,21,50176
mvaas 184,44,108
mvaas 156,48,104
buffer_load_dwordx4 v1, s[36:39], s81 offen offset:1024 lds
mvaas 156,52,108
mvaas 188,56,104
rqa 96,16,40960
mvaas 188,60,108
s_waitcnt lgkmcnt(3)
mvaas 32,0,112
rta 76,21,57344
mvaas 32,4,116
mvaas 192,8,112
rqa 100,17,40960
mvaas 192,12,116
buffer_load_dwordx4 v2, s[36:39], s81 offen offset:2048 lds
mvaas 36,16,112
mvaas 36,20,116
rta 78,21,58368
mvaas 196,24,112
mvaas 196,28,116
mvaas 48,32,112
mvaas 48,36,116
mvaas 208,40,112
buffer_load_dwordx4 v3, s[36:39], s81 offen offset:3072 lds
mvaas 208,44,116
s_add_u32 m0, s84, 4096
rta 80,22,49152
s_mov_b32 s81, 33536
mvaas 52,48,112
mvaas 52,52,116
s_and_b32 s6, s97, 3
s_cmp_eq_u32 s6, 2
s_cselect_b32 s6, 0, 4096
mvaas 212,56,112
rqa 104,16,43008
mvaas 212,60,116
mvaas 40,0,120
rta 82,22,50176
mvaas 40,4,124
buffer_load_dwordx4 v0, s[36:39], s81 offen offset:0 lds
mvaas 200,8,120
rqa 108,17,43008
mvaas 200,12,124
mvaas 44,16,120
buffer_atomic_add v27, v28, s[76:79], s6 offen sc1
mvaas 44,20,124
mvaas 204,24,120
rta 84,22,57344
mvaas 204,28,124
mvaas 56,32,120
buffer_load_dwordx4 v1, s[36:39], s81 offen offset:1024 lds
mvaas 56,36,124
mvaas 216,40,120
mvaas 216,44,124
rta 86,22,58368
mvaas 60,48,120
mvaas 60,52,124
mvaas 220,56,120
rqa 112,16,45056
s_waitcnt lgkmcnt(3)
mvaas 220,60,124
buffer_load_dwordx4 v2, s[36:39], s81 offen offset:2048 lds
mvaas 64,0,96
mvaas 64,4,100
rta 88,23,49152
mvaas 224,8,96
rqa 116,17,45056
mvaas 224,12,100
mvaas 68,16,96
mvaas 68,20,100
mvaas 228,24,96
buffer_load_dwordx4 v3, s[36:39], s81 offen offset:3072 lds
mvaas 228,28,100
rta 90,23,50176
mvaas 80,32,96
mvaas 80,36,100
mvaas 240,40,96
mvaas 240,44,100
mvaas 84,48,96
rta 92,23,57344
mvaas 84,52,100
mvaas 244,56,96
rqa 120,16,47104
mvaas 244,60,100
mvaas 72,0,104
mvaas 72,4,108
rta 94,23,58368
mvaas 232,8,104
rqa 124,17,47104
mvaas 232,12,108
mvaas 76,16,104
mvaas 76,20,108
mvaas 236,24,104
mvaas 236,28,108
mvaas 88,32,104
mvaas 88,36,108
mvaas 248,40,104
mvaas 248,44,108
mvaas 92,48,104
mvaas 92,52,108
s_waitcnt vmcnt(10) lgkmcnt(0)
mvaas 252,56,104
mvaas 252,60,108
s_barrier
mvaas 96,0,112
s_add_u32 m0, s85, 147456
rqa 96,18,0
s_mov_b32 s83, 3670016
mvaas 96,4,116
buffer_load_dwordx4 v12, s[48:51], s83 offen offset:0 lds
maaas 224,8,112
rqa 100,19,0
maaas 224,12,116
mvaas 100,16,112
buffer_load_dwordx4 v13, s[48:51], s83 offen offset:1024 lds
mvaas 100,20,116
maaas 228,24,112
rqa 104,18,2048
maaas 228,28,116
mvaas 112,32,112
mvaas 112,36,116
rqa 108,19,2048
maaas 240,40,112
maaas 240,44,116
buffer_load_dwordx4 v14, s[48:51], s83 offen offset:2048 lds
mvaas 116,48,112
mvaas 116,52,116
maaas 244,56,112
maaas 244,60,116
mvaas 104,0,120
rta 0,20,16384
mvaas 104,4,124
rta 2,20,17408
maaas 232,8,120
buffer_load_dwordx4 v15, s[48:51], s83 offen offset:3072 lds
maaas 232,12,124
s_add_u32 m0, s85, 98304
rta 4,20,24576
s_mov_b32 s82, 3145728
mvaas 108,16,120
rta 6,20,25600
mvaas 108,20,124
rta 8,21,16384
maaas 236,24,120
rta 10,21,17408
maaas 236,28,124
rta 12,21,24576
mvaas 120,32,120
rta 14,21,25600
mvaas 120,36,124
rta 16,22,16384
maaas 248,40,120
rta 18,22,17408
maaas 248,44,124
rta 20,22,24576
mvaas 124,48,120
rta 22,22,25600
mvaas 124,52,124
rta 24,23,16384
rta 26,23,17408
maaas 252,56,120
buffer_load_dwordx4 v12, s[44:47], s82 offen offset:0 lds
maaas 252,60,124
s_waitcnt lgkmcnt(10)
rta 28,23,24576
rta 30,23,25600
mvaas 128,0,96
buffer_load_dwordx4 v13, s[44:47], s82 offen offset:1024 lds
mvaas 128,4,100
rta 32,20,32768
s_waitcnt lgkmcnt(11)
mvaas 160,8,96
rqa 112,18,4096
s_waitcnt lgkmcnt(10)
mvaas 160,12,100
s_waitcnt lgkmcnt(8)
mvaas 132,16,96
rqa 116,19,4096
s_waitcnt lgkmcnt(7)
mvaas 132,20,100
rta 34,20,33792
s_waitcnt lgkmcnt(6)
mvaas 164,24,96
s_waitcnt lgkmcnt(4)
mvaas 164,28,100
buffer_load_dwordx4 v14, s[44:47], s82 offen offset:2048 lds
mvaas 144,64,96
mvaas 144,68,100
mvaas 176,72,96
rta 36,20,40960
mvaas 176,76,100
v_min_u32 v25, 17, v24
v_lshlrev_b32 v25, 7, v25
mvaas 148,80,96
mvaas 148,84,100
mvaas 180,88,96
buffer_load_dwordx4 v15, s[44:47], s82 offen offset:3072 lds
mvaas 180,92,100
s_add_u32 m0, s84, 32768
rqa 120,18,6144
s_mov_b32 s81, 896
mvaas 136,0,104
rta 38,20,41984
mvaas 136,4,108
s_mul_i32 s35, s34, 2160
s_add_u32 s35, s35, 0
v_add_u32 v25, s35, v25
mvaas 168,8,104
rqa 124,19,6144
v_min_u32 v25, 2211836, v25
mvaas 168,12,108
mvaas 140,16,104
mvaas 140,20,108
buffer_load_dwordx4 v0, s[36:39], s81 offen offset:0 lds
mvaas 172,24,104
rta 40,21,32768
mvaas 172,28,108
mvaas 152,64,104
global_load_dword a223, v25, s[22:23]
mvaas 152,68,108
mvaas 184,72,104
rta 42,21,33792
mvaas 184,76,108
mvaas 156,80,104
buffer_load_dwordx4 v1, s[36:39], s81 offen offset:1024 lds
mvaas 156,84,108
mvaas 188,88,104
rqa 96,18,8192
mvaas 188,92,108
s_waitcnt lgkmcnt(3)
mvaas 32,0,112
rta 44,21,40960
mvaas 32,4,116
mvaas 192,8,112
rqa 100,19,8192
mvaas 192,12,116
buffer_load_dwordx4 v2, s[36:39], s81 offen offset:2048 lds
mvaas 36,16,112
mvaas 36,20,116
rta 46,21,41984
mvaas 196,24,112
mvaas 196,28,116
mvaas 48,64,112
mvaas 48,68,116
mvaas 208,72,112
buffer_load_dwordx4 v3, s[36:39], s81 offen offset:3072 lds
mvaas 208,76,116
s_add_u32 m0, s84, 36864
rta 48,22,32768
s_mov_b32 s81, 33664
mvaas 52,80,112
mvaas 52,84,116
s_and_b32 s6, s97, 3
s_cmp_eq_u32 s6, 3
s_cselect_b32 s6, 0, 4096
mvaas 212,88,112
rqa 104,18,10240
mvaas 212,92,116
mvaas 40,0,120
rta 50,22,33792
mvaas 40,4,124
buffer_load_dwordx4 v0, s[36:39], s81 offen offset:0 lds
mvaas 200,8,120
rqa 108,19,10240
mvaas 200,12,124
mvaas 44,16,120
buffer_atomic_add v27, v28, s[76:79], s6 offen sc1
mvaas 44,20,124
mvaas 204,24,120
rta 52,22,40960
mvaas 204,28,124
mvaas 56,64,120
buffer_load_dwordx4 v1, s[36:39], s81 offen offset:1024 lds
mvaas 56,68,124
mvaas 216,72,120
mvaas 216,76,124
rta 54,22,41984
mvaas 60,80,120
mvaas 60,84,124
mvaas 220,88,120
rqa 112,18,12288
s_waitcnt lgkmcnt(3)
mvaas 220,92,124
buffer_load_dwordx4 v2, s[36:39], s81 offen offset:2048 lds
mvaas 64,0,96
mvaas 64,4,100
rta 56,23,32768
mvaas 224,8,96
rqa 116,19,12288
mvaas 224,12,100
mvaas 68,16,96
mvaas 68,20,100
mvaas 228,24,96
buffer_load_dwordx4 v3, s[36:39], s81 offen offset:3072 lds
mvaas 228,28,100
rta 58,23,33792
mvaas 80,64,96
mvaas 80,68,100
mvaas 240,72,96
mvaas 240,76,100
mvaas 84,80,96
rta 60,23,40960
mvaas 84,84,100
mvaas 244,88,96
rqa 120,18,14336
mvaas 244,92,100
mvaas 72,0,104
mvaas 72,4,108
rta 62,23,41984
mvaas 232,8,104
rqa 124,19,14336
mvaas 232,12,108
mvaas 76,16,104
mvaas 76,20,108
mvaas 236,24,104
mvaas 236,28,108
mvaas 88,64,104
mvaas 88,68,108
mvaas 248,72,104
mvaas 248,76,108
mvaas 92,80,104
mvaas 92,84,108
s_waitcnt vmcnt(10) lgkmcnt(0)
mvaas 252,88,104
mvaas 252,92,108
s_barrier
mvaas 96,0,112
s_add_u32 m0, s86, 131072
rqa 96,16,0
s_mov_b32 s83, 0
mvaas 96,4,116
buffer_load_dwordx4 v4, s[56:59], s83 offen offset:0 lds
maaas 224,8,112
rqa 100,17,0
maaas 224,12,116
mvaas 100,16,112
buffer_load_dwordx4 v5, s[56:59], s83 offen offset:1024 lds
mvaas 100,20,116
s_add_u32 m0, s86, 139264
maaas 228,24,112
rqa 104,16,2048
maaas 228,28,116
mvaas 112,64,112
mvaas 112,68,116
rqa 108,17,2048
maaas 240,72,112
maaas 240,76,116
buffer_load_dwordx4 v4, s[60:63], s83 offen offset:0 lds
mvaas 116,80,112
mvaas 116,84,116
maaas 244,88,112
maaas 244,92,116
mvaas 104,0,120
rta 0,20,0
mvaas 104,4,124
rta 2,20,1024
maaas 232,8,120
buffer_load_dwordx4 v5, s[60:63], s83 offen offset:1024 lds
maaas 232,12,124
s_add_u32 m0, s85, 114688
rta 4,20,8192
s_mov_b32 s82, 3670016
mvaas 108,16,120
rta 6,20,9216
mvaas 108,20,124
rta 8,21,0
maaas 236,24,120
rta 10,21,1024
maaas 236,28,124
rta 12,21,8192
mvaas 120,64,120
rta 14,21,9216
mvaas 120,68,124
rta 16,22,0
maaas 248,72,120
rta 18,22,1024
maaas 248,76,124
rta 20,22,8192
mvaas 124,80,120
rta 22,22,9216
mvaas 124,84,124
rta 24,23,0
rta 26,23,1024
maaas 252,88,120
buffer_load_dwordx4 v12, s[44:47], s82 offen offset:0 lds
maaas 252,92,124
s_waitcnt lgkmcnt(10)
rta 28,23,8192
rta 30,23,9216
mvaas 128,0,96
buffer_load_dwordx4 v13, s[44:47], s82 offen offset:1024 lds
mvaas 128,4,100
rta 64,20,49152
s_waitcnt lgkmcnt(11)
mvaas 160,8,96
rqa 112,16,4096
s_waitcnt lgkmcnt(10)
mvaas 160,12,100
s_waitcnt lgkmcnt(8)
mvaas 132,16,96
rqa 116,17,4096
s_waitcnt lgkmcnt(7)
mvaas 132,20,100
rta 66,20,50176
s_waitcnt lgkmcnt(6)
mvaas 164,24,96
s_waitcnt lgkmcnt(4)
mvaas 164,28,100
buffer_load_dwordx4 v14, s[44:47], s82 offen offset:2048 lds
mvaas 144,32,96
mvaas 144,36,100
mvaas 176,40,96
rta 68,20,57344
mvaas 176,44,100
v_min_u32 v25, 17, v24
v_lshlrev_b32 v25, 7, v25
mvaas 148,48,96
mvaas 148,52,100
mvaas 180,56,96
buffer_load_dwordx4 v15, s[44:47], s82 offen offset:3072 lds
mvaas 180,60,100
s_add_u32 m0, s84, 65536
rqa 120,16,6144
s_mov_b32 s81, 0
mvaas 136,0,104
rta 70,20,58368
mvaas 136,4,108
s_mul_i32 s35, s34, 2160
s_add_u32 s35, s35, 0
v_add_u32 v25, s35, v25
mvaas 168,8,104
rqa 124,17,6144
v_min_u32 v25, 2211836, v25
mvaas 168,12,108
mvaas 140,16,104
mvaas 140,20,108
buffer_load_dwordx4 v8, s[40:43], s81 offen offset:0 lds
mvaas 172,24,104
rta 72,21,49152
mvaas 172,28,108
mvaas 152,32,104
global_load_dword a223, v25, s[24:25]
mvaas 152,36,108
mvaas 184,40,104
rta 74,21,50176
mvaas 184,44,108
mvaas 156,48,104
buffer_load_dwordx4 v9, s[40:43], s81 offen offset:1024 lds
mvaas 156,52,108
mvaas 188,56,104
rqa 96,16,8192
mvaas 188,60,108
s_waitcnt lgkmcnt(3)
mvaas 32,0,112
rta 76,21,57344
mvaas 32,4,116
mvaas 192,8,112
rqa 100,17,8192
mvaas 192,12,116
buffer_load_dwordx4 v10, s[40:43], s81 offen offset:2048 lds
mvaas 36,16,112
mvaas 36,20,116
rta 78,21,58368
mvaas 196,24,112
mvaas 196,28,116
mvaas 48,32,112
mvaas 48,36,116
mvaas 208,40,112
buffer_load_dwordx4 v11, s[40:43], s81 offen offset:3072 lds
mvaas 208,44,116
s_add_u32 m0, s84, 69632
rta 80,22,49152
s_mov_b32 s81, 40960
mvaas 52,48,112
mvaas 52,52,116
mvaas 212,56,112
rqa 104,16,10240
mvaas 212,60,116
mvaas 40,0,120
rta 82,22,50176
mvaas 40,4,124
buffer_load_dwordx4 v8, s[40:43], s81 offen offset:0 lds
mvaas 200,8,120
rqa 108,17,10240
mvaas 200,12,124
mvaas 44,16,120
mvaas 44,20,124
mvaas 204,24,120
rta 84,22,57344
mvaas 204,28,124
mvaas 56,32,120
buffer_load_dwordx4 v9, s[40:43], s81 offen offset:1024 lds
mvaas 56,36,124
mvaas 216,40,120
mvaas 216,44,124
rta 86,22,58368
mvaas 60,48,120
mvaas 60,52,124
mvaas 220,56,120
rqa 112,16,12288
s_waitcnt lgkmcnt(3)
mvaas 220,60,124
buffer_load_dwordx4 v10, s[40:43], s81 offen offset:2048 lds
mvaas 64,0,96
mvaas 64,4,100
rta 88,23,49152
mvaas 224,8,96
rqa 116,17,12288
mvaas 224,12,100
mvaas 68,16,96
mvaas 68,20,100
mvaas 228,24,96
buffer_load_dwordx4 v11, s[40:43], s81 offen offset:3072 lds
mvaas 228,28,100
rta 90,23,50176
mvaas 80,32,96
mvaas 80,36,100
mvaas 240,40,96
mvaas 240,44,100
mvaas 84,48,96
rta 92,23,57344
mvaas 84,52,100
mvaas 244,56,96
rqa 120,16,14336
mvaas 244,60,100
mvaas 72,0,104
mvaas 72,4,108
rta 94,23,58368
mvaas 232,8,104
rqa 124,17,14336
mvaas 232,12,108
mvaas 76,16,104
mvaas 76,20,108
mvaas 236,24,104
mvaas 236,28,108
mvaas 88,32,104
mvaas 88,36,108
mvaas 248,40,104
mvaas 248,44,108
mvaas 92,48,104
mvaas 92,52,108
s_waitcnt vmcnt(9) lgkmcnt(0)
mvaas 252,56,104
mvaas 252,60,108
s_barrier
mvaas 96,0,112
s_add_u32 m0, s86, 147456
rqa 96,16,32768
s_mov_b32 s83, 221184
mvaas 96,4,116
buffer_load_dwordx4 v4, s[56:59], s83 offen offset:0 lds
maaas 224,8,112
rqa 100,17,32768
maaas 224,12,116
mvaas 100,16,112
buffer_load_dwordx4 v5, s[56:59], s83 offen offset:1024 lds
mvaas 100,20,116
s_add_u32 m0, s86, 155648
maaas 228,24,112
rqa 104,16,34816
maaas 228,28,116
mvaas 112,32,112
mvaas 112,36,116
rqa 108,17,34816
maaas 240,40,112
maaas 240,44,116
buffer_load_dwordx4 v4, s[60:63], s83 offen offset:0 lds
mvaas 116,48,112
mvaas 116,52,116
maaas 244,56,112
maaas 244,60,116
mvaas 104,0,120
rta 0,20,16384
mvaas 104,4,124
rta 2,20,17408
maaas 232,8,120
buffer_load_dwordx4 v5, s[60:63], s83 offen offset:1024 lds
maaas 232,12,124
s_add_u32 m0, s85, 98304
rta 4,20,24576
s_mov_b32 s82, 0
mvaas 108,16,120
rta 6,20,25600
mvaas 108,20,124
rta 8,21,16384
maaas 236,24,120
rta 10,21,17408
maaas 236,28,124
rta 12,21,24576
mvaas 120,32,120
rta 14,21,25600
mvaas 120,36,124
rta 16,22,16384
maaas 248,40,120
rta 18,22,17408
maaas 248,44,124
rta 20,22,24576
mvaas 124,48,120
rta 22,22,25600
mvaas 124,52,124
rta 24,23,16384
rta 26,23,17408
maaas 252,56,120
buffer_load_dwordx4 v12, s[52:55], s82 offen offset:0 lds
maaas 252,60,124
s_waitcnt lgkmcnt(10)
rta 28,23,24576
rta 30,23,25600
mvaas 128,0,96
buffer_load_dwordx4 v13, s[52:55], s82 offen offset:1024 lds
mvaas 128,4,100
rta 32,30,32768
s_waitcnt lgkmcnt(11)
mvaas 160,8,96
rqa 112,16,36864
s_waitcnt lgkmcnt(10)
mvaas 160,12,100
s_waitcnt lgkmcnt(8)
mvaas 132,16,96
rqa 116,17,36864
s_waitcnt lgkmcnt(7)
mvaas 132,20,100
rta 34,30,33280
s_waitcnt lgkmcnt(6)
mvaas 164,24,96
s_waitcnt lgkmcnt(4)
mvaas 164,28,100
buffer_load_dwordx4 v14, s[52:55], s82 offen offset:2048 lds
mvaas 144,64,96
mvaas 144,68,100
mvaas 176,72,96
rta 36,30,36864
mvaas 176,76,100
mvaas 148,80,96
mvaas 148,84,100
mvaas 180,88,96
buffer_load_dwordx4 v15, s[52:55], s82 offen offset:3072 lds
mvaas 180,92,100
s_add_u32 m0, s84, 0
rqa 120,16,38912
s_mov_b32 s81, 128
mvaas 136,0,104
rta 38,30,37376
mvaas 136,4,108
v_mul_f32 v128, s90, v128
v_mul_f32 v129, s90, v129
mvaas 168,8,104
rqa 124,17,38912
v_mul_f32 v130, s90, v130
mvaas 168,12,108
v_mul_f32 v131, s90, v131
v_mul_f32 v160, s90, v160
mvaas 140,16,104
v_mul_f32 v161, s90, v161
v_mul_f32 v162, s90, v162
mvaas 140,20,108
rta 40,31,32768
v_mul_f32 v163, s90, v163
mvaas 172,24,104
buffer_load_dwordx4 v8, s[40:43], s81 offen offset:0 lds
mvaas 172,28,108
v_cvt_pk_bf16_f32 v128, v128, v129
v_cvt_pk_bf16_f32 v129, v130, v131
mvaas 152,64,104
v_cvt_pk_bf16_f32 v130, v160, v161
v_cvt_pk_bf16_f32 v131, v162, v163
mvaas 152,68,108
v_mul_f32 v132, s90, v132
v_mul_f32 v133, s90, v133
mvaas 184,72,104
rta 42,31,33280
v_mul_f32 v134, s90, v134
mvaas 184,76,108
v_mul_f32 v135, s90, v135
v_mul_f32 v164, s90, v164
mvaas 156,80,104
buffer_load_dwordx4 v9, s[40:43], s81 offen offset:1024 lds
mvaas 156,84,108
v_mul_f32 v165, s90, v165
v_mul_f32 v166, s90, v166
mvaas 188,88,104
rqa 96,16,40960
v_mul_f32 v167, s90, v167
mvaas 188,92,108
s_waitcnt lgkmcnt(3)
v_cvt_pk_bf16_f32 v132, v132, v133
v_cvt_pk_bf16_f32 v133, v134, v135
mvaas 32,0,112
rta 44,31,36864
v_cvt_pk_bf16_f32 v134, v164, v165
mvaas 32,4,116
v_cvt_pk_bf16_f32 v135, v166, v167
v_mul_f32 v136, s90, v136
mvaas 192,8,112
rqa 100,17,40960
v_mul_f32 v137, s90, v137
mvaas 192,12,116
buffer_load_dwordx4 v10, s[40:43], s81 offen offset:2048 lds
mvaas 36,16,112
v_mul_f32 v138, s90, v138
v_mul_f32 v139, s90, v139
mvaas 36,20,116
rta 46,31,37376
v_mul_f32 v168, s90, v168
mvaas 196,24,112
v_mul_f32 v169, s90, v169
v_mul_f32 v170, s90, v170
mvaas 196,28,116
v_mul_f32 v171, s90, v171
v_cvt_pk_bf16_f32 v136, v136, v137
mvaas 48,64,112
v_cvt_pk_bf16_f32 v137, v138, v139
v_cvt_pk_bf16_f32 v138, v168, v169
mvaas 48,68,116
v_cvt_pk_bf16_f32 v139, v170, v171
v_mul_f32 v140, s90, v140
mvaas 208,72,112
buffer_load_dwordx4 v11, s[40:43], s81 offen offset:3072 lds
mvaas 208,76,116
s_add_u32 m0, s84, 4096
rta 48,30,40960
v_mul_f32 v141, s90, v141
mvaas 52,80,112
s_mov_b32 s81, 41088
v_mul_f32 v142, s90, v142
v_mul_f32 v143, s90, v143
mvaas 52,84,116
v_mul_f32 v172, s90, v172
v_mul_f32 v173, s90, v173
mvaas 212,88,112
rqa 104,16,43008
v_mul_f32 v174, s90, v174
mvaas 212,92,116
v_mul_f32 v175, s90, v175
v_cvt_pk_bf16_f32 v140, v140, v141
mvaas 40,0,120
rta 50,30,41472
v_cvt_pk_bf16_f32 v141, v142, v143
mvaas 40,4,124
buffer_load_dwordx4 v8, s[40:43], s81 offen offset:0 lds
mvaas 200,8,120
rqa 108,17,43008
v_cvt_pk_bf16_f32 v142, v172, v173
mvaas 200,12,124
v_cvt_pk_bf16_f32 v143, v174, v175
v_mul_f32 v144, s90, v144
mvaas 44,16,120
v_mul_f32 v145, s90, v145
v_mul_f32 v146, s90, v146
mvaas 44,20,124
v_mul_f32 v147, s90, v147
v_mul_f32 v176, s90, v176
mvaas 204,24,120
rta 52,30,45056
v_mul_f32 v177, s90, v177
mvaas 204,28,124
v_mul_f32 v178, s90, v178
v_mul_f32 v179, s90, v179
mvaas 56,64,120
v_cvt_pk_bf16_f32 v144, v144, v145
v_cvt_pk_bf16_f32 v145, v146, v147
mvaas 56,68,124
v_cvt_pk_bf16_f32 v146, v176, v177
v_cvt_pk_bf16_f32 v147, v178, v179
mvaas 216,72,120
buffer_load_dwordx4 v9, s[40:43], s81 offen offset:1024 lds
mvaas 216,76,124
v_mul_f32 v148, s90, v148
v_mul_f32 v149, s90, v149
mvaas 60,80,120
s_mov_b32 s87, 0
v_mul_f32 v150, s90, v150
v_mul_f32 v151, s90, v151
mvaas 60,84,124
rta 54,30,45568
v_mul_f32 v180, s90, v180
mvaas 220,88,120
v_mul_f32 v181, s90, v181
v_mul_f32 v182, s90, v182
mvaas 220,92,124
s_waitcnt lgkmcnt(2)
v_mul_f32 v183, s90, v183
v_cvt_pk_bf16_f32 v148, v148, v149
mvaas 64,0,96
rqa 112,16,45056
v_cvt_pk_bf16_f32 v149, v150, v151
mvaas 64,4,100
v_cvt_pk_bf16_f32 v150, v180, v181
v_cvt_pk_bf16_f32 v151, v182, v183
mvaas 224,8,96
v_mul_f32 v152, s90, v152
v_mul_f32 v153, s90, v153
mvaas 224,12,100
v_mul_f32 v154, s90, v154
v_mul_f32 v155, s90, v155
mvaas 68,16,96
buffer_load_dwordx4 v10, s[40:43], s81 offen offset:2048 lds
mvaas 68,20,100
rta 56,31,40960
v_mul_f32 v184, s90, v184
mvaas 228,24,96
v_mul_f32 v185, s90, v185
v_mul_f32 v186, s90, v186
mvaas 228,28,100
buffer_store_dwordx4 v[128:131], v6, s[64:67], s87 offen offset:0 sc1
rqa 116,17,45056
v_mul_f32 v187, s90, v187
v_cvt_pk_bf16_f32 v152, v152, v153
mvaas 80,64,96
s_mov_b32 s87, 0
v_cvt_pk_bf16_f32 v153, v154, v155
v_cvt_pk_bf16_f32 v154, v184, v185
mvaas 80,68,100
v_cvt_pk_bf16_f32 v155, v186, v187
v_mul_f32 v156, s90, v156
v_mul_f32 v157, s90, v157
mvaas 240,72,96
v_mul_f32 v158, s90, v158
v_mul_f32 v159, s90, v159
mvaas 240,76,100
rta 58,31,41472
v_mul_f32 v188, s90, v188
v_mul_f32 v189, s90, v189
mvaas 84,80,96
buffer_load_dwordx4 v11, s[40:43], s81 offen offset:3072 lds
v_mul_f32 v190, s90, v190
v_mul_f32 v191, s90, v191
mvaas 84,84,100
v_cvt_pk_bf16_f32 v156, v156, v157
v_cvt_pk_bf16_f32 v157, v158, v159
mvaas 244,88,96
v_cvt_pk_bf16_f32 v158, v188, v189
v_cvt_pk_bf16_f32 v159, v190, v191
mvaas 244,92,100
buffer_store_dwordx4 v[132:135], v6, s[64:67], s87 offen offset:1024 sc1
v_mul_f32 v32, s90, v32
v_mul_f32 v33, s90, v33
v_mul_f32 v34, s90, v34
mvaas 72,0,104
s_mov_b32 s87, 0
rta 60,31,45056
v_mul_f32 v35, s90, v35
mvaas 72,4,108
v_mul_f32 v192, s90, v192
v_mul_f32 v193, s90, v193
mvaas 232,8,104
v_mul_f32 v194, s90, v194
v_mul_f32 v195, s90, v195
mvaas 232,12,108
rqa 120,16,47104
v_cvt_pk_bf16_f32 v32, v32, v33
v_cvt_pk_bf16_f32 v33, v34, v35
mvaas 76,16,104
v_cvt_pk_bf16_f32 v34, v192, v193
v_cvt_pk_bf16_f32 v35, v194, v195
mvaas 76,20,108
v_mul_f32 v36, s90, v36
v_mul_f32 v37, s90, v37
mvaas 236,24,104
rta 62,31,45568
v_mul_f32 v38, s90, v38
v_mul_f32 v39, s90, v39
mvaas 236,28,108
buffer_store_dwordx4 v[136:139], v6, s[64:67], s87 offen offset:2048 sc1
rqa 124,17,47104
v_mul_f32 v196, s90, v196
v_mul_f32 v197, s90, v197
mvaas 88,64,104
s_mov_b32 s87, 0
v_mul_f32 v198, s90, v198
v_mul_f32 v199, s90, v199
mvaas 88,68,108
v_cvt_pk_bf16_f32 v36, v36, v37
v_cvt_pk_bf16_f32 v37, v38, v39
mvaas 248,72,104
v_cvt_pk_bf16_f32 v38, v196, v197
v_cvt_pk_bf16_f32 v39, v198, v199
mvaas 248,76,108
v_mul_f32 v40, s90, v40
v_mul_f32 v41, s90, v41
mvaas 92,80,104
v_mul_f32 v42, s90, v42
v_mul_f32 v43, s90, v43
mvaas 92,84,108
v_mul_f32 v200, s90, v200
v_mul_f32 v201, s90, v201
mvaas 252,88,104
buffer_store_dwordx4 v[140:143], v6, s[64:67], s87 offen offset:3072 sc1
v_mul_f32 v202, s90, v202
v_mul_f32 v203, s90, v203
v_cvt_pk_bf16_f32 v40, v40, v41
v_cvt_pk_bf16_f32 v41, v42, v43
s_waitcnt vmcnt(12) lgkmcnt(0)
mvaas 252,92,108
s_barrier
mvaas 96,0,112
s_add_u32 m0, s86, 131072
s_mov_b32 s83, 442368
rqa 96,18,0
mvaas 96,4,116
v_cvt_pk_bf16_f32 v42, v200, v201
v_cvt_pk_bf16_f32 v43, v202, v203
v_mul_f32 v44, s90, v44
maaas 224,8,112
buffer_load_dwordx4 v4, s[56:59], s83 offen offset:0 lds
v_mul_f32 v45, s90, v45
maaas 224,12,116
v_mul_f32 v46, s90, v46
v_mul_f32 v47, s90, v47
v_mul_f32 v204, s90, v204
mvaas 100,16,112
v_mul_f32 v205, s90, v205
v_mul_f32 v206, s90, v206
v_mul_f32 v207, s90, v207
mvaas 100,20,116
v_cvt_pk_bf16_f32 v44, v44, v45
v_cvt_pk_bf16_f32 v45, v46, v47
maaas 228,24,112
rqa 100,19,0
v_cvt_pk_bf16_f32 v46, v204, v205
maaas 228,28,116
v_cvt_pk_bf16_f32 v47, v206, v207
v_mul_f32 v48, s90, v48
mvaas 112,64,112
v_mul_f32 v49, s90, v49
v_mul_f32 v50, s90, v50
mvaas 112,68,116
buffer_load_dwordx4 v5, s[56:59], s83 offen offset:1024 lds
maaas 240,72,112
s_add_u32 m0, s86, 139264
v_mul_f32 v51, s90, v51
v_mul_f32 v208, s90, v208
maaas 240,76,116
rqa 104,18,2048
v_mul_f32 v209, s90, v209
v_mul_f32 v210, s90, v210
mvaas 116,80,112
v_mul_f32 v211, s90, v211
v_cvt_pk_bf16_f32 v48, v48, v49
mvaas 116,84,116
v_cvt_pk_bf16_f32 v49, v50, v51
v_cvt_pk_bf16_f32 v50, v208, v209
maaas 244,88,112
rqa 108,19,2048
v_cvt_pk_bf16_f32 v51, v210, v211
v_mul_f32 v52, s90, v52
maaas 244,92,116
v_mul_f32 v53, s90, v53
v_mul_f32 v54, s90, v54
mvaas 104,0,120
v_mul_f32 v55, s90, v55
v_mul_f32 v212, s90, v212
mvaas 104,4,124
buffer_load_dwordx4 v4, s[60:63], s83 offen offset:0 lds
v_mul_f32 v213, s90, v213
maaas 232,8,120
v_mul_f32 v214, s90, v214
v_mul_f32 v215, s90, v215
maaas 232,12,124
rta 0,20,0
v_cvt_pk_bf16_f32 v52, v52, v53
v_cvt_pk_bf16_f32 v53, v54, v55
mvaas 108,16,120
rta 2,20,1024
v_cvt_pk_bf16_f32 v54, v212, v213
v_cvt_pk_bf16_f32 v55, v214, v215
mvaas 108,20,124
rta 4,20,8192
v_mul_f32 v56, s90, v56
v_mul_f32 v57, s90, v57
maaas 236,24,120
s_mov_b32 s82, 524288
rta 6,20,9216
v_mul_f32 v58, s90, v58
v_mul_f32 v59, s90, v59
maaas 236,28,124
rta 8,21,0
v_mul_f32 v216, s90, v216
v_mul_f32 v217, s90, v217
mvaas 120,64,120
buffer_load_dwordx4 v5, s[60:63], s83 offen offset:1024 lds
rta 10,21,1024
v_mul_f32 v218, s90, v218
v_mul_f32 v219, s90, v219
mvaas 120,68,124
s_add_u32 m0, s85, 114688
rta 12,21,8192
v_cvt_pk_bf16_f32 v56, v56, v57
maaas 248,72,120
s_cmp_lg_u32 s101, -1
rta 14,21,9216
v_cvt_pk_bf16_f32 v57, v58, v59
v_cvt_pk_bf16_f32 v58, v216, v217
maaas 248,76,124
rta 16,22,0
v_cvt_pk_bf16_f32 v59, v218, v219
v_mul_f32 v60, s90, v60
mvaas 124,80,120
rta 18,22,1024
v_mul_f32 v61, s90, v61
v_mul_f32 v62, s90, v62
mvaas 124,84,124
rta 20,22,8192
v_mul_f32 v63, s90, v63
v_mul_f32 v220, s90, v220
maaas 252,88,120
buffer_load_dwordx4 v12, s[52:55], s82 offen offset:0 lds
rta 22,22,9216
v_mul_f32 v221, s90, v221
v_mul_f32 v222, s90, v222
rta 24,23,0
v_mul_f32 v223, s90, v223
v_cvt_pk_bf16_f32 v60, v60, v61
rta 26,23,1024
v_cvt_pk_bf16_f32 v61, v62, v63
v_cvt_pk_bf16_f32 v62, v220, v221
rta 28,23,8192
v_cvt_pk_bf16_f32 v63, v222, v223
maaas 252,92,124
s_cbranch_scc1 K_spare
s_waitcnt lgkmcnt(0)
maaaz 128,0,96
rta 30,23,9216
v_mul_f32 v64, s90, v64
maaas 128,4,100
rta 64,30,49152
v_mul_f32 v65, s90, v65
maaaz 132,8,96
rqa 112,18,4096
v_mul_f32 v66, s90, v66
maaas 132,12,100
v_mul_f32 v67, s90, v67
v_mul_f32 v224, s90, v224
maaaz 136,16,96
buffer_load_dwordx4 v13, s[52:55], s82 offen offset:1024 lds
maaas 136,20,100
v_mul_f32 v225, s90, v225
v_mul_f32 v226, s90, v226
maaaz 140,24,96
s_waitcnt lgkmcnt(2)
v_mul_f32 v227, s90, v227
v_cvt_pk_bf16_f32 v64, v64, v65
maaas 140,28,100
v_cvt_pk_bf16_f32 v65, v66, v67
v_cvt_pk_bf16_f32 v66, v224, v225
mvaaz 160,32,96
rqa 116,19,4096
v_cvt_pk_bf16_f32 v67, v226, v227
mvaas 160,36,100
rta 66,30,49664
v_mul_f32 v68, s90, v68
mvaaz 164,40,96
v_mul_f32 v69, s90, v69
v_mul_f32 v70, s90, v70
mvaas 164,44,100
v_mul_f32 v71, s90, v71
v_mul_f32 v228, s90, v228
mvaaz 168,48,96
v_mul_f32 v229, s90, v229
v_mul_f32 v230, s90, v230
v_mul_f32 v231, s90, v231
mvaas 168,52,100
buffer_load_dwordx4 v14, s[52:55], s82 offen offset:2048 lds
v_cvt_pk_bf16_f32 v68, v68, v69
v_cvt_pk_bf16_f32 v69, v70, v71
mvaaz 172,56,96
v_cvt_pk_bf16_f32 v70, v228, v229
v_cvt_pk_bf16_f32 v71, v230, v231
mvaas 172,60,100
rta 68,30,53248
v_mul_f32 v72, s90, v72
v_mul_f32 v73, s90, v73
v_mul_f32 v74, s90, v74
maaaz 144,0,104
v_mul_f32 v75, s90, v75
v_mul_f32 v232, s90, v232
maaas 144,4,108
v_mul_f32 v233, s90, v233
v_mul_f32 v234, s90, v234
v_mul_f32 v235, s90, v235
maaaz 148,8,104
v_cvt_pk_bf16_f32 v72, v72, v73
v_cvt_pk_bf16_f32 v73, v74, v75
maaas 148,12,108
rqa 120,18,6144
v_cvt_pk_bf16_f32 v74, v232, v233
v_cvt_pk_bf16_f32 v75, v234, v235
maaaz 152,16,104
buffer_load_dwordx4 v15, s[52:55], s82 offen offset:3072 lds
rta 70,30,53760
v_mul_f32 v76, s90, v76
v_mul_f32 v77, s90, v77
v_mul_f32 v78, s90, v78
maaas 152,20,108
s_add_u32 m0, s84, 32768
v_mul_f32 v79, s90, v79
v_mul_f32 v236, s90, v236
maaaz 156,24,104
s_mov_b32 s81, 256
v_mul_f32 v237, s90, v237
v_mul_f32 v238, s90, v238
v_mul_f32 v239, s90, v239
maaas 156,28,108
s_mov_b32 s87, 524288
rqa 124,19,6144
v_cvt_pk_bf16_f32 v76, v76, v77
v_cvt_pk_bf16_f32 v77, v78, v79
mvaaz 176,32,104
v_cvt_pk_bf16_f32 v78, v236, v237
v_cvt_pk_bf16_f32 v79, v238, v239
mvaas 176,36,108
v_mul_f32 v80, s90, v80
v_mul_f32 v81, s90, v81
v_mul_f32 v82, s90, v82
mvaaz 180,40,104
rta 72,31,49152
v_mul_f32 v83, s90, v83
v_mul_f32 v240, s90, v240
mvaas 180,44,108
buffer_load_dwordx4 v8, s[40:43], s81 offen offset:0 lds
v_mul_f32 v241, s90, v241
v_mul_f32 v242, s90, v242
v_mul_f32 v243, s90, v243
mvaaz 184,48,104
v_cvt_pk_bf16_f32 v80, v80, v81
v_cvt_pk_bf16_f32 v81, v82, v83
mvaas 184,52,108
v_cvt_pk_bf16_f32 v82, v240, v241
v_cvt_pk_bf16_f32 v83, v242, v243
mvaaz 188,56,104
buffer_store_dwordx4 v[144:147], v6, s[64:67], s87 offen offset:0 sc1
v_mul_f32 v84, s90, v84
v_mul_f32 v85, s90, v85
v_mul_f32 v86, s90, v86
mvaas 188,60,108
s_waitcnt lgkmcnt(1)
rta 74,31,49664
v_mul_f32 v87, s90, v87
v_mul_f32 v244, s90, v244
maaaz 160,0,112
v_mul_f32 v245, s90, v245
v_mul_f32 v246, s90, v246
v_mul_f32 v247, s90, v247
maaas 160,4,116
v_cvt_pk_bf16_f32 v84, v84, v85
v_cvt_pk_bf16_f32 v85, v86, v87
maaaz 164,8,112
buffer_load_dwordx4 v9, s[40:43], s81 offen offset:1024 lds
v_cvt_pk_bf16_f32 v86, v244, v245
v_cvt_pk_bf16_f32 v87, v246, v247
maaas 164,12,116
rqa 96,18,8192
v_mul_f32 v88, s90, v88
v_mul_f32 v89, s90, v89
v_mul_f32 v90, s90, v90
maaaz 168,16,112
v_mul_f32 v91, s90, v91
v_mul_f32 v248, s90, v248
maaas 168,20,116
s_mov_b32 s87, 524288
rta 76,31,53248
v_mul_f32 v249, s90, v249
v_mul_f32 v250, s90, v250
v_mul_f32 v251, s90, v251
maaaz 172,24,112
v_cvt_pk_bf16_f32 v88, v88, v89
v_cvt_pk_bf16_f32 v89, v90, v91
maaas 172,28,116
rqa 100,19,8192
v_cvt_pk_bf16_f32 v90, v248, v249
v_cvt_pk_bf16_f32 v91, v250, v251
mvaaz 192,32,112
v_mul_f32 v92, s90, v92
v_mul_f32 v93, s90, v93
v_mul_f32 v94, s90, v94
mvaas 192,36,116
buffer_load_dwordx4 v10, s[40:43], s81 offen offset:2048 lds
v_mul_f32 v95, s90, v95
v_mul_f32 v252, s90, v252
mvaaz 196,40,112
rta 78,31,53760
v_mul_f32 v253, s90, v253
v_mul_f32 v254, s90, v254
v_mul_f32 v255, s90, v255
mvaas 196,44,116
v_cvt_pk_bf16_f32 v92, v92, v93
v_cvt_pk_bf16_f32 v93, v94, v95
mvaaz 200,48,112
buffer_store_dwordx4 v[148:151], v6, s[64:67], s87 offen offset:1024 sc1
v_cvt_pk_bf16_f32 v94, v252, v253
v_cvt_pk_bf16_f32 v95, v254, v255
v_accvgpr_read_b32 v0, a224
mvaas 200,52,116
v_accvgpr_read_b32 v1, a225
v_accvgpr_read_b32 v2, a226
mvaaz 204,56,112
v_accvgpr_read_b32 v3, a227
v_mul_f32 v96, s90, v96
mvaas 204,60,116
v_mul_f32 v97, s90, v97
v_mul_f32 v98, s90, v98
v_mul_f32 v99, s90, v99
maaaz 176,0,120
buffer_load_dwordx4 v11, s[40:43], s81 offen offset:3072 lds
rta 80,30,57344
v_mul_f32 v0, s90, v0
v_mul_f32 v1, s90, v1
maaas 176,4,124
s_add_u32 m0, s84, 36864
v_mul_f32 v2, s90, v2
v_mul_f32 v3, s90, v3
maaaz 180,8,120
s_mov_b32 s81, 41216
v_cvt_pk_bf16_f32 v96, v96, v97
v_cvt_pk_bf16_f32 v97, v98, v99
v_cvt_pk_bf16_f32 v98, v0, v1
maaas 180,12,124
s_mov_b32 s87, 524288
rqa 104,18,10240
v_cvt_pk_bf16_f32 v99, v2, v3
v_accvgpr_read_b32 v24, a228
maaaz 184,16,120
v_accvgpr_read_b32 v25, a229
v_accvgpr_read_b32 v26, a230
maaas 184,20,124
rta 82,30,57856
v_accvgpr_read_b32 v27, a231
v_mul_f32 v100, s90, v100
v_mul_f32 v101, s90, v101
maaaz 188,24,120
v_mul_f32 v102, s90, v102
v_mul_f32 v103, s90, v103
maaas 188,28,124
buffer_load_dwordx4 v8, s[40:43], s81 offen offset:0 lds
rqa 108,19,10240
v_mul_f32 v24, s90, v24
v_mul_f32 v25, s90, v25
v_mul_f32 v26, s90, v26
mvaaz 208,32,120
v_mul_f32 v27, s90, v27
v_cvt_pk_bf16_f32 v100, v100, v101
mvaas 208,36,124
v_cvt_pk_bf16_f32 v101, v102, v103
v_cvt_pk_bf16_f32 v102, v24, v25
mvaaz 212,40,120
buffer_store_dwordx4 v[152:155], v6, s[64:67], s87 offen offset:2048 sc1
v_cvt_pk_bf16_f32 v103, v26, v27
v_accvgpr_read_b32 v0, a232
v_accvgpr_read_b32 v1, a233
mvaas 212,44,124
rta 84,30,61440
v_accvgpr_read_b32 v2, a234
v_accvgpr_read_b32 v3, a235
mvaaz 216,48,120
v_mul_f32 v104, s90, v104
v_mul_f32 v105, s90, v105
mvaas 216,52,124
s_waitcnt lgkmcnt(2)
v_mul_f32 v106, s90, v106
v_mul_f32 v107, s90, v107
v_mul_f32 v0, s90, v0
mvaaz 220,56,120
buffer_load_dwordx4 v9, s[40:43], s81 offen offset:1024 lds
v_mul_f32 v1, s90, v1
v_mul_f32 v2, s90, v2
mvaas 220,60,124
s_mov_b32 s87, 524288
v_mul_f32 v3, s90, v3
v_cvt_pk_bf16_f32 v104, v104, v105
v_cvt_pk_bf16_f32 v105, v106, v107
maaaz 192,0,96
rta 86,30,61952
v_cvt_pk_bf16_f32 v106, v0, v1
v_cvt_pk_bf16_f32 v107, v2, v3
maaas 192,4,100
v_accvgpr_read_b32 v24, a236
v_accvgpr_read_b32 v25, a237
maaaz 196,8,96
v_accvgpr_read_b32 v26, a238
v_accvgpr_read_b32 v27, a239
v_mul_f32 v108, s90, v108
maaas 196,12,100
rqa 112,18,12288
v_mul_f32 v109, s90, v109
v_mul_f32 v110, s90, v110
maaaz 200,16,96
v_mul_f32 v111, s90, v111
v_mul_f32 v24, s90, v24
maaas 200,20,100
buffer_load_dwordx4 v10, s[40:43], s81 offen offset:2048 lds
v_mul_f32 v25, s90, v25
v_mul_f32 v26, s90, v26
v_mul_f32 v27, s90, v27
maaaz 204,24,96
rta 88,31,57344
v_cvt_pk_bf16_f32 v108, v108, v109
v_cvt_pk_bf16_f32 v109, v110, v111
maaas 204,28,100
rqa 116,19,12288
v_cvt_pk_bf16_f32 v110, v24, v25
v_cvt_pk_bf16_f32 v111, v26, v27
mvaaz 224,32,96
buffer_store_dwordx4 v[156:159], v6, s[64:67], s87 offen offset:3072 sc1
v_accvgpr_read_b32 v0, a240
v_accvgpr_read_b32 v1, a241
v_accvgpr_read_b32 v2, a242
mvaas 224,36,100
v_accvgpr_read_b32 v3, a243
v_mul_f32 v112, s90, v112
mvaaz 228,40,96
v_mul_f32 v113, s90, v113
v_mul_f32 v114, s90, v114
v_mul_f32 v115, s90, v115
mvaas 228,44,100
rta 90,31,57856
v_mul_f32 v0, s90, v0
v_mul_f32 v1, s90, v1
mvaaz 232,48,96
buffer_load_dwordx4 v11, s[40:43], s81 offen offset:3072 lds
v_mul_f32 v2, s90, v2
v_mul_f32 v3, s90, v3
mvaas 232,52,100
v_cvt_pk_bf16_f32 v112, v112, v113
v_cvt_pk_bf16_f32 v113, v114, v115
v_cvt_pk_bf16_f32 v114, v0, v1
mvaaz 236,56,96
v_cvt_pk_bf16_f32 v115, v2, v3
v_accvgpr_read_b32 v24, a244
mvaas 236,60,100
v_accvgpr_read_b32 v25, a245
v_accvgpr_read_b32 v26, a246
maaaz 208,0,104
s_waitcnt lgkmcnt(1)
v_accvgpr_read_b32 v27, a247
v_mul_f32 v116, s90, v116
v_mul_f32 v117, s90, v117
maaas 208,4,108
rta 92,31,61440
v_mul_f32 v118, s90, v118
v_mul_f32 v119, s90, v119
maaaz 212,8,104
v_mul_f32 v24, s90, v24
v_mul_f32 v25, s90, v25
v_mul_f32 v26, s90, v26
maaas 212,12,108
rqa 120,18,14336
v_mul_f32 v27, s90, v27
v_cvt_pk_bf16_f32 v116, v116, v117
maaaz 216,16,104
v_cvt_pk_bf16_f32 v117, v118, v119
v_cvt_pk_bf16_f32 v118, v24, v25
maaas 216,20,108
v_cvt_pk_bf16_f32 v119, v26, v27
v_accvgpr_read_b32 v0, a248
v_accvgpr_read_b32 v1, a249
maaaz 220,24,104
rta 94,31,61952
v_accvgpr_read_b32 v2, a250
v_accvgpr_read_b32 v3, a251
maaas 220,28,108
rqa 124,19,14336
v_mul_f32 v120, s90, v120
v_mul_f32 v121, s90, v121
mvaaz 240,32,104
v_mul_f32 v122, s90, v122
v_mul_f32 v123, s90, v123
v_mul_f32 v0, s90, v0
mvaas 240,36,108
v_mul_f32 v1, s90, v1
v_mul_f32 v2, s90, v2
mvaaz 244,40,104
v_mul_f32 v3, s90, v3
v_cvt_pk_bf16_f32 v120, v120, v121
v_cvt_pk_bf16_f32 v121, v122, v123
mvaas 244,44,108
v_cvt_pk_bf16_f32 v122, v0, v1
v_cvt_pk_bf16_f32 v123, v2, v3
mvaaz 248,48,104
v_accvgpr_read_b32 v24, a252
v_accvgpr_read_b32 v25, a253
mvaas 248,52,108
s_waitcnt vmcnt(12) lgkmcnt(0)
v_accvgpr_read_b32 v26, a254
v_accvgpr_read_b32 v27, a255
v_mul_f32 v124, s90, v124
mvaaz 252,56,104
v_mul_f32 v125, s90, v125
v_mul_f32 v126, s90, v126
v_mul_f32 v127, s90, v127
v_mul_f32 v24, s90, v24
v_mul_f32 v25, s90, v25
v_mul_f32 v26, s90, v26
v_mul_f32 v27, s90, v27
v_cvt_pk_bf16_f32 v124, v124, v125
v_cvt_pk_bf16_f32 v125, v126, v127
v_cvt_pk_bf16_f32 v126, v24, v25
v_cvt_pk_bf16_f32 v127, v26, v27
mvaas 252,60,108
s_barrier
maaaz 224,0,112
s_add_u32 m0, s86, 147456
rqa 96,16,0
s_mov_b32 s83, 663552
maaas 224,4,116
buffer_load_dwordx4 v4, s[56:59], s83 offen offset:0 lds
maaaz 228,8,112
s_mov_b32 s44, s18
rqa 100,17,0
s_mov_b32 s45, s19
maaas 228,12,116
s_mov_b32 s46, 5242880
s_mov_b32 s48, s26
s_mov_b32 s49, s27
maaaz 232,16,112
buffer_load_dwordx4 v5, s[56:59], s83 offen offset:1024 lds
maaas 232,20,116
s_mov_b32 s50, 2211840
s_and_b32 s5, s30, 3
s_lshl2_add_u32 s5, s31, s5
maaaz 236,24,112
s_lshl3_add_u32 s5, s5, s94
rqa 104,16,2048
s_mul_i32 s5, s5, 73728
maaas 236,28,116
s_mul_i32 s6, s80, 14336
s_add_u32 s5, s5, s6
s_add_u32 s5, s5, 100663296
mvaaz 128,32,112
s_add_u32 s36, s64, s5
s_addc_u32 s37, s65, 0
s_add_u32 m0, s86, 155648
mvaas 128,36,116
s_lshl_b32 s6, s80, 12
rqa 108,17,2048
s_add_u32 s38, s6, 18432
mvaaz 132,40,112
mvaas 132,44,116
buffer_load_dwordx4 v4, s[60:63], s83 offen offset:0 lds
mvaaz 136,48,112
mvaas 136,52,116
mvaaz 140,56,112
mvaas 140,60,116
maaaz 240,0,120
rta 0,20,16384
maaas 240,4,124
rta 2,20,17408
maaaz 244,8,120
buffer_load_dwordx4 v5, s[60:63], s83 offen offset:1024 lds
maaas 244,12,124
s_add_u32 m0, s85, 98304
rta 4,20,24576
s_mov_b32 s82, 1048576
maaaz 248,16,120
rta 6,20,25600
maaas 248,20,124
rta 8,21,16384
maaaz 252,24,120
rta 10,21,17408
maaas 252,28,124
rta 12,21,24576
mvaaz 144,32,120
rta 14,21,25600
mvaas 144,36,124
rta 16,22,16384
mvaaz 148,40,120
rta 18,22,17408
mvaas 148,44,124
rta 20,22,24576
mvaaz 152,48,120
buffer_load_dwordx4 v12, s[52:55], s82 offen offset:0 lds
mvaas 152,52,124
rta 22,22,25600
rta 24,23,16384
mvaaz 156,56,120
rta 26,23,17408
rta 28,23,24576
mvaas 156,60,124
s_branch K_ph2
K_progV:
s_waitcnt lgkmcnt(0)
mvaaz 128,96,0
s_add_u32 m0, s84, 36864
rqa 112,16,4096
s_mov_b32 s81, 32896
mvaas 128,100,4
buffer_load_dwordx4 v0, s[36:39], s81 offen offset:0 lds
mvaaz 132,96,8
rqa 116,17,4096
mvaas 132,100,12
buffer_load_dwordx4 v1, s[36:39], s81 offen offset:1024 lds
mvaaz 136,96,16
s_mov_b32 s82, 524288
mvaas 136,100,20
buffer_load_dwordx4 v2, s[36:39], s81 offen offset:2048 lds
mvaaz 140,96,24
mvaas 140,100,28
buffer_load_dwordx4 v3, s[36:39], s81 offen offset:3072 lds
mvaaz 144,96,32
s_add_u32 m0, s85, 114688
mvaas 144,100,36
mvaaz 148,96,40
mvaas 148,100,44
buffer_load_dwordx4 v12, s[44:47], s82 offen offset:0 lds
mvaaz 152,96,48
mvaas 152,100,52
mvaaz 156,96,56
rqa 120,16,6144
mvaas 156,100,60
buffer_load_dwordx4 v13, s[44:47], s82 offen offset:1024 lds
mvaaz 160,104,0
mvaas 160,108,4
mvaaz 164,104,8
buffer_load_dwordx4 v14, s[44:47], s82 offen offset:2048 lds
mvaas 164,108,12
rqa 124,17,6144
mvaaz 168,104,16
mvaas 168,108,20
mvaaz 172,104,24
buffer_load_dwordx4 v15, s[44:47], s82 offen offset:3072 lds
mvaas 172,108,28
mvaaz 176,104,32
mvaas 176,108,36
mvaaz 180,104,40
mvaas 180,108,44
mvaaz 184,104,48
mvaas 184,108,52
s_waitcnt vmcnt(14) lgkmcnt(0)
mvaaz 188,104,56
mvaas 188,108,60
s_barrier
mvaaz 32,112,0
s_add_u32 m0, s85, 131072
rta 64,20,49152
s_mov_b32 s83, 1048576
mvaas 32,116,4
buffer_load_dwordx4 v12, s[48:51], s83 offen offset:0 lds
mvaaz 36,112,8
rqa 96,16,8192
mvaas 36,116,12
rta 66,20,50176
mvaaz 40,112,16
rqa 100,17,8192
mvaas 40,116,20
buffer_load_dwordx4 v13, s[48:51], s83 offen offset:1024 lds
mvaaz 44,112,24
rta 68,20,57344
mvaas 44,116,28
rta 70,20,58368
mvaaz 48,112,32
mvaas 48,116,36
mvaaz 52,112,40
mvaas 52,116,44
rta 72,21,49152
mvaaz 56,112,48
mvaas 56,116,52
buffer_load_dwordx4 v14, s[48:51], s83 offen offset:2048 lds
mvaaz 60,112,56
rqa 104,16,10240
mvaas 60,116,60
rta 74,21,50176
mvaaz 192,120,0
mvaas 192,124,4
mvaaz 196,120,8
rqa 108,17,10240
mvaas 196,124,12
rta 76,21,57344
mvaaz 200,120,16
mvaas 200,124,20
buffer_load_dwordx4 v15, s[48:51], s83 offen offset:3072 lds
mvaaz 204,120,24
rta 78,21,58368
mvaas 204,124,28
mvaaz 208,120,32
mvaas 208,124,36
mvaaz 212,120,40
s_add_u32 m0, s84, 65536
rta 80,22,49152
s_mov_b32 s81, 256
mvaas 212,124,44
mvaaz 216,120,48
mvaas 216,124,52
rta 82,22,50176
mvaaz 220,120,56
rqa 112,16,12288
mvaas 220,124,60
s_waitcnt lgkmcnt(4)
mvaaz 64,96,0
mvaas 64,100,4
buffer_load_dwordx4 v0, s[36:39], s81 offen offset:0 lds
mvaaz 68,96,8
rta 84,22,57344
mvaas 68,100,12
rqa 116,17,12288
mvaaz 72,96,16
rta 86,22,58368
mvaas 72,100,20
mvaaz 76,96,24
mvaas 76,100,28
mvaaz 80,96,32
rta 88,23,49152
mvaas 80,100,36
buffer_load_dwordx4 v1, s[36:39], s81 offen offset:1024 lds
mvaaz 84,96,40
mvaas 84,100,44
mvaaz 88,96,48
rta 90,23,50176
mvaas 88,100,52
v_med3_u32 v26, v24, 24, 39
v_lshrrev_b32 v25, 3, v26
mvaaz 92,96,56
rqa 120,16,14336
v_lshlrev_b32 v25, 19, v25
mvaas 92,100,60
rta 92,23,57344
v_and_b32 v26, 7, v26
mvaaz 224,104,0
v_lshl_add_u32 v25, v26, 7, v25
v_and_b32 v26, 4, v26
mvaas 224,108,4
buffer_load_dwordx4 v2, s[36:39], s81 offen offset:2048 lds
mvaaz 228,104,8
rqa 124,17,14336
mvaas 228,108,12
s_mov_b32 s7, 1920
rta 94,23,58368
v_mad_u32_u24 v25, v26, s7, v25
mvaaz 232,104,16
s_lshl2_add_u32 s6, s97, s80
mvaas 232,108,20
mvaaz 236,104,24
mvaas 236,108,28
mvaaz 240,104,32
mvaas 240,108,36
buffer_load_dwordx4 v3, s[36:39], s81 offen offset:3072 lds
mvaaz 244,104,40
s_add_u32 m0, s84, 69632
s_mov_b32 s81, 33024
s_lshl_b32 s6, s6, 14
mvaas 244,108,44
buffer_load_dwordx4 v0, s[36:39], s81 offen offset:0 lds
mvaaz 248,104,48
mvaas 248,108,52
buffer_load_dwordx4 v1, s[36:39], s81 offen offset:1024 lds
mvaaz 252,104,56
buffer_load_dwordx4 v2, s[36:39], s81 offen offset:2048 lds
buffer_load_dwordx4 v3, s[36:39], s81 offen offset:3072 lds
buffer_load_dword a223, v25, s[44:47], s6 offen
s_waitcnt vmcnt(9) lgkmcnt(0)
mvaas 252,108,60
s_barrier
mvaaz 96,112,0
s_add_u32 m0, s85, 147456
rqa 96,16,32768
s_mov_b32 s83, 1572864
mvaas 96,116,4
buffer_load_dwordx4 v12, s[48:51], s83 offen offset:0 lds
mvaaz 100,112,8
rqa 100,17,32768
mvaas 100,116,12
mvaaz 104,112,16
buffer_load_dwordx4 v13, s[48:51], s83 offen offset:1024 lds
mvaas 104,116,20
mvaaz 108,112,24
rqa 104,16,34816
mvaas 108,116,28
mvaaz 112,112,32
mvaas 112,116,36
rqa 108,17,34816
mvaaz 116,112,40
mvaas 116,116,44
buffer_load_dwordx4 v14, s[48:51], s83 offen offset:2048 lds
mvaaz 120,112,48
mvaas 120,116,52
mvaaz 124,112,56
mvaas 124,116,60
maaaz 224,120,0
rta 0,20,16384
maaas 224,124,4
rta 2,20,17408
maaaz 228,120,8
buffer_load_dwordx4 v15, s[48:51], s83 offen offset:3072 lds
maaas 228,124,12
s_add_u32 m0, s85, 98304
rta 4,20,24576
s_mov_b32 s82, 1048576
maaaz 232,120,16
rta 6,20,25600
maaas 232,124,20
rta 8,21,16384
maaaz 236,120,24
rta 10,21,17408
maaas 236,124,28
rta 12,21,24576
maaaz 240,120,32
rta 14,21,25600
maaas 240,124,36
rta 16,22,16384
maaaz 244,120,40
rta 18,22,17408
maaas 244,124,44
rta 20,22,24576
maaaz 248,120,48
rta 22,22,25600
maaas 248,124,52
rta 24,23,16384
rta 26,23,17408
maaaz 252,120,56
buffer_load_dwordx4 v12, s[44:47], s82 offen offset:0 lds
maaas 252,124,60
s_waitcnt lgkmcnt(10)
rta 28,23,24576
rta 30,23,25600
mvaas 128,96,0
buffer_load_dwordx4 v13, s[44:47], s82 offen offset:1024 lds
mvaas 128,100,4
rta 32,20,32768
s_waitcnt lgkmcnt(11)
mvaas 132,96,8
rqa 112,16,36864
s_waitcnt lgkmcnt(10)
mvaas 132,100,12
s_waitcnt lgkmcnt(8)
mvaas 136,96,16
rqa 116,17,36864
s_waitcnt lgkmcnt(7)
mvaas 136,100,20
rta 34,20,33792
s_waitcnt lgkmcnt(6)
mvaas 140,96,24
s_waitcnt lgkmcnt(4)
mvaas 140,100,28
buffer_load_dwordx4 v14, s[44:47], s82 offen offset:2048 lds
mvaas 144,96,64
mvaas 144,100,68
mvaas 148,96,72
rta 36,20,40960
mvaas 148,100,76
v_med3_u32 v26, v24, 40, 63
v_lshrrev_b32 v25, 3, v26
mvaas 152,96,80
v_lshlrev_b32 v25, 19, v25
v_and_b32 v26, 7, v26
mvaas 152,100,84
v_lshl_add_u32 v25, v26, 7, v25
v_and_b32 v26, 4, v26
mvaas 156,96,88
buffer_load_dwordx4 v15, s[44:47], s82 offen offset:3072 lds
mvaas 156,100,92
s_add_u32 m0, s84, 0
rqa 120,16,38912
s_mov_b32 s81, 384
mvaas 160,104,0
rta 38,20,41984
mvaas 160,108,4
s_mov_b32 s7, 1920
v_mad_u32_u24 v25, v26, s7, v25
s_lshl2_add_u32 s6, s97, s80
mvaas 164,104,8
rqa 124,17,38912
s_lshl_b32 s6, s6, 14
mvaas 164,108,12
mvaas 168,104,16
mvaas 168,108,20
buffer_load_dwordx4 v0, s[36:39], s81 offen offset:0 lds
mvaas 172,104,24
rta 40,21,32768
mvaas 172,108,28
mvaas 176,104,64
buffer_load_dword a223, v25, s[44:47], s6 offen
mvaas 176,108,68
mvaas 180,104,72
rta 42,21,33792
mvaas 180,108,76
mvaas 184,104,80
buffer_load_dwordx4 v1, s[36:39], s81 offen offset:1024 lds
mvaas 184,108,84
mvaas 188,104,88
rqa 96,16,40960
mvaas 188,108,92
s_waitcnt lgkmcnt(3)
mvaas 32,112,0
rta 44,21,40960
mvaas 32,116,4
mvaas 36,112,8
rqa 100,17,40960
mvaas 36,116,12
buffer_load_dwordx4 v2, s[36:39], s81 offen offset:2048 lds
mvaas 40,112,16
mvaas 40,116,20
rta 46,21,41984
mvaas 44,112,24
mvaas 44,116,28
mvaas 48,112,64
mvaas 48,116,68
mvaas 52,112,72
buffer_load_dwordx4 v3, s[36:39], s81 offen offset:3072 lds
mvaas 52,116,76
s_add_u32 m0, s84, 4096
rta 48,22,32768
s_mov_b32 s81, 33152
mvaas 56,112,80
mvaas 56,116,84
mvaas 60,112,88
rqa 104,16,43008
mvaas 60,116,92
mvaas 192,120,0
rta 50,22,33792
mvaas 192,124,4
buffer_load_dwordx4 v0, s[36:39], s81 offen offset:0 lds
mvaas 196,120,8
rqa 108,17,43008
mvaas 196,124,12
mvaas 200,120,16
mvaas 200,124,20
mvaas 204,120,24
rta 52,22,40960
mvaas 204,124,28
mvaas 208,120,64
buffer_load_dwordx4 v1, s[36:39], s81 offen offset:1024 lds
mvaas 208,124,68
mvaas 212,120,72
mvaas 212,124,76
rta 54,22,41984
mvaas 216,120,80
mvaas 216,124,84
mvaas 220,120,88
rqa 112,16,45056
s_waitcnt lgkmcnt(3)
mvaas 220,124,92
buffer_load_dwordx4 v2, s[36:39], s81 offen offset:2048 lds
mvaas 64,96,0
mvaas 64,100,4
rta 56,23,32768
mvaas 68,96,8
rqa 116,17,45056
mvaas 68,100,12
mvaas 72,96,16
mvaas 72,100,20
mvaas 76,96,24
buffer_load_dwordx4 v3, s[36:39], s81 offen offset:3072 lds
mvaas 76,100,28
rta 58,23,33792
mvaas 80,96,64
mvaas 80,100,68
mvaas 84,96,72
mvaas 84,100,76
mvaas 88,96,80
rta 60,23,40960
mvaas 88,100,84
mvaas 92,96,88
rqa 120,16,47104
mvaas 92,100,92
mvaas 224,104,0
mvaas 224,108,4
rta 62,23,41984
mvaas 228,104,8
rqa 124,17,47104
mvaas 228,108,12
mvaas 232,104,16
mvaas 232,108,20
mvaas 236,104,24
mvaas 236,108,28
mvaas 240,104,64
mvaas 240,108,68
mvaas 244,104,72
mvaas 244,108,76
mvaas 248,104,80
mvaas 248,108,84
s_waitcnt vmcnt(9) lgkmcnt(0)
mvaas 252,104,88
mvaas 252,108,92
s_barrier
mvaas 96,112,0
s_add_u32 m0, s85, 131072
rqa 96,18,0
s_mov_b32 s83, 2097152
mvaas 96,116,4
buffer_load_dwordx4 v12, s[48:51], s83 offen offset:0 lds
mvaas 100,112,8
rqa 100,19,0
mvaas 100,116,12
mvaas 104,112,16
buffer_load_dwordx4 v13, s[48:51], s83 offen offset:1024 lds
mvaas 104,116,20
mvaas 108,112,24
rqa 104,18,2048
mvaas 108,116,28
mvaas 112,112,64
mvaas 112,116,68
rqa 108,19,2048
mvaas 116,112,72
mvaas 116,116,76
buffer_load_dwordx4 v14, s[48:51], s83 offen offset:2048 lds
mvaas 120,112,80
mvaas 120,116,84
mvaas 124,112,88
mvaas 124,116,92
maaas 224,120,0
rta 0,20,0
maaas 224,124,4
rta 2,20,1024
maaas 228,120,8
buffer_load_dwordx4 v15, s[48:51], s83 offen offset:3072 lds
maaas 228,124,12
s_add_u32 m0, s85, 114688
rta 4,20,8192
s_mov_b32 s82, 1572864
maaas 232,120,16
rta 6,20,9216
maaas 232,124,20
rta 8,21,0
maaas 236,120,24
rta 10,21,1024
maaas 236,124,28
rta 12,21,8192
maaas 240,120,64
rta 14,21,9216
maaas 240,124,68
rta 16,22,0
maaas 244,120,72
rta 18,22,1024
maaas 244,124,76
rta 20,22,8192
maaas 248,120,80
rta 22,22,9216
maaas 248,124,84
rta 24,23,0
rta 26,23,1024
maaas 252,120,88
buffer_load_dwordx4 v12, s[44:47], s82 offen offset:0 lds
maaas 252,124,92
s_waitcnt lgkmcnt(10)
rta 28,23,8192
rta 30,23,9216
mvaas 128,96,0
buffer_load_dwordx4 v13, s[44:47], s82 offen offset:1024 lds
mvaas 128,100,4
rta 64,20,49152
s_waitcnt lgkmcnt(11)
mvaas 132,96,8
rqa 112,18,4096
s_waitcnt lgkmcnt(10)
mvaas 132,100,12
s_waitcnt lgkmcnt(8)
mvaas 136,96,16
rqa 116,19,4096
s_waitcnt lgkmcnt(7)
mvaas 136,100,20
rta 66,20,50176
s_waitcnt lgkmcnt(6)
mvaas 140,96,24
s_waitcnt lgkmcnt(4)
mvaas 140,100,28
buffer_load_dwordx4 v14, s[44:47], s82 offen offset:2048 lds
mvaas 144,96,32
mvaas 144,100,36
mvaas 148,96,40
rta 68,20,57344
mvaas 148,100,44
v_min_u32 v25, 19, v24
v_lshlrev_b32 v25, 7, v25
mvaas 152,96,48
mvaas 152,100,52
mvaas 156,96,56
buffer_load_dwordx4 v15, s[44:47], s82 offen offset:3072 lds
mvaas 156,100,60
s_add_u32 m0, s84, 32768
rqa 120,18,6144
s_mov_b32 s81, 512
mvaas 160,104,0
rta 70,20,58368
mvaas 160,108,4
s_mul_i32 s35, s34, 2560
s_add_u32 s35, s35, 0
v_add_u32 v25, s35, v25
mvaas 164,104,8
rqa 124,19,6144
v_min_u32 v25, 2621436, v25
mvaas 164,108,12
mvaas 168,104,16
mvaas 168,108,20
buffer_load_dwordx4 v0, s[36:39], s81 offen offset:0 lds
mvaas 172,104,24
rta 72,21,49152
mvaas 172,108,28
mvaas 176,104,32
global_load_dword a223, v25, s[8:9]
mvaas 176,108,36
mvaas 180,104,40
rta 74,21,50176
mvaas 180,108,44
mvaas 184,104,48
buffer_load_dwordx4 v1, s[36:39], s81 offen offset:1024 lds
mvaas 184,108,52
mvaas 188,104,56
rqa 96,18,8192
mvaas 188,108,60
s_waitcnt lgkmcnt(3)
mvaas 32,112,0
rta 76,21,57344
mvaas 32,116,4
mvaas 36,112,8
rqa 100,19,8192
mvaas 36,116,12
buffer_load_dwordx4 v2, s[36:39], s81 offen offset:2048 lds
mvaas 40,112,16
mvaas 40,116,20
rta 78,21,58368
mvaas 44,112,24
mvaas 44,116,28
mvaas 48,112,32
mvaas 48,116,36
mvaas 52,112,40
buffer_load_dwordx4 v3, s[36:39], s81 offen offset:3072 lds
mvaas 52,116,44
s_add_u32 m0, s84, 36864
rta 80,22,49152
s_mov_b32 s81, 33280
mvaas 56,112,48
mvaas 56,116,52
s_and_b32 s6, s97, 3
s_cmp_eq_u32 s6, 0
s_cselect_b32 s6, 0, 4096
mvaas 60,112,56
rqa 104,18,10240
mvaas 60,116,60
mvaas 192,120,0
rta 82,22,50176
mvaas 192,124,4
buffer_load_dwordx4 v0, s[36:39], s81 offen offset:0 lds
mvaas 196,120,8
rqa 108,19,10240
mvaas 196,124,12
mvaas 200,120,16
buffer_atomic_add v27, v28, s[76:79], s6 offen sc1
mvaas 200,124,20
mvaas 204,120,24
rta 84,22,57344
mvaas 204,124,28
mvaas 208,120,32
buffer_load_dwordx4 v1, s[36:39], s81 offen offset:1024 lds
mvaas 208,124,36
mvaas 212,120,40
mvaas 212,124,44
rta 86,22,58368
mvaas 216,120,48
mvaas 216,124,52
mvaas 220,120,56
rqa 112,18,12288
s_waitcnt lgkmcnt(3)
mvaas 220,124,60
buffer_load_dwordx4 v2, s[36:39], s81 offen offset:2048 lds
mvaas 64,96,0
mvaas 64,100,4
rta 88,23,49152
mvaas 68,96,8
rqa 116,19,12288
mvaas 68,100,12
mvaas 72,96,16
mvaas 72,100,20
mvaas 76,96,24
buffer_load_dwordx4 v3, s[36:39], s81 offen offset:3072 lds
mvaas 76,100,28
rta 90,23,50176
mvaas 80,96,32
mvaas 80,100,36
mvaas 84,96,40
mvaas 84,100,44
mvaas 88,96,48
rta 92,23,57344
mvaas 88,100,52
mvaas 92,96,56
rqa 120,18,14336
mvaas 92,100,60
mvaas 224,104,0
mvaas 224,108,4
rta 94,23,58368
mvaas 228,104,8
rqa 124,19,14336
mvaas 228,108,12
mvaas 232,104,16
mvaas 232,108,20
mvaas 236,104,24
mvaas 236,108,28
mvaas 240,104,32
mvaas 240,108,36
mvaas 244,104,40
mvaas 244,108,44
mvaas 248,104,48
mvaas 248,108,52
s_waitcnt vmcnt(10) lgkmcnt(0)
mvaas 252,104,56
mvaas 252,108,60
s_barrier
mvaas 96,112,0
s_add_u32 m0, s85, 147456
rqa 96,16,0
s_mov_b32 s83, 2621440
mvaas 96,116,4
buffer_load_dwordx4 v12, s[48:51], s83 offen offset:0 lds
mvaas 100,112,8
rqa 100,17,0
mvaas 100,116,12
mvaas 104,112,16
buffer_load_dwordx4 v13, s[48:51], s83 offen offset:1024 lds
mvaas 104,116,20
mvaas 108,112,24
rqa 104,16,2048
mvaas 108,116,28
mvaas 112,112,32
mvaas 112,116,36
rqa 108,17,2048
mvaas 116,112,40
mvaas 116,116,44
buffer_load_dwordx4 v14, s[48:51], s83 offen offset:2048 lds
mvaas 120,112,48
mvaas 120,116,52
mvaas 124,112,56
mvaas 124,116,60
maaas 224,120,0
rta 0,20,16384
maaas 224,124,4
rta 2,20,17408
maaas 228,120,8
buffer_load_dwordx4 v15, s[48:51], s83 offen offset:3072 lds
maaas 228,124,12
s_add_u32 m0, s85, 98304
rta 4,20,24576
s_mov_b32 s82, 2097152
maaas 232,120,16
rta 6,20,25600
maaas 232,124,20
rta 8,21,16384
maaas 236,120,24
rta 10,21,17408
maaas 236,124,28
rta 12,21,24576
maaas 240,120,32
rta 14,21,25600
maaas 240,124,36
rta 16,22,16384
maaas 244,120,40
rta 18,22,17408
maaas 244,124,44
rta 20,22,24576
maaas 248,120,48
rta 22,22,25600
maaas 248,124,52
rta 24,23,16384
rta 26,23,17408
maaas 252,120,56
buffer_load_dwordx4 v12, s[44:47], s82 offen offset:0 lds
maaas 252,124,60
s_waitcnt lgkmcnt(10)
rta 28,23,24576
rta 30,23,25600
mvaas 128,96,0
buffer_load_dwordx4 v13, s[44:47], s82 offen offset:1024 lds
mvaas 128,100,4
rta 32,20,32768
s_waitcnt lgkmcnt(11)
mvaas 132,96,8
rqa 112,16,4096
s_waitcnt lgkmcnt(10)
mvaas 132,100,12
s_waitcnt lgkmcnt(8)
mvaas 136,96,16
rqa 116,17,4096
s_waitcnt lgkmcnt(7)
mvaas 136,100,20
rta 34,20,33792
s_waitcnt lgkmcnt(6)
mvaas 140,96,24
s_waitcnt lgkmcnt(4)
mvaas 140,100,28
buffer_load_dwordx4 v14, s[44:47], s82 offen offset:2048 lds
mvaas 144,96,64
mvaas 144,100,68
mvaas 148,96,72
rta 36,20,40960
mvaas 148,100,76
v_min_u32 v25, 19, v24
v_lshlrev_b32 v25, 7, v25
mvaas 152,96,80
mvaas 152,100,84
mvaas 156,96,88
buffer_load_dwordx4 v15, s[44:47], s82 offen offset:3072 lds
mvaas 156,100,92
s_add_u32 m0, s84, 65536
rqa 120,16,6144
s_mov_b32 s81, 640
mvaas 160,104,0
rta 38,20,41984
mvaas 160,108,4
s_mul_i32 s35, s34, 5120
s_add_u32 s35, s35, 0
v_add_u32 v25, s35, v25
mvaas 164,104,8
rqa 124,17,6144
v_min_u32 v25, 5242876, v25
mvaas 164,108,12
mvaas 168,104,16
mvaas 168,108,20
buffer_load_dwordx4 v0, s[36:39], s81 offen offset:0 lds
mvaas 172,104,24
rta 40,21,32768
mvaas 172,108,28
mvaas 176,104,64
global_load_dword a223, v25, s[12:13]
mvaas 176,108,68
mvaas 180,104,72
rta 42,21,33792
mvaas 180,108,76
mvaas 184,104,80
buffer_load_dwordx4 v1, s[36:39], s81 offen offset:1024 lds
mvaas 184,108,84
mvaas 188,104,88
rqa 96,16,8192
mvaas 188,108,92
s_waitcnt lgkmcnt(3)
mvaas 32,112,0
rta 44,21,40960
mvaas 32,116,4
mvaas 36,112,8
rqa 100,17,8192
mvaas 36,116,12
buffer_load_dwordx4 v2, s[36:39], s81 offen offset:2048 lds
mvaas 40,112,16
mvaas 40,116,20
rta 46,21,41984
mvaas 44,112,24
mvaas 44,116,28
mvaas 48,112,64
mvaas 48,116,68
mvaas 52,112,72
buffer_load_dwordx4 v3, s[36:39], s81 offen offset:3072 lds
mvaas 52,116,76
s_add_u32 m0, s84, 69632
rta 48,22,32768
s_mov_b32 s81, 33408
mvaas 56,112,80
mvaas 56,116,84
s_and_b32 s6, s97, 3
s_cmp_eq_u32 s6, 1
s_cselect_b32 s6, 0, 4096
mvaas 60,112,88
rqa 104,16,10240
mvaas 60,116,92
mvaas 192,120,0
rta 50,22,33792
mvaas 192,124,4
buffer_load_dwordx4 v0, s[36:39], s81 offen offset:0 lds
mvaas 196,120,8
rqa 108,17,10240
mvaas 196,124,12
mvaas 200,120,16
buffer_atomic_add v27, v28, s[76:79], s6 offen sc1
mvaas 200,124,20
mvaas 204,120,24
rta 52,22,40960
mvaas 204,124,28
mvaas 208,120,64
buffer_load_dwordx4 v1, s[36:39], s81 offen offset:1024 lds
mvaas 208,124,68
mvaas 212,120,72
mvaas 212,124,76
rta 54,22,41984
mvaas 216,120,80
mvaas 216,124,84
mvaas 220,120,88
rqa 112,16,12288
s_waitcnt lgkmcnt(3)
mvaas 220,124,92
buffer_load_dwordx4 v2, s[36:39], s81 offen offset:2048 lds
mvaas 64,96,0
mvaas 64,100,4
rta 56,23,32768
mvaas 68,96,8
rqa 116,17,12288
mvaas 68,100,12
mvaas 72,96,16
mvaas 72,100,20
mvaas 76,96,24
buffer_load_dwordx4 v3, s[36:39], s81 offen offset:3072 lds
mvaas 76,100,28
rta 58,23,33792
mvaas 80,96,64
mvaas 80,100,68
mvaas 84,96,72
mvaas 84,100,76
mvaas 88,96,80
rta 60,23,40960
mvaas 88,100,84
mvaas 92,96,88
rqa 120,16,14336
mvaas 92,100,92
mvaas 224,104,0
mvaas 224,108,4
rta 62,23,41984
mvaas 228,104,8
rqa 124,17,14336
mvaas 228,108,12
mvaas 232,104,16
mvaas 232,108,20
mvaas 236,104,24
mvaas 236,108,28
mvaas 240,104,64
mvaas 240,108,68
mvaas 244,104,72
mvaas 244,108,76
mvaas 248,104,80
mvaas 248,108,84
s_waitcnt vmcnt(10) lgkmcnt(0)
mvaas 252,104,88
mvaas 252,108,92
s_barrier
mvaas 96,112,0
s_add_u32 m0, s85, 131072
rqa 96,16,32768
s_mov_b32 s83, 3145728
mvaas 96,116,4
buffer_load_dwordx4 v12, s[48:51], s83 offen offset:0 lds
mvaas 100,112,8
rqa 100,17,32768
mvaas 100,116,12
mvaas 104,112,16
buffer_load_dwordx4 v13, s[48:51], s83 offen offset:1024 lds
mvaas 104,116,20
mvaas 108,112,24
rqa 104,16,34816
mvaas 108,116,28
mvaas 112,112,64
mvaas 112,116,68
rqa 108,17,34816
mvaas 116,112,72
mvaas 116,116,76
buffer_load_dwordx4 v14, s[48:51], s83 offen offset:2048 lds
mvaas 120,112,80
mvaas 120,116,84
mvaas 124,112,88
mvaas 124,116,92
maaas 224,120,0
rta 0,20,0
maaas 224,124,4
rta 2,20,1024
maaas 228,120,8
buffer_load_dwordx4 v15, s[48:51], s83 offen offset:3072 lds
maaas 228,124,12
s_add_u32 m0, s85, 114688
rta 4,20,8192
s_mov_b32 s82, 2621440
maaas 232,120,16
rta 6,20,9216
maaas 232,124,20
rta 8,21,0
maaas 236,120,24
rta 10,21,1024
maaas 236,124,28
rta 12,21,8192
maaas 240,120,64
rta 14,21,9216
maaas 240,124,68
rta 16,22,0
maaas 244,120,72
rta 18,22,1024
maaas 244,124,76
rta 20,22,8192
maaas 248,120,80
rta 22,22,9216
maaas 248,124,84
rta 24,23,0
rta 26,23,1024
maaas 252,120,88
buffer_load_dwordx4 v12, s[44:47], s82 offen offset:0 lds
maaas 252,124,92
s_waitcnt lgkmcnt(10)
rta 28,23,8192
rta 30,23,9216
mvaas 128,96,0
buffer_load_dwordx4 v13, s[44:47], s82 offen offset:1024 lds
mvaas 128,100,4
rta 64,20,49152
s_waitcnt lgkmcnt(11)
mvaas 132,96,8
rqa 112,16,36864
s_waitcnt lgkmcnt(10)
mvaas 132,100,12
s_waitcnt lgkmcnt(8)
mvaas 136,96,16
rqa 116,17,36864
s_waitcnt lgkmcnt(7)
mvaas 136,100,20
rta 66,20,50176
s_waitcnt lgkmcnt(6)
mvaas 140,96,24
s_waitcnt lgkmcnt(4)
mvaas 140,100,28
buffer_load_dwordx4 v14, s[44:47], s82 offen offset:2048 lds
mvaas 144,96,32
mvaas 144,100,36
mvaas 148,96,40
rta 68,20,57344
mvaas 148,100,44
v_min_u32 v25, 19, v24
v_lshlrev_b32 v25, 7, v25
mvaas 152,96,48
mvaas 152,100,52
mvaas 156,96,56
buffer_load_dwordx4 v15, s[44:47], s82 offen offset:3072 lds
mvaas 156,100,60
s_add_u32 m0, s84, 0
rqa 120,16,38912
s_mov_b32 s81, 768
mvaas 160,104,0
rta 70,20,58368
mvaas 160,108,4
s_mul_i32 s35, s34, 5120
s_add_u32 s35, s35, 2560
v_add_u32 v25, s35, v25
mvaas 164,104,8
rqa 124,17,38912
v_min_u32 v25, 5242876, v25
mvaas 164,108,12
mvaas 168,104,16
mvaas 168,108,20
buffer_load_dwordx4 v0, s[36:39], s81 offen offset:0 lds
mvaas 172,104,24
rta 72,21,49152
mvaas 172,108,28
mvaas 176,104,32
global_load_dword a223, v25, s[12:13]
mvaas 176,108,36
mvaas 180,104,40
rta 74,21,50176
mvaas 180,108,44
mvaas 184,104,48
buffer_load_dwordx4 v1, s[36:39], s81 offen offset:1024 lds
mvaas 184,108,52
mvaas 188,104,56
rqa 96,16,40960
mvaas 188,108,60
s_waitcnt lgkmcnt(3)
mvaas 32,112,0
rta 76,21,57344
mvaas 32,116,4
mvaas 36,112,8
rqa 100,17,40960
mvaas 36,116,12
buffer_load_dwordx4 v2, s[36:39], s81 offen offset:2048 lds
mvaas 40,112,16
mvaas 40,116,20
rta 78,21,58368
mvaas 44,112,24
mvaas 44,116,28
mvaas 48,112,32
mvaas 48,116,36
mvaas 52,112,40
buffer_load_dwordx4 v3, s[36:39], s81 offen offset:3072 lds
mvaas 52,116,44
s_add_u32 m0, s84, 4096
rta 80,22,49152
s_mov_b32 s81, 33536
mvaas 56,112,48
mvaas 56,116,52
s_and_b32 s6, s97, 3
s_cmp_eq_u32 s6, 2
s_cselect_b32 s6, 0, 4096
mvaas 60,112,56
rqa 104,16,43008
mvaas 60,116,60
mvaas 192,120,0
rta 82,22,50176
mvaas 192,124,4
buffer_load_dwordx4 v0, s[36:39], s81 offen offset:0 lds
mvaas 196,120,8
rqa 108,17,43008
mvaas 196,124,12
mvaas 200,120,16
buffer_atomic_add v27, v28, s[76:79], s6 offen sc1
mvaas 200,124,20
mvaas 204,120,24
rta 84,22,57344
mvaas 204,124,28
mvaas 208,120,32
buffer_load_dwordx4 v1, s[36:39], s81 offen offset:1024 lds
mvaas 208,124,36
mvaas 212,120,40
mvaas 212,124,44
rta 86,22,58368
mvaas 216,120,48
mvaas 216,124,52
mvaas 220,120,56
rqa 112,16,45056
s_waitcnt lgkmcnt(3)
mvaas 220,124,60
buffer_load_dwordx4 v2, s[36:39], s81 offen offset:2048 lds
mvaas 64,96,0
mvaas 64,100,4
rta 88,23,49152
mvaas 68,96,8
rqa 116,17,45056
mvaas 68,100,12
mvaas 72,96,16
mvaas 72,100,20
mvaas 76,96,24
buffer_load_dwordx4 v3, s[36:39], s81 offen offset:3072 lds
mvaas 76,100,28
rta 90,23,50176
mvaas 80,96,32
mvaas 80,100,36
mvaas 84,96,40
mvaas 84,100,44
mvaas 88,96,48
rta 92,23,57344
mvaas 88,100,52
mvaas 92,96,56
rqa 120,16,47104
mvaas 92,100,60
mvaas 224,104,0
mvaas 224,108,4
rta 94,23,58368
mvaas 228,104,8
rqa 124,17,47104
mvaas 228,108,12
mvaas 232,104,16
mvaas 232,108,20
mvaas 236,104,24
mvaas 236,108,28
mvaas 240,104,32
mvaas 240,108,36
mvaas 244,104,40
mvaas 244,108,44
mvaas 248,104,48
mvaas 248,108,52
s_waitcnt vmcnt(10) lgkmcnt(0)
mvaas 252,104,56
mvaas 252,108,60
s_barrier
mvaas 96,112,0
s_add_u32 m0, s85, 147456
rqa 96,18,0
s_mov_b32 s83, 3670016
mvaas 96,116,4
buffer_load_dwordx4 v12, s[48:51], s83 offen offset:0 lds
mvaas 100,112,8
rqa 100,19,0
mvaas 100,116,12
mvaas 104,112,16
buffer_load_dwordx4 v13, s[48:51], s83 offen offset:1024 lds
mvaas 104,116,20
mvaas 108,112,24
rqa 104,18,2048
mvaas 108,116,28
mvaas 112,112,32
mvaas 112,116,36
rqa 108,19,2048
mvaas 116,112,40
mvaas 116,116,44
buffer_load_dwordx4 v14, s[48:51], s83 offen offset:2048 lds
mvaas 120,112,48
mvaas 120,116,52
mvaas 124,112,56
mvaas 124,116,60
maaas 224,120,0
rta 0,20,16384
maaas 224,124,4
rta 2,20,17408
maaas 228,120,8
buffer_load_dwordx4 v15, s[48:51], s83 offen offset:3072 lds
maaas 228,124,12
s_add_u32 m0, s85, 98304
rta 4,20,24576
s_mov_b32 s82, 3145728
maaas 232,120,16
rta 6,20,25600
maaas 232,124,20
rta 8,21,16384
maaas 236,120,24
rta 10,21,17408
maaas 236,124,28
rta 12,21,24576
maaas 240,120,32
rta 14,21,25600
maaas 240,124,36
rta 16,22,16384
maaas 244,120,40
rta 18,22,17408
maaas 244,124,44
rta 20,22,24576
maaas 248,120,48
rta 22,22,25600
maaas 248,124,52
rta 24,23,16384
rta 26,23,17408
maaas 252,120,56
buffer_load_dwordx4 v12, s[44:47], s82 offen offset:0 lds
maaas 252,124,60
s_waitcnt lgkmcnt(10)
rta 28,23,24576
rta 30,23,25600
mvaas 128,96,0
buffer_load_dwordx4 v13, s[44:47], s82 offen offset:1024 lds
mvaas 128,100,4
rta 32,20,32768
s_waitcnt lgkmcnt(11)
mvaas 132,96,8
rqa 112,18,4096
s_waitcnt lgkmcnt(10)
mvaas 132,100,12
s_waitcnt lgkmcnt(8)
mvaas 136,96,16
rqa 116,19,4096
s_waitcnt lgkmcnt(7)
mvaas 136,100,20
rta 34,20,33792
s_waitcnt lgkmcnt(6)
mvaas 140,96,24
s_waitcnt lgkmcnt(4)
mvaas 140,100,28
buffer_load_dwordx4 v14, s[44:47], s82 offen offset:2048 lds
mvaas 144,96,64
mvaas 144,100,68
mvaas 148,96,72
rta 36,20,40960
mvaas 148,100,76
v_min_u32 v25, 17, v24
v_lshlrev_b32 v25, 7, v25
mvaas 152,96,80
mvaas 152,100,84
mvaas 156,96,88
buffer_load_dwordx4 v15, s[44:47], s82 offen offset:3072 lds
mvaas 156,100,92
s_add_u32 m0, s84, 32768
rqa 120,18,6144
s_mov_b32 s81, 896
mvaas 160,104,0
rta 38,20,41984
mvaas 160,108,4
s_mul_i32 s35, s34, 2160
s_add_u32 s35, s35, 0
v_add_u32 v25, s35, v25
mvaas 164,104,8
rqa 124,19,6144
v_min_u32 v25, 2211836, v25
mvaas 164,108,12
mvaas 168,104,16
mvaas 168,108,20
buffer_load_dwordx4 v0, s[36:39], s81 offen offset:0 lds
mvaas 172,104,24
rta 40,21,32768
mvaas 172,108,28
mvaas 176,104,64
global_load_dword a223, v25, s[22:23]
mvaas 176,108,68
mvaas 180,104,72
rta 42,21,33792
mvaas 180,108,76
mvaas 184,104,80
buffer_load_dwordx4 v1, s[36:39], s81 offen offset:1024 lds
mvaas 184,108,84
mvaas 188,104,88
rqa 96,18,8192
mvaas 188,108,92
s_waitcnt lgkmcnt(3)
mvaas 32,112,0
rta 44,21,40960
mvaas 32,116,4
mvaas 36,112,8
rqa 100,19,8192
mvaas 36,116,12
buffer_load_dwordx4 v2, s[36:39], s81 offen offset:2048 lds
mvaas 40,112,16
mvaas 40,116,20
rta 46,21,41984
mvaas 44,112,24
mvaas 44,116,28
mvaas 48,112,64
mvaas 48,116,68
mvaas 52,112,72
buffer_load_dwordx4 v3, s[36:39], s81 offen offset:3072 lds
mvaas 52,116,76
s_add_u32 m0, s84, 36864
rta 48,22,32768
s_mov_b32 s81, 33664
mvaas 56,112,80
mvaas 56,116,84
s_and_b32 s6, s97, 3
s_cmp_eq_u32 s6, 3
s_cselect_b32 s6, 0, 4096
mvaas 60,112,88
rqa 104,18,10240
mvaas 60,116,92
mvaas 192,120,0
rta 50,22,33792
mvaas 192,124,4
buffer_load_dwordx4 v0, s[36:39], s81 offen offset:0 lds
mvaas 196,120,8
rqa 108,19,10240
mvaas 196,124,12
mvaas 200,120,16
buffer_atomic_add v27, v28, s[76:79], s6 offen sc1
mvaas 200,124,20
mvaas 204,120,24
rta 52,22,40960
mvaas 204,124,28
mvaas 208,120,64
buffer_load_dwordx4 v1, s[36:39], s81 offen offset:1024 lds
mvaas 208,124,68
mvaas 212,120,72
mvaas 212,124,76
rta 54,22,41984
mvaas 216,120,80
mvaas 216,124,84
mvaas 220,120,88
rqa 112,18,12288
s_waitcnt lgkmcnt(3)
mvaas 220,124,92
buffer_load_dwordx4 v2, s[36:39], s81 offen offset:2048 lds
mvaas 64,96,0
mvaas 64,100,4
rta 56,23,32768
mvaas 68,96,8
rqa 116,19,12288
mvaas 68,100,12
mvaas 72,96,16
mvaas 72,100,20
mvaas 76,96,24
buffer_load_dwordx4 v3, s[36:39], s81 offen offset:3072 lds
mvaas 76,100,28
rta 58,23,33792
mvaas 80,96,64
mvaas 80,100,68
mvaas 84,96,72
mvaas 84,100,76
mvaas 88,96,80
rta 60,23,40960
mvaas 88,100,84
mvaas 92,96,88
rqa 120,18,14336
mvaas 92,100,92
mvaas 224,104,0
mvaas 224,108,4
rta 62,23,41984
mvaas 228,104,8
rqa 124,19,14336
mvaas 228,108,12
mvaas 232,104,16
mvaas 232,108,20
mvaas 236,104,24
mvaas 236,108,28
mvaas 240,104,64
mvaas 240,108,68
mvaas 244,104,72
mvaas 244,108,76
mvaas 248,104,80
mvaas 248,108,84
s_waitcnt vmcnt(10) lgkmcnt(0)
mvaas 252,104,88
mvaas 252,108,92
s_barrier
mvaas 96,112,0
s_add_u32 m0, s86, 131072
rqa 96,16,0
s_mov_b32 s83, 0
mvaas 96,116,4
buffer_load_dwordx4 v4, s[56:59], s83 offen offset:0 lds
mvaas 100,112,8
rqa 100,17,0
mvaas 100,116,12
mvaas 104,112,16
buffer_load_dwordx4 v5, s[56:59], s83 offen offset:1024 lds
mvaas 104,116,20
s_add_u32 m0, s86, 139264
mvaas 108,112,24
rqa 104,16,2048
mvaas 108,116,28
mvaas 112,112,64
mvaas 112,116,68
rqa 108,17,2048
mvaas 116,112,72
mvaas 116,116,76
buffer_load_dwordx4 v4, s[60:63], s83 offen offset:0 lds
mvaas 120,112,80
mvaas 120,116,84
mvaas 124,112,88
mvaas 124,116,92
maaas 224,120,0
rta 0,20,0
maaas 224,124,4
rta 2,20,1024
maaas 228,120,8
buffer_load_dwordx4 v5, s[60:63], s83 offen offset:1024 lds
maaas 228,124,12
s_add_u32 m0, s85, 114688
rta 4,20,8192
s_mov_b32 s82, 3670016
maaas 232,120,16
rta 6,20,9216
maaas 232,124,20
rta 8,21,0
maaas 236,120,24
rta 10,21,1024
maaas 236,124,28
rta 12,21,8192
maaas 240,120,64
rta 14,21,9216
maaas 240,124,68
rta 16,22,0
maaas 244,120,72
rta 18,22,1024
maaas 244,124,76
rta 20,22,8192
maaas 248,120,80
rta 22,22,9216
maaas 248,124,84
rta 24,23,0
rta 26,23,1024
maaas 252,120,88
buffer_load_dwordx4 v12, s[44:47], s82 offen offset:0 lds
maaas 252,124,92
s_waitcnt lgkmcnt(10)
rta 28,23,8192
rta 30,23,9216
mvaas 128,96,0
buffer_load_dwordx4 v13, s[44:47], s82 offen offset:1024 lds
mvaas 128,100,4
rta 64,20,49152
s_waitcnt lgkmcnt(11)
mvaas 132,96,8
rqa 112,16,4096
s_waitcnt lgkmcnt(10)
mvaas 132,100,12
s_waitcnt lgkmcnt(8)
mvaas 136,96,16
rqa 116,17,4096
s_waitcnt lgkmcnt(7)
mvaas 136,100,20
rta 66,20,50176
s_waitcnt lgkmcnt(6)
mvaas 140,96,24
s_waitcnt lgkmcnt(4)
mvaas 140,100,28
buffer_load_dwordx4 v14, s[44:47], s82 offen offset:2048 lds
mvaas 144,96,32
mvaas 144,100,36
mvaas 148,96,40
rta 68,20,57344
mvaas 148,100,44
v_min_u32 v25, 17, v24
v_lshlrev_b32 v25, 7, v25
mvaas 152,96,48
mvaas 152,100,52
mvaas 156,96,56
buffer_load_dwordx4 v15, s[44:47], s82 offen offset:3072 lds
mvaas 156,100,60
s_add_u32 m0, s84, 65536
rqa 120,16,6144
s_mov_b32 s81, 0
mvaas 160,104,0
rta 70,20,58368
mvaas 160,108,4
s_mul_i32 s35, s34, 2160
s_add_u32 s35, s35, 0
v_add_u32 v25, s35, v25
mvaas 164,104,8
rqa 124,17,6144
v_min_u32 v25, 2211836, v25
mvaas 164,108,12
mvaas 168,104,16
mvaas 168,108,20
buffer_load_dwordx4 v8, s[40:43], s81 offen offset:0 lds
mvaas 172,104,24
rta 72,21,49152
mvaas 172,108,28
mvaas 176,104,32
global_load_dword a223, v25, s[24:25]
mvaas 176,108,36
mvaas 180,104,40
rta 74,21,50176
mvaas 180,108,44
mvaas 184,104,48
buffer_load_dwordx4 v9, s[40:43], s81 offen offset:1024 lds
mvaas 184,108,52
mvaas 188,104,56
rqa 96,16,8192
mvaas 188,108,60
s_waitcnt lgkmcnt(3)
mvaas 32,112,0
rta 76,21,57344
mvaas 32,116,4
mvaas 36,112,8
rqa 100,17,8192
mvaas 36,116,12
buffer_load_dwordx4 v10, s[40:43], s81 offen offset:2048 lds
mvaas 40,112,16
mvaas 40,116,20
rta 78,21,58368
mvaas 44,112,24
mvaas 44,116,28
mvaas 48,112,32
mvaas 48,116,36
mvaas 52,112,40
buffer_load_dwordx4 v11, s[40:43], s81 offen offset:3072 lds
mvaas 52,116,44
s_add_u32 m0, s84, 69632
rta 80,22,49152
s_mov_b32 s81, 40960
mvaas 56,112,48
mvaas 56,116,52
mvaas 60,112,56
rqa 104,16,10240
mvaas 60,116,60
mvaas 192,120,0
rta 82,22,50176
mvaas 192,124,4
buffer_load_dwordx4 v8, s[40:43], s81 offen offset:0 lds
mvaas 196,120,8
rqa 108,17,10240
mvaas 196,124,12
mvaas 200,120,16
mvaas 200,124,20
mvaas 204,120,24
rta 84,22,57344
mvaas 204,124,28
mvaas 208,120,32
buffer_load_dwordx4 v9, s[40:43], s81 offen offset:1024 lds
mvaas 208,124,36
mvaas 212,120,40
mvaas 212,124,44
rta 86,22,58368
mvaas 216,120,48
mvaas 216,124,52
mvaas 220,120,56
rqa 112,16,12288
s_waitcnt lgkmcnt(3)
mvaas 220,124,60
buffer_load_dwordx4 v10, s[40:43], s81 offen offset:2048 lds
mvaas 64,96,0
mvaas 64,100,4
rta 88,23,49152
mvaas 68,96,8
rqa 116,17,12288
mvaas 68,100,12
mvaas 72,96,16
mvaas 72,100,20
mvaas 76,96,24
buffer_load_dwordx4 v11, s[40:43], s81 offen offset:3072 lds
mvaas 76,100,28
rta 90,23,50176
mvaas 80,96,32
mvaas 80,100,36
mvaas 84,96,40
mvaas 84,100,44
mvaas 88,96,48
rta 92,23,57344
mvaas 88,100,52
mvaas 92,96,56
rqa 120,16,14336
mvaas 92,100,60
mvaas 224,104,0
mvaas 224,108,4
rta 94,23,58368
mvaas 228,104,8
rqa 124,17,14336
mvaas 228,108,12
mvaas 232,104,16
mvaas 232,108,20
mvaas 236,104,24
mvaas 236,108,28
mvaas 240,104,32
mvaas 240,108,36
mvaas 244,104,40
mvaas 244,108,44
mvaas 248,104,48
mvaas 248,108,52
s_waitcnt vmcnt(9) lgkmcnt(0)
mvaas 252,104,56
mvaas 252,108,60
s_barrier
mvaas 96,112,0
s_add_u32 m0, s86, 147456
rqa 96,16,32768
s_mov_b32 s83, 221184
mvaas 96,116,4
buffer_load_dwordx4 v4, s[56:59], s83 offen offset:0 lds
mvaas 100,112,8
rqa 100,17,32768
mvaas 100,116,12
mvaas 104,112,16
buffer_load_dwordx4 v5, s[56:59], s83 offen offset:1024 lds
mvaas 104,116,20
s_add_u32 m0, s86, 155648
mvaas 108,112,24
rqa 104,16,34816
mvaas 108,116,28
mvaas 112,112,32
mvaas 112,116,36
rqa 108,17,34816
mvaas 116,112,40
mvaas 116,116,44
buffer_load_dwordx4 v4, s[60:63], s83 offen offset:0 lds
mvaas 120,112,48
mvaas 120,116,52
mvaas 124,112,56
mvaas 124,116,60
maaas 224,120,0
rta 0,20,16384
maaas 224,124,4
rta 2,20,17408
maaas 228,120,8
buffer_load_dwordx4 v5, s[60:63], s83 offen offset:1024 lds
maaas 228,124,12
s_add_u32 m0, s85, 98304
rta 4,20,24576
s_mov_b32 s82, 0
maaas 232,120,16
rta 6,20,25600
maaas 232,124,20
rta 8,21,16384
maaas 236,120,24
rta 10,21,17408
maaas 236,124,28
rta 12,21,24576
maaas 240,120,32
rta 14,21,25600
maaas 240,124,36
rta 16,22,16384
maaas 244,120,40
rta 18,22,17408
maaas 244,124,44
rta 20,22,24576
maaas 248,120,48
rta 22,22,25600
maaas 248,124,52
rta 24,23,16384
rta 26,23,17408
maaas 252,120,56
buffer_load_dwordx4 v12, s[52:55], s82 offen offset:0 lds
maaas 252,124,60
s_waitcnt lgkmcnt(10)
rta 28,23,24576
rta 30,23,25600
mvaas 128,96,0
buffer_load_dwordx4 v13, s[52:55], s82 offen offset:1024 lds
mvaas 128,100,4
rta 32,30,32768
s_waitcnt lgkmcnt(11)
mvaas 132,96,8
rqa 112,16,36864
s_waitcnt lgkmcnt(10)
mvaas 132,100,12
s_waitcnt lgkmcnt(8)
mvaas 136,96,16
rqa 116,17,36864
s_waitcnt lgkmcnt(7)
mvaas 136,100,20
rta 34,30,33280
s_waitcnt lgkmcnt(6)
mvaas 140,96,24
s_waitcnt lgkmcnt(4)
mvaas 140,100,28
buffer_load_dwordx4 v14, s[52:55], s82 offen offset:2048 lds
mvaas 144,96,64
mvaas 144,100,68
mvaas 148,96,72
rta 36,30,36864
mvaas 148,100,76
mvaas 152,96,80
mvaas 152,100,84
mvaas 156,96,88
buffer_load_dwordx4 v15, s[52:55], s82 offen offset:3072 lds
mvaas 156,100,92
s_add_u32 m0, s84, 0
rqa 120,16,38912
s_mov_b32 s81, 128
mvaas 160,104,0
rta 38,30,37376
mvaas 160,108,4
v_cvt_pk_bf16_f32 v128, v128, v129
mvaas 164,104,8
rqa 124,17,38912
v_cvt_pk_bf16_f32 v129, v130, v131
mvaas 164,108,12
mvaas 168,104,16
mvaas 168,108,20
rta 40,31,32768
v_cvt_pk_bf16_f32 v130, v160, v161
mvaas 172,104,24
buffer_load_dwordx4 v8, s[40:43], s81 offen offset:0 lds
mvaas 172,108,28
v_cvt_pk_bf16_f32 v131, v162, v163
v_cvt_pk_bf16_f32 v132, v132, v133
mvaas 176,104,64
v_cvt_pk_bf16_f32 v133, v134, v135
mvaas 176,108,68
v_cvt_pk_bf16_f32 v134, v164, v165
mvaas 180,104,72
rta 42,31,33280
v_cvt_pk_bf16_f32 v135, v166, v167
mvaas 180,108,76
mvaas 184,104,80
buffer_load_dwordx4 v9, s[40:43], s81 offen offset:1024 lds
mvaas 184,108,84
v_cvt_pk_bf16_f32 v136, v136, v137
v_cvt_pk_bf16_f32 v137, v138, v139
mvaas 188,104,88
rqa 96,16,40960
v_cvt_pk_bf16_f32 v138, v168, v169
mvaas 188,108,92
s_waitcnt lgkmcnt(3)
mvaas 32,112,0
rta 44,31,36864
v_cvt_pk_bf16_f32 v139, v170, v171
mvaas 32,116,4
v_cvt_pk_bf16_f32 v140, v140, v141
mvaas 36,112,8
rqa 100,17,40960
v_cvt_pk_bf16_f32 v141, v142, v143
mvaas 36,116,12
buffer_load_dwordx4 v10, s[40:43], s81 offen offset:2048 lds
mvaas 40,112,16
v_cvt_pk_bf16_f32 v142, v172, v173
mvaas 40,116,20
rta 46,31,37376
v_cvt_pk_bf16_f32 v143, v174, v175
mvaas 44,112,24
mvaas 44,116,28
v_cvt_pk_bf16_f32 v144, v144, v145
mvaas 48,112,64
v_cvt_pk_bf16_f32 v145, v146, v147
mvaas 48,116,68
v_cvt_pk_bf16_f32 v146, v176, v177
mvaas 52,112,72
buffer_load_dwordx4 v11, s[40:43], s81 offen offset:3072 lds
mvaas 52,116,76
s_add_u32 m0, s84, 4096
rta 48,30,40960
v_cvt_pk_bf16_f32 v147, v178, v179
mvaas 56,112,80
v_cvt_pk_bf16_f32 v148, v148, v149
s_mov_b32 s81, 41088
mvaas 56,116,84
v_cvt_pk_bf16_f32 v149, v150, v151
mvaas 60,112,88
rqa 104,16,43008
mvaas 60,116,92
v_cvt_pk_bf16_f32 v150, v180, v181
mvaas 192,120,0
rta 50,30,41472
v_cvt_pk_bf16_f32 v151, v182, v183
mvaas 192,124,4
buffer_load_dwordx4 v8, s[40:43], s81 offen offset:0 lds
mvaas 196,120,8
rqa 108,17,43008
v_cvt_pk_bf16_f32 v152, v152, v153
mvaas 196,124,12
v_cvt_pk_bf16_f32 v153, v154, v155
mvaas 200,120,16
v_cvt_pk_bf16_f32 v154, v184, v185
mvaas 200,124,20
mvaas 204,120,24
rta 52,30,45056
v_cvt_pk_bf16_f32 v155, v186, v187
mvaas 204,124,28
v_cvt_pk_bf16_f32 v156, v156, v157
mvaas 208,120,64
buffer_load_dwordx4 v9, s[40:43], s81 offen offset:1024 lds
mvaas 208,124,68
v_cvt_pk_bf16_f32 v157, v158, v159
mvaas 212,120,72
v_cvt_pk_bf16_f32 v158, v188, v189
s_mov_b32 s87, 0
mvaas 212,124,76
rta 54,30,45568
v_cvt_pk_bf16_f32 v159, v190, v191
mvaas 216,120,80
mvaas 216,124,84
v_cvt_pk_bf16_f32 v32, v32, v33
mvaas 220,120,88
s_waitcnt lgkmcnt(2)
rqa 112,16,45056
v_cvt_pk_bf16_f32 v33, v34, v35
mvaas 220,124,92
buffer_load_dwordx4 v10, s[40:43], s81 offen offset:2048 lds
mvaas 64,96,0
v_cvt_pk_bf16_f32 v34, v192, v193
mvaas 64,100,4
rta 56,31,40960
v_cvt_pk_bf16_f32 v35, v194, v195
mvaas 68,96,8
buffer_store_dwordx4 v[128:131], v6, s[64:67], s87 offen offset:0 sc1
rqa 116,17,45056
s_mov_b32 s87, 0
mvaas 68,100,12
v_cvt_pk_bf16_f32 v36, v36, v37
mvaas 72,96,16
v_cvt_pk_bf16_f32 v37, v38, v39
mvaas 72,100,20
mvaas 76,96,24
rta 58,31,41472
v_cvt_pk_bf16_f32 v38, v196, v197
mvaas 76,100,28
buffer_load_dwordx4 v11, s[40:43], s81 offen offset:3072 lds
mvaas 80,96,64
v_cvt_pk_bf16_f32 v39, v198, v199
mvaas 80,100,68
buffer_store_dwordx4 v[132:135], v6, s[64:67], s87 offen offset:1024 sc1
v_cvt_pk_bf16_f32 v40, v40, v41
mvaas 84,96,72
s_mov_b32 s87, 0
mvaas 84,100,76
v_cvt_pk_bf16_f32 v41, v42, v43
mvaas 88,96,80
rta 60,31,45056
v_cvt_pk_bf16_f32 v42, v200, v201
mvaas 88,100,84
mvaas 92,96,88
rqa 120,16,47104
v_cvt_pk_bf16_f32 v43, v202, v203
mvaas 92,100,92
mvaas 224,104,0
mvaas 224,108,4
buffer_store_dwordx4 v[136:139], v6, s[64:67], s87 offen offset:2048 sc1
rta 62,31,45568
mvaas 228,104,8
rqa 124,17,47104
s_mov_b32 s87, 0
mvaas 228,108,12
mvaas 232,104,16
mvaas 232,108,20
mvaas 236,104,24
mvaas 236,108,28
mvaas 240,104,64
mvaas 240,108,68
buffer_store_dwordx4 v[140:143], v6, s[64:67], s87 offen offset:3072 sc1
mvaas 244,104,72
mvaas 244,108,76
mvaas 248,104,80
mvaas 248,108,84
s_waitcnt vmcnt(12) lgkmcnt(0)
mvaas 252,104,88
mvaas 252,108,92
s_barrier
mvaas 96,112,0
s_add_u32 m0, s86, 131072
rqa 96,18,0
s_mov_b32 s83, 442368
mvaas 96,116,4
buffer_load_dwordx4 v4, s[56:59], s83 offen offset:0 lds
mvaas 100,112,8
v_cvt_pk_bf16_f32 v44, v44, v45
v_cvt_pk_bf16_f32 v45, v46, v47
v_cvt_pk_bf16_f32 v46, v204, v205
mvaas 100,116,12
rqa 100,19,0
mvaas 104,112,16
buffer_load_dwordx4 v5, s[56:59], s83 offen offset:1024 lds
mvaas 104,116,20
s_add_u32 m0, s86, 139264
v_cvt_pk_bf16_f32 v47, v206, v207
v_cvt_pk_bf16_f32 v48, v48, v49
mvaas 108,112,24
rqa 104,18,2048
v_cvt_pk_bf16_f32 v49, v50, v51
mvaas 108,116,28
v_cvt_pk_bf16_f32 v50, v208, v209
v_cvt_pk_bf16_f32 v51, v210, v211
mvaas 112,112,64
v_cvt_pk_bf16_f32 v52, v52, v53
v_cvt_pk_bf16_f32 v53, v54, v55
mvaas 112,116,68
rqa 108,19,2048
v_cvt_pk_bf16_f32 v54, v212, v213
mvaas 116,112,72
v_cvt_pk_bf16_f32 v55, v214, v215
v_cvt_pk_bf16_f32 v56, v56, v57
mvaas 116,116,76
buffer_load_dwordx4 v4, s[60:63], s83 offen offset:0 lds
mvaas 120,112,80
v_cvt_pk_bf16_f32 v57, v58, v59
v_cvt_pk_bf16_f32 v58, v216, v217
mvaas 120,116,84
v_cvt_pk_bf16_f32 v59, v218, v219
v_cvt_pk_bf16_f32 v60, v60, v61
mvaas 124,112,88
v_cvt_pk_bf16_f32 v61, v62, v63
v_cvt_pk_bf16_f32 v62, v220, v221
mvaas 124,116,92
v_cvt_pk_bf16_f32 v63, v222, v223
maaas 224,120,0
rta 0,20,0
maaas 224,124,4
rta 2,20,1024
maaas 228,120,8
buffer_load_dwordx4 v5, s[60:63], s83 offen offset:1024 lds
maaas 228,124,12
s_add_u32 m0, s85, 114688
rta 4,20,8192
s_mov_b32 s82, 524288
maaas 232,120,16
rta 6,20,9216
maaas 232,124,20
rta 8,21,0
s_cmp_lg_u32 s101, -1
maaas 236,120,24
rta 10,21,1024
maaas 236,124,28
rta 12,21,8192
maaas 240,120,64
rta 14,21,9216
maaas 240,124,68
rta 16,22,0
maaas 244,120,72
rta 18,22,1024
maaas 244,124,76
rta 20,22,8192
maaas 248,120,80
buffer_load_dwordx4 v12, s[52:55], s82 offen offset:0 lds
maaas 248,124,84
rta 22,22,9216
rta 24,23,0
maaas 252,120,88
rta 26,23,1024
rta 28,23,8192
maaas 252,124,92
s_cbranch_scc1 K_spare
s_waitcnt lgkmcnt(0)
maaaz 128,0,96
rta 30,23,9216
v_cvt_pk_bf16_f32 v64, v64, v65
maaas 128,4,100
rta 64,30,49152
v_cvt_pk_bf16_f32 v65, v66, v67
maaaz 132,8,96
rqa 112,18,4096
v_cvt_pk_bf16_f32 v66, v224, v225
maaas 132,12,100
buffer_load_dwordx4 v13, s[52:55], s82 offen offset:1024 lds
maaaz 136,16,96
v_cvt_pk_bf16_f32 v67, v226, v227
v_cvt_pk_bf16_f32 v68, v68, v69
maaas 136,20,100
rqa 116,19,4096
v_cvt_pk_bf16_f32 v69, v70, v71
maaaz 140,24,96
s_waitcnt lgkmcnt(3)
rta 66,30,49664
v_cvt_pk_bf16_f32 v70, v228, v229
maaas 140,28,100
v_cvt_pk_bf16_f32 v71, v230, v231
v_cvt_pk_bf16_f32 v72, v72, v73
mvaaz 160,32,96
buffer_load_dwordx4 v14, s[52:55], s82 offen offset:2048 lds
mvaas 160,36,100
v_cvt_pk_bf16_f32 v73, v74, v75
v_cvt_pk_bf16_f32 v74, v232, v233
mvaaz 164,40,96
rta 68,30,53248
v_cvt_pk_bf16_f32 v75, v234, v235
mvaas 164,44,100
v_cvt_pk_bf16_f32 v76, v76, v77
v_cvt_pk_bf16_f32 v77, v78, v79
mvaaz 168,48,96
v_cvt_pk_bf16_f32 v78, v236, v237
v_cvt_pk_bf16_f32 v79, v238, v239
mvaas 168,52,100
v_cvt_pk_bf16_f32 v80, v80, v81
v_cvt_pk_bf16_f32 v81, v82, v83
mvaaz 172,56,96
s_mov_b32 s81, 256
rqa 120,18,6144
v_cvt_pk_bf16_f32 v82, v240, v241
mvaas 172,60,100
buffer_load_dwordx4 v15, s[52:55], s82 offen offset:3072 lds
maaaz 144,0,104
s_add_u32 m0, s84, 32768
rta 70,30,53760
v_cvt_pk_bf16_f32 v83, v242, v243
maaas 144,4,108
s_mov_b32 s87, 524288
v_cvt_pk_bf16_f32 v84, v84, v85
v_cvt_pk_bf16_f32 v85, v86, v87
maaaz 148,8,104
rqa 124,19,6144
v_cvt_pk_bf16_f32 v86, v244, v245
maaas 148,12,108
v_cvt_pk_bf16_f32 v87, v246, v247
v_cvt_pk_bf16_f32 v88, v88, v89
maaaz 152,16,104
v_cvt_pk_bf16_f32 v89, v90, v91
v_cvt_pk_bf16_f32 v90, v248, v249
maaas 152,20,108
rta 72,31,49152
v_cvt_pk_bf16_f32 v91, v250, v251
maaaz 156,24,104
buffer_load_dwordx4 v8, s[40:43], s81 offen offset:0 lds
maaas 156,28,108
v_cvt_pk_bf16_f32 v92, v92, v93
v_cvt_pk_bf16_f32 v93, v94, v95
mvaaz 176,32,104
buffer_store_dwordx4 v[144:147], v6, s[64:67], s87 offen offset:0 sc1
v_cvt_pk_bf16_f32 v94, v252, v253
v_cvt_pk_bf16_f32 v95, v254, v255
mvaas 176,36,108
v_accvgpr_read_b32 v0, a224
v_accvgpr_read_b32 v1, a225
mvaaz 180,40,104
rta 74,31,49664
v_accvgpr_read_b32 v2, a226
mvaas 180,44,108
v_accvgpr_read_b32 v3, a227
mvaaz 184,48,104
buffer_load_dwordx4 v9, s[40:43], s81 offen offset:1024 lds
mvaas 184,52,108
v_cvt_pk_bf16_f32 v96, v96, v97
v_cvt_pk_bf16_f32 v97, v98, v99
mvaaz 188,56,104
s_waitcnt lgkmcnt(2)
rqa 96,18,8192
v_cvt_pk_bf16_f32 v98, v0, v1
mvaas 188,60,108
s_mov_b32 s87, 524288
v_cvt_pk_bf16_f32 v99, v2, v3
v_accvgpr_read_b32 v24, a228
maaaz 160,0,112
rta 76,31,53248
v_accvgpr_read_b32 v25, a229
maaas 160,4,116
v_accvgpr_read_b32 v26, a230
maaaz 164,8,112
rqa 100,19,8192
v_accvgpr_read_b32 v27, a231
maaas 164,12,116
buffer_load_dwordx4 v10, s[40:43], s81 offen offset:2048 lds
maaaz 168,16,112
v_cvt_pk_bf16_f32 v100, v100, v101
v_cvt_pk_bf16_f32 v101, v102, v103
maaas 168,20,116
rta 78,31,53760
v_cvt_pk_bf16_f32 v102, v24, v25
maaaz 172,24,112
buffer_store_dwordx4 v[148:151], v6, s[64:67], s87 offen offset:1024 sc1
v_cvt_pk_bf16_f32 v103, v26, v27
v_accvgpr_read_b32 v0, a232
maaas 172,28,116
v_accvgpr_read_b32 v1, a233
mvaaz 192,32,112
v_accvgpr_read_b32 v2, a234
mvaas 192,36,116
v_accvgpr_read_b32 v3, a235
v_cvt_pk_bf16_f32 v104, v104, v105
mvaaz 196,40,112
buffer_load_dwordx4 v11, s[40:43], s81 offen offset:3072 lds
mvaas 196,44,116
s_add_u32 m0, s84, 36864
rta 80,30,57344
v_cvt_pk_bf16_f32 v105, v106, v107
mvaaz 200,48,112
s_mov_b32 s81, 41216
v_cvt_pk_bf16_f32 v106, v0, v1
v_cvt_pk_bf16_f32 v107, v2, v3
mvaas 200,52,116
v_accvgpr_read_b32 v24, a236
s_mov_b32 s87, 524288
mvaaz 204,56,112
rqa 104,18,10240
v_accvgpr_read_b32 v25, a237
mvaas 204,60,116
v_accvgpr_read_b32 v26, a238
v_accvgpr_read_b32 v27, a239
maaaz 176,0,120
rta 82,30,57856
v_cvt_pk_bf16_f32 v108, v108, v109
maaas 176,4,124
buffer_load_dwordx4 v8, s[40:43], s81 offen offset:0 lds
maaaz 180,8,120
rqa 108,19,10240
v_cvt_pk_bf16_f32 v109, v110, v111
maaas 180,12,124
v_cvt_pk_bf16_f32 v110, v24, v25
v_cvt_pk_bf16_f32 v111, v26, v27
maaaz 184,16,120
buffer_store_dwordx4 v[152:155], v6, s[64:67], s87 offen offset:2048 sc1
v_accvgpr_read_b32 v0, a240
v_accvgpr_read_b32 v1, a241
maaas 184,20,124
v_accvgpr_read_b32 v2, a242
maaaz 188,24,120
rta 84,30,61440
v_accvgpr_read_b32 v3, a243
maaas 188,28,124
v_cvt_pk_bf16_f32 v112, v112, v113
mvaaz 208,32,120
buffer_load_dwordx4 v9, s[40:43], s81 offen offset:1024 lds
mvaas 208,36,124
v_cvt_pk_bf16_f32 v113, v114, v115
v_cvt_pk_bf16_f32 v114, v0, v1
mvaaz 212,40,120
v_cvt_pk_bf16_f32 v115, v2, v3
v_accvgpr_read_b32 v24, a244
mvaas 212,44,124
s_mov_b32 s87, 524288
rta 86,30,61952
v_accvgpr_read_b32 v25, a245
mvaaz 216,48,120
v_accvgpr_read_b32 v26, a246
mvaas 216,52,124
v_accvgpr_read_b32 v27, a247
mvaaz 220,56,120
s_waitcnt lgkmcnt(2)
rqa 112,18,12288
v_cvt_pk_bf16_f32 v116, v116, v117
mvaas 220,60,124
buffer_load_dwordx4 v10, s[40:43], s81 offen offset:2048 lds
maaaz 192,0,96
v_cvt_pk_bf16_f32 v117, v118, v119
v_cvt_pk_bf16_f32 v118, v24, v25
maaas 192,4,100
rta 88,31,57344
v_cvt_pk_bf16_f32 v119, v26, v27
maaaz 196,8,96
rqa 116,19,12288
v_accvgpr_read_b32 v0, a248
maaas 196,12,100
buffer_store_dwordx4 v[156:159], v6, s[64:67], s87 offen offset:3072 sc1
v_accvgpr_read_b32 v1, a249
v_accvgpr_read_b32 v2, a250
maaaz 200,16,96
v_accvgpr_read_b32 v3, a251
v_cvt_pk_bf16_f32 v120, v120, v121
maaas 200,20,100
v_cvt_pk_bf16_f32 v121, v122, v123
maaaz 204,24,96
rta 90,31,57856
v_cvt_pk_bf16_f32 v122, v0, v1
maaas 204,28,100
buffer_load_dwordx4 v11, s[40:43], s81 offen offset:3072 lds
mvaaz 224,32,96
v_cvt_pk_bf16_f32 v123, v2, v3
v_accvgpr_read_b32 v24, a252
mvaas 224,36,100
v_accvgpr_read_b32 v25, a253
v_accvgpr_read_b32 v26, a254
mvaaz 228,40,96
v_accvgpr_read_b32 v27, a255
mvaas 228,44,100
v_cvt_pk_bf16_f32 v124, v124, v125
mvaaz 232,48,96
rta 92,31,61440
v_cvt_pk_bf16_f32 v125, v126, v127
mvaas 232,52,100
v_cvt_pk_bf16_f32 v126, v24, v25
mvaaz 236,56,96
rqa 120,18,14336
v_cvt_pk_bf16_f32 v127, v26, v27
mvaas 236,60,100
maaaz 208,0,104
maaas 208,4,108
rta 94,31,61952
maaaz 212,8,104
rqa 124,19,14336
maaas 212,12,108
maaaz 216,16,104
maaas 216,20,108
maaaz 220,24,104
maaas 220,28,108
mvaaz 240,32,104
mvaas 240,36,108
mvaaz 244,40,104
mvaas 244,44,108
mvaaz 248,48,104
mvaas 248,52,108
s_waitcnt vmcnt(12) lgkmcnt(0)
mvaaz 252,56,104
mvaas 252,60,108
s_barrier
maaaz 224,0,112
s_add_u32 m0, s86, 147456
rqa 96,16,0
s_mov_b32 s83, 663552
maaas 224,4,116
buffer_load_dwordx4 v4, s[56:59], s83 offen offset:0 lds
maaaz 228,8,112
s_mov_b32 s44, s18
rqa 100,17,0
s_mov_b32 s45, s19
maaas 228,12,116
s_mov_b32 s46, 5242880
s_mov_b32 s48, s26
s_mov_b32 s49, s27
maaaz 232,16,112
buffer_load_dwordx4 v5, s[56:59], s83 offen offset:1024 lds
maaas 232,20,116
s_mov_b32 s50, 2211840
s_and_b32 s5, s30, 3
s_lshl2_add_u32 s5, s31, s5
maaaz 236,24,112
s_lshl3_add_u32 s5, s5, s94
rqa 104,16,2048
s_mul_i32 s5, s5, 73728
maaas 236,28,116
s_mul_i32 s6, s80, 14336
s_add_u32 s5, s5, s6
s_add_u32 s5, s5, 100663296
mvaaz 128,32,112
s_add_u32 s36, s64, s5
s_addc_u32 s37, s65, 0
s_add_u32 m0, s86, 155648
mvaas 128,36,116
s_lshl_b32 s6, s80, 12
rqa 108,17,2048
s_add_u32 s38, s6, 18432
mvaaz 132,40,112
mvaas 132,44,116
buffer_load_dwordx4 v4, s[60:63], s83 offen offset:0 lds
mvaaz 136,48,112
mvaas 136,52,116
mvaaz 140,56,112
mvaas 140,60,116
maaaz 240,0,120
rta 0,20,16384
maaas 240,4,124
rta 2,20,17408
maaaz 244,8,120
buffer_load_dwordx4 v5, s[60:63], s83 offen offset:1024 lds
maaas 244,12,124
s_add_u32 m0, s85, 98304
rta 4,20,24576
s_mov_b32 s82, 1048576
maaaz 248,16,120
rta 6,20,25600
maaas 248,20,124
rta 8,21,16384
maaaz 252,24,120
rta 10,21,17408
maaas 252,28,124
rta 12,21,24576
mvaaz 144,32,120
rta 14,21,25600
mvaas 144,36,124
rta 16,22,16384
mvaaz 148,40,120
rta 18,22,17408
mvaas 148,44,124
rta 20,22,24576
mvaaz 152,48,120
buffer_load_dwordx4 v12, s[52:55], s82 offen offset:0 lds
mvaas 152,52,124
rta 22,22,25600
rta 24,23,16384
mvaaz 156,56,120
rta 26,23,17408
rta 28,23,24576
mvaas 156,60,124
K_ph2:
s_waitcnt lgkmcnt(0)
maaas 128,0,96
s_mov_b32 s14, 0x26800000
rta 30,23,25600
s_mov_b32 s15, 0x58800000
maaas 128,4,100
s_sub_u32 s11, 16, s31
rta 32,30,32768
v_mbcnt_lo_u32_b32 v26, -1, 0
maaas 132,8,96
buffer_load_dwordx4 v13, s[52:55], s82 offen offset:1024 lds
maaas 132,12,100
s_lshl_b32 s11, s11, 15
rqa 112,16,4096
s_add_u32 s12, s11, 16384
maaas 136,16,96
s_add_u32 s16, s31, 1
rqa 116,17,4096
v_mbcnt_hi_u32_b32 v26, -1, v26
maaas 136,20,100
s_lshl_b32 s16, s16, 15
rta 34,30,33280
v_lshlrev_b32 v27, 4, v26
maaas 140,24,96
s_sub_u32 s13, 8, s31
s_mov_b32 s9, 65536
s_lshl_b32 s8, s80, 12
s_waitcnt lgkmcnt(4)
maaas 140,28,100
buffer_load_dwordx4 v14, s[52:55], s82 offen offset:2048 lds
mvaas 160,64,96
s_mov_b32 s10, 98304
v_add_u32 v1, s8, v27
s_cmp_eq_u32 s80, 0
mvaas 160,68,100
s_cselect_b32 s34, 16, 0
s_mov_b32 s20, 0x20e624a1
s_mov_b32 s21, 0x22f6ace3
mvaas 164,72,96
rta 36,30,36864
mvaas 164,76,100
mvaas 168,80,96
s_lshr_b32 s5, s80, 1
s_xor_b32 s5, s5, s80
s_lshl_b32 s5, s5, 12
mvaas 168,84,100
v_add_u32 v2, s5, v27
s_lshl_b32 s5, s33, 13
mvaas 172,88,96
s_mov_b32 s81, 384
rqa 120,16,6144
v_add_u32 v0, s5, v27
mvaas 172,92,100
buffer_load_dwordx4 v15, s[52:55], s82 offen offset:3072 lds
maaas 144,0,104
s_add_u32 m0, s84, 65536
rta 38,30,37376
s_lshl_b32 s5, s32, 12
maaas 144,4,108
s_lshl_b32 s6, s33, 11
s_add_u32 s5, s5, s6
s_add_u32 s5, s5, 98304
maaas 148,8,104
s_mov_b32 s87, 8192
rqa 124,17,6144
v_add_u32 v24, s5, v27
maaas 148,12,108
s_lshl_b32 s5, s32, 13
s_add_u32 s5, s5, 98304
v_add_u32 v25, s5, v27
maaas 152,16,104
s_lshl1_add_u32 s5, s33, 0
s_add_u32 s6, s32, 0
s_cmp_gt_u32 s5, s6
maaas 152,20,108
buffer_load_dwordx4 v8, s[40:43], s81 offen offset:0 lds
maaas 156,24,104
s_cselect_b32 s22, 0xff800000, 0
rta 40,31,32768
s_cmp_eq_u32 s5, s6
maaas 156,28,108
s_cselect_b32 s22, -2.0, s22
s_lshl1_add_u32 s5, s33, 1
s_add_u32 s6, s32, 0
mvaas 176,64,104
buffer_store_dwordx4 v[32:35], v6, s[64:67], s87 offen offset:0 sc1
s_cmp_gt_u32 s5, s6
s_cselect_b32 s23, 0xff800000, 0
mvaas 176,68,108
s_cmp_eq_u32 s5, s6
s_cselect_b32 s23, -2.0, s23
mvaas 180,72,104
rta 42,31,33280
mvaas 180,76,108
s_lshl1_add_u32 s5, s33, 0
s_add_u32 s6, s32, 2
mvaas 184,80,104
buffer_load_dwordx4 v9, s[40:43], s81 offen offset:1024 lds
mvaas 184,84,108
s_cmp_gt_u32 s5, s6
s_cselect_b32 s24, 0xff800000, 0
s_waitcnt lgkmcnt(2)
mvaas 188,88,104
s_cmp_eq_u32 s5, s6
rqa 96,16,8192
v_and_b32 v27, 15, v26
mvaas 188,92,108
s_cselect_b32 s24, -2.0, s24
v_lshlrev_b32 v26, 2, v27
s_lshl1_add_u32 s5, s33, 1
maaas 160,0,112
rta 44,31,36864
s_add_u32 s6, s32, 2
maaas 160,4,116
s_cmp_gt_u32 s5, s6
s_cselect_b32 s25, 0xff800000, 0
maaas 164,8,112
s_cmp_eq_u32 s5, s6
rqa 100,17,8192
s_cselect_b32 s25, -2.0, s25
maaas 164,12,116
buffer_load_dwordx4 v10, s[40:43], s81 offen offset:2048 lds
maaas 168,16,112
maaas 168,20,116
rta 46,31,37376
maaas 172,24,112
maaas 172,28,116
mvaas 192,64,112
mvaas 192,68,116
mvaas 196,72,112
buffer_load_dwordx4 v11, s[40:43], s81 offen offset:3072 lds
mvaas 196,76,116
s_add_u32 m0, s84, 69632
rta 48,30,40960
s_mov_b32 s81, 41344
mvaas 200,80,112
mvaas 200,84,116
s_mov_b32 s87, 8192
mvaas 204,88,112
rqa 104,16,10240
mvaas 204,92,116
maaas 176,0,120
rta 50,30,41472
maaas 176,4,124
buffer_load_dwordx4 v8, s[40:43], s81 offen offset:0 lds
maaas 180,8,120
rqa 108,17,10240
maaas 180,12,124
maaas 184,16,120
buffer_store_dwordx4 v[36:39], v6, s[64:67], s87 offen offset:1024 sc1
maaas 184,20,124
maaas 188,24,120
rta 52,30,45056
maaas 188,28,124
mvaas 208,64,120
buffer_load_dwordx4 v9, s[40:43], s81 offen offset:1024 lds
mvaas 208,68,124
mvaas 212,72,120
mvaas 212,76,124
rta 54,30,45568
mvaas 216,80,120
mvaas 216,84,124
mvaas 220,88,120
rqa 112,16,12288
s_waitcnt lgkmcnt(3)
mvaas 220,92,124
buffer_load_dwordx4 v10, s[40:43], s81 offen offset:2048 lds
maaas 192,0,96
maaas 192,4,100
rta 56,31,40960
maaas 196,8,96
rqa 116,17,12288
maaas 196,12,100
maaas 200,16,96
maaas 200,20,100
maaas 204,24,96
buffer_load_dwordx4 v11, s[40:43], s81 offen offset:3072 lds
maaas 204,28,100
rta 58,31,41472
mvaas 224,64,96
mvaas 224,68,100
mvaas 228,72,96
mvaas 228,76,100
mvaas 232,80,96
rta 60,31,45056
mvaas 232,84,100
mvaas 236,88,96
rqa 120,16,14336
mvaas 236,92,100
maaas 208,0,104
maaas 208,4,108
rta 62,31,45568
maaas 212,8,104
rqa 124,17,14336
maaas 212,12,108
maaas 216,16,104
maaas 216,20,108
maaas 220,24,104
maaas 220,28,108
mvaas 240,64,104
mvaas 240,68,108
mvaas 244,72,104
mvaas 244,76,108
mvaas 248,80,104
mvaas 248,84,108
s_waitcnt vmcnt(10) lgkmcnt(0)
mvaas 252,88,104
mvaas 252,92,108
s_barrier
maaas 224,0,112
s_add_u32 m0, s86, 131072
rqa 96,16,32768
s_mov_b32 s83, 884736
maaas 224,4,116
buffer_load_dwordx4 v4, s[56:59], s83 offen offset:0 lds
maaas 228,8,112
rqa 100,17,32768
maaas 228,12,116
maaas 232,16,112
buffer_load_dwordx4 v5, s[56:59], s83 offen offset:1024 lds
maaas 232,20,116
s_add_u32 m0, s86, 139264
maaas 236,24,112
rqa 104,16,34816
maaas 236,28,116
mvaas 128,64,112
mvaas 128,68,116
rqa 108,17,34816
mvaas 132,72,112
mvaas 132,76,116
buffer_load_dwordx4 v4, s[60:63], s83 offen offset:0 lds
mvaas 136,80,112
mvaas 136,84,116
mvaas 140,88,112
mvaas 140,92,116
maaas 240,0,120
rta 0,20,0
maaas 240,4,124
rta 2,20,1024
maaas 244,8,120
buffer_load_dwordx4 v5, s[60:63], s83 offen offset:1024 lds
maaas 244,12,124
s_add_u32 m0, s85, 114688
rta 4,20,8192
s_mov_b32 s82, 1572864
maaas 248,16,120
rta 6,20,9216
maaas 248,20,124
rta 8,21,0
maaas 252,24,120
rta 10,21,1024
maaas 252,28,124
rta 12,21,8192
mvaas 144,64,120
rta 14,21,9216
mvaas 144,68,124
rta 16,22,0
mvaas 148,72,120
rta 18,22,1024
mvaas 148,76,124
rta 20,22,8192
mvaas 152,80,120
rta 22,22,9216
mvaas 152,84,124
rta 24,23,0
rta 26,23,1024
mvaas 156,88,120
buffer_load_dwordx4 v12, s[52:55], s82 offen offset:0 lds
mvaas 156,92,124
s_waitcnt lgkmcnt(10)
rta 28,23,8192
rta 30,23,9216
maaas 128,0,96
buffer_load_dwordx4 v13, s[52:55], s82 offen offset:1024 lds
maaas 128,4,100
rta 64,30,49152
s_waitcnt lgkmcnt(9)
maaas 132,8,96
buffer_load_dword v27, v26, s[76:79], s8 offen sc1
maaas 132,12,100
rqa 112,16,36864
s_waitcnt lgkmcnt(8)
maaas 136,16,96
rqa 116,17,36864
s_waitcnt lgkmcnt(7)
maaas 136,20,100
rta 66,30,49664
s_waitcnt lgkmcnt(6)
maaas 140,24,96
s_waitcnt lgkmcnt(4)
maaas 140,28,100
buffer_load_dwordx4 v14, s[52:55], s82 offen offset:2048 lds
mvaas 160,32,96
mvaas 160,36,100
mvaas 164,40,96
rta 68,30,53248
mvaas 164,44,100
mvaas 168,48,96
mvaas 168,52,100
mvaas 172,56,96
buffer_load_dwordx4 v15, s[52:55], s82 offen offset:3072 lds
mvaas 172,60,100
s_add_u32 m0, s84, 0
rqa 120,16,38912
s_mov_b32 s81, 512
maaas 144,0,104
rta 70,30,53760
maaas 144,4,108
s_mov_b32 s87, 8192
maaas 148,8,104
rqa 124,17,38912
maaas 148,12,108
maaas 152,16,104
maaas 152,20,108
buffer_load_dwordx4 v8, s[40:43], s81 offen offset:0 lds
maaas 156,24,104
rta 72,31,49152
maaas 156,28,108
mvaas 176,32,104
buffer_store_dwordx4 v[40:43], v6, s[64:67], s87 offen offset:2048 sc1
mvaas 176,36,108
mvaas 180,40,104
rta 74,31,49664
mvaas 180,44,108
mvaas 184,48,104
buffer_load_dwordx4 v9, s[40:43], s81 offen offset:1024 lds
mvaas 184,52,108
mvaas 188,56,104
rqa 96,16,40960
mvaas 188,60,108
s_waitcnt lgkmcnt(2)
maaas 160,0,112
rta 76,31,53248
maaas 160,4,116
maaas 164,8,112
rqa 100,17,40960
maaas 164,12,116
buffer_load_dwordx4 v10, s[40:43], s81 offen offset:2048 lds
maaas 168,16,112
maaas 168,20,116
rta 78,31,53760
maaas 172,24,112
s_mov_b32 s87, 8192
maaas 172,28,116
mvaas 192,32,112
mvaas 192,36,116
mvaas 196,40,112
buffer_load_dwordx4 v11, s[40:43], s81 offen offset:3072 lds
mvaas 196,44,116
s_add_u32 m0, s84, 4096
rta 80,30,57344
s_mov_b32 s81, 41472
mvaas 200,48,112
mvaas 200,52,116
buffer_store_dwordx4 v[44:47], v6, s[64:67], s87 offen offset:3072 sc1
mvaas 204,56,112
rqa 104,16,43008
mvaas 204,60,116
maaas 176,0,120
rta 82,30,57856
maaas 176,4,124
buffer_load_dwordx4 v8, s[40:43], s81 offen offset:0 lds
maaas 180,8,120
rqa 108,17,43008
maaas 180,12,124
maaas 184,16,120
maaas 184,20,124
maaas 188,24,120
rta 84,30,61440
maaas 188,28,124
mvaas 208,32,120
buffer_load_dwordx4 v9, s[40:43], s81 offen offset:1024 lds
mvaas 208,36,124
mvaas 212,40,120
mvaas 212,44,124
rta 86,30,61952
s_mov_b32 s87, 532480
mvaas 216,48,120
mvaas 216,52,124
mvaas 220,56,120
rqa 112,16,45056
s_waitcnt lgkmcnt(3)
mvaas 220,60,124
buffer_load_dwordx4 v10, s[40:43], s81 offen offset:2048 lds
maaas 192,0,96
maaas 192,4,100
rta 88,31,57344
maaas 196,8,96
buffer_store_dwordx4 v[48:51], v6, s[64:67], s87 offen offset:0 sc1
rqa 116,17,45056
maaas 196,12,100
maaas 200,16,96
maaas 200,20,100
maaas 204,24,96
buffer_load_dwordx4 v11, s[40:43], s81 offen offset:3072 lds
maaas 204,28,100
rta 90,31,57856
mvaas 224,32,96
mvaas 224,36,100
mvaas 228,40,96
mvaas 228,44,100
mvaas 232,48,96
rta 92,31,61440
mvaas 232,52,100
mvaas 236,56,96
rqa 120,16,47104
mvaas 236,60,100
maaas 208,0,104
maaas 208,4,108
rta 94,31,61952
maaas 212,8,104
rqa 124,17,47104
maaas 212,12,108
maaas 216,16,104
maaas 216,20,108
maaas 220,24,104
maaas 220,28,108
mvaas 240,32,104
mvaas 240,36,108
mvaas 244,40,104
mvaas 244,44,108
mvaas 248,48,104
mvaas 248,52,108
s_waitcnt vmcnt(11) lgkmcnt(0)
mvaas 252,56,104
mvaas 252,60,108
s_barrier
maaas 224,0,112
s_add_u32 m0, s86, 147456
rqa 96,18,0
s_mov_b32 s83, 1105920
maaas 224,4,116
buffer_load_dwordx4 v4, s[56:59], s83 offen offset:0 lds
maaas 228,8,112
rqa 100,19,0
maaas 228,12,116
maaas 232,16,112
buffer_load_dwordx4 v5, s[56:59], s83 offen offset:1024 lds
maaas 232,20,116
s_add_u32 m0, s86, 155648
maaas 236,24,112
rqa 104,18,2048
maaas 236,28,116
mvaas 128,32,112
mvaas 128,36,116
rqa 108,19,2048
mvaas 132,40,112
mvaas 132,44,116
buffer_load_dwordx4 v4, s[60:63], s83 offen offset:0 lds
mvaas 136,48,112
mvaas 136,52,116
mvaas 140,56,112
mvaas 140,60,116
maaas 240,0,120
rta 0,20,16384
maaas 240,4,124
rta 2,20,17408
maaas 244,8,120
buffer_load_dwordx4 v5, s[60:63], s83 offen offset:1024 lds
maaas 244,12,124
s_add_u32 m0, s85, 98304
rta 4,20,24576
s_mov_b32 s82, 2097152
maaas 248,16,120
rta 6,20,25600
maaas 248,20,124
rta 8,21,16384
maaas 252,24,120
rta 10,21,17408
maaas 252,28,124
rta 12,21,24576
mvaas 144,32,120
rta 14,21,25600
mvaas 144,36,124
rta 16,22,16384
mvaas 148,40,120
rta 18,22,17408
mvaas 148,44,124
rta 20,22,24576
mvaas 152,48,120
rta 22,22,25600
mvaas 152,52,124
rta 24,23,16384
rta 26,23,17408
mvaas 156,56,120
buffer_load_dwordx4 v12, s[52:55], s82 offen offset:0 lds
mvaas 156,60,124
s_waitcnt lgkmcnt(10)
rta 28,23,24576
rta 30,23,25600
maaas 128,0,96
buffer_load_dwordx4 v13, s[52:55], s82 offen offset:1024 lds
maaas 128,4,100
rta 32,30,32768
s_waitcnt lgkmcnt(11)
maaas 132,8,96
rqa 112,18,4096
s_waitcnt lgkmcnt(10)
maaas 132,12,100
s_waitcnt lgkmcnt(8)
maaas 136,16,96
rqa 116,19,4096
s_waitcnt lgkmcnt(7)
maaas 136,20,100
s_waitcnt lgkmcnt(5)
rta 34,30,33280
v_accvgpr_read_b32 v32, a128
maaas 140,24,96
s_waitcnt lgkmcnt(4)
v_accvgpr_read_b32 v33, a129
v_accvgpr_read_b32 v34, a130
maaas 140,28,100
buffer_load_dwordx4 v14, s[52:55], s82 offen offset:2048 lds
mvaas 160,64,96
v_accvgpr_read_b32 v35, a131
v_accvgpr_read_b32 v36, a132
mvaas 160,68,100
v_accvgpr_read_b32 v37, a133
v_accvgpr_read_b32 v38, a134
mvaas 164,72,96
rta 36,30,36864
v_accvgpr_read_b32 v39, a135
mvaas 164,76,100
v_accvgpr_read_b32 v40, a136
v_accvgpr_read_b32 v41, a137
mvaas 168,80,96
v_accvgpr_read_b32 v42, a138
v_accvgpr_read_b32 v43, a139
mvaas 168,84,100
v_accvgpr_read_b32 v44, a140
v_accvgpr_read_b32 v45, a141
mvaas 172,88,96
s_mov_b32 s81, 640
rqa 120,18,6144
v_accvgpr_read_b32 v46, a142
mvaas 172,92,100
buffer_load_dwordx4 v15, s[52:55], s82 offen offset:3072 lds
maaas 144,0,104
s_add_u32 m0, s84, 32768
rta 38,30,37376
v_accvgpr_read_b32 v47, a143
maaas 144,4,108
s_mov_b32 s87, 532480
maaas 148,8,104
rqa 124,19,6144
maaas 148,12,108
maaas 152,16,104
maaas 152,20,108
buffer_load_dwordx4 v8, s[40:43], s81 offen offset:0 lds
maaas 156,24,104
rta 40,31,32768
maaas 156,28,108
mvaas 176,64,104
buffer_store_dwordx4 v[52:55], v6, s[64:67], s87 offen offset:1024 sc1
mvaas 176,68,108
mvaas 180,72,104
rta 42,31,33280
mvaas 180,76,108
mvaas 184,80,104
buffer_load_dwordx4 v9, s[40:43], s81 offen offset:1024 lds
mvaas 184,84,108
mvaas 188,88,104
rqa 96,18,8192
mvaas 188,92,108
s_waitcnt lgkmcnt(2)
maaas 160,0,112
rta 44,31,36864
maaas 160,4,116
maaas 164,8,112
rqa 100,19,8192
maaas 164,12,116
buffer_load_dwordx4 v10, s[40:43], s81 offen offset:2048 lds
maaas 168,16,112
maaas 168,20,116
rta 46,31,37376
maaas 172,24,112
s_mov_b32 s87, 532480
maaas 172,28,116
mvaas 192,64,112
mvaas 192,68,116
mvaas 196,72,112
buffer_load_dwordx4 v11, s[40:43], s81 offen offset:3072 lds
mvaas 196,76,116
s_add_u32 m0, s84, 36864
rta 48,30,40960
s_mov_b32 s81, 41600
mvaas 200,80,112
mvaas 200,84,116
buffer_store_dwordx4 v[56:59], v6, s[64:67], s87 offen offset:2048 sc1
mvaas 204,88,112
rqa 104,18,10240
mvaas 204,92,116
maaas 176,0,120
rta 50,30,41472
maaas 176,4,124
buffer_load_dwordx4 v8, s[40:43], s81 offen offset:0 lds
maaas 180,8,120
rqa 108,19,10240
maaas 180,12,124
maaas 184,16,120
maaas 184,20,124
maaas 188,24,120
rta 52,30,45056
maaas 188,28,124
mvaas 208,64,120
buffer_load_dwordx4 v9, s[40:43], s81 offen offset:1024 lds
mvaas 208,68,124
mvaas 212,72,120
mvaas 212,76,124
rta 54,30,45568
s_mov_b32 s87, 532480
mvaas 216,80,120
mvaas 216,84,124
mvaas 220,88,120
rqa 112,18,12288
s_waitcnt lgkmcnt(3)
mvaas 220,92,124
buffer_load_dwordx4 v10, s[40:43], s81 offen offset:2048 lds
maaas 192,0,96
maaas 192,4,100
rta 56,31,40960
maaas 196,8,96
buffer_store_dwordx4 v[60:63], v6, s[64:67], s87 offen offset:3072 sc1
rqa 116,19,12288
maaas 196,12,100
maaas 200,16,96
maaas 200,20,100
maaas 204,24,96
buffer_load_dwordx4 v11, s[40:43], s81 offen offset:3072 lds
maaas 204,28,100
rta 58,31,41472
mvaas 224,64,96
mvaas 224,68,100
mvaas 228,72,96
mvaas 228,76,100
mvaas 232,80,96
rta 60,31,45056
mvaas 232,84,100
mvaas 236,88,96
rqa 120,18,14336
mvaas 236,92,100
maaas 208,0,104
maaas 208,4,108
rta 62,31,45568
maaas 212,8,104
rqa 124,19,14336
maaas 212,12,108
maaas 216,16,104
maaas 216,20,108
maaas 220,24,104
maaas 220,28,108
mvaas 240,64,104
mvaas 240,68,108
mvaas 244,72,104
mvaas 244,76,108
mvaas 248,80,104
mvaas 248,84,108
s_waitcnt vmcnt(11) lgkmcnt(0)
mvaas 252,88,104
mvaas 252,92,108
s_barrier
maaas 224,0,112
s_add_u32 m0, s86, 131072
rqa 96,16,0
s_mov_b32 s83, 1327104
maaas 224,4,116
buffer_load_dwordx4 v4, s[56:59], s83 offen offset:0 lds
maaas 228,8,112
rqa 100,17,0
maaas 228,12,116
maaas 232,16,112
buffer_load_dwordx4 v5, s[56:59], s83 offen offset:1024 lds
maaas 232,20,116
v_cmp_gt_u32 vcc, s34, v27
s_add_u32 m0, s86, 139264
maaas 236,24,112
rqa 104,16,2048
maaas 236,28,116
mvaas 128,64,112
mvaas 128,68,116
rqa 108,17,2048
mvaas 132,72,112
mvaas 132,76,116
buffer_load_dwordx4 v4, s[60:63], s83 offen offset:0 lds
mvaas 136,80,112
mvaas 136,84,116
mvaas 140,88,112
mvaas 140,92,116
maaas 240,0,120
s_cbranch_vccnz PCK_spin
PCK_ok:
rta 0,20,0
maaas 240,4,124
rta 2,20,1024
maaas 244,8,120
buffer_load_dwordx4 v5, s[60:63], s83 offen offset:1024 lds
maaas 244,12,124
s_add_u32 m0, s85, 114688
rta 4,20,8192
s_mov_b32 s82, 2621440
maaas 248,16,120
rta 6,20,9216
v_mbcnt_lo_u32_b32 v26, -1, 0
maaas 248,20,124
rta 8,21,0
maaas 252,24,120
rta 10,21,1024
maaas 252,28,124
rta 12,21,8192
mvaas 144,64,120
rta 14,21,9216
v_mbcnt_hi_u32_b32 v26, -1, v26
mvaas 144,68,124
rta 16,22,0
mvaas 148,72,120
rta 18,22,1024
mvaas 148,76,124
rta 20,22,8192
mvaas 152,80,120
rta 22,22,9216
v_lshlrev_b32 v26, 2, v26
mvaas 152,84,124
rta 24,23,0
rta 26,23,1024
mvaas 156,88,120
buffer_load_dwordx4 v12, s[52:55], s82 offen offset:0 lds
mvaas 156,92,124
s_waitcnt lgkmcnt(10)
rta 28,23,8192
rta 30,23,9216
mvaas 32,0,96
buffer_load_dwordx4 v13, s[52:55], s82 offen offset:1024 lds
mvaas 32,4,100
rta 64,30,49152
s_waitcnt lgkmcnt(11)
mvaas 36,8,96
rqa 112,16,4096
s_waitcnt lgkmcnt(10)
mvaas 36,12,100
s_waitcnt lgkmcnt(8)
mvaas 40,16,96
rqa 116,17,4096
s_waitcnt lgkmcnt(7)
mvaas 40,20,100
rta 66,30,49664
s_waitcnt lgkmcnt(6)
mvaas 44,24,96
s_waitcnt lgkmcnt(4)
mvaas 44,28,100
buffer_load_dwordx4 v14, s[52:55], s82 offen offset:2048 lds
mvaas 160,32,96
mvaas 160,36,100
mvaas 164,40,96
rta 68,30,53248
mvaas 164,44,100
mvaas 168,48,96
mvaas 168,52,100
mvaas 172,56,96
buffer_load_dwordx4 v15, s[52:55], s82 offen offset:3072 lds
mvaas 172,60,100
s_add_u32 m0, s84, 65536
rqa 120,16,6144
s_mov_b32 s81, 768
maaas 144,0,104
rta 70,30,53760
maaas 144,4,108
s_mov_b32 s87, 16384
maaas 148,8,104
rqa 124,17,6144
maaas 148,12,108
maaas 152,16,104
maaas 152,20,108
buffer_load_dwordx4 v8, s[40:43], s81 offen offset:0 lds
maaas 156,24,104
rta 72,31,49152
v_accvgpr_read_b32 v48, a144
maaas 156,28,108
v_accvgpr_read_b32 v49, a145
v_accvgpr_read_b32 v50, a146
mvaas 176,32,104
buffer_store_dwordx4 v[64:67], v6, s[64:67], s87 offen offset:0 sc1
v_accvgpr_read_b32 v51, a147
v_accvgpr_read_b32 v52, a148
v_accvgpr_read_b32 v53, a149
mvaas 176,36,108
v_accvgpr_read_b32 v54, a150
v_accvgpr_read_b32 v55, a151
mvaas 180,40,104
rta 74,31,49664
v_accvgpr_read_b32 v56, a152
mvaas 180,44,108
v_accvgpr_read_b32 v57, a153
v_accvgpr_read_b32 v58, a154
mvaas 184,48,104
buffer_load_dwordx4 v9, s[40:43], s81 offen offset:1024 lds
mvaas 184,52,108
v_accvgpr_read_b32 v59, a155
v_accvgpr_read_b32 v60, a156
mvaas 188,56,104
rqa 96,16,8192
v_accvgpr_read_b32 v61, a157
mvaas 188,60,108
s_waitcnt lgkmcnt(3)
v_accvgpr_read_b32 v62, a158
v_accvgpr_read_b32 v63, a159
maaas 160,0,112
rta 76,31,53248
maaas 160,4,116
maaas 164,8,112
rqa 100,17,8192
maaas 164,12,116
buffer_load_dwordx4 v10, s[40:43], s81 offen offset:2048 lds
maaas 168,16,112
maaas 168,20,116
rta 78,31,53760
maaas 172,24,112
s_mov_b32 s87, 16384
maaas 172,28,116
mvaas 192,32,112
mvaas 192,36,116
mvaas 196,40,112
buffer_load_dwordx4 v11, s[40:43], s81 offen offset:3072 lds
mvaas 196,44,116
s_add_u32 m0, s84, 69632
rta 80,30,57344
s_mov_b32 s81, 41728
mvaas 200,48,112
mvaas 200,52,116
buffer_store_dwordx4 v[68:71], v6, s[64:67], s87 offen offset:1024 sc1
mvaas 204,56,112
rqa 104,16,10240
mvaas 204,60,116
maaas 176,0,120
rta 82,30,57856
maaas 176,4,124
buffer_load_dwordx4 v8, s[40:43], s81 offen offset:0 lds
maaas 180,8,120
rqa 108,17,10240
maaas 180,12,124
maaas 184,16,120
maaas 184,20,124
maaas 188,24,120
rta 84,30,61440
maaas 188,28,124
mvaas 208,32,120
buffer_load_dwordx4 v9, s[40:43], s81 offen offset:1024 lds
mvaas 208,36,124
mvaas 212,40,120
mvaas 212,44,124
rta 86,30,61952
s_mov_b32 s87, 16384
mvaas 216,48,120
mvaas 216,52,124
mvaas 220,56,120
rqa 112,16,12288
s_waitcnt lgkmcnt(3)
mvaas 220,60,124
buffer_load_dwordx4 v10, s[40:43], s81 offen offset:2048 lds
maaas 192,0,96
maaas 192,4,100
rta 88,31,57344
maaas 196,8,96
buffer_store_dwordx4 v[72:75], v6, s[64:67], s87 offen offset:2048 sc1
rqa 116,17,12288
maaas 196,12,100
maaas 200,16,96
maaas 200,20,100
maaas 204,24,96
buffer_load_dwordx4 v11, s[40:43], s81 offen offset:3072 lds
maaas 204,28,100
rta 90,31,57856
mvaas 224,32,96
mvaas 224,36,100
mvaas 228,40,96
mvaas 228,44,100
mvaas 232,48,96
rta 92,31,61440
mvaas 232,52,100
mvaas 236,56,96
rqa 120,16,14336
mvaas 236,60,100
maaas 208,0,104
maaas 208,4,108
rta 94,31,61952
maaas 212,8,104
rqa 124,17,14336
maaas 212,12,108
maaas 216,16,104
maaas 216,20,108
maaas 220,24,104
maaas 220,28,108
mvaas 240,32,104
mvaas 240,36,108
mvaas 244,40,104
mvaas 244,44,108
mvaas 248,48,104
mvaas 248,52,108
s_waitcnt vmcnt(11) lgkmcnt(0)
mvaas 252,56,104
mvaas 252,60,108
s_barrier
maaas 224,0,112
s_cmp_eq_u32 s80, 0
rqa 96,16,32768
s_cselect_b32 s87, s100, 268435456
maaas 224,4,116
s_add_u32 m0, s86, 147456
v_mov_b32 v27, 1
v_and_b32 v28, 12, v26
s_mov_b32 s83, 1548288
maaas 228,8,112
buffer_store_dword v27, v28, s[64:67], s87 offen sc1
maaas 228,12,116
buffer_load_dwordx4 v4, s[56:59], s83 offen offset:0 lds
maaas 232,16,112
rqa 100,17,32768
maaas 232,20,116
buffer_load_dwordx4 v5, s[56:59], s83 offen offset:1024 lds
maaas 236,24,112
rqa 104,16,34816
s_add_u32 m0, s86, 155648
maaas 236,28,116
mvaas 128,32,112
mvaas 128,36,116
rqa 108,17,34816
mvaas 132,40,112
mvaas 132,44,116
buffer_load_dwordx4 v4, s[60:63], s83 offen offset:0 lds
mvaas 136,48,112
mvaas 136,52,116
mvaas 140,56,112
mvaas 140,60,116
maaas 240,0,120
rta 0,20,16384
maaas 240,4,124
rta 2,20,17408
maaas 244,8,120
buffer_load_dwordx4 v5, s[60:63], s83 offen offset:1024 lds
maaas 244,12,124
s_add_u32 m0, s85, 98304
rta 4,20,24576
s_mov_b32 s82, 3145728
maaas 248,16,120
rta 6,20,25600
maaas 248,20,124
rta 8,21,16384
maaas 252,24,120
rta 10,21,17408
maaas 252,28,124
rta 12,21,24576
mvaas 144,32,120
rta 14,21,25600
mvaas 144,36,124
rta 16,22,16384
mvaas 148,40,120
rta 18,22,17408
mvaas 148,44,124
rta 20,22,24576
mvaas 152,48,120
rta 22,22,25600
mvaas 152,52,124
rta 24,23,16384
rta 26,23,17408
mvaas 156,56,120
buffer_load_dwordx4 v12, s[52:55], s82 offen offset:0 lds
mvaas 156,60,124
s_waitcnt lgkmcnt(10)
rta 28,23,24576
rta 30,23,25600
mvaas 32,0,96
buffer_load_dwordx4 v13, s[52:55], s82 offen offset:1024 lds
mvaas 32,4,100
rta 32,30,32768
s_waitcnt lgkmcnt(11)
mvaas 36,8,96
rqa 112,16,36864
s_waitcnt lgkmcnt(10)
mvaas 36,12,100
s_waitcnt lgkmcnt(8)
mvaas 40,16,96
rqa 116,17,36864
s_waitcnt lgkmcnt(7)
mvaas 40,20,100
rta 34,30,33280
s_waitcnt lgkmcnt(6)
mvaas 44,24,96
s_waitcnt lgkmcnt(4)
mvaas 44,28,100
buffer_load_dwordx4 v14, s[52:55], s82 offen offset:2048 lds
mvaas 160,64,96
mvaas 160,68,100
mvaas 164,72,96
rta 36,30,36864
mvaas 164,76,100
mvaas 168,80,96
mvaas 168,84,100
mvaas 172,88,96
buffer_load_dwordx4 v15, s[52:55], s82 offen offset:3072 lds
mvaas 172,92,100
s_add_u32 m0, s84, 0
rqa 120,16,38912
s_mov_b32 s81, 896
mvaas 48,0,104
rta 38,30,37376
mvaas 48,4,108
s_mov_b32 s87, 16384
mvaas 52,8,104
rqa 124,17,38912
mvaas 52,12,108
mvaas 56,16,104
mvaas 56,20,108
buffer_load_dwordx4 v8, s[40:43], s81 offen offset:0 lds
mvaas 60,24,104
rta 40,31,32768
mvaas 60,28,108
mvaas 176,64,104
buffer_store_dwordx4 v[76:79], v6, s[64:67], s87 offen offset:3072 sc1
mvaas 176,68,108
mvaas 180,72,104
rta 42,31,33280
mvaas 180,76,108
mvaas 184,80,104
buffer_load_dwordx4 v9, s[40:43], s81 offen offset:1024 lds
mvaas 184,84,108
mvaas 188,88,104
rqa 96,16,40960
mvaas 188,92,108
s_waitcnt lgkmcnt(2)
maaas 160,0,112
rta 44,31,36864
maaas 160,4,116
maaas 164,8,112
rqa 100,17,40960
maaas 164,12,116
buffer_load_dwordx4 v10, s[40:43], s81 offen offset:2048 lds
maaas 168,16,112
maaas 168,20,116
rta 46,31,37376
maaas 172,24,112
s_mov_b32 s87, 540672
maaas 172,28,116
mvaas 192,64,112
mvaas 192,68,116
mvaas 196,72,112
buffer_load_dwordx4 v11, s[40:43], s81 offen offset:3072 lds
mvaas 196,76,116
s_add_u32 m0, s84, 4096
rta 48,30,40960
s_mov_b32 s81, 41856
mvaas 200,80,112
mvaas 200,84,116
buffer_store_dwordx4 v[80:83], v6, s[64:67], s87 offen offset:0 sc1
mvaas 204,88,112
rqa 104,16,43008
mvaas 204,92,116
maaas 176,0,120
rta 50,30,41472
maaas 176,4,124
buffer_load_dwordx4 v8, s[40:43], s81 offen offset:0 lds
maaas 180,8,120
rqa 108,17,43008
maaas 180,12,124
maaas 184,16,120
maaas 184,20,124
maaas 188,24,120
rta 52,30,45056
maaas 188,28,124
mvaas 208,64,120
buffer_load_dwordx4 v9, s[40:43], s81 offen offset:1024 lds
mvaas 208,68,124
mvaas 212,72,120
mvaas 212,76,124
rta 54,30,45568
s_mov_b32 s87, 540672
mvaas 216,80,120
mvaas 216,84,124
mvaas 220,88,120
rqa 112,16,45056
s_waitcnt lgkmcnt(3)
mvaas 220,92,124
buffer_load_dwordx4 v10, s[40:43], s81 offen offset:2048 lds
maaas 192,0,96
maaas 192,4,100
rta 56,31,40960
maaas 196,8,96
buffer_store_dwordx4 v[84:87], v6, s[64:67], s87 offen offset:1024 sc1
rqa 116,17,45056
maaas 196,12,100
maaas 200,16,96
maaas 200,20,100
maaas 204,24,96
buffer_load_dwordx4 v11, s[40:43], s81 offen offset:3072 lds
maaas 204,28,100
rta 58,31,41472
mvaas 224,64,96
mvaas 224,68,100
mvaas 228,72,96
mvaas 228,76,100
mvaas 232,80,96
rta 60,31,45056
mvaas 232,84,100
mvaas 236,88,96
rqa 120,16,47104
mvaas 236,92,100
maaas 208,0,104
maaas 208,4,108
rta 62,31,45568
maaas 212,8,104
rqa 124,17,47104
maaas 212,12,108
maaas 216,16,104
maaas 216,20,108
maaas 220,24,104
maaas 220,28,108
mvaas 240,64,104
mvaas 240,68,108
mvaas 244,72,104
mvaas 244,76,108
mvaas 248,80,104
mvaas 248,84,108
s_waitcnt vmcnt(11) lgkmcnt(0)
mvaas 252,88,104
mvaas 252,92,108
s_barrier
maaas 224,0,112
s_add_u32 m0, s86, 131072
rqa 96,18,0
s_mov_b32 s83, 1769472
maaas 224,4,116
buffer_load_dwordx4 v4, s[56:59], s83 offen offset:0 lds
maaas 228,8,112
rqa 100,19,0
maaas 228,12,116
maaas 232,16,112
buffer_load_dwordx4 v5, s[56:59], s83 offen offset:1024 lds
maaas 232,20,116
s_add_u32 m0, s86, 139264
maaas 236,24,112
rqa 104,18,2048
maaas 236,28,116
mvaas 128,64,112
mvaas 128,68,116
rqa 108,19,2048
mvaas 132,72,112
mvaas 132,76,116
buffer_load_dwordx4 v4, s[60:63], s83 offen offset:0 lds
mvaas 136,80,112
mvaas 136,84,116
mvaas 140,88,112
mvaas 140,92,116
maaas 240,0,120
rta 0,20,0
maaas 240,4,124
rta 2,20,1024
maaas 244,8,120
buffer_load_dwordx4 v5, s[60:63], s83 offen offset:1024 lds
maaas 244,12,124
s_add_u32 m0, s85, 114688
rta 4,20,8192
s_mov_b32 s82, 3670016
maaas 248,16,120
rta 6,20,9216
maaas 248,20,124
rta 8,21,0
maaas 252,24,120
rta 10,21,1024
maaas 252,28,124
rta 12,21,8192
mvaas 144,64,120
rta 14,21,9216
mvaas 144,68,124
rta 16,22,0
mvaas 148,72,120
rta 18,22,1024
mvaas 148,76,124
rta 20,22,8192
mvaas 152,80,120
rta 22,22,9216
mvaas 152,84,124
rta 24,23,0
rta 26,23,1024
mvaas 156,88,120
buffer_load_dwordx4 v12, s[52:55], s82 offen offset:0 lds
mvaas 156,92,124
s_waitcnt lgkmcnt(10)
rta 28,23,8192
rta 30,23,9216
mvaas 32,0,96
buffer_load_dwordx4 v13, s[52:55], s82 offen offset:1024 lds
mvaas 32,4,100
rta 64,30,49152
s_waitcnt lgkmcnt(11)
mvaas 36,8,96
rqa 112,18,4096
s_waitcnt lgkmcnt(10)
mvaas 36,12,100
s_waitcnt lgkmcnt(8)
mvaas 40,16,96
rqa 116,19,4096
s_waitcnt lgkmcnt(7)
mvaas 40,20,100
rta 66,30,49664
s_waitcnt lgkmcnt(6)
mvaas 44,24,96
s_waitcnt lgkmcnt(4)
mvaas 44,28,100
buffer_load_dwordx4 v14, s[52:55], s82 offen offset:2048 lds
mvaas 160,32,96
mvaas 160,36,100
mvaas 164,40,96
rta 68,30,53248
mvaas 164,44,100
mvaas 168,48,96
mvaas 168,52,100
mvaas 172,56,96
buffer_load_dwordx4 v15, s[52:55], s82 offen offset:3072 lds
mvaas 172,60,100
s_add_u32 m0, s84, 32768
rqa 120,18,6144
s_mov_b32 s81, 1024
mvaas 48,0,104
rta 70,30,53760
mvaas 48,4,108
s_mov_b32 s87, 540672
mvaas 52,8,104
rqa 124,19,6144
mvaas 52,12,108
mvaas 56,16,104
mvaas 56,20,108
buffer_load_dwordx4 v8, s[40:43], s81 offen offset:0 lds
mvaas 60,24,104
rta 72,31,49152
mvaas 60,28,108
mvaas 176,32,104
buffer_store_dwordx4 v[88:91], v6, s[64:67], s87 offen offset:2048 sc1
mvaas 176,36,108
mvaas 180,40,104
rta 74,31,49664
mvaas 180,44,108
mvaas 184,48,104
buffer_load_dwordx4 v9, s[40:43], s81 offen offset:1024 lds
mvaas 184,52,108
mvaas 188,56,104
rqa 96,18,8192
mvaas 188,60,108
s_waitcnt lgkmcnt(2)
maaas 160,0,112
rta 76,31,53248
maaas 160,4,116
maaas 164,8,112
rqa 100,19,8192
maaas 164,12,116
buffer_load_dwordx4 v10, s[40:43], s81 offen offset:2048 lds
maaas 168,16,112
maaas 168,20,116
rta 78,31,53760
maaas 172,24,112
s_mov_b32 s87, 540672
v_accvgpr_read_b32 v64, a160
v_accvgpr_read_b32 v65, a161
maaas 172,28,116
v_accvgpr_read_b32 v66, a162
v_accvgpr_read_b32 v67, a163
mvaas 192,32,112
v_accvgpr_read_b32 v68, a164
v_accvgpr_read_b32 v69, a165
mvaas 192,36,116
v_accvgpr_read_b32 v70, a166
v_accvgpr_read_b32 v71, a167
mvaas 196,40,112
buffer_load_dwordx4 v11, s[40:43], s81 offen offset:3072 lds
mvaas 196,44,116
s_add_u32 m0, s84, 36864
rta 80,30,57344
v_accvgpr_read_b32 v72, a168
mvaas 200,48,112
s_mov_b32 s81, 41984
v_accvgpr_read_b32 v73, a169
v_accvgpr_read_b32 v74, a170
mvaas 200,52,116
buffer_store_dwordx4 v[92:95], v6, s[64:67], s87 offen offset:3072 sc1
v_accvgpr_read_b32 v75, a171
v_accvgpr_read_b32 v76, a172
v_accvgpr_read_b32 v77, a173
mvaas 204,56,112
rqa 104,18,10240
v_accvgpr_read_b32 v78, a174
mvaas 204,60,116
v_accvgpr_read_b32 v79, a175
maaas 176,0,120
rta 82,30,57856
maaas 176,4,124
buffer_load_dwordx4 v8, s[40:43], s81 offen offset:0 lds
maaas 180,8,120
rqa 108,19,10240
maaas 180,12,124
maaas 184,16,120
maaas 184,20,124
maaas 188,24,120
rta 84,30,61440
maaas 188,28,124
mvaas 208,32,120
buffer_load_dwordx4 v9, s[40:43], s81 offen offset:1024 lds
mvaas 208,36,124
mvaas 212,40,120
mvaas 212,44,124
rta 86,30,61952
s_mov_b32 s87, 24576
mvaas 216,48,120
mvaas 216,52,124
mvaas 220,56,120
rqa 112,18,12288
s_waitcnt lgkmcnt(3)
mvaas 220,60,124
buffer_load_dwordx4 v10, s[40:43], s81 offen offset:2048 lds
maaas 192,0,96
maaas 192,4,100
rta 88,31,57344
maaas 196,8,96
buffer_store_dwordx4 v[96:99], v6, s[64:67], s87 offen offset:0 sc1
rqa 116,19,12288
maaas 196,12,100
maaas 200,16,96
maaas 200,20,100
maaas 204,24,96
buffer_load_dwordx4 v11, s[40:43], s81 offen offset:3072 lds
maaas 204,28,100
rta 90,31,57856
mvaas 224,32,96
mvaas 224,36,100
mvaas 228,40,96
mvaas 228,44,100
mvaas 232,48,96
rta 92,31,61440
mvaas 232,52,100
mvaas 236,56,96
rqa 120,18,14336
mvaas 236,60,100
maaas 208,0,104
maaas 208,4,108
rta 94,31,61952
maaas 212,8,104
rqa 124,19,14336
maaas 212,12,108
maaas 216,16,104
maaas 216,20,108
maaas 220,24,104
maaas 220,28,108
mvaas 240,32,104
mvaas 240,36,108
mvaas 244,40,104
mvaas 244,44,108
mvaas 248,48,104
mvaas 248,52,108
s_waitcnt vmcnt(11) lgkmcnt(0)
mvaas 252,56,104
mvaas 252,60,108
s_barrier
maaas 224,0,112
s_add_u32 m0, s86, 147456
rqa 96,16,0
s_mov_b32 s83, 1990656
maaas 224,4,116
buffer_load_dwordx4 v4, s[56:59], s83 offen offset:0 lds
maaas 228,8,112
rqa 100,17,0
maaas 228,12,116
maaas 232,16,112
buffer_load_dwordx4 v5, s[56:59], s83 offen offset:1024 lds
maaas 232,20,116
s_add_u32 m0, s86, 155648
maaas 236,24,112
rqa 104,16,2048
maaas 236,28,116
mvaas 128,32,112
mvaas 128,36,116
rqa 108,17,2048
mvaas 132,40,112
mvaas 132,44,116
buffer_load_dwordx4 v4, s[60:63], s83 offen offset:0 lds
mvaas 136,48,112
mvaas 136,52,116
mvaas 140,56,112
mvaas 140,60,116
maaas 240,0,120
rta 0,20,16384
maaas 240,4,124
rta 2,20,17408
maaas 244,8,120
buffer_load_dwordx4 v5, s[60:63], s83 offen offset:1024 lds
maaas 244,12,124
s_add_u32 m0, s85, 98304
rta 4,20,24576
s_mov_b32 s82, 4194304
maaas 248,16,120
rta 6,20,25600
maaas 248,20,124
rta 8,21,16384
maaas 252,24,120
rta 10,21,17408
maaas 252,28,124
rta 12,21,24576
mvaas 144,32,120
rta 14,21,25600
mvaas 144,36,124
rta 16,22,16384
mvaas 148,40,120
rta 18,22,17408
mvaas 148,44,124
rta 20,22,24576
mvaas 152,48,120
rta 22,22,25600
mvaas 152,52,124
rta 24,23,16384
rta 26,23,17408
mvaas 156,56,120
buffer_load_dwordx4 v12, s[52:55], s82 offen offset:0 lds
mvaas 156,60,124
s_waitcnt lgkmcnt(10)
rta 28,23,24576
rta 30,23,25600
mvaas 32,0,96
buffer_load_dwordx4 v13, s[52:55], s82 offen offset:1024 lds
mvaas 32,4,100
rta 32,30,32768
s_waitcnt lgkmcnt(11)
mvaas 36,8,96
rqa 112,16,4096
s_waitcnt lgkmcnt(10)
mvaas 36,12,100
s_waitcnt lgkmcnt(8)
mvaas 40,16,96
rqa 116,17,4096
s_waitcnt lgkmcnt(7)
mvaas 40,20,100
rta 34,30,33280
s_waitcnt lgkmcnt(6)
mvaas 44,24,96
s_waitcnt lgkmcnt(4)
mvaas 44,28,100
buffer_load_dwordx4 v14, s[52:55], s82 offen offset:2048 lds
mvaas 160,64,96
mvaas 160,68,100
mvaas 164,72,96
rta 36,30,36864
mvaas 164,76,100
mvaas 168,80,96
mvaas 168,84,100
mvaas 172,88,96
buffer_load_dwordx4 v15, s[52:55], s82 offen offset:3072 lds
mvaas 172,92,100
s_add_u32 m0, s84, 65536
rqa 120,16,6144
s_mov_b32 s81, 1152
mvaas 48,0,104
rta 38,30,37376
mvaas 48,4,108
s_mov_b32 s87, 24576
mvaas 52,8,104
rqa 124,17,6144
mvaas 52,12,108
mvaas 56,16,104
mvaas 56,20,108
buffer_load_dwordx4 v8, s[40:43], s81 offen offset:0 lds
mvaas 60,24,104
rta 40,31,32768
mvaas 60,28,108
mvaas 176,64,104
buffer_store_dwordx4 v[100:103], v6, s[64:67], s87 offen offset:1024 sc1
mvaas 176,68,108
mvaas 180,72,104
rta 42,31,33280
mvaas 180,76,108
mvaas 184,80,104
buffer_load_dwordx4 v9, s[40:43], s81 offen offset:1024 lds
mvaas 184,84,108
mvaas 188,88,104
rqa 96,16,8192
mvaas 188,92,108
s_waitcnt lgkmcnt(2)
mvaas 64,0,112
rta 44,31,36864
mvaas 64,4,116
mvaas 68,8,112
rqa 100,17,8192
mvaas 68,12,116
buffer_load_dwordx4 v10, s[40:43], s81 offen offset:2048 lds
mvaas 72,16,112
mvaas 72,20,116
rta 46,31,37376
mvaas 76,24,112
s_mov_b32 s87, 24576
mvaas 76,28,116
mvaas 192,64,112
mvaas 192,68,116
mvaas 196,72,112
buffer_load_dwordx4 v11, s[40:43], s81 offen offset:3072 lds
mvaas 196,76,116
s_add_u32 m0, s84, 69632
rta 48,30,40960
s_mov_b32 s81, 42112
mvaas 200,80,112
mvaas 200,84,116
buffer_store_dwordx4 v[104:107], v6, s[64:67], s87 offen offset:2048 sc1
mvaas 204,88,112
rqa 104,16,10240
mvaas 204,92,116
maaas 176,0,120
rta 50,30,41472
maaas 176,4,124
buffer_load_dwordx4 v8, s[40:43], s81 offen offset:0 lds
maaas 180,8,120
rqa 108,17,10240
maaas 180,12,124
maaas 184,16,120
maaas 184,20,124
maaas 188,24,120
rta 52,30,45056
v_accvgpr_read_b32 v80, a176
maaas 188,28,124
v_accvgpr_read_b32 v81, a177
v_accvgpr_read_b32 v82, a178
mvaas 208,64,120
buffer_load_dwordx4 v9, s[40:43], s81 offen offset:1024 lds
mvaas 208,68,124
v_accvgpr_read_b32 v83, a179
v_accvgpr_read_b32 v84, a180
mvaas 212,72,120
v_accvgpr_read_b32 v85, a181
v_accvgpr_read_b32 v86, a182
mvaas 212,76,124
s_mov_b32 s87, 24576
rta 54,30,45568
v_accvgpr_read_b32 v87, a183
mvaas 216,80,120
v_accvgpr_read_b32 v88, a184
v_accvgpr_read_b32 v89, a185
mvaas 216,84,124
v_accvgpr_read_b32 v90, a186
v_accvgpr_read_b32 v91, a187
mvaas 220,88,120
s_waitcnt lgkmcnt(2)
rqa 112,16,12288
v_accvgpr_read_b32 v92, a188
mvaas 220,92,124
buffer_load_dwordx4 v10, s[40:43], s81 offen offset:2048 lds
maaas 192,0,96
v_accvgpr_read_b32 v93, a189
v_accvgpr_read_b32 v94, a190
maaas 192,4,100
rta 56,31,40960
v_accvgpr_read_b32 v95, a191
maaas 196,8,96
buffer_store_dwordx4 v[108:111], v6, s[64:67], s87 offen offset:3072 sc1
rqa 116,17,12288
maaas 196,12,100
maaas 200,16,96
maaas 200,20,100
maaas 204,24,96
buffer_load_dwordx4 v11, s[40:43], s81 offen offset:3072 lds
maaas 204,28,100
rta 58,31,41472
mvaas 224,64,96
mvaas 224,68,100
mvaas 228,72,96
mvaas 228,76,100
mvaas 232,80,96
rta 60,31,45056
mvaas 232,84,100
mvaas 236,88,96
rqa 120,16,14336
mvaas 236,92,100
maaas 208,0,104
maaas 208,4,108
rta 62,31,45568
maaas 212,8,104
rqa 124,17,14336
maaas 212,12,108
maaas 216,16,104
maaas 216,20,108
maaas 220,24,104
maaas 220,28,108
mvaas 240,64,104
mvaas 240,68,108
mvaas 244,72,104
mvaas 244,76,108
mvaas 248,80,104
mvaas 248,84,108
s_waitcnt vmcnt(11) lgkmcnt(0)
mvaas 252,88,104
mvaas 252,92,108
s_barrier
maaas 224,0,112
s_add_u32 m0, s85, 114688
rqa 96,16,32768
s_mov_b32 s82, 4718592
maaas 224,4,116
buffer_load_dwordx4 v12, s[52:55], s82 offen offset:0 lds
maaas 228,8,112
rqa 100,17,32768
maaas 228,12,116
maaas 232,16,112
maaas 232,20,116
buffer_load_dwordx4 v13, s[52:55], s82 offen offset:1024 lds
maaas 236,24,112
rqa 104,16,34816
maaas 236,28,116
mvaas 128,64,112
mvaas 128,68,116
rqa 108,17,34816
mvaas 132,72,112
mvaas 132,76,116
mvaas 136,80,112
mvaas 136,84,116
buffer_load_dwordx4 v14, s[52:55], s82 offen offset:2048 lds
mvaas 140,88,112
mvaas 140,92,116
maaas 240,0,120
rta 0,20,0
maaas 240,4,124
rta 2,20,1024
maaas 244,8,120
rta 4,20,8192
maaas 244,12,124
rta 6,20,9216
maaas 248,16,120
rta 8,21,0
maaas 248,20,124
buffer_load_dwordx4 v15, s[52:55], s82 offen offset:3072 lds
maaas 252,24,120
rta 10,21,1024
maaas 252,28,124
rta 12,21,8192
mvaas 144,64,120
rta 14,21,9216
mvaas 144,68,124
rta 16,22,0
mvaas 148,72,120
rta 18,22,1024
s_mov_b32 s87, 548864
mvaas 148,76,124
rta 20,22,8192
mvaas 152,80,120
rta 22,22,9216
mvaas 152,84,124
rta 24,23,0
rta 26,23,1024
mvaas 156,88,120
rta 28,23,8192
mvaas 156,92,124
rta 30,23,9216
s_waitcnt lgkmcnt(11)
mvaas 32,0,96
rta 64,30,49152
mvaas 32,4,100
buffer_store_dwordx4 v[112:115], v6, s[64:67], s87 offen offset:0 sc1
rqa 112,16,36864
s_waitcnt lgkmcnt(10)
mvaas 36,8,96
mvaas 36,12,100
s_waitcnt lgkmcnt(8)
mvaas 40,16,96
rqa 116,17,36864
s_waitcnt lgkmcnt(7)
mvaas 40,20,100
rta 66,30,49664
s_waitcnt lgkmcnt(6)
mvaas 44,24,96
s_waitcnt lgkmcnt(4)
mvaas 44,28,100
mvaas 160,32,96
mvaas 160,36,100
mvaas 164,40,96
rta 68,30,53248
s_mov_b32 s87, 548864
mvaas 164,44,100
mvaas 168,48,96
mvaas 168,52,100
mvaas 172,56,96
rqa 120,16,38912
mvaas 172,60,100
rta 70,30,53760
mvaas 48,0,104
mvaas 48,4,108
buffer_store_dwordx4 v[116:119], v6, s[64:67], s87 offen offset:1024 sc1
mvaas 52,8,104
rqa 124,17,38912
mvaas 52,12,108
mvaas 56,16,104
mvaas 56,20,108
rta 72,31,49152
mvaas 60,24,104
mvaas 60,28,108
mvaas 176,32,104
mvaas 176,36,108
mvaas 180,40,104
rta 74,31,49664
s_mov_b32 s87, 548864
mvaas 180,44,108
mvaas 184,48,104
mvaas 184,52,108
mvaas 188,56,104
rqa 96,16,40960
mvaas 188,60,108
s_waitcnt lgkmcnt(3)
mvaas 64,0,112
rta 76,31,53248
mvaas 64,4,116
buffer_store_dwordx4 v[120:123], v6, s[64:67], s87 offen offset:2048 sc1
mvaas 68,8,112
rqa 100,17,40960
mvaas 68,12,116
mvaas 72,16,112
mvaas 72,20,116
rta 78,31,53760
mvaas 76,24,112
mvaas 76,28,116
mvaas 192,32,112
mvaas 192,36,116
mvaas 196,40,112
s_mov_b32 s87, 548864
mvaas 196,44,116
rta 80,30,57344
mvaas 200,48,112
mvaas 200,52,116
mvaas 204,56,112
rqa 104,16,43008
mvaas 204,60,116
mvaas 80,0,120
rta 82,30,57856
mvaas 80,4,124
buffer_store_dwordx4 v[124:127], v6, s[64:67], s87 offen offset:3072 sc1
mvaas 84,8,120
rqa 108,17,43008
mvaas 84,12,124
mvaas 88,16,120
mvaas 88,20,124
mvaas 92,24,120
rta 84,30,61440
mvaas 92,28,124
mvaas 208,32,120
mvaas 208,36,124
mvaas 212,40,120
mvaas 212,44,124
rta 86,30,61952
mvaas 216,48,120
mvaas 216,52,124
mvaas 220,56,120
rqa 112,16,45056
mvaas 220,60,124
s_waitcnt lgkmcnt(3)
maaas 192,0,96
maaas 192,4,100
rta 88,31,57344
maaas 196,8,96
rqa 116,17,45056
maaas 196,12,100
maaas 200,16,96
maaas 200,20,100
maaas 204,24,96
rta 90,31,57856
v_accvgpr_read_b32 v96, a192
maaas 204,28,100
v_accvgpr_read_b32 v97, a193
v_accvgpr_read_b32 v98, a194
mvaas 224,32,96
v_accvgpr_read_b32 v99, a195
v_accvgpr_read_b32 v100, a196
mvaas 224,36,100
v_accvgpr_read_b32 v101, a197
v_accvgpr_read_b32 v102, a198
mvaas 228,40,96
v_accvgpr_read_b32 v103, a199
v_accvgpr_read_b32 v104, a200
mvaas 228,44,100
v_accvgpr_read_b32 v105, a201
v_accvgpr_read_b32 v106, a202
mvaas 232,48,96
rta 92,31,61440
v_accvgpr_read_b32 v107, a203
mvaas 232,52,100
v_accvgpr_read_b32 v108, a204
v_accvgpr_read_b32 v109, a205
mvaas 236,56,96
rqa 120,16,47104
v_accvgpr_read_b32 v110, a206
mvaas 236,60,100
maaas 208,0,104
maaas 208,4,108
rta 94,31,61952
maaas 212,8,104
rqa 124,17,47104
maaas 212,12,108
maaas 216,16,104
maaas 216,20,108
maaas 220,24,104
maaas 220,28,108
mvaas 240,32,104
mvaas 240,36,108
mvaas 244,40,104
mvaas 244,44,108
mvaas 248,48,104
mvaas 248,52,108
s_waitcnt vmcnt(4) lgkmcnt(0)
mvaas 252,56,104
mvaas 252,60,108
s_barrier
maaas 224,0,112
rqa 96,18,12288
maaas 224,4,116
maaas 228,8,112
rqa 100,19,12288
maaas 228,12,116
v_accvgpr_read_b32 v111, a207
v_accvgpr_read_b32 v112, a208
v_accvgpr_read_b32 v113, a209
maaas 232,16,112
maaas 232,20,116
v_accvgpr_read_b32 v114, a210
v_accvgpr_read_b32 v115, a211
maaas 236,24,112
s_lshr_b32 s81, s30, 1
v_accvgpr_read_b32 v116, a212
v_accvgpr_read_b32 v117, a213
maaas 236,28,116
s_lshl_b32 s81, s81, 8
v_accvgpr_read_b32 v118, a214
v_accvgpr_read_b32 v119, a215
mvaas 128,32,112
s_add_u32 s81, s81, 79691776
rqa 104,18,14336
v_accvgpr_read_b32 v120, a216
mvaas 128,36,116
v_accvgpr_read_b32 v121, a217
v_accvgpr_read_b32 v122, a218
mvaas 132,40,112
rqa 108,19,14336
v_accvgpr_read_b32 v123, a219
mvaas 132,44,116
v_accvgpr_read_b32 v124, a220
v_accvgpr_read_b32 v125, a221
mvaas 136,48,112
v_accvgpr_read_b32 v126, a222
v_accvgpr_read_b32 v127, a223
mvaas 136,52,116
buffer_load_dword v27, v26, s[64:67], s81 offen sc1
mvaas 140,56,112
mvaas 140,60,116
maaas 240,0,120
rta 0,20,16384
maaas 240,4,124
rta 2,20,17408
maaas 244,8,120
rta 4,20,24576
maaas 244,12,124
rta 6,20,25600
maaas 248,16,120
rta 8,21,16384
maaas 248,20,124
rta 10,21,17408
maaas 252,24,120
rta 12,21,24576
maaas 252,28,124
rta 14,21,25600
mvaas 144,32,120
rta 16,22,16384
mvaas 144,36,124
rta 18,22,17408
mvaas 148,40,120
rta 20,22,24576
mvaas 148,44,124
rta 22,22,25600
mvaas 152,48,120
rta 24,23,16384
mvaas 152,52,124
rta 26,23,17408
mvaas 156,56,120
rta 28,23,24576
mvaas 156,60,124
rta 30,23,25600
s_waitcnt lgkmcnt(11)
maaas 224,0,96
rqa 112,18,0
maaas 224,4,100
s_waitcnt lgkmcnt(10)
maaas 228,8,96
s_waitcnt lgkmcnt(9)
maaas 228,12,100
s_waitcnt lgkmcnt(7)
maaas 232,16,96
rqa 116,19,0
s_waitcnt lgkmcnt(6)
maaas 232,20,100
s_waitcnt lgkmcnt(4)
maaas 236,24,96
s_waitcnt lgkmcnt(2)
maaas 236,28,100
v_accvgpr_read_b32 v8, a224
mvaas 128,64,96
v_accvgpr_read_b32 v9, a225
v_accvgpr_read_b32 v10, a226
mvaas 128,68,100
v_accvgpr_read_b32 v11, a227
v_accvgpr_read_b32 v12, a228
mvaas 132,72,96
v_accvgpr_read_b32 v13, a229
v_accvgpr_read_b32 v14, a230
mvaas 132,76,100
v_accvgpr_read_b32 v15, a231
v_cvt_pk_bf16_f32 v8, v8, v9
mvaas 136,80,96
v_cvt_pk_bf16_f32 v9, v10, v11
v_cvt_pk_bf16_f32 v10, v12, v13
mvaas 136,84,100
v_cvt_pk_bf16_f32 v11, v14, v15
v_accvgpr_read_b32 v12, a236
mvaas 140,88,96
ds_write_b128 v24, v[8:11] offset:0
mvaas 140,92,100
s_add_u32 m0, s8, 0
rqa 120,18,2048
v_accvgpr_read_b32 v8, a232
maaas 240,0,104
v_accvgpr_read_b32 v9, a233
v_accvgpr_read_b32 v10, a234
maaas 240,4,108
v_accvgpr_read_b32 v11, a235
v_accvgpr_read_b32 v13, a237
maaas 244,8,104
rqa 124,19,2048
v_accvgpr_read_b32 v14, a238
maaas 244,12,108
v_accvgpr_read_b32 v15, a239
v_cvt_pk_bf16_f32 v8, v8, v9
maaas 248,16,104
v_cvt_pk_bf16_f32 v9, v10, v11
v_cvt_pk_bf16_f32 v10, v12, v13
maaas 248,20,108
v_cvt_pk_bf16_f32 v11, v14, v15
v_mul_f32 v136, v136, v128
maaas 252,24,104
ds_write_b128 v24, v[8:11] offset:1024
maaas 252,28,108
v_accvgpr_read_b32 v8, a240
v_accvgpr_read_b32 v9, a241
mvaas 144,64,104
s_waitcnt vmcnt(0)
v_cmp_gt_u32 vcc, 1, v27
v_accvgpr_read_b32 v10, a242
mvaas 144,68,108
s_cbranch_vccnz PFK_spin
PFK_ok:
s_mov_b32 s81, 0
mvaas 148,72,104
buffer_load_dwordx4 v1, s[68:71], s81 offen offset:0 sc1 lds
mvaas 148,76,108
v_accvgpr_read_b32 v11, a243
v_accvgpr_read_b32 v12, a244
mvaas 152,80,104
v_accvgpr_read_b32 v13, a245
v_accvgpr_read_b32 v14, a246
mvaas 152,84,108
buffer_load_dwordx4 v1, s[68:71], s81 offen offset:1024 sc1 lds
mvaas 156,88,104
v_accvgpr_read_b32 v15, a247
v_cvt_pk_bf16_f32 v8, v8, v9
mvaas 156,92,108
s_waitcnt lgkmcnt(1)
v_cvt_pk_bf16_f32 v9, v10, v11
v_cvt_pk_bf16_f32 v10, v12, v13
mvaas 32,0,112
v_cvt_pk_bf16_f32 v11, v14, v15
v_mul_f32 v137, v137, v129
mvaas 32,4,116
ds_write_b128 v24, v[8:11] offset:8192
mvaas 36,8,112
rqa 96,18,4096
v_accvgpr_read_b32 v8, a248
mvaas 36,12,116
buffer_load_dwordx4 v1, s[68:71], s81 offen offset:2048 sc1 lds
mvaas 40,16,112
v_accvgpr_read_b32 v9, a249
v_mul_f32 v138, v138, v130
mvaas 40,20,116
v_accvgpr_read_b32 v10, a250
v_accvgpr_read_b32 v11, a251
mvaas 44,24,112
v_mul_f32 v139, v139, v131
v_accvgpr_read_b32 v12, a252
mvaas 44,28,116
rqa 100,19,4096
v_accvgpr_read_b32 v13, a253
v_mul_f32 v140, v140, v132
mvaas 160,64,112
buffer_load_dwordx4 v1, s[68:71], s81 offen offset:3072 sc1 lds
v_accvgpr_read_b32 v14, a254
v_accvgpr_read_b32 v15, a255
v_mul_f32 v141, v141, v133
mvaas 160,68,116
s_add_u32 m0, s8, 16384
v_cvt_pk_bf16_f32 v8, v8, v9
v_cvt_pk_bf16_f32 v9, v10, v11
v_mul_f32 v142, v142, v134
mvaas 164,72,112
s_mov_b32 s81, 32768
v_cvt_pk_bf16_f32 v10, v12, v13
v_cvt_pk_bf16_f32 v11, v14, v15
v_mul_f32 v143, v143, v135
mvaas 164,76,116
v_mul_f32 v128, s88, v128
v_mul_f32 v129, s88, v129
mvaas 168,80,112
v_mul_f32 v130, s88, v130
v_mul_f32 v131, s88, v131
mvaas 168,84,116
buffer_load_dwordx4 v1, s[68:71], s81 offen offset:0 sc1 lds
mvaas 172,88,112
v_cvt_pk_bf16_f32 v32, v32, v33
v_mul_f32 v132, s88, v132
mvaas 172,92,116
ds_write_b128 v24, v[8:11] offset:9216
v_cvt_pk_bf16_f32 v33, v34, v35
v_mul_f32 v133, s88, v133
mvaas 48,0,120
v_cvt_pk_bf16_f32 v34, v36, v37
v_mul_f32 v134, s88, v134
mvaas 48,4,124
buffer_load_dwordx4 v1, s[68:71], s81 offen offset:1024 sc1 lds
v_mul_f32 v135, s88, v135
mvaas 52,8,120
v_cvt_pk_bf16_f32 v35, v38, v39
v_exp_f32 v128, v128
mvaas 52,12,124
ds_write_b128 v24, v[32:35] offset:49152
rqa 104,18,6144
v_exp_f32 v129, v129
mvaas 56,16,120
v_exp_f32 v130, v130
mvaas 56,20,124
buffer_load_dwordx4 v1, s[68:71], s81 offen offset:2048 sc1 lds
v_cvt_pk_bf16_f32 v40, v40, v41
v_exp_f32 v131, v131
mvaas 60,24,120
v_cvt_pk_bf16_f32 v41, v42, v43
v_exp_f32 v132, v132
mvaas 60,28,124
rqa 108,19,6144
v_cvt_pk_bf16_f32 v42, v44, v45
v_exp_f32 v133, v133
v_exp_f32 v134, v134
mvaas 176,64,120
v_exp_f32 v135, v135
mvaas 176,68,124
buffer_load_dwordx4 v1, s[68:71], s81 offen offset:3072 sc1 lds
v_cvt_pk_bf16_f32 v43, v46, v47
v_add_f32 v128, 1.0, v128
mvaas 180,72,120
s_add_u32 m0, s8, 32768
v_add_f32 v129, 1.0, v129
v_add_f32 v130, 1.0, v130
mvaas 180,76,124
s_mov_b32 s81, 65536
v_add_f32 v131, 1.0, v131
v_add_f32 v132, 1.0, v132
mvaas 184,80,120
ds_write_b128 v24, v[40:43] offset:50176
mvaas 184,84,124
v_cvt_pk_bf16_f32 v48, v48, v49
v_add_f32 v133, 1.0, v133
mvaas 188,88,120
buffer_load_dwordx4 v1, s[68:71], s81 offen offset:0 sc1 lds
mvaas 188,92,124
s_waitcnt lgkmcnt(2)
v_cvt_pk_bf16_f32 v49, v50, v51
v_add_f32 v134, 1.0, v134
mvaas 64,0,96
v_cvt_pk_bf16_f32 v50, v52, v53
v_add_f32 v135, 1.0, v135
v_rcp_f32 v128, v128
mvaas 64,4,100
v_rcp_f32 v129, v129
mvaas 68,8,96
buffer_load_dwordx4 v1, s[68:71], s81 offen offset:1024 sc1 lds
v_cvt_pk_bf16_f32 v51, v54, v55
v_rcp_f32 v130, v130
mvaas 68,12,100
ds_write_b128 v24, v[48:51] offset:57344
rqa 112,18,8192
v_rcp_f32 v131, v131
mvaas 72,16,96
v_rcp_f32 v132, v132
mvaas 72,20,100
s_mov_b32 s87, 745472
v_cvt_pk_bf16_f32 v56, v56, v57
v_rcp_f32 v133, v133
mvaas 76,24,96
buffer_load_dwordx4 v1, s[68:71], s81 offen offset:2048 sc1 lds
v_cvt_pk_bf16_f32 v57, v58, v59
v_rcp_f32 v134, v134
mvaas 76,28,100
rqa 116,19,8192
v_cvt_pk_bf16_f32 v58, v60, v61
v_rcp_f32 v135, v135
mvaas 192,64,96
v_mul_f32 v136, v136, v128
v_cvt_pk_bf16_f32 v59, v62, v63
mvaas 192,68,100
v_mul_f32 v137, v137, v129
v_mul_f32 v138, v138, v130
mvaas 196,72,96
buffer_load_dwordx4 v1, s[68:71], s81 offen offset:3072 sc1 lds
v_mul_f32 v139, v139, v131
mvaas 196,76,100
s_add_u32 m0, s8, 49152
v_mul_f32 v140, v140, v132
v_mul_f32 v141, v141, v133
mvaas 200,80,96
s_mov_b32 s81, 0
v_mul_f32 v142, v142, v134
v_cvt_pk_bf16_f32 v64, v64, v65
mvaas 200,84,100
ds_write_b128 v24, v[56:59] offset:58368
mvaas 204,88,96
v_mul_f32 v143, v143, v135
v_cvt_pk_bf16_f32 v65, v66, v67
mvaas 204,92,100
buffer_load_dwordx4 v2, s[72:75], s81 offen offset:0 sc1 lds
v_cvt_pk_bf16_f32 v128, v136, v137
mvaas 80,0,104
s_waitcnt lgkmcnt(1)
v_cvt_pk_bf16_f32 v66, v68, v69
v_cvt_pk_bf16_f32 v129, v138, v139
mvaas 80,4,108
v_cvt_pk_bf16_f32 v130, v140, v141
v_cvt_pk_bf16_f32 v131, v142, v143
mvaas 84,8,104
buffer_store_dwordx4 v[128:131], v7, s[64:67], s87 offen offset:2048 sc1
buffer_load_dwordx4 v2, s[72:75], s81 offen offset:1024 sc1 lds
v_cvt_pk_bf16_f32 v67, v70, v71
mvaas 84,12,108
ds_write_b128 v24, v[64:67] offset:32768
rqa 120,18,10240
mvaas 88,16,104
v_mul_f32 v152, v152, v144
v_mul_f32 v153, v153, v145
mvaas 88,20,108
v_cvt_pk_bf16_f32 v72, v72, v73
v_mul_f32 v154, v154, v146
mvaas 92,24,104
v_cvt_pk_bf16_f32 v73, v74, v75
v_mul_f32 v155, v155, v147
mvaas 92,28,108
buffer_load_dwordx4 v2, s[72:75], s81 offen offset:2048 sc1 lds
rqa 124,19,10240
v_cvt_pk_bf16_f32 v74, v76, v77
v_mul_f32 v156, v156, v148
mvaas 208,64,104
v_mul_f32 v157, v157, v149
v_cvt_pk_bf16_f32 v75, v78, v79
mvaas 208,68,108
v_mul_f32 v158, v158, v150
v_mul_f32 v159, v159, v151
mvaas 212,72,104
v_mul_f32 v144, s88, v144
v_mul_f32 v145, s88, v145
mvaas 212,76,108
buffer_load_dwordx4 v2, s[72:75], s81 offen offset:3072 sc1 lds
mvaas 216,80,104
v_mul_f32 v146, s88, v146
v_mul_f32 v147, s88, v147
mvaas 216,84,108
ds_write_b128 v24, v[72:75] offset:33792
mvaas 220,88,104
v_cvt_pk_bf16_f32 v80, v80, v81
v_mul_f32 v148, s88, v148
v_cvt_pk_bf16_f32 v81, v82, v83
v_mul_f32 v149, s88, v149
v_cvt_pk_bf16_f32 v82, v84, v85
v_mul_f32 v150, s88, v150
v_mul_f32 v151, s88, v151
v_cvt_pk_bf16_f32 v83, v86, v87
v_exp_f32 v144, v144
s_waitcnt lgkmcnt(0)
mvaas 220,92,108
s_barrier
mvaas 96,0,112
s_cmp_eq_u32 s80, 0
s_cselect_b32 s87, s100, 268435456
mvaas 96,4,116
v_mov_b32 v27, 2
v_and_b32 v28, 12, v26
v_exp_f32 v145, v145
mvaas 100,8,112
buffer_store_dword v27, v28, s[64:67], s87 offen sc1
v_exp_f32 v146, v146
mvaas 100,12,116
v_cvt_pk_bf16_f32 v88, v88, v89
v_exp_f32 v147, v147
mvaas 104,16,112
v_cvt_pk_bf16_f32 v89, v90, v91
v_exp_f32 v148, v148
mvaas 104,20,116
v_cvt_pk_bf16_f32 v90, v92, v93
v_exp_f32 v149, v149
v_exp_f32 v150, v150
mvaas 108,24,112
v_exp_f32 v151, v151
mvaas 108,28,116
ds_write_b128 v24, v[80:83] offset:40960
v_cvt_pk_bf16_f32 v91, v94, v95
v_add_f32 v144, 1.0, v144
mvaas 224,64,112
v_add_f32 v145, 1.0, v145
v_add_f32 v146, 1.0, v146
mvaas 224,68,116
v_add_f32 v147, 1.0, v147
v_add_f32 v148, 1.0, v148
mvaas 228,72,112
v_cvt_pk_bf16_f32 v96, v96, v97
v_add_f32 v149, 1.0, v149
mvaas 228,76,116
v_cvt_pk_bf16_f32 v97, v98, v99
v_add_f32 v150, 1.0, v150
mvaas 232,80,112
ds_write_b128 v24, v[88:91] offset:41984
mvaas 232,84,116
v_cvt_pk_bf16_f32 v98, v100, v101
v_add_f32 v151, 1.0, v151
mvaas 236,88,112
v_rcp_f32 v144, v144
mvaas 236,92,116
v_rcp_f32 v145, v145
mvaas 112,0,120
v_cvt_pk_bf16_f32 v99, v102, v103
v_rcp_f32 v146, v146
mvaas 112,4,124
v_rcp_f32 v147, v147
mvaas 116,8,120
v_rcp_f32 v148, v148
mvaas 116,12,124
v_cvt_pk_bf16_f32 v104, v104, v105
v_rcp_f32 v149, v149
mvaas 120,16,120
v_cvt_pk_bf16_f32 v105, v106, v107
v_rcp_f32 v150, v150
mvaas 120,20,124
s_mov_b32 s87, 745472
v_cvt_pk_bf16_f32 v106, v108, v109
v_rcp_f32 v151, v151
mvaas 124,24,120
v_mul_f32 v152, v152, v144
v_cvt_pk_bf16_f32 v107, v110, v111
mvaas 124,28,124
ds_write_b128 v24, v[96:99] offset:16384
v_mul_f32 v153, v153, v145
mvaas 240,64,120
v_mul_f32 v154, v154, v146
v_mul_f32 v155, v155, v147
mvaas 240,68,124
v_mul_f32 v156, v156, v148
v_mul_f32 v157, v157, v149
mvaas 244,72,120
v_mul_f32 v158, v158, v150
v_cvt_pk_bf16_f32 v112, v112, v113
mvaas 244,76,124
v_cvt_pk_bf16_f32 v113, v114, v115
v_mul_f32 v159, v159, v151
mvaas 248,80,120
v_cvt_pk_bf16_f32 v114, v116, v117
v_cvt_pk_bf16_f32 v115, v118, v119
mvaas 248,84,124
v_cvt_pk_bf16_f32 v144, v152, v153
v_cvt_pk_bf16_f32 v145, v154, v155
v_cvt_pk_bf16_f32 v146, v156, v157
v_cvt_pk_bf16_f32 v147, v158, v159
mvaas 252,88,120
buffer_store_dwordx4 v[144:147], v7, s[64:67], s87 offen offset:3072 sc1
ds_write_b128 v24, v[104:107] offset:17408
ds_write_b128 v24, v[112:115] offset:24576
v_cvt_pk_bf16_f32 v120, v120, v121
v_cvt_pk_bf16_f32 v121, v122, v123
v_cvt_pk_bf16_f32 v122, v124, v125
v_cvt_pk_bf16_f32 v123, v126, v127
ds_write_b128 v24, v[120:123] offset:25600
s_waitcnt vmcnt(11) lgkmcnt(0)
mvaas 252,92,124
s_barrier
rqa 128,0,0
rqa 132,0,1024
rqa 136,0,4096
rqa 140,0,5120
rqa 0,25,49152
rqa 4,25,50176
rqa 8,25,51200
rqa 12,25,52224
rqa 144,0,2048
rqa 148,0,3072
rqa 152,0,6144
rqa 156,0,7168
v_pk_mul_f32 v[168:169], v[168:169], v[160:161]
v_pk_mul_f32 v[170:171], v[170:171], v[162:163]
v_pk_mul_f32 v[172:173], v[172:173], v[164:165]
v_pk_mul_f32 v[174:175], v[174:175], v[166:167]
v_pk_mul_f32 v[160:161], v[160:161], s[88:89]
v_pk_mul_f32 v[162:163], v[162:163], s[88:89]
v_pk_mul_f32 v[164:165], v[164:165], s[88:89]
v_pk_mul_f32 v[166:167], v[166:167], s[88:89]
v_exp_f32 v160, v160
v_exp_f32 v161, v161
v_exp_f32 v162, v162
v_exp_f32 v163, v163
v_exp_f32 v164, v164
v_exp_f32 v165, v165
v_exp_f32 v166, v166
v_exp_f32 v167, v167
v_pk_add_f32 v[160:161], v[160:161], 1.0 op_sel_hi:[1,0]
v_pk_add_f32 v[162:163], v[162:163], 1.0 op_sel_hi:[1,0]
v_pk_add_f32 v[164:165], v[164:165], 1.0 op_sel_hi:[1,0]
v_pk_add_f32 v[166:167], v[166:167], 1.0 op_sel_hi:[1,0]
v_rcp_f32 v160, v160
v_rcp_f32 v161, v161
v_rcp_f32 v162, v162
v_rcp_f32 v163, v163
v_rcp_f32 v164, v164
v_rcp_f32 v165, v165
v_rcp_f32 v166, v166
v_rcp_f32 v167, v167
v_pk_mul_f32 v[168:169], v[168:169], v[160:161]
v_pk_mul_f32 v[170:171], v[170:171], v[162:163]
v_pk_mul_f32 v[172:173], v[172:173], v[164:165]
v_pk_mul_f32 v[174:175], v[174:175], v[166:167]
v_pk_mul_f32 v[184:185], v[184:185], v[176:177]
v_pk_mul_f32 v[186:187], v[186:187], v[178:179]
v_pk_mul_f32 v[188:189], v[188:189], v[180:181]
v_pk_mul_f32 v[190:191], v[190:191], v[182:183]
v_pk_mul_f32 v[176:177], v[176:177], s[88:89]
v_pk_mul_f32 v[178:179], v[178:179], s[88:89]
v_pk_mul_f32 v[180:181], v[180:181], s[88:89]
v_pk_mul_f32 v[182:183], v[182:183], s[88:89]
v_exp_f32 v176, v176
v_exp_f32 v177, v177
v_exp_f32 v178, v178
v_exp_f32 v179, v179
v_exp_f32 v180, v180
v_exp_f32 v181, v181
v_exp_f32 v182, v182
v_exp_f32 v183, v183
v_pk_add_f32 v[176:177], v[176:177], 1.0 op_sel_hi:[1,0]
v_pk_add_f32 v[178:179], v[178:179], 1.0 op_sel_hi:[1,0]
v_pk_add_f32 v[180:181], v[180:181], 1.0 op_sel_hi:[1,0]
v_pk_add_f32 v[182:183], v[182:183], 1.0 op_sel_hi:[1,0]
v_rcp_f32 v176, v176
v_rcp_f32 v177, v177
v_rcp_f32 v178, v178
v_rcp_f32 v179, v179
v_rcp_f32 v180, v180
v_rcp_f32 v181, v181
v_rcp_f32 v182, v182
v_rcp_f32 v183, v183
v_pk_mul_f32 v[184:185], v[184:185], v[176:177]
v_pk_mul_f32 v[186:187], v[186:187], v[178:179]
v_pk_mul_f32 v[188:189], v[188:189], v[180:181]
v_pk_mul_f32 v[190:191], v[190:191], v[182:183]
s_waitcnt lgkmcnt(0)
mvaaz 96,128,0
s_add_u32 m0, s8, 65536
rqa 16,25,32768
s_mov_b32 s81, 98304
v_cvt_pk_bf16_f32 v160, v168, v169
v_cvt_pk_bf16_f32 v161, v170, v171
v_cvt_pk_bf16_f32 v162, v172, v173
v_cvt_pk_bf16_f32 v163, v174, v175
s_mov_b32 s87, 0
mvaas 96,132,4
rqa 20,25,33792
rqa 24,25,34816
rqa 28,25,35840
rqa 32,25,16384
rqa 36,25,17408
rqa 40,25,18432
rqa 44,25,19456
rqa 48,25,0
rqa 52,25,1024
rqa 56,25,2048
rqa 60,25,3072
buffer_load_dwordx4 v1, s[68:71], s81 offen offset:0 sc1 lds
buffer_load_dwordx4 v1, s[68:71], s81 offen offset:1024 sc1 lds
buffer_load_dwordx4 v1, s[68:71], s81 offen offset:2048 sc1 lds
buffer_load_dwordx4 v1, s[68:71], s81 offen offset:3072 sc1 lds
buffer_store_dwordx4 v[160:163], v7, s[64:67], s87 offen offset:0 sc1
s_add_u32 m0, s8, 81920
s_mov_b32 s81, 32768
v_cvt_pk_bf16_f32 v176, v184, v185
v_cvt_pk_bf16_f32 v177, v186, v187
v_cvt_pk_bf16_f32 v178, v188, v189
v_cvt_pk_bf16_f32 v179, v190, v191
s_mov_b32 s87, 0
v_lshrrev_b32 v8, 4, v0
v_xor_b32 v8, v8, v0
v_and_b32 v8, 32, v8
v_mov_b32 v9, 0x3f803f80
v_cmp_eq_u32 vcc, 0, v8
v_and_b32 v8, 16, v0
s_nop 0
v_cndmask_b32 v9, 0, v9, vcc
v_mov_b32 v15, 0x44444444
v_accvgpr_write_b32 a192, v9
v_accvgpr_write_b32 a193, v9
v_accvgpr_write_b32 a194, v9
v_accvgpr_write_b32 a195, v9
v_cmp_eq_u32 vcc, 0, v8
v_mov_b32 v10, 0xeeeeeeee
v_bfe_u32 v8, v0, 8, 2
v_cndmask_b32 v15, v10, v15, vcc
v_bfe_u32 v9, v0, 4, 4
v_lshlrev_b32 v8, 2, v8
v_sub_u32 v8, v9, v8
v_mov_b32 v9, 0x00800000
v_mov_b32 v10, 0x7f000000
v_cmp_gt_i32 vcc, 0, v8
v_mov_b32 v32, 0
v_mov_b32 v33, 0
v_cndmask_b32 v44, v9, v10, vcc
v_cmp_gt_i32 vcc, 1, v8
v_mov_b32 v34, 0
v_mov_b32 v35, 0
v_cndmask_b32 v45, v9, v10, vcc
v_cmp_gt_i32 vcc, 2, v8
v_mov_b32 v36, 0
v_mov_b32 v37, 0
v_cndmask_b32 v46, v9, v10, vcc
v_cmp_gt_i32 vcc, 3, v8
v_mov_b32 v38, 0
v_mov_b32 v39, 0
v_cndmask_b32 v47, v9, v10, vcc
mvaas 96,136,8
buffer_load_dwordx4 v2, s[72:75], s81 offen offset:0 sc1 lds
buffer_load_dwordx4 v2, s[72:75], s81 offen offset:1024 sc1 lds
buffer_load_dwordx4 v2, s[72:75], s81 offen offset:2048 sc1 lds
buffer_load_dwordx4 v2, s[72:75], s81 offen offset:3072 sc1 lds
buffer_store_dwordx4 v[176:179], v7, s[64:67], s87 offen offset:1024 sc1
rqa 64,25,53248
v_mul_f32 v200, v200, v192
v_mul_f32 v201, v201, v193
mvaas 96,140,12
s_xor_b32 s8, s8, 0x10000
rqa 68,25,54272
v_mul_f32 v202, v202, v194
v_mul_f32 v203, v203, v195
mvaaz 100,144,0
rqa 72,25,55296
rqa 76,25,56320
v_mul_f32 v204, v204, v196
mvaas 100,148,4
v_mul_f32 v205, v205, v197
v_mul_f32 v206, v206, v198
mvaas 100,152,8
v_mul_f32 v207, v207, v199
v_mul_f32 v192, s88, v192
mvaas 100,156,12
s_waitcnt lgkmcnt(4)
rqa 80,25,36864
v_mul_f32 v193, s88, v193
mvaaz 104,128,16
rqa 84,25,37888
v_mul_f32 v194, s88, v194
v_mul_f32 v195, s88, v195
mvaas 104,132,20
rqa 88,25,38912
v_mul_f32 v196, s88, v196
v_mul_f32 v197, s88, v197
mvaas 104,136,24
rqa 92,25,39936
v_mul_f32 v198, s88, v198
mvaas 104,140,28
v_mul_f32 v199, s88, v199
v_exp_f32 v192, v192
mvaaz 108,144,16
rqa 96,25,20480
v_exp_f32 v193, v193
v_exp_f32 v194, v194
mvaas 108,148,20
rqa 100,25,21504
v_exp_f32 v195, v195
mvaas 108,152,24
v_exp_f32 v196, v196
v_exp_f32 v197, v197
mvaas 108,156,28
rqa 104,25,22528
v_exp_f32 v198, v198
v_exp_f32 v199, v199
mvaaz 112,128,32
rqa 108,25,23552
v_add_f32 v192, 1.0, v192
mvaas 112,132,36
rqa 112,25,4096
v_add_f32 v193, 1.0, v193
v_add_f32 v194, 1.0, v194
mvaas 112,136,40
v_add_f32 v195, 1.0, v195
v_add_f32 v196, 1.0, v196
mvaas 112,140,44
rqa 116,25,5120
v_add_f32 v197, 1.0, v197
mvaaz 116,144,32
rqa 120,25,6144
v_add_f32 v198, 1.0, v198
v_add_f32 v199, 1.0, v199
mvaas 116,148,36
s_mov_b32 s87, 0
rqa 124,25,7168
v_rcp_f32 v192, v192
v_rcp_f32 v193, v193
mvaas 116,152,40
v_rcp_f32 v194, v194
mvaas 116,156,44
v_rcp_f32 v195, v195
v_rcp_f32 v196, v196
mvaaz 120,128,48
v_rcp_f32 v197, v197
v_rcp_f32 v198, v198
mvaas 120,132,52
v_rcp_f32 v199, v199
mvaas 120,136,56
v_mul_f32 v200, v200, v192
v_mul_f32 v201, v201, v193
mvaas 120,140,60
v_mul_f32 v202, v202, v194
v_mul_f32 v203, v203, v195
mvaaz 124,144,48
v_mul_f32 v204, v204, v196
v_mul_f32 v205, v205, v197
mvaas 124,148,52
v_mul_f32 v206, v206, v198
v_mul_f32 v207, v207, v199
v_cvt_pk_bf16_f32 v192, v200, v201
v_cvt_pk_bf16_f32 v193, v202, v203
v_cvt_pk_bf16_f32 v194, v204, v205
v_cvt_pk_bf16_f32 v195, v206, v207
mvaas 124,152,56
buffer_store_dwordx4 v[192:195], v7, s[64:67], s87 offen offset:2048 sc1
s_waitcnt lgkmcnt(0)
mvaas 124,156,60
s_barrier
rqa 128,0,16384
rqa 132,0,17408
rqa 136,0,20480
rqa 140,0,21504
rqa 144,0,18432
rqa 148,0,19456
rqa 152,0,22528
rqa 156,0,23552
s_add_u32 m0, s8, 49152
v_pk_mul_f32 v[216:217], v[216:217], v[208:209]
v_pk_mul_f32 v[218:219], v[218:219], v[210:211]
v_pk_mul_f32 v[220:221], v[220:221], v[212:213]
v_pk_mul_f32 v[222:223], v[222:223], v[214:215]
v_pk_mul_f32 v[208:209], v[208:209], s[88:89]
v_pk_mul_f32 v[210:211], v[210:211], s[88:89]
v_pk_mul_f32 v[212:213], v[212:213], s[88:89]
v_pk_mul_f32 v[214:215], v[214:215], s[88:89]
v_exp_f32 v208, v208
v_exp_f32 v209, v209
buffer_load_dwordx4 v2, s[72:75], s9 offen offset:0 sc1 lds
v_exp_f32 v210, v210
v_exp_f32 v211, v211
v_exp_f32 v212, v212
v_exp_f32 v213, v213
v_exp_f32 v214, v214
v_exp_f32 v215, v215
v_pk_add_f32 v[208:209], v[208:209], 1.0 op_sel_hi:[1,0]
v_pk_add_f32 v[210:211], v[210:211], 1.0 op_sel_hi:[1,0]
v_pk_add_f32 v[212:213], v[212:213], 1.0 op_sel_hi:[1,0]
buffer_load_dwordx4 v2, s[72:75], s9 offen offset:1024 sc1 lds
v_pk_add_f32 v[214:215], v[214:215], 1.0 op_sel_hi:[1,0]
v_rcp_f32 v208, v208
v_rcp_f32 v209, v209
v_rcp_f32 v210, v210
v_rcp_f32 v211, v211
v_rcp_f32 v212, v212
v_rcp_f32 v213, v213
v_rcp_f32 v214, v214
v_rcp_f32 v215, v215
buffer_load_dwordx4 v2, s[72:75], s9 offen offset:2048 sc1 lds
v_pk_mul_f32 v[216:217], v[216:217], v[208:209]
v_pk_mul_f32 v[218:219], v[218:219], v[210:211]
v_pk_mul_f32 v[220:221], v[220:221], v[212:213]
v_pk_mul_f32 v[222:223], v[222:223], v[214:215]
v_cvt_pk_bf16_f32 v208, v216, v217
v_cvt_pk_bf16_f32 v209, v218, v219
v_cvt_pk_bf16_f32 v210, v220, v221
v_cvt_pk_bf16_f32 v211, v222, v223
s_mov_b32 s87, 0
buffer_store_dwordx4 v[208:211], v7, s[64:67], s87 offen offset:3072 sc1
buffer_load_dwordx4 v2, s[72:75], s9 offen offset:3072 sc1 lds
v_pk_mul_f32 v[232:233], v[232:233], v[224:225]
v_pk_mul_f32 v[234:235], v[234:235], v[226:227]
v_pk_mul_f32 v[236:237], v[236:237], v[228:229]
v_pk_mul_f32 v[238:239], v[238:239], v[230:231]
v_pk_mul_f32 v[224:225], v[224:225], s[88:89]
v_pk_mul_f32 v[226:227], v[226:227], s[88:89]
v_pk_mul_f32 v[228:229], v[228:229], s[88:89]
v_pk_mul_f32 v[230:231], v[230:231], s[88:89]
v_exp_f32 v224, v224
v_exp_f32 v225, v225
s_mov_b32 s9, 131072
v_exp_f32 v226, v226
v_exp_f32 v227, v227
v_exp_f32 v228, v228
v_exp_f32 v229, v229
v_exp_f32 v230, v230
v_exp_f32 v231, v231
v_pk_add_f32 v[224:225], v[224:225], 1.0 op_sel_hi:[1,0]
v_pk_add_f32 v[226:227], v[226:227], 1.0 op_sel_hi:[1,0]
v_pk_add_f32 v[228:229], v[228:229], 1.0 op_sel_hi:[1,0]
s_add_u32 m0, s8, 32768
v_pk_add_f32 v[230:231], v[230:231], 1.0 op_sel_hi:[1,0]
v_rcp_f32 v224, v224
v_rcp_f32 v225, v225
v_rcp_f32 v226, v226
v_rcp_f32 v227, v227
v_rcp_f32 v228, v228
v_rcp_f32 v229, v229
v_rcp_f32 v230, v230
v_rcp_f32 v231, v231
buffer_load_dwordx4 v1, s[68:71], s9 offen offset:0 sc1 lds
v_pk_mul_f32 v[232:233], v[232:233], v[224:225]
v_pk_mul_f32 v[234:235], v[234:235], v[226:227]
v_pk_mul_f32 v[236:237], v[236:237], v[228:229]
v_pk_mul_f32 v[238:239], v[238:239], v[230:231]
v_cvt_pk_bf16_f32 v224, v232, v233
v_cvt_pk_bf16_f32 v225, v234, v235
v_cvt_pk_bf16_f32 v226, v236, v237
v_cvt_pk_bf16_f32 v227, v238, v239
s_mov_b32 s87, 745472
buffer_store_dwordx4 v[224:227], v7, s[64:67], s87 offen offset:0 sc1
buffer_load_dwordx4 v1, s[68:71], s9 offen offset:1024 sc1 lds
v_pk_mul_f32 v[248:249], v[248:249], v[240:241]
v_pk_mul_f32 v[250:251], v[250:251], v[242:243]
v_pk_mul_f32 v[252:253], v[252:253], v[244:245]
v_pk_mul_f32 v[254:255], v[254:255], v[246:247]
v_pk_mul_f32 v[240:241], v[240:241], s[88:89]
v_pk_mul_f32 v[242:243], v[242:243], s[88:89]
v_pk_mul_f32 v[244:245], v[244:245], s[88:89]
v_pk_mul_f32 v[246:247], v[246:247], s[88:89]
v_exp_f32 v240, v240
v_exp_f32 v241, v241
buffer_load_dwordx4 v1, s[68:71], s9 offen offset:2048 sc1 lds
v_exp_f32 v242, v242
v_exp_f32 v243, v243
v_exp_f32 v244, v244
v_exp_f32 v245, v245
v_exp_f32 v246, v246
v_exp_f32 v247, v247
v_pk_add_f32 v[240:241], v[240:241], 1.0 op_sel_hi:[1,0]
v_pk_add_f32 v[242:243], v[242:243], 1.0 op_sel_hi:[1,0]
v_pk_add_f32 v[244:245], v[244:245], 1.0 op_sel_hi:[1,0]
buffer_load_dwordx4 v1, s[68:71], s9 offen offset:3072 sc1 lds
v_pk_add_f32 v[246:247], v[246:247], 1.0 op_sel_hi:[1,0]
v_rcp_f32 v240, v240
v_rcp_f32 v241, v241
v_rcp_f32 v242, v242
v_rcp_f32 v243, v243
v_rcp_f32 v244, v244
v_rcp_f32 v245, v245
v_rcp_f32 v246, v246
v_rcp_f32 v247, v247
s_xor_b32 s8, s8, 0x10000
v_pk_mul_f32 v[248:249], v[248:249], v[240:241]
v_pk_mul_f32 v[250:251], v[250:251], v[242:243]
v_pk_mul_f32 v[252:253], v[252:253], v[244:245]
v_pk_mul_f32 v[254:255], v[254:255], v[246:247]
v_cvt_pk_bf16_f32 v240, v248, v249
v_cvt_pk_bf16_f32 v241, v250, v251
v_cvt_pk_bf16_f32 v242, v252, v253
v_cvt_pk_bf16_f32 v243, v254, v255
s_mov_b32 s87, 745472
buffer_store_dwordx4 v[240:243], v7, s[64:67], s87 offen offset:1024 sc1
v_exp_f32 v96, v96
v_exp_f32 v97, v97
v_exp_f32 v98, v98
v_exp_f32 v99, v99
v_cvt_pk_bf16_f32 v64, v96, v97
v_cvt_pk_bf16_f32 v65, v98, v99
v_exp_f32 v100, v100
v_exp_f32 v101, v101
v_exp_f32 v102, v102
v_exp_f32 v103, v103
v_cvt_pk_bf16_f32 v66, v100, v101
v_cvt_pk_bf16_f32 v67, v102, v103
v_exp_f32 v104, v104
v_exp_f32 v105, v105
v_exp_f32 v106, v106
v_exp_f32 v107, v107
v_cvt_pk_bf16_f32 v68, v104, v105
v_cvt_pk_bf16_f32 v69, v106, v107
v_exp_f32 v108, v108
v_exp_f32 v109, v109
v_exp_f32 v110, v110
v_exp_f32 v111, v111
v_cvt_pk_bf16_f32 v70, v108, v109
v_cvt_pk_bf16_f32 v71, v110, v111
v_exp_f32 v112, v112
v_exp_f32 v113, v113
v_exp_f32 v114, v114
v_exp_f32 v115, v115
v_cvt_pk_bf16_f32 v72, v112, v113
v_cvt_pk_bf16_f32 v73, v114, v115
v_exp_f32 v116, v116
v_exp_f32 v117, v117
v_exp_f32 v118, v118
v_exp_f32 v119, v119
v_cvt_pk_bf16_f32 v74, v116, v117
v_cvt_pk_bf16_f32 v75, v118, v119
v_exp_f32 v120, v120
v_exp_f32 v121, v121
v_exp_f32 v122, v122
v_exp_f32 v123, v123
v_cvt_pk_bf16_f32 v76, v120, v121
v_cvt_pk_bf16_f32 v77, v122, v123
v_exp_f32 v124, v124
v_exp_f32 v125, v125
v_exp_f32 v126, v126
v_exp_f32 v127, v127
v_cvt_pk_bf16_f32 v78, v124, v125
v_cvt_pk_bf16_f32 v79, v126, v127
v_and_b32 v7, 0x3ff, v0
s_lshl_b32 s6, s30, 14
s_lshl_b32 s7, s33, 13
s_add_u32 s6, s6, s7
s_lshl_b32 s7, s32, 10
s_add_u32 s83, s6, s7
s_sub_u32 s3, 15, s31
s_lshl_b32 s84, s33, 11
s_mul_i32 s7, s32, 745472
s_add_u32 s84, s84, s7
s_mov_b32 s82, 0
s_mul_i32 s5, s3, 1490944
s_add_u32 s5, s5, 50331648
v_add_u32 v5, s5, v7
s_mul_i32 s5, s31, 1490944
s_add_u32 s5, s5, 50331648
v_add_u32 v6, s5, v7
s_lshl_b32 s5, s80, 13
s_add_u32 s5, s5, 131072
v_add_u32 v7, s5, v7
v_xor_b32 v30, 0x2000, v7
s_lshl_b32 s5, s31, 9
s_lshl_b32 s6, s30, 4
s_add_u32 s5, s5, s6
s_lshl2_add_u32 s5, s80, s5
s_add_u32 s100, s5, 79695872
s_cmp_eq_u32 s80, 0
s_cselect_b32 s19, s100, 268435456
v_accvgpr_write_b32 a204, -1
v_accvgpr_write_b32 a205, -1
v_accvgpr_write_b32 a206, -1
v_accvgpr_write_b32 a207, -1
s_waitcnt vmcnt(16) lgkmcnt(0)
s_barrier
K_att:
mvaaz 96,128,0
s_lshr_b32 s81, s30, 1
rqa 160,0,49152
s_lshl_b32 s81, s81, 8
mvaas 96,132,4
s_add_u32 s81, s81, 79691776
rqa 164,0,50176
s_add_u32 m0, s8, 16384
mvaas 96,136,8
rqa 168,0,51200
mvaas 96,140,12
rqa 172,0,52224
mvaaz 100,144,0
rqa 176,0,53248
mvaas 100,148,4
v_and_b32 v22, 0x3ff, v0
v_lshrrev_b32 v22, 2, v22
mvaas 100,152,8
rqa 180,0,54272
v_mov_b32 v9, 0x3f80
mvaas 100,156,12
buffer_load_dword v20, v22, s[64:67], s81 offen sc1
mvaaz 104,128,16
rqa 184,0,55296
rqa 188,0,56320
mvaas 104,132,20
buffer_load_dwordx4 v2, s[72:75], s10 offen offset:0 sc1 lds
mvaas 104,136,24
v_exp_f32 v96, v96
mvaas 104,140,28
buffer_load_dwordx4 v2, s[72:75], s10 offen offset:1024 sc1 lds
mvaaz 108,144,16
v_exp_f32 v97, v97
mvaas 108,148,20
v_cmp_eq_u32 vcc, 0, v8
v_cvt_pk_bf16_f32 v80, v96, v97
mvaas 108,152,24
v_cndmask_b32 v58, 0, v9, vcc
v_cmp_eq_u32 vcc, 1, v8
mvaas 108,156,28
buffer_load_dwordx4 v2, s[72:75], s10 offen offset:2048 sc1 lds
mvaaz 112,128,32
v_cndmask_b32 v58, v58, 1.0, vcc
v_mov_b32 v60, v58
mvaas 112,132,36
v_exp_f32 v98, v98
mvaas 112,136,40
buffer_load_dwordx4 v2, s[72:75], s10 offen offset:3072 sc1 lds
mvaas 112,140,44
s_mov_b32 s10, 163840
v_exp_f32 v99, v99
mvaaz 116,144,32
s_add_u32 m0, s8, 0
v_cvt_pk_bf16_f32 v81, v98, v99
v_cmp_eq_u32 vcc, 2, v8
mvaas 116,148,36
v_mov_b32 v56, 0
v_cndmask_b32 v59, 0, v9, vcc
mvaas 116,152,40
v_exp_f32 v100, v100
mvaas 116,156,44
v_cmp_eq_u32 vcc, 3, v8
v_mov_b32 v57, 0
mvaaz 120,128,48
v_cndmask_b32 v59, v59, 1.0, vcc
v_mov_b32 v61, v59
mvaas 120,132,52
buffer_load_dwordx4 v1, s[68:71], s10 offen offset:0 sc1 lds
mvaas 120,136,56
v_exp_f32 v101, v101
mvaas 120,140,60
buffer_load_dwordx4 v1, s[68:71], s10 offen offset:1024 sc1 lds
mvaaz 124,144,48
v_exp_f32 v102, v102
mvaas 124,148,52
v_exp_f32 v103, v103
mvaas 124,152,56
rqa 128,0,32768
v_cvt_pk_bf16_f32 v82, v100, v101
mvaas 124,156,60
s_waitcnt lgkmcnt(1)
v_cvt_pk_bf16_f32 v83, v102, v103
v_mov_b32 v62, 0
v_smfmac_f32_16x16x64_bf16 v[32:35], a[192:195], v[64:71], v15
buffer_load_dwordx4 v1, s[68:71], s10 offen offset:2048 sc1 lds
mvavz 128,160,64
rqa 132,0,33792
v_mov_b32 v63, 0
mvavz 144,164,64
v_exp_f32 v104, v104
mvavz 160,168,64
v_exp_f32 v105, v105
mvavz 176,172,64
v_exp_f32 v106, v106
mvavz 192,176,64
rqa 136,0,36864
v_mov_b32 v48, 0
mvavz 208,180,64
buffer_load_dwordx4 v1, s[68:71], s10 offen offset:3072 sc1 lds
mvavz 224,184,64
v_exp_f32 v107, v107
mvavz 240,188,64
rqa 140,0,37888
v_mov_b32 v49, 0
mvavz 132,160,68
v_mov_b32 v50, 0
v_mov_b32 v51, 0
mvavz 148,164,68
rqa 144,0,34816
v_cvt_pk_bf16_f32 v84, v104, v105
mvavz 164,168,68
v_cvt_pk_bf16_f32 v85, v106, v107
v_mov_b32 v52, 0
mvavz 180,172,68
v_exp_f32 v108, v108
mvavz 196,176,68
rqa 148,0,35840
v_mov_b32 v53, 0
mvavz 212,180,68
v_exp_f32 v109, v109
mvavz 228,184,68
v_exp_f32 v110, v110
mvavz 244,188,68
rqa 152,0,38912
v_cvt_pk_bf16_f32 v86, v108, v109
v_smfmac_f32_16x16x64_bf16 v[36:39], a[192:195], v[72:79], v15
v_mov_b32 v54, 0
mvavz 136,160,72
v_exp_f32 v111, v111
mvavz 152,164,72
rqa 156,0,39936
v_cvt_pk_bf16_f32 v87, v110, v111
mvavz 168,168,72
v_exp_f32 v112, v112
mvavz 184,172,72
v_exp_f32 v113, v113
mvavz 200,176,72
v_mov_b32 v55, 0
v_cvt_pk_bf16_f32 v88, v112, v113
mvavz 216,180,72
v_exp_f32 v114, v114
mvavz 232,184,72
v_exp_f32 v115, v115
mvavz 248,188,72
v_cvt_pk_bf16_f32 v89, v114, v115
v_xor_b32 v0, 0x10000, v0
mvavz 140,160,76
v_exp_f32 v116, v116
mvavz 156,164,76
v_exp_f32 v117, v117
mvavz 172,168,76
v_exp_f32 v118, v118
mvavz 188,172,76
v_exp_f32 v119, v119
mvavz 204,176,76
v_cvt_pk_bf16_f32 v90, v116, v117
v_cvt_pk_bf16_f32 v91, v118, v119
mvavz 220,180,76
v_exp_f32 v120, v120
mvavz 236,184,76
s_waitcnt vmcnt(8)
v_exp_f32 v121, v121
v_exp_f32 v122, v122
v_exp_f32 v123, v123
v_cvt_pk_bf16_f32 v92, v120, v121
v_cvt_pk_bf16_f32 v93, v122, v123
v_exp_f32 v124, v124
v_exp_f32 v125, v125
v_exp_f32 v126, v126
v_exp_f32 v127, v127
v_cvt_pk_bf16_f32 v94, v124, v125
v_cvt_pk_bf16_f32 v95, v126, v127
v_mov_b32 v27, 1
v_cmp_gt_u32 vcc, 2, v20
s_nop 0
s_cbranch_vccnz PF2_spin
PF2_ok:
s_waitcnt vmcnt(16) lgkmcnt(0)
mvavz 252,188,76
s_barrier
mvaaz 96,128,0
buffer_store_dword v27, off, s[64:67], s19 sc1
L_A_loop1:
mvaas 96,132,4
rqa 160,0,16384
s_add_u32 m0, s8, 49152
mvaas 96,136,8
rqa 164,0,17408
mvaas 96,140,12
rqa 168,0,18432
mvaaz 100,144,0
rqa 172,0,19456
mvaas 100,148,4
rqa 176,0,20480
mvaas 100,152,8
rqa 180,0,21504
mvaas 100,156,12
rqa 184,0,22528
mvaaz 104,128,16
rqa 188,0,23552
mvaas 104,132,20
buffer_load_dwordx4 v2, s[72:75], s9 offen offset:0 sc1 lds
mvaas 104,136,24
v_exp_f32 v96, v96
mvaas 104,140,28
v_exp_f32 v97, v97
mvaaz 108,144,16
v_exp_f32 v98, v98
mvaas 108,148,20
buffer_load_dwordx4 v2, s[72:75], s9 offen offset:1024 sc1 lds
mvaas 108,152,24
v_exp_f32 v99, v99
mvaas 108,156,28
v_cvt_pk_bf16_f32 v64, v96, v97
v_cvt_pk_bf16_f32 v65, v98, v99
mvaaz 112,128,32
v_exp_f32 v100, v100
mvaas 112,132,36
buffer_load_dwordx4 v2, s[72:75], s9 offen offset:2048 sc1 lds
mvaas 112,136,40
v_exp_f32 v101, v101
mvaas 112,140,44
v_exp_f32 v102, v102
mvaaz 116,144,32
v_exp_f32 v103, v103
mvaas 116,148,36
buffer_load_dwordx4 v2, s[72:75], s9 offen offset:3072 sc1 lds
mvaas 116,152,40
s_and_b32 s9, s20, 31
v_cvt_pk_bf16_f32 v66, v100, v101
v_cvt_pk_bf16_f32 v67, v102, v103
mvaas 116,156,44
s_lshl_b32 s9, s9, 14
v_exp_f32 v104, v104
mvaaz 120,128,48
s_add_u32 m0, s8, 32768
v_exp_f32 v105, v105
mvaas 120,132,52
buffer_load_dwordx4 v1, s[68:71], s9 offen offset:0 sc1 lds
mvaas 120,136,56
s_lshr_b32 s20, s20, 5
v_exp_f32 v106, v106
mvaas 120,140,60
v_exp_f32 v107, v107
mvaaz 124,144,48
buffer_load_dwordx4 v1, s[68:71], s9 offen offset:1024 sc1 lds
mvaas 124,148,52
v_cvt_pk_bf16_f32 v68, v104, v105
v_cvt_pk_bf16_f32 v69, v106, v107
mvaas 124,152,56
v_exp_f32 v108, v108
mvaas 124,156,60
s_waitcnt lgkmcnt(0)
v_exp_f32 v109, v109
v_smfmac_f32_16x16x64_bf16 v[32:35], a[192:195], v[80:87], v15
buffer_load_dwordx4 v1, s[68:71], s9 offen offset:2048 sc1 lds
mvavs 128,160,80
s_xor_b32 s8, s8, 0x10000
rqa 128,0,0
v_cvt_pk_bf16_f32 v70, v108, v109
mvavs 144,164,80
v_exp_f32 v110, v110
mvavs 160,168,80
v_exp_f32 v111, v111
mvavs 176,172,80
rqa 132,0,1024
v_cvt_pk_bf16_f32 v71, v110, v111
mvavs 192,176,80
v_exp_f32 v112, v112
mvavs 208,180,80
buffer_load_dwordx4 v1, s[68:71], s9 offen offset:3072 sc1 lds
mvavs 224,184,80
rqa 136,0,4096
mvavs 240,188,80
v_exp_f32 v113, v113
mvavs 132,160,84
v_exp_f32 v114, v114
mvavs 148,164,84
rqa 140,0,5120
v_cvt_pk_bf16_f32 v72, v112, v113
mvavs 164,168,84
v_exp_f32 v115, v115
mvavs 180,172,84
rqa 144,0,2048
v_cvt_pk_bf16_f32 v73, v114, v115
mvavs 196,176,84
v_exp_f32 v116, v116
mvavs 212,180,84
buffer_store_dwordx4 a[204:207], v1, s[36:39], s82 offen offset:0 sc1
rqa 148,0,3072
v_exp_f32 v117, v117
mvavs 228,184,84
v_exp_f32 v118, v118
mvavs 244,188,84
v_exp_f32 v119, v119
v_smfmac_f32_16x16x64_bf16 v[36:39], a[192:195], v[88:95], v15
v_cvt_pk_bf16_f32 v74, v116, v117
mvavs 136,160,88
rqa 152,0,6144
v_cvt_pk_bf16_f32 v75, v118, v119
mvavs 152,164,88
v_exp_f32 v120, v120
mvavs 168,168,88
buffer_store_dwordx4 a[204:207], v1, s[36:39], s82 offen offset:1024 sc1
rqa 156,0,7168
v_exp_f32 v121, v121
mvavs 184,172,88
v_exp_f32 v122, v122
mvavs 200,176,88
v_exp_f32 v123, v123
mvavs 216,180,88
v_cvt_pk_bf16_f32 v76, v120, v121
v_cvt_pk_bf16_f32 v77, v122, v123
mvavs 232,184,88
v_exp_f32 v124, v124
mvavs 248,188,88
buffer_store_dwordx4 a[204:207], v1, s[36:39], s82 offen offset:2048 sc1
v_exp_f32 v125, v125
mvavs 140,160,92
v_exp_f32 v126, v126
mvavs 156,164,92
v_exp_f32 v127, v127
mvavs 172,168,92
v_cvt_pk_bf16_f32 v78, v124, v125
v_cvt_pk_bf16_f32 v79, v126, v127
mvavs 188,172,92
mvavs 204,176,92
mvavs 220,180,92
s_waitcnt vmcnt(19) lgkmcnt(0)
mvavs 236,184,92
mvavs 252,188,92
s_barrier
mvaaz 96,128,0
rqa 160,0,49152
s_add_u32 m0, s8, 16384
mvaas 96,132,4
rqa 164,0,50176
mvaas 96,136,8
rqa 168,0,51200
mvaas 96,140,12
rqa 172,0,52224
mvaaz 100,144,0
rqa 176,0,53248
mvaas 100,148,4
rqa 180,0,54272
mvaas 100,152,8
rqa 184,0,55296
mvaas 100,156,12
rqa 188,0,56320
mvaaz 104,128,16
buffer_load_dwordx4 v2, s[72:75], s10 offen offset:0 sc1 lds
mvaas 104,132,20
v_exp_f32 v96, v96
mvaas 104,136,24
v_exp_f32 v97, v97
mvaas 104,140,28
v_exp_f32 v98, v98
mvaaz 108,144,16
buffer_load_dwordx4 v2, s[72:75], s10 offen offset:1024 sc1 lds
mvaas 108,148,20
v_exp_f32 v99, v99
mvaas 108,152,24
v_cvt_pk_bf16_f32 v80, v96, v97
v_cvt_pk_bf16_f32 v81, v98, v99
mvaas 108,156,28
v_exp_f32 v100, v100
mvaaz 112,128,32
buffer_load_dwordx4 v2, s[72:75], s10 offen offset:2048 sc1 lds
mvaas 112,132,36
v_exp_f32 v101, v101
mvaas 112,136,40
v_exp_f32 v102, v102
mvaas 112,140,44
buffer_load_dwordx4 v2, s[72:75], s10 offen offset:3072 sc1 lds
mvaaz 116,144,32
s_and_b32 s10, s21, 31
v_exp_f32 v103, v103
mvaas 116,148,36
s_lshl_b32 s10, s10, 14
v_cvt_pk_bf16_f32 v82, v100, v101
v_cvt_pk_bf16_f32 v83, v102, v103
mvaas 116,152,40
s_add_u32 m0, s8, 0
v_exp_f32 v104, v104
mvaas 116,156,44
buffer_load_dwordx4 v1, s[68:71], s10 offen offset:0 sc1 lds
mvaaz 120,128,48
s_lshr_b32 s21, s21, 5
v_exp_f32 v105, v105
mvaas 120,132,52
v_exp_f32 v106, v106
mvaas 120,136,56
v_exp_f32 v107, v107
mvaas 120,140,60
buffer_load_dwordx4 v1, s[68:71], s10 offen offset:1024 sc1 lds
mvaaz 124,144,48
v_cvt_pk_bf16_f32 v84, v104, v105
v_cvt_pk_bf16_f32 v85, v106, v107
mvaas 124,148,52
v_exp_f32 v108, v108
mvaas 124,152,56
v_exp_f32 v109, v109
mvaas 124,156,60
s_waitcnt lgkmcnt(0)
rqa 128,0,32768
v_cvt_pk_bf16_f32 v86, v108, v109
v_smfmac_f32_16x16x64_bf16 v[32:35], a[192:195], v[64:71], v15
buffer_load_dwordx4 v1, s[68:71], s10 offen offset:2048 sc1 lds
mvavs 128,160,64
v_exp_f32 v110, v110
mvavs 144,164,64
v_exp_f32 v111, v111
mvavs 160,168,64
rqa 132,0,33792
v_cvt_pk_bf16_f32 v87, v110, v111
mvavs 176,172,64
buffer_load_dwordx4 v1, s[68:71], s10 offen offset:3072 sc1 lds
mvavs 192,176,64
v_exp_f32 v112, v112
mvavs 208,180,64
v_exp_f32 v113, v113
mvavs 224,184,64
rqa 136,0,36864
v_cvt_pk_bf16_f32 v88, v112, v113
mvavs 240,188,64
v_exp_f32 v114, v114
mvavs 132,160,68
v_exp_f32 v115, v115
mvavs 148,164,68
rqa 140,0,37888
v_cvt_pk_bf16_f32 v89, v114, v115
mvavs 164,168,68
v_exp_f32 v116, v116
mvavs 180,172,68
v_exp_f32 v117, v117
mvavs 196,176,68
rqa 144,0,34816
v_cvt_pk_bf16_f32 v90, v116, v117
mvavs 212,180,68
v_exp_f32 v118, v118
mvavs 228,184,68
v_exp_f32 v119, v119
mvavs 244,188,68
rqa 148,0,35840
v_cvt_pk_bf16_f32 v91, v118, v119
v_smfmac_f32_16x16x64_bf16 v[36:39], a[192:195], v[72:79], v15
rqa 152,0,38912
mvavs 136,160,72
v_exp_f32 v120, v120
mvavs 152,164,72
v_exp_f32 v121, v121
mvavs 168,168,72
rqa 156,0,39936
v_cvt_pk_bf16_f32 v92, v120, v121
mvavs 184,172,72
s_add_u32 s82, s82, 3072
v_exp_f32 v122, v122
mvavs 200,176,72
s_cmp_lg_u32 s82, 18432
v_exp_f32 v123, v123
mvavs 216,180,72
v_cvt_pk_bf16_f32 v93, v122, v123
v_xor_b32 v0, 0x10000, v0
mvavs 232,184,72
v_exp_f32 v124, v124
mvavs 248,188,72
v_exp_f32 v125, v125
mvavs 140,160,76
v_exp_f32 v126, v126
mvavs 156,164,76
v_exp_f32 v127, v127
mvavs 172,168,76
v_cvt_pk_bf16_f32 v94, v124, v125
v_cvt_pk_bf16_f32 v95, v126, v127
mvavs 188,172,76
mvavs 204,176,76
mvavs 220,180,76
s_waitcnt vmcnt(19) lgkmcnt(0)
mvavs 236,184,76
mvavs 252,188,76
s_barrier
mvaaz 96,128,0
s_cbranch_scc1 L_A_loop1
L_A_loop:
mvaas 96,132,4
rqa 160,0,16384
s_add_u32 m0, s8, 49152
mvaas 96,136,8
rqa 164,0,17408
mvaas 96,140,12
rqa 168,0,18432
mvaaz 100,144,0
rqa 172,0,19456
mvaas 100,148,4
rqa 176,0,20480
mvaas 100,152,8
rqa 180,0,21504
mvaas 100,156,12
rqa 184,0,22528
mvaaz 104,128,16
rqa 188,0,23552
mvaas 104,132,20
buffer_load_dwordx4 v2, s[72:75], s9 offen offset:0 sc1 lds
mvaas 104,136,24
v_exp_f32 v96, v96
mvaas 104,140,28
v_exp_f32 v97, v97
mvaaz 108,144,16
v_exp_f32 v98, v98
mvaas 108,148,20
buffer_load_dwordx4 v2, s[72:75], s9 offen offset:1024 sc1 lds
mvaas 108,152,24
v_exp_f32 v99, v99
mvaas 108,156,28
v_cvt_pk_bf16_f32 v64, v96, v97
v_cvt_pk_bf16_f32 v65, v98, v99
mvaaz 112,128,32
v_exp_f32 v100, v100
mvaas 112,132,36
buffer_load_dwordx4 v2, s[72:75], s9 offen offset:2048 sc1 lds
mvaas 112,136,40
v_exp_f32 v101, v101
mvaas 112,140,44
v_exp_f32 v102, v102
mvaaz 116,144,32
v_exp_f32 v103, v103
mvaas 116,148,36
buffer_load_dwordx4 v2, s[72:75], s9 offen offset:3072 sc1 lds
mvaas 116,152,40
s_add_u32 s9, s9, 32768
v_cvt_pk_bf16_f32 v66, v100, v101
v_cvt_pk_bf16_f32 v67, v102, v103
mvaas 116,156,44
s_cmp_eq_u32 s9, s11
v_exp_f32 v104, v104
mvaaz 120,128,48
s_cselect_b32 s9, 0, s9
v_exp_f32 v105, v105
mvaas 120,132,52
s_add_u32 m0, s8, 32768
v_exp_f32 v106, v106
mvaas 120,136,56
buffer_load_dwordx4 v1, s[68:71], s9 offen offset:0 sc1 lds
mvaas 120,140,60
v_exp_f32 v107, v107
mvaaz 124,144,48
buffer_load_dwordx4 v1, s[68:71], s9 offen offset:1024 sc1 lds
mvaas 124,148,52
v_cvt_pk_bf16_f32 v68, v104, v105
v_cvt_pk_bf16_f32 v69, v106, v107
mvaas 124,152,56
v_exp_f32 v108, v108
mvaas 124,156,60
s_waitcnt lgkmcnt(0)
v_exp_f32 v109, v109
v_smfmac_f32_16x16x64_bf16 v[32:35], a[192:195], v[80:87], v15
buffer_load_dwordx4 v1, s[68:71], s9 offen offset:2048 sc1 lds
mvavs 128,160,80
s_xor_b32 s8, s8, 0x10000
rqa 128,0,0
v_cvt_pk_bf16_f32 v70, v108, v109
mvavs 144,164,80
v_exp_f32 v110, v110
mvavs 160,168,80
v_exp_f32 v111, v111
mvavs 176,172,80
rqa 132,0,1024
v_cvt_pk_bf16_f32 v71, v110, v111
mvavs 192,176,80
buffer_load_dwordx4 v1, s[68:71], s9 offen offset:3072 sc1 lds
mvavs 208,180,80
v_exp_f32 v112, v112
mvavs 224,184,80
rqa 136,0,4096
mvavs 240,188,80
v_exp_f32 v113, v113
mvavs 132,160,84
rqa 140,0,5120
v_cvt_pk_bf16_f32 v72, v112, v113
mvavs 148,164,84
v_exp_f32 v114, v114
mvavs 164,168,84
v_exp_f32 v115, v115
mvavs 180,172,84
rqa 144,0,2048
v_cvt_pk_bf16_f32 v73, v114, v115
mvavs 196,176,84
v_exp_f32 v116, v116
mvavs 212,180,84
v_exp_f32 v117, v117
mvavs 228,184,84
rqa 148,0,3072
v_cvt_pk_bf16_f32 v74, v116, v117
mvavs 244,188,84
v_exp_f32 v118, v118
v_smfmac_f32_16x16x64_bf16 v[36:39], a[192:195], v[88:95], v15
rqa 152,0,6144
mvavs 136,160,88
v_exp_f32 v119, v119
mvavs 152,164,88
rqa 156,0,7168
v_cvt_pk_bf16_f32 v75, v118, v119
mvavs 168,168,88
v_exp_f32 v120, v120
mvavs 184,172,88
v_exp_f32 v121, v121
mvavs 200,176,88
v_exp_f32 v122, v122
mvavs 216,180,88
v_exp_f32 v123, v123
mvavs 232,184,88
v_cvt_pk_bf16_f32 v76, v120, v121
v_cvt_pk_bf16_f32 v77, v122, v123
mvavs 248,188,88
v_exp_f32 v124, v124
mvavs 140,160,92
v_exp_f32 v125, v125
mvavs 156,164,92
v_exp_f32 v126, v126
mvavs 172,168,92
v_exp_f32 v127, v127
mvavs 188,172,92
v_cvt_pk_bf16_f32 v78, v124, v125
v_cvt_pk_bf16_f32 v79, v126, v127
mvavs 204,176,92
mvavs 220,180,92
s_waitcnt vmcnt(16) lgkmcnt(0)
mvavs 236,184,92
mvavs 252,188,92
s_barrier
mvaaz 96,128,0
rqa 160,0,49152
s_add_u32 m0, s8, 16384
mvaas 96,132,4
rqa 164,0,50176
mvaas 96,136,8
rqa 168,0,51200
mvaas 96,140,12
rqa 172,0,52224
mvaaz 100,144,0
rqa 176,0,53248
mvaas 100,148,4
rqa 180,0,54272
mvaas 100,152,8
rqa 184,0,55296
mvaas 100,156,12
rqa 188,0,56320
mvaaz 104,128,16
buffer_load_dwordx4 v2, s[72:75], s10 offen offset:0 sc1 lds
mvaas 104,132,20
v_exp_f32 v96, v96
mvaas 104,136,24
v_exp_f32 v97, v97
mvaas 104,140,28
v_exp_f32 v98, v98
mvaaz 108,144,16
buffer_load_dwordx4 v2, s[72:75], s10 offen offset:1024 sc1 lds
mvaas 108,148,20
v_exp_f32 v99, v99
mvaas 108,152,24
v_cvt_pk_bf16_f32 v80, v96, v97
v_cvt_pk_bf16_f32 v81, v98, v99
mvaas 108,156,28
v_exp_f32 v100, v100
mvaaz 112,128,32
buffer_load_dwordx4 v2, s[72:75], s10 offen offset:2048 sc1 lds
mvaas 112,132,36
v_exp_f32 v101, v101
mvaas 112,136,40
v_exp_f32 v102, v102
mvaas 112,140,44
buffer_load_dwordx4 v2, s[72:75], s10 offen offset:3072 sc1 lds
mvaaz 116,144,32
s_add_u32 s10, s10, 32768
v_exp_f32 v103, v103
mvaas 116,148,36
s_cmp_eq_u32 s10, s12
v_cvt_pk_bf16_f32 v82, v100, v101
v_cvt_pk_bf16_f32 v83, v102, v103
mvaas 116,152,40
s_cselect_b32 s10, 16384, s10
v_exp_f32 v104, v104
mvaas 116,156,44
s_add_u32 m0, s8, 0
v_exp_f32 v105, v105
mvaaz 120,128,48
buffer_load_dwordx4 v1, s[68:71], s10 offen offset:0 sc1 lds
mvaas 120,132,52
v_exp_f32 v106, v106
mvaas 120,136,56
v_exp_f32 v107, v107
mvaas 120,140,60
buffer_load_dwordx4 v1, s[68:71], s10 offen offset:1024 sc1 lds
mvaaz 124,144,48
v_cvt_pk_bf16_f32 v84, v104, v105
v_cvt_pk_bf16_f32 v85, v106, v107
mvaas 124,148,52
v_exp_f32 v108, v108
mvaas 124,152,56
v_exp_f32 v109, v109
mvaas 124,156,60
s_waitcnt lgkmcnt(0)
rqa 128,0,32768
v_cvt_pk_bf16_f32 v86, v108, v109
v_smfmac_f32_16x16x64_bf16 v[32:35], a[192:195], v[64:71], v15
buffer_load_dwordx4 v1, s[68:71], s10 offen offset:2048 sc1 lds
mvavs 128,160,64
v_exp_f32 v110, v110
mvavs 144,164,64
v_exp_f32 v111, v111
mvavs 160,168,64
rqa 132,0,33792
v_cvt_pk_bf16_f32 v87, v110, v111
mvavs 176,172,64
buffer_load_dwordx4 v1, s[68:71], s10 offen offset:3072 sc1 lds
mvavs 192,176,64
v_exp_f32 v112, v112
mvavs 208,180,64
v_exp_f32 v113, v113
mvavs 224,184,64
rqa 136,0,36864
v_cvt_pk_bf16_f32 v88, v112, v113
mvavs 240,188,64
v_exp_f32 v114, v114
mvavs 132,160,68
v_exp_f32 v115, v115
mvavs 148,164,68
rqa 140,0,37888
v_cvt_pk_bf16_f32 v89, v114, v115
mvavs 164,168,68
v_exp_f32 v116, v116
mvavs 180,172,68
v_exp_f32 v117, v117
mvavs 196,176,68
rqa 144,0,34816
v_cvt_pk_bf16_f32 v90, v116, v117
mvavs 212,180,68
v_exp_f32 v118, v118
mvavs 228,184,68
v_exp_f32 v119, v119
mvavs 244,188,68
rqa 148,0,35840
v_cvt_pk_bf16_f32 v91, v118, v119
v_smfmac_f32_16x16x64_bf16 v[36:39], a[192:195], v[72:79], v15
rqa 152,0,38912
mvavs 136,160,72
v_exp_f32 v120, v120
mvavs 152,164,72
v_exp_f32 v121, v121
mvavs 168,168,72
rqa 156,0,39936
v_cvt_pk_bf16_f32 v92, v120, v121
mvavs 184,172,72
s_sub_u32 s13, s13, 1
v_exp_f32 v122, v122
mvavs 200,176,72
s_cmp_lg_u32 s13, 0
v_exp_f32 v123, v123
mvavs 216,180,72
v_cvt_pk_bf16_f32 v93, v122, v123
v_xor_b32 v0, 0x10000, v0
mvavs 232,184,72
v_exp_f32 v124, v124
mvavs 248,188,72
v_exp_f32 v125, v125
mvavs 140,160,76
v_exp_f32 v126, v126
mvavs 156,164,76
v_exp_f32 v127, v127
mvavs 172,168,76
v_cvt_pk_bf16_f32 v94, v124, v125
v_cvt_pk_bf16_f32 v95, v126, v127
mvavs 188,172,76
mvavs 204,176,76
mvavs 220,180,76
s_waitcnt vmcnt(16) lgkmcnt(0)
mvavs 236,184,76
mvavs 252,188,76
s_barrier
mvaaz 96,128,0
s_cbranch_scc1 L_A_loop
mvaas 96,132,4
s_and_b32 s81, s100, -512
rqa 160,0,16384
s_add_u32 m0, s8, 49152
mvaas 96,136,8
rqa 164,0,17408
mvaas 96,140,12
rqa 168,0,18432
mvaaz 100,144,0
rqa 172,0,19456
mvaas 100,148,4
rqa 176,0,20480
v_and_b32 v22, 0x1ff, v0
mvaas 100,152,8
rqa 180,0,21504
v_fmac_f32 v96, s22, v44
mvaas 100,156,12
rqa 184,0,22528
v_fmac_f32 v97, s22, v45
mvaaz 104,128,16
rqa 188,0,23552
v_fmac_f32 v98, s22, v46
mvaas 104,132,20
buffer_load_dword v20, v22, s[64:67], s81 offen sc1
mvaas 104,136,24
v_fmac_f32 v99, s22, v47
v_fmac_f32 v100, s23, v44
mvaas 104,140,28
buffer_load_dwordx4 v2, s[72:75], s9 offen offset:0 sc1 lds
mvaaz 108,144,16
v_exp_f32 v96, v96
mvaas 108,148,20
v_exp_f32 v97, v97
mvaas 108,152,24
buffer_load_dwordx4 v2, s[72:75], s9 offen offset:1024 sc1 lds
mvaas 108,156,28
v_exp_f32 v98, v98
mvaaz 112,128,32
v_exp_f32 v99, v99
mvaas 112,132,36
v_cvt_pk_bf16_f32 v64, v96, v97
v_cvt_pk_bf16_f32 v65, v98, v99
mvaas 112,136,40
buffer_load_dwordx4 v2, s[72:75], s9 offen offset:2048 sc1 lds
mvaas 112,140,44
v_fmac_f32 v101, s23, v45
v_fmac_f32 v102, s23, v46
mvaaz 116,144,32
v_fmac_f32 v103, s23, v47
v_fmac_f32 v104, s24, v44
mvaas 116,148,36
v_exp_f32 v100, v100
mvaas 116,152,40
buffer_load_dwordx4 v2, s[72:75], s9 offen offset:3072 sc1 lds
mvaas 116,156,44
s_add_u32 s9, s9, 32768
v_exp_f32 v101, v101
mvaaz 120,128,48
s_cmp_eq_u32 s9, s11
v_exp_f32 v102, v102
mvaas 120,132,52
s_cselect_b32 s9, 0, s9
v_exp_f32 v103, v103
mvaas 120,136,56
s_add_u32 m0, s8, 32768
v_cvt_pk_bf16_f32 v66, v100, v101
v_cvt_pk_bf16_f32 v67, v102, v103
mvaas 120,140,60
buffer_load_dwordx4 v1, s[68:71], s9 offen offset:0 sc1 lds
mvaaz 124,144,48
v_fmac_f32 v105, s24, v45
v_fmac_f32 v106, s24, v46
mvaas 124,148,52
v_fmac_f32 v107, s24, v47
v_fmac_f32 v108, s25, v44
mvaas 124,152,56
buffer_load_dwordx4 v1, s[68:71], s9 offen offset:1024 sc1 lds
mvaas 124,156,60
v_exp_f32 v104, v104
v_smfmac_f32_16x16x64_bf16 v[32:35], a[192:195], v[80:87], v15
s_xor_b32 s8, s8, 0x10000
s_waitcnt lgkmcnt(0)
rqa 128,0,0
mvavs 128,160,80
v_exp_f32 v105, v105
mvavs 144,164,80
v_exp_f32 v106, v106
mvavs 160,168,80
v_exp_f32 v107, v107
mvavs 176,172,80
buffer_load_dwordx4 v1, s[68:71], s9 offen offset:2048 sc1 lds
mvavs 192,176,80
rqa 132,0,1024
v_cvt_pk_bf16_f32 v68, v104, v105
mvavs 208,180,80
v_cvt_pk_bf16_f32 v69, v106, v107
v_fmac_f32 v109, s25, v45
mvavs 224,184,80
rqa 136,0,4096
v_fmac_f32 v110, s25, v46
mvavs 240,188,80
rqa 140,0,5120
v_fmac_f32 v111, s25, v47
mvavs 132,160,84
buffer_load_dwordx4 v1, s[68:71], s9 offen offset:3072 sc1 lds
mvavs 148,164,84
v_exp_f32 v108, v108
mvavs 164,168,84
v_exp_f32 v109, v109
mvavs 180,172,84
v_exp_f32 v110, v110
mvavs 196,176,84
v_exp_f32 v111, v111
mvavs 212,180,84
rqa 144,0,2048
v_cvt_pk_bf16_f32 v70, v108, v109
mvavs 228,184,84
rqa 148,0,3072
v_cvt_pk_bf16_f32 v71, v110, v111
mvavs 244,188,84
v_exp_f32 v112, v112
v_smfmac_f32_16x16x64_bf16 v[36:39], a[192:195], v[88:95], v15
rqa 152,0,6144
mvavs 136,160,88
v_exp_f32 v113, v113
mvavs 152,164,88
v_exp_f32 v114, v114
mvavs 168,168,88
v_exp_f32 v115, v115
mvavs 184,172,88
v_cvt_pk_bf16_f32 v72, v112, v113
v_cvt_pk_bf16_f32 v73, v114, v115
mvavs 200,176,88
v_exp_f32 v116, v116
mvavs 216,180,88
v_exp_f32 v117, v117
mvavs 232,184,88
rqa 156,0,7168
v_exp_f32 v118, v118
mvavs 248,188,88
v_exp_f32 v119, v119
v_cvt_pk_bf16_f32 v74, v116, v117
v_cvt_pk_bf16_f32 v75, v118, v119
mvavs 140,160,92
v_exp_f32 v120, v120
mvavs 156,164,92
v_exp_f32 v121, v121
mvavs 172,168,92
v_exp_f32 v122, v122
mvavs 188,172,92
v_exp_f32 v123, v123
mvavs 204,176,92
v_cvt_pk_bf16_f32 v76, v120, v121
v_cvt_pk_bf16_f32 v77, v122, v123
mvavs 220,180,92
s_waitcnt vmcnt(17) lgkmcnt(0)
v_exp_f32 v124, v124
mvavs 236,184,92
v_exp_f32 v125, v125
v_exp_f32 v126, v126
v_exp_f32 v127, v127
v_cvt_pk_bf16_f32 v78, v124, v125
v_cvt_pk_bf16_f32 v79, v126, v127
mvavs 252,188,92
s_barrier
mvaaz 112,128,32
rqa 176,0,53248
s_add_u32 m0, s8, 16384
mvaas 112,132,36
rqa 180,0,54272
mvaas 112,136,40
rqa 184,0,55296
mvaas 112,140,44
rqa 188,0,56320
mvaaz 116,144,32
rqa 160,0,49152
mvaas 116,148,36
rqa 164,0,50176
v_mov_b32 v27, 2
mvaas 116,152,40
rqa 168,0,51200
v_fmac_f32 v112, s22, v44
mvaas 116,156,44
rqa 172,0,52224
v_fmac_f32 v113, s22, v45
mvaaz 120,128,48
buffer_store_dword v27, off, s[64:67], s19 sc1
mvaas 120,132,52
buffer_load_dwordx4 v2, s[72:75], s10 offen offset:0 sc1 lds
mvaas 120,136,56
v_fmac_f32 v114, s22, v46
v_fmac_f32 v115, s22, v47
mvaas 120,140,60
v_exp_f32 v112, v112
mvaaz 124,144,48
buffer_load_dwordx4 v2, s[72:75], s10 offen offset:1024 sc1 lds
mvaas 124,148,52
v_exp_f32 v113, v113
mvaas 124,152,56
v_exp_f32 v114, v114
mvaas 124,156,60
s_waitcnt lgkmcnt(3)
v_exp_f32 v115, v115
mvavs 192,176,64
buffer_load_dwordx4 v2, s[72:75], s10 offen offset:2048 sc1 lds
mvavs 208,180,64
v_cvt_pk_bf16_f32 v88, v112, v113
v_cvt_pk_bf16_f32 v89, v114, v115
mvavs 224,184,64
rqa 128,0,32768
v_fmac_f32 v116, s23, v44
mvavs 240,188,64
buffer_load_dwordx4 v2, s[72:75], s10 offen offset:3072 sc1 lds
mvavs 196,176,68
s_add_u32 s10, s10, 32768
rqa 132,0,33792
v_fmac_f32 v117, s23, v45
mvavs 212,180,68
s_cmp_eq_u32 s10, s12
v_exp_f32 v116, v116
mvavs 228,184,68
s_cselect_b32 s10, 16384, s10
v_fmac_f32 v118, s23, v46
s_add_u32 m0, s8, 0
mvavs 244,188,68
buffer_load_dwordx4 v1, s[68:71], s10 offen offset:0 sc1 lds
v_smfmac_f32_16x16x64_bf16 v[32:35], a[192:195], v[64:71], v15
v_fmac_f32 v119, s23, v47
mvavs 128,160,64
s_waitcnt lgkmcnt(2)
rqa 136,0,36864
v_exp_f32 v117, v117
mvavs 144,164,64
buffer_load_dwordx4 v1, s[68:71], s10 offen offset:1024 sc1 lds
mvavs 160,168,64
v_exp_f32 v118, v118
mvavs 176,172,64
rqa 140,0,37888
v_exp_f32 v119, v119
v_cvt_pk_bf16_f32 v192, v192, v193
mvavs 132,160,68
v_cvt_pk_bf16_f32 v193, v194, v195
v_cvt_pk_bf16_f32 v90, v116, v117
mvavs 148,164,68
buffer_load_dwordx4 v1, s[68:71], s10 offen offset:2048 sc1 lds
v_cvt_pk_bf16_f32 v91, v118, v119
v_cvt_pk_bf16_f32 v194, v208, v209
mvavs 164,168,68
rqa 144,0,34816
v_fmac_f32 v120, s24, v44
v_fmac_f32 v121, s24, v45
v_fmac_f32 v122, s24, v46
v_fmac_f32 v123, s24, v47
v_cvt_pk_bf16_f32 v195, v210, v211
mvavs 180,172,68
v_exp_f32 v120, v120
v_smfmac_f32_16x16x64_bf16 v[36:39], a[192:195], v[72:79], v15
v_cvt_pk_bf16_f32 v224, v224, v225
mvavs 136,160,72
buffer_load_dwordx4 v1, s[68:71], s10 offen offset:3072 sc1 lds
ds_write_b128 v7, v[192:195] offset:0
rqa 148,0,35840
v_exp_f32 v121, v121
v_cvt_pk_bf16_f32 v225, v226, v227
mvavs 152,164,72
v_exp_f32 v122, v122
v_exp_f32 v123, v123
v_cvt_pk_bf16_f32 v226, v240, v241
mvavs 168,168,72
s_waitcnt vmcnt(17)
v_cmp_gt_u32 vcc, 1, v20
v_cvt_pk_bf16_f32 v227, v242, v243
mvavs 184,172,72
s_cbranch_vccnz PH_spin
PH_ok:
rqa 152,0,38912
v_lshrrev_b32 v22, 2, v22
v_and_b32 v22, 60, v22
mvavs 200,176,72
s_sub_u32 s81, 15, s31
s_lshl3_add_u32 s81, s81, s32
s_lshl_b32 s81, s81, 6
s_add_u32 s81, s81, 75497472
v_cvt_pk_bf16_f32 v196, v196, v197
mvavs 216,180,72
buffer_load_dword a196, v22, s[64:67], s81 offen offset:0 sc1
buffer_load_dword a197, v22, s[64:67], s81 offen offset:128 sc1
v_cvt_pk_bf16_f32 v92, v120, v121
v_cvt_pk_bf16_f32 v93, v122, v123
v_cvt_pk_bf16_f32 v197, v198, v199
mvavs 232,184,72
ds_write_b128 v7, v[224:227] offset:1024
rqa 156,0,39936
v_cvt_pk_bf16_f32 v198, v212, v213
mvavs 248,188,72
buffer_load_dword a198, v22, s[64:67], s81 offen offset:256 sc1
buffer_load_dword a199, v22, s[64:67], s81 offen offset:384 sc1
v_fmac_f32 v124, s25, v44
v_fmac_f32 v125, s25, v45
v_cvt_pk_bf16_f32 v199, v214, v215
mvavs 140,160,76
s_lshl3_add_u32 s81, s31, s32
v_fmac_f32 v126, s25, v46
v_fmac_f32 v127, s25, v47
mvavs 156,164,76
s_lshl_b32 s81, s81, 6
v_cvt_pk_bf16_f32 v228, v228, v229
s_add_u32 s81, s81, 75497472
mvavs 172,168,76
v_cvt_pk_bf16_f32 v229, v230, v231
v_cvt_pk_bf16_f32 v230, v244, v245
mvavs 188,172,76
buffer_load_dword a200, v22, s[64:67], s81 offen offset:0 sc1
buffer_load_dword a201, v22, s[64:67], s81 offen offset:128 sc1
v_exp_f32 v124, v124
v_exp_f32 v125, v125
mvavs 204,176,76
v_cvt_pk_bf16_f32 v231, v246, v247
v_cvt_pk_bf16_f32 v94, v124, v125
mvavs 220,180,76
buffer_load_dword a202, v22, s[64:67], s81 offen offset:256 sc1
buffer_load_dword a203, v22, s[64:67], s81 offen offset:384 sc1
v_exp_f32 v126, v126
mvavs 236,184,76
ds_write_b128 v7, v[196:199] offset:2048
ds_write_b128 v7, v[228:231] offset:3072
v_exp_f32 v127, v127
s_nop 0
v_cvt_pk_bf16_f32 v95, v126, v127
v_xor_b32 v0, 0x10000, v0
s_waitcnt lgkmcnt(0)
mvavs 252,188,76
s_barrier
s_cmp_eq_u32 s31, 0
s_cbranch_scc1 L_B_om1
v_smfmac_f32_16x16x64_bf16 v[36:39], a[192:195], v[88:95], v15
s_mul_i32 s59, s94, 24576
s_add_u32 s59, s59, 540672
rqa 176,0,20480
mvaaz 96,128,64
s_add_u32 s59, s59, s84
rqa 180,0,21504
s_mov_b32 s70, s16
mvaas 96,132,68
s_mov_b32 s74, s16
rqa 184,0,22528
s_add_u32 m0, s8, 49152
mvaas 96,136,72
buffer_load_dwordx4 a[208:211], v5, s[64:67], s59 offen offset:0 sc1
mvaas 96,140,76
rqa 188,0,23552
mvaaz 100,144,64
rqa 160,0,16384
v_add_f32 v32, v32, v33
mvaas 100,148,68
rqa 164,0,17408
v_add_f32 v33, v34, v35
mvaas 100,152,72
rqa 168,0,18432
v_add_f32 v34, v36, v37
mvaas 100,156,76
buffer_load_dwordx4 a[212:215], v5, s[64:67], s59 offen offset:1024 sc1
mvaaz 104,128,80
rqa 172,0,19456
rqv 224,30,0
mvaas 104,132,84
v_exp_f32 v96, v96
mvaas 104,136,88
rqv 240,30,1024
v_exp_f32 v97, v97
mvaas 104,140,92
rqv 228,30,2048
v_exp_f32 v98, v98
mvaaz 108,144,80
buffer_load_dwordx4 a[216:219], v6, s[64:67], s59 offen offset:0 sc1
rqv 244,30,3072
v_exp_f32 v99, v99
mvaas 108,148,84
buffer_load_dwordx4 v2, s[72:75], s9 offen offset:0 sc1 lds
v_cvt_pk_bf16_f32 v64, v96, v97
v_cvt_pk_bf16_f32 v65, v98, v99
mvaas 108,152,88
v_add_f32 v35, v38, v39
mvaas 108,156,92
s_waitcnt lgkmcnt(5)
v_exp_f32 v100, v100
mvavs 200,176,88
buffer_load_dwordx4 v2, s[72:75], s9 offen offset:1024 sc1 lds
v_exp_f32 v101, v101
mvavs 216,180,88
buffer_load_dwordx4 a[220:223], v6, s[64:67], s59 offen offset:1024 sc1
v_exp_f32 v102, v102
mvavs 232,184,88
s_add_u32 s59, s59, 4096
v_exp_f32 v103, v103
mvavs 248,188,88
buffer_load_dwordx4 v2, s[72:75], s9 offen offset:2048 sc1 lds
v_cvt_pk_bf16_f32 v66, v100, v101
v_cvt_pk_bf16_f32 v67, v102, v103
mvavs 204,176,92
ds_write_b128 v30, v[32:35]
mvavs 220,180,92
buffer_load_dwordx4 a[224:227], v5, s[64:67], s59 offen offset:0 sc1
v_exp_f32 v104, v104
mvavs 236,184,92
buffer_load_dwordx4 v2, s[72:75], s9 offen offset:3072 sc1 lds
v_exp_f32 v105, v105
mvavs 252,188,92
s_add_u32 s9, s9, 32768
v_exp_f32 v106, v106
mvaaz 112,128,96
s_cmp_eq_u32 s9, s11
v_exp_f32 v107, v107
mvaas 112,132,100
s_cselect_b32 s9, 0, s9
v_cvt_pk_bf16_f32 v68, v104, v105
v_cvt_pk_bf16_f32 v69, v106, v107
mvaas 112,136,104
buffer_load_dwordx4 a[228:231], v5, s[64:67], s59 offen offset:1024 sc1
mvaas 112,140,108
s_add_u32 m0, s8, 32768
v_exp_f32 v108, v108
mvaaz 116,144,96
v_cvt_pk_bf16_f32 v200, v200, v201
v_exp_f32 v109, v109
mvaas 116,148,100
v_cvt_pk_bf16_f32 v201, v202, v203
v_exp_f32 v110, v110
mvaas 116,152,104
buffer_load_dwordx4 a[232:235], v6, s[64:67], s59 offen offset:0 sc1
v_cvt_pk_bf16_f32 v202, v216, v217
v_exp_f32 v111, v111
mvaas 116,156,108
buffer_load_dwordx4 v1, s[68:71], s9 offen offset:0 sc1 lds
v_cvt_pk_bf16_f32 v70, v108, v109
v_cvt_pk_bf16_f32 v71, v110, v111
mvaaz 120,128,112
v_cvt_pk_bf16_f32 v203, v218, v219
v_cvt_pk_bf16_f32 v232, v232, v233
mvaas 120,132,116
v_exp_f32 v112, v112
mvaas 120,136,120
buffer_load_dwordx4 v1, s[68:71], s9 offen offset:1024 sc1 lds
buffer_load_dwordx4 a[236:239], v6, s[64:67], s59 offen offset:1024 sc1
v_exp_f32 v113, v113
mvaas 120,140,124
s_lshl_b32 s59, s94, 12
v_exp_f32 v114, v114
mvaaz 124,144,112
s_add_u32 s59, s59, 720896
v_cvt_pk_bf16_f32 v233, v234, v235
v_exp_f32 v115, v115
mvaas 124,148,116
buffer_load_dwordx4 v1, s[68:71], s9 offen offset:2048 sc1 lds
v_cvt_pk_bf16_f32 v234, v248, v249
v_cvt_pk_bf16_f32 v72, v112, v113
v_cvt_pk_bf16_f32 v73, v114, v115
mvaas 124,152,120
s_cmp_ge_u32 s94, 6
s_cselect_b32 s59, 268435456, s59
s_add_u32 s59, s59, s84
v_cvt_pk_bf16_f32 v235, v250, v251
mvaas 124,156,124
buffer_load_dwordx4 a[240:243], v5, s[64:67], s59 offen offset:0 sc1
ds_write_b128 v7, v[200:203] offset:4096
v_exp_f32 v116, v116
mvavs 136,160,88
buffer_load_dwordx4 v1, s[68:71], s9 offen offset:3072 sc1 lds
v_exp_f32 v117, v117
mvavs 152,164,88
s_xor_b32 s8, s8, 0x10000
v_cvt_pk_bf16_f32 v204, v204, v205
v_exp_f32 v118, v118
mvavs 168,168,88
s_waitcnt lgkmcnt(1)
ds_write_b128 v7, v[232:235] offset:5120
rqa 128,0,0
v_cvt_pk_bf16_f32 v205, v206, v207
v_exp_f32 v119, v119
mvavs 184,172,88
buffer_load_dwordx4 a[244:247], v5, s[64:67], s59 offen offset:1024 sc1
rqa 132,0,1024
v_cvt_pk_bf16_f32 v74, v116, v117
v_cvt_pk_bf16_f32 v75, v118, v119
mvavs 140,160,92
rqa 136,0,4096
v_cvt_pk_bf16_f32 v206, v220, v221
mvavs 156,164,92
rqa 140,0,5120
v_cvt_pk_bf16_f32 v207, v222, v223
v_exp_f32 v120, v120
mvavs 172,168,92
v_exp_f32 v121, v121
mvavs 188,172,92
ds_write_b128 v7, v[204:207] offset:6144
rqa 144,0,2048
v_exp_f32 v122, v122
mvvvs 128,60,224
buffer_load_dwordx4 a[248:251], v6, s[64:67], s59 offen offset:0 sc1
rqa 148,0,3072
v_cvt_pk_bf16_f32 v236, v236, v237
v_exp_f32 v123, v123
mvvvs 144,56,224
rqa 152,0,6144
v_cvt_pk_bf16_f32 v237, v238, v239
v_cvt_pk_bf16_f32 v76, v120, v121
v_cvt_pk_bf16_f32 v77, v122, v123
mvvvs 160,60,240
rqa 156,0,7168
v_cvt_pk_bf16_f32 v238, v252, v253
mvvvs 176,56,240
v_exp_f32 v124, v124
mvvvs 132,60,228
buffer_load_dwordx4 a[252:255], v6, s[64:67], s59 offen offset:1024 sc1
v_cvt_pk_bf16_f32 v239, v254, v255
v_exp_f32 v125, v125
mvvvs 148,56,228
v_exp_f32 v126, v126
mvvvs 164,60,244
ds_write_b128 v7, v[236:239] offset:7168
v_exp_f32 v127, v127
v_cvt_pk_bf16_f32 v78, v124, v125
v_cvt_pk_bf16_f32 v79, v126, v127
s_waitcnt vmcnt(37) lgkmcnt(0)
mvvvs 180,56,244
s_barrier
ds_read_b128 v[36:39], v7
mvaaz 96,128,64
s_add_u32 m0, s8, 16384
rqv 232,30,4096
rqv 248,30,5120
mvaas 96,132,68
rqv 236,30,6144
rqv 252,30,7168
mvaas 96,136,72
mvaas 96,140,76
mvaaz 100,144,64
mvaas 100,148,68
s_waitcnt lgkmcnt(4)
v_add_f32 v36, v36, v32
v_add_f32 v37, v37, v33
v_add_f32 v38, v38, v34
mvaas 100,152,72
v_add_f32 v39, v39, v35
v_max3_u32 v32, v36, v37, v38
mvaas 100,156,76
v_min3_u32 v33, v36, v37, v38
v_max_u32 v32, v32, v39
v_min_u32 v33, v33, v39
v_cmp_lt_u32 s[4:5], s15, v32
v_cmp_gt_u32 vcc, s14, v33
s_nop 0
s_or_b64 vcc, vcc, s[4:5]
s_cbranch_vccnz FBa_spin
FBa_ok:
s_waitcnt vmcnt(25) lgkmcnt(2)
mvvvs 136,60,232
s_add_u32 s87, s83, 0
v_accvgpr_read_b32 v32, a196
v_accvgpr_read_b32 v33, a197
mvvvs 152,56,232
s_mul_i32 s59, s94, 24576
rqa 160,0,49152
v_accvgpr_read_b32 v34, a198
mvvvs 168,60,248
s_add_u32 s59, s59, 524288
rqa 164,0,50176
s_waitcnt vmcnt(24) lgkmcnt(2)
v_accvgpr_read_b32 v35, a199
mvvvs 184,56,248
s_add_u32 s59, s59, s84
v_rcp_f32 v36, v36
v_rcp_f32 v37, v37
mvvvs 140,60,236
v_rcp_f32 v38, v38
v_rcp_f32 v39, v39
v_mul_f32 v36, v36, v32
rqa 168,0,51200
v_mul_f32 v37, v37, v33
v_pk_mul_f32 v[128:129], v[128:129], v[36:37] op_sel:[0,0] op_sel_hi:[1,0]
v_pk_mul_f32 v[130:131], v[130:131], v[36:37] op_sel:[0,0] op_sel_hi:[1,0]
v_pk_mul_f32 v[144:145], v[144:145], v[36:37] op_sel:[0,0] op_sel_hi:[1,0]
v_pk_mul_f32 v[146:147], v[146:147], v[36:37] op_sel:[0,0] op_sel_hi:[1,0]
v_pk_mul_f32 v[160:161], v[160:161], v[36:37] op_sel:[0,0] op_sel_hi:[1,0]
v_pk_mul_f32 v[162:163], v[162:163], v[36:37] op_sel:[0,0] op_sel_hi:[1,0]
v_pk_mul_f32 v[176:177], v[176:177], v[36:37] op_sel:[0,0] op_sel_hi:[1,0]
v_pk_mul_f32 v[178:179], v[178:179], v[36:37] op_sel:[0,0] op_sel_hi:[1,0]
mvvvs 156,56,236
buffer_load_dwordx4 v2, s[72:75], s10 offen offset:0 sc1 lds
rqa 172,0,52224
v_mul_f32 v38, v38, v34
v_mul_f32 v39, v39, v35
mvvvs 172,60,252
rqa 176,0,53248
v_cvt_pk_bf16_f32 v128, v128, v129
mvvvs 188,56,252
rqa 180,0,54272
v_cvt_pk_bf16_f32 v129, v130, v131
mvaaz 104,128,80
rqa 184,0,55296
v_cvt_pk_bf16_f32 v130, v144, v145
mvaas 104,132,84
buffer_load_dwordx4 v2, s[72:75], s10 offen offset:1024 sc1 lds
rqa 188,0,56320
v_exp_f32 v96, v96
v_exp_f32 v97, v97
mvaas 104,136,88
v_cvt_pk_bf16_f32 v131, v146, v147
v_exp_f32 v98, v98
mvaas 104,140,92
v_exp_f32 v99, v99
mvaaz 108,144,80
buffer_store_dwordx4 v[128:131], v5, s[64:67], s87 offen offset:0 sc1
v_cvt_pk_bf16_f32 v160, v160, v161
v_cvt_pk_bf16_f32 v80, v96, v97
v_cvt_pk_bf16_f32 v81, v98, v99
mvaas 108,148,84
s_add_u32 s87, s83, 4096
v_cvt_pk_bf16_f32 v161, v162, v163
v_cvt_pk_bf16_f32 v162, v176, v177
mvaas 108,152,88
buffer_load_dwordx4 v2, s[72:75], s10 offen offset:2048 sc1 lds
buffer_load_dwordx4 a[0:3], v5, s[64:67], s59 offen offset:0 sc1
v_exp_f32 v100, v100
v_pk_mul_f32 v[132:133], v[132:133], v[36:37] op_sel:[0,1] op_sel_hi:[1,1]
v_pk_mul_f32 v[134:135], v[134:135], v[36:37] op_sel:[0,1] op_sel_hi:[1,1]
v_pk_mul_f32 v[148:149], v[148:149], v[36:37] op_sel:[0,1] op_sel_hi:[1,1]
v_pk_mul_f32 v[150:151], v[150:151], v[36:37] op_sel:[0,1] op_sel_hi:[1,1]
v_pk_mul_f32 v[164:165], v[164:165], v[36:37] op_sel:[0,1] op_sel_hi:[1,1]
v_pk_mul_f32 v[166:167], v[166:167], v[36:37] op_sel:[0,1] op_sel_hi:[1,1]
v_pk_mul_f32 v[180:181], v[180:181], v[36:37] op_sel:[0,1] op_sel_hi:[1,1]
v_pk_mul_f32 v[182:183], v[182:183], v[36:37] op_sel:[0,1] op_sel_hi:[1,1]
mvaas 108,156,92
v_cvt_pk_bf16_f32 v163, v178, v179
v_exp_f32 v101, v101
mvaaz 112,128,96
buffer_store_dwordx4 v[160:163], v5, s[64:67], s87 offen offset:0 sc1
buffer_load_dwordx4 a[4:7], v5, s[64:67], s59 offen offset:1024 sc1
v_cvt_pk_bf16_f32 v132, v132, v133
mvaas 112,132,100
v_cvt_pk_bf16_f32 v133, v134, v135
v_cvt_pk_bf16_f32 v134, v148, v149
mvaas 112,136,104
buffer_load_dwordx4 v2, s[72:75], s10 offen offset:3072 sc1 lds
v_exp_f32 v102, v102
mvaas 112,140,108
s_add_u32 s10, s10, 32768
v_cvt_pk_bf16_f32 v135, v150, v151
s_cmp_eq_u32 s10, s12
mvaaz 116,144,96
buffer_load_dwordx4 a[8:11], v6, s[64:67], s59 offen offset:0 sc1
mvaas 116,148,100
s_cselect_b32 s10, 16384, s10
s_add_u32 s87, s83, 0
s_add_u32 m0, s8, 0
mvaas 116,152,104
buffer_store_dwordx4 v[132:135], v5, s[64:67], s87 offen offset:2048 sc1
buffer_load_dwordx4 v1, s[68:71], s10 offen offset:0 sc1 lds
v_cvt_pk_bf16_f32 v164, v164, v165
mvaas 116,156,108
buffer_load_dwordx4 a[12:15], v6, s[64:67], s59 offen offset:1024 sc1
v_cvt_pk_bf16_f32 v165, v166, v167
v_exp_f32 v103, v103
mvaaz 120,128,112
v_cvt_pk_bf16_f32 v166, v180, v181
v_cvt_pk_bf16_f32 v82, v100, v101
v_cvt_pk_bf16_f32 v83, v102, v103
v_pk_mul_f32 v[136:137], v[136:137], v[38:39] op_sel:[0,0] op_sel_hi:[1,0]
v_pk_mul_f32 v[138:139], v[138:139], v[38:39] op_sel:[0,0] op_sel_hi:[1,0]
v_pk_mul_f32 v[152:153], v[152:153], v[38:39] op_sel:[0,0] op_sel_hi:[1,0]
v_pk_mul_f32 v[154:155], v[154:155], v[38:39] op_sel:[0,0] op_sel_hi:[1,0]
v_pk_mul_f32 v[168:169], v[168:169], v[38:39] op_sel:[0,0] op_sel_hi:[1,0]
v_pk_mul_f32 v[170:171], v[170:171], v[38:39] op_sel:[0,0] op_sel_hi:[1,0]
v_pk_mul_f32 v[184:185], v[184:185], v[38:39] op_sel:[0,0] op_sel_hi:[1,0]
v_pk_mul_f32 v[186:187], v[186:187], v[38:39] op_sel:[0,0] op_sel_hi:[1,0]
mvaas 120,132,116
s_add_u32 s87, s83, 4096
v_cvt_pk_bf16_f32 v167, v182, v183
v_exp_f32 v104, v104
v_exp_f32 v105, v105
mvaas 120,136,120
s_add_u32 s59, s59, 4096
v_cvt_pk_bf16_f32 v136, v136, v137
v_cvt_pk_bf16_f32 v137, v138, v139
mvaas 120,140,124
buffer_store_dwordx4 v[164:167], v5, s[64:67], s87 offen offset:2048 sc1
buffer_load_dwordx4 a[16:19], v5, s[64:67], s59 offen offset:0 sc1
v_cvt_pk_bf16_f32 v138, v152, v153
mvaaz 124,144,112
buffer_load_dwordx4 v1, s[68:71], s10 offen offset:1024 sc1 lds
v_exp_f32 v106, v106
mvaas 124,148,116
s_add_u32 s87, s83, 745472
v_cvt_pk_bf16_f32 v139, v154, v155
v_cvt_pk_bf16_f32 v84, v104, v105
mvaas 124,152,120
buffer_load_dwordx4 a[20:23], v5, s[64:67], s59 offen offset:1024 sc1
v_exp_f32 v107, v107
mvaas 124,156,124
s_waitcnt lgkmcnt(0)
v_cvt_pk_bf16_f32 v85, v106, v107
v_cvt_pk_bf16_f32 v168, v168, v169
v_smfmac_f32_16x16x64_bf16 v[48:51], a[192:195], v[64:71], v15
buffer_store_dwordx4 v[136:139], v5, s[64:67], s87 offen offset:0 sc1
buffer_load_dwordx4 v1, s[68:71], s10 offen offset:2048 sc1 lds
v_cvt_pk_bf16_f32 v169, v170, v171
mvavz 128,160,64
buffer_load_dwordx4 a[24:27], v6, s[64:67], s59 offen offset:0 sc1
v_exp_f32 v108, v108
mvavz 144,164,64
v_cvt_pk_bf16_f32 v170, v184, v185
v_exp_f32 v109, v109
v_pk_mul_f32 v[140:141], v[140:141], v[38:39] op_sel:[0,1] op_sel_hi:[1,1]
v_pk_mul_f32 v[142:143], v[142:143], v[38:39] op_sel:[0,1] op_sel_hi:[1,1]
v_pk_mul_f32 v[156:157], v[156:157], v[38:39] op_sel:[0,1] op_sel_hi:[1,1]
v_pk_mul_f32 v[158:159], v[158:159], v[38:39] op_sel:[0,1] op_sel_hi:[1,1]
v_pk_mul_f32 v[172:173], v[172:173], v[38:39] op_sel:[0,1] op_sel_hi:[1,1]
v_pk_mul_f32 v[174:175], v[174:175], v[38:39] op_sel:[0,1] op_sel_hi:[1,1]
v_pk_mul_f32 v[188:189], v[188:189], v[38:39] op_sel:[0,1] op_sel_hi:[1,1]
v_pk_mul_f32 v[190:191], v[190:191], v[38:39] op_sel:[0,1] op_sel_hi:[1,1]
mvavz 160,168,64
s_add_u32 s87, s83, 749568
rqa 128,0,32768
v_cvt_pk_bf16_f32 v171, v186, v187
v_exp_f32 v110, v110
mvavz 176,172,64
buffer_store_dwordx4 v[168:171], v5, s[64:67], s87 offen offset:0 sc1
buffer_load_dwordx4 a[28:31], v6, s[64:67], s59 offen offset:1024 sc1
v_cvt_pk_bf16_f32 v140, v140, v141
mvavz 192,176,64
s_add_u32 s59, s59, 4096
v_exp_f32 v111, v111
mvavz 208,180,64
s_add_u32 s87, s83, 745472
rqa 132,0,33792
v_cvt_pk_bf16_f32 v141, v142, v143
mvavz 224,184,64
buffer_load_dwordx4 v1, s[68:71], s10 offen offset:3072 sc1 lds
v_cvt_pk_bf16_f32 v142, v156, v157
mvavz 240,188,64
buffer_load_dwordx4 a[32:35], v5, s[64:67], s59 offen offset:0 sc1
v_cvt_pk_bf16_f32 v143, v158, v159
v_cvt_pk_bf16_f32 v86, v108, v109
v_cvt_pk_bf16_f32 v87, v110, v111
mvavz 132,160,68
rqa 136,0,36864
v_exp_f32 v112, v112
v_exp_f32 v113, v113
mvavz 148,164,68
buffer_store_dwordx4 v[140:143], v5, s[64:67], s87 offen offset:2048 sc1
buffer_load_dwordx4 a[36:39], v5, s[64:67], s59 offen offset:1024 sc1
v_cvt_pk_bf16_f32 v172, v172, v173
mvavz 164,168,68
s_add_u32 s87, s83, 749568
v_cvt_pk_bf16_f32 v173, v174, v175
v_exp_f32 v114, v114
mvavz 180,172,68
rqa 140,0,37888
v_cvt_pk_bf16_f32 v174, v188, v189
v_exp_f32 v115, v115
mvavz 196,176,68
v_cvt_pk_bf16_f32 v175, v190, v191
v_cvt_pk_bf16_f32 v88, v112, v113
v_cvt_pk_bf16_f32 v89, v114, v115
mvavz 212,180,68
buffer_store_dwordx4 v[172:175], v5, s[64:67], s87 offen offset:2048 sc1
buffer_load_dwordx4 a[40:43], v6, s[64:67], s59 offen offset:0 sc1
rqa 144,0,34816
mvavz 228,184,68
v_exp_f32 v116, v116
mvavz 244,188,68
v_exp_f32 v117, v117
v_smfmac_f32_16x16x64_bf16 v[52:55], a[192:195], v[72:79], v15
buffer_load_dwordx4 a[44:47], v6, s[64:67], s59 offen offset:1024 sc1
mvavz 136,160,72
s_add_u32 s59, s59, 4096
rqa 148,0,35840
v_exp_f32 v118, v118
mvavz 152,164,72
v_exp_f32 v119, v119
mvavz 168,168,72
buffer_load_dwordx4 a[48:51], v5, s[64:67], s59 offen offset:0 sc1
mvavz 184,172,72
s_sub_u32 s13, s31, 2
rqa 152,0,38912
v_cvt_pk_bf16_f32 v90, v116, v117
v_cvt_pk_bf16_f32 v91, v118, v119
mvavz 200,176,72
s_cmp_eq_u32 s31, 1
v_exp_f32 v120, v120
v_exp_f32 v121, v121
mvavz 216,180,72
buffer_load_dwordx4 a[52:55], v5, s[64:67], s59 offen offset:1024 sc1
mvavz 232,184,72
rqa 156,0,39936
v_exp_f32 v122, v122
mvavz 248,188,72
v_exp_f32 v123, v123
mvavz 140,160,76
v_cvt_pk_bf16_f32 v92, v120, v121
v_cvt_pk_bf16_f32 v93, v122, v123
mvavz 156,164,76
buffer_load_dwordx4 a[56:59], v6, s[64:67], s59 offen offset:0 sc1
mvavz 172,168,76
v_exp_f32 v124, v124
mvavz 188,172,76
v_exp_f32 v125, v125
mvavz 204,176,76
buffer_load_dwordx4 a[60:63], v6, s[64:67], s59 offen offset:1024 sc1
mvavz 220,180,76
s_waitcnt lgkmcnt(0)
v_exp_f32 v126, v126
mvavz 236,184,76
v_exp_f32 v127, v127
v_cvt_pk_bf16_f32 v94, v124, v125
v_cvt_pk_bf16_f32 v95, v126, v127
v_xor_b32 v0, 0x10000, v0
mvavz 252,188,76
s_barrier
mvaaz 96,128,64
s_cbranch_scc1 L_B_tail
s_cmp_eq_u32 s13, 0
s_cbranch_scc1 L_B_peel
L_B_loop:
mvaas 96,132,68
rqa 160,0,16384
s_add_u32 m0, s8, 49152
mvaas 96,136,72
rqa 164,0,17408
mvaas 96,140,76
rqa 168,0,18432
mvaaz 100,144,64
rqa 172,0,19456
mvaas 100,148,68
rqa 176,0,20480
mvaas 100,152,72
rqa 180,0,21504
mvaas 100,156,76
rqa 184,0,22528
mvaaz 104,128,80
rqa 188,0,23552
mvaas 104,132,84
buffer_load_dwordx4 v2, s[72:75], s9 offen offset:0 sc1 lds
mvaas 104,136,88
v_exp_f32 v96, v96
mvaas 104,140,92
v_exp_f32 v97, v97
mvaaz 108,144,80
v_exp_f32 v98, v98
mvaas 108,148,84
buffer_load_dwordx4 v2, s[72:75], s9 offen offset:1024 sc1 lds
mvaas 108,152,88
v_exp_f32 v99, v99
mvaas 108,156,92
v_cvt_pk_bf16_f32 v64, v96, v97
v_cvt_pk_bf16_f32 v65, v98, v99
mvaaz 112,128,96
v_exp_f32 v100, v100
mvaas 112,132,100
buffer_load_dwordx4 v2, s[72:75], s9 offen offset:2048 sc1 lds
mvaas 112,136,104
v_exp_f32 v101, v101
mvaas 112,140,108
v_exp_f32 v102, v102
mvaaz 116,144,96
v_exp_f32 v103, v103
mvaas 116,148,100
buffer_load_dwordx4 v2, s[72:75], s9 offen offset:3072 sc1 lds
mvaas 116,152,104
s_add_u32 s9, s9, 32768
v_cvt_pk_bf16_f32 v66, v100, v101
v_cvt_pk_bf16_f32 v67, v102, v103
mvaas 116,156,108
s_cmp_eq_u32 s9, s11
v_exp_f32 v104, v104
mvaaz 120,128,112
s_cselect_b32 s9, 0, s9
v_exp_f32 v105, v105
mvaas 120,132,116
s_add_u32 m0, s8, 32768
v_exp_f32 v106, v106
mvaas 120,136,120
buffer_load_dwordx4 v1, s[68:71], s9 offen offset:0 sc1 lds
mvaas 120,140,124
v_exp_f32 v107, v107
mvaaz 124,144,112
buffer_load_dwordx4 v1, s[68:71], s9 offen offset:1024 sc1 lds
mvaas 124,148,116
v_cvt_pk_bf16_f32 v68, v104, v105
v_cvt_pk_bf16_f32 v69, v106, v107
mvaas 124,152,120
v_exp_f32 v108, v108
mvaas 124,156,124
s_waitcnt lgkmcnt(0)
v_exp_f32 v109, v109
v_smfmac_f32_16x16x64_bf16 v[48:51], a[192:195], v[80:87], v15
buffer_load_dwordx4 v1, s[68:71], s9 offen offset:2048 sc1 lds
mvavs 128,160,80
s_xor_b32 s8, s8, 0x10000
rqa 128,0,0
v_cvt_pk_bf16_f32 v70, v108, v109
mvavs 144,164,80
v_exp_f32 v110, v110
mvavs 160,168,80
v_exp_f32 v111, v111
mvavs 176,172,80
rqa 132,0,1024
v_cvt_pk_bf16_f32 v71, v110, v111
mvavs 192,176,80
buffer_load_dwordx4 v1, s[68:71], s9 offen offset:3072 sc1 lds
mvavs 208,180,80
v_exp_f32 v112, v112
mvavs 224,184,80
rqa 136,0,4096
mvavs 240,188,80
v_exp_f32 v113, v113
mvavs 132,160,84
rqa 140,0,5120
v_cvt_pk_bf16_f32 v72, v112, v113
mvavs 148,164,84
v_exp_f32 v114, v114
mvavs 164,168,84
v_exp_f32 v115, v115
mvavs 180,172,84
rqa 144,0,2048
v_cvt_pk_bf16_f32 v73, v114, v115
mvavs 196,176,84
v_exp_f32 v116, v116
mvavs 212,180,84
v_exp_f32 v117, v117
mvavs 228,184,84
rqa 148,0,3072
v_cvt_pk_bf16_f32 v74, v116, v117
mvavs 244,188,84
v_exp_f32 v118, v118
v_smfmac_f32_16x16x64_bf16 v[52:55], a[192:195], v[88:95], v15
rqa 152,0,6144
mvavs 136,160,88
v_exp_f32 v119, v119
mvavs 152,164,88
rqa 156,0,7168
v_cvt_pk_bf16_f32 v75, v118, v119
mvavs 168,168,88
v_exp_f32 v120, v120
mvavs 184,172,88
v_exp_f32 v121, v121
mvavs 200,176,88
v_exp_f32 v122, v122
mvavs 216,180,88
v_exp_f32 v123, v123
mvavs 232,184,88
v_cvt_pk_bf16_f32 v76, v120, v121
v_cvt_pk_bf16_f32 v77, v122, v123
mvavs 248,188,88
v_exp_f32 v124, v124
mvavs 140,160,92
v_exp_f32 v125, v125
mvavs 156,164,92
v_exp_f32 v126, v126
mvavs 172,168,92
v_exp_f32 v127, v127
mvavs 188,172,92
v_cvt_pk_bf16_f32 v78, v124, v125
v_cvt_pk_bf16_f32 v79, v126, v127
mvavs 204,176,92
mvavs 220,180,92
s_waitcnt vmcnt(16) lgkmcnt(0)
mvavs 236,184,92
mvavs 252,188,92
s_barrier
mvaaz 96,128,64
rqa 160,0,49152
s_add_u32 m0, s8, 16384
mvaas 96,132,68
rqa 164,0,50176
mvaas 96,136,72
rqa 168,0,51200
mvaas 96,140,76
rqa 172,0,52224
mvaaz 100,144,64
rqa 176,0,53248
mvaas 100,148,68
rqa 180,0,54272
mvaas 100,152,72
rqa 184,0,55296
mvaas 100,156,76
rqa 188,0,56320
mvaaz 104,128,80
buffer_load_dwordx4 v2, s[72:75], s10 offen offset:0 sc1 lds
mvaas 104,132,84
v_exp_f32 v96, v96
mvaas 104,136,88
v_exp_f32 v97, v97
mvaas 104,140,92
v_exp_f32 v98, v98
mvaaz 108,144,80
buffer_load_dwordx4 v2, s[72:75], s10 offen offset:1024 sc1 lds
mvaas 108,148,84
v_exp_f32 v99, v99
mvaas 108,152,88
v_cvt_pk_bf16_f32 v80, v96, v97
v_cvt_pk_bf16_f32 v81, v98, v99
mvaas 108,156,92
v_exp_f32 v100, v100
mvaaz 112,128,96
buffer_load_dwordx4 v2, s[72:75], s10 offen offset:2048 sc1 lds
mvaas 112,132,100
v_exp_f32 v101, v101
mvaas 112,136,104
v_exp_f32 v102, v102
mvaas 112,140,108
buffer_load_dwordx4 v2, s[72:75], s10 offen offset:3072 sc1 lds
mvaaz 116,144,96
s_add_u32 s10, s10, 32768
v_exp_f32 v103, v103
mvaas 116,148,100
s_cmp_eq_u32 s10, s12
v_cvt_pk_bf16_f32 v82, v100, v101
v_cvt_pk_bf16_f32 v83, v102, v103
mvaas 116,152,104
s_cselect_b32 s10, 16384, s10
v_exp_f32 v104, v104
mvaas 116,156,108
s_add_u32 m0, s8, 0
v_exp_f32 v105, v105
mvaaz 120,128,112
buffer_load_dwordx4 v1, s[68:71], s10 offen offset:0 sc1 lds
mvaas 120,132,116
v_exp_f32 v106, v106
mvaas 120,136,120
v_exp_f32 v107, v107
mvaas 120,140,124
buffer_load_dwordx4 v1, s[68:71], s10 offen offset:1024 sc1 lds
mvaaz 124,144,112
v_cvt_pk_bf16_f32 v84, v104, v105
v_cvt_pk_bf16_f32 v85, v106, v107
mvaas 124,148,116
v_exp_f32 v108, v108
mvaas 124,152,120
v_exp_f32 v109, v109
mvaas 124,156,124
s_waitcnt lgkmcnt(0)
rqa 128,0,32768
v_cvt_pk_bf16_f32 v86, v108, v109
v_smfmac_f32_16x16x64_bf16 v[48:51], a[192:195], v[64:71], v15
buffer_load_dwordx4 v1, s[68:71], s10 offen offset:2048 sc1 lds
mvavs 128,160,64
v_exp_f32 v110, v110
mvavs 144,164,64
v_exp_f32 v111, v111
mvavs 160,168,64
rqa 132,0,33792
v_cvt_pk_bf16_f32 v87, v110, v111
mvavs 176,172,64
buffer_load_dwordx4 v1, s[68:71], s10 offen offset:3072 sc1 lds
mvavs 192,176,64
v_exp_f32 v112, v112
mvavs 208,180,64
v_exp_f32 v113, v113
mvavs 224,184,64
rqa 136,0,36864
v_cvt_pk_bf16_f32 v88, v112, v113
mvavs 240,188,64
v_exp_f32 v114, v114
mvavs 132,160,68
v_exp_f32 v115, v115
mvavs 148,164,68
rqa 140,0,37888
v_cvt_pk_bf16_f32 v89, v114, v115
mvavs 164,168,68
v_exp_f32 v116, v116
mvavs 180,172,68
v_exp_f32 v117, v117
mvavs 196,176,68
rqa 144,0,34816
v_cvt_pk_bf16_f32 v90, v116, v117
mvavs 212,180,68
v_exp_f32 v118, v118
mvavs 228,184,68
v_exp_f32 v119, v119
mvavs 244,188,68
rqa 148,0,35840
v_cvt_pk_bf16_f32 v91, v118, v119
v_smfmac_f32_16x16x64_bf16 v[52:55], a[192:195], v[72:79], v15
rqa 152,0,38912
mvavs 136,160,72
v_exp_f32 v120, v120
mvavs 152,164,72
v_exp_f32 v121, v121
mvavs 168,168,72
rqa 156,0,39936
v_cvt_pk_bf16_f32 v92, v120, v121
mvavs 184,172,72
s_sub_u32 s13, s13, 1
v_exp_f32 v122, v122
mvavs 200,176,72
s_cmp_lg_u32 s13, 0
v_exp_f32 v123, v123
mvavs 216,180,72
v_cvt_pk_bf16_f32 v93, v122, v123
v_xor_b32 v0, 0x10000, v0
mvavs 232,184,72
v_exp_f32 v124, v124
mvavs 248,188,72
v_exp_f32 v125, v125
mvavs 140,160,76
v_exp_f32 v126, v126
mvavs 156,164,76
v_exp_f32 v127, v127
mvavs 172,168,76
v_cvt_pk_bf16_f32 v94, v124, v125
v_cvt_pk_bf16_f32 v95, v126, v127
mvavs 188,172,76
mvavs 204,176,76
mvavs 220,180,76
s_waitcnt vmcnt(16) lgkmcnt(0)
mvavs 236,184,76
mvavs 252,188,76
s_barrier
mvaaz 96,128,64
s_cbranch_scc1 L_B_loop
L_B_peel:
mvaas 96,132,68
rqa 160,0,16384
s_add_u32 m0, s8, 49152
mvaas 96,136,72
rqa 164,0,17408
mvaas 96,140,76
buffer_load_dwordx4 v2, s[72:75], s9 offen offset:0 sc1 lds
mvaaz 100,144,64
rqa 168,0,18432
mvaas 100,148,68
rqa 172,0,19456
v_and_b32 v23, 0x3ff, v0
mvaas 100,152,72
rqa 176,0,20480
v_min_u32 v23, 848, v23
mvaas 100,156,76
s_xor_b32 s8, s8, 0x10000
rqa 180,0,21504
v_lshlrev_b32 v23, 3, v23
mvaaz 104,128,80
buffer_load_dwordx4 v2, s[72:75], s9 offen offset:1024 sc1 lds
mvaas 104,132,84
s_lshl2_add_u32 s17, s95, s80
rqa 184,0,22528
rqa 188,0,23552
mvaas 104,136,88
s_mul_i32 s17, s17, 6912
v_exp_f32 v96, v96
mvaas 104,140,92
buffer_load_dwordx4 v2, s[72:75], s9 offen offset:2048 sc1 lds
mvaaz 108,144,80
s_mul_i32 s18, s94, 655360
v_exp_f32 v97, v97
mvaas 108,148,84
s_add_u32 s17, s17, s18
v_exp_f32 v98, v98
mvaas 108,152,88
s_sub_u32 s17, s17, 221184
v_exp_f32 v99, v99
mvaas 108,156,92
buffer_load_dwordx4 v2, s[72:75], s9 offen offset:3072 sc1 lds
mvaaz 112,128,96
v_cvt_pk_bf16_f32 v64, v96, v97
v_cvt_pk_bf16_f32 v65, v98, v99
mvaas 112,132,100
v_exp_f32 v100, v100
mvaas 112,136,104
v_exp_f32 v101, v101
mvaas 112,140,108
buffer_load_dword v24, v23, s[44:47], s17 offen
mvaaz 116,144,96
v_exp_f32 v102, v102
mvaas 116,148,100
v_exp_f32 v103, v103
mvaas 116,152,104
v_cvt_pk_bf16_f32 v66, v100, v101
v_cvt_pk_bf16_f32 v67, v102, v103
mvaas 116,156,108
v_exp_f32 v104, v104
mvaaz 120,128,112
v_exp_f32 v105, v105
mvaas 120,132,116
v_exp_f32 v106, v106
mvaas 120,136,120
v_exp_f32 v107, v107
mvaas 120,140,124
v_cvt_pk_bf16_f32 v68, v104, v105
v_cvt_pk_bf16_f32 v69, v106, v107
mvaaz 124,144,112
v_exp_f32 v108, v108
mvaas 124,148,116
v_exp_f32 v109, v109
mvaas 124,152,120
rqa 128,0,0
v_cvt_pk_bf16_f32 v70, v108, v109
mvaas 124,156,124
v_exp_f32 v110, v110
v_smfmac_f32_16x16x64_bf16 v[48:51], a[192:195], v[80:87], v15
s_waitcnt lgkmcnt(1)
mvavs 128,160,80
v_exp_f32 v111, v111
mvavs 144,164,80
rqa 132,0,1024
v_cvt_pk_bf16_f32 v71, v110, v111
mvavs 160,168,80
v_exp_f32 v112, v112
mvavs 176,172,80
v_exp_f32 v113, v113
mvavs 192,176,80
rqa 136,0,4096
v_cvt_pk_bf16_f32 v72, v112, v113
mvavs 208,180,80
v_exp_f32 v114, v114
mvavs 224,184,80
v_exp_f32 v115, v115
mvavs 240,188,80
rqa 140,0,5120
v_cvt_pk_bf16_f32 v73, v114, v115
mvavs 132,160,84
v_exp_f32 v116, v116
mvavs 148,164,84
v_exp_f32 v117, v117
mvavs 164,168,84
rqa 144,0,2048
v_cvt_pk_bf16_f32 v74, v116, v117
mvavs 180,172,84
v_exp_f32 v118, v118
mvavs 196,176,84
v_exp_f32 v119, v119
mvavs 212,180,84
rqa 148,0,3072
v_cvt_pk_bf16_f32 v75, v118, v119
mvavs 228,184,84
v_exp_f32 v120, v120
mvavs 244,188,84
v_exp_f32 v121, v121
v_smfmac_f32_16x16x64_bf16 v[52:55], a[192:195], v[88:95], v15
rqa 152,0,6144
mvavs 136,160,88
v_exp_f32 v122, v122
mvavs 152,164,88
rqa 156,0,7168
v_cvt_pk_bf16_f32 v76, v120, v121
mvavs 168,168,88
v_exp_f32 v123, v123
mvavs 184,172,88
v_exp_f32 v124, v124
mvavs 200,176,88
v_exp_f32 v125, v125
mvavs 216,180,88
v_cvt_pk_bf16_f32 v77, v122, v123
v_cvt_pk_bf16_f32 v78, v124, v125
mvavs 232,184,88
v_exp_f32 v126, v126
mvavs 248,188,88
v_exp_f32 v127, v127
mvavs 140,160,92
v_cvt_pk_bf16_f32 v79, v126, v127
mvavs 156,164,92
mvavs 172,168,92
mvavs 188,172,92
mvavs 204,176,92
mvavs 220,180,92
s_waitcnt vmcnt(13) lgkmcnt(0)
mvavs 236,184,92
mvavs 252,188,92
s_barrier
mvaaz 96,128,64
rqa 160,0,49152
s_add_u32 m0, s8, 16384
mvaas 96,132,68
rqa 164,0,50176
mvaas 96,136,72
rqa 168,0,51200
mvaas 96,140,76
rqa 172,0,52224
mvaaz 100,144,64
rqa 176,0,53248
mvaas 100,148,68
rqa 180,0,54272
mvaas 100,152,72
rqa 184,0,55296
mvaas 100,156,76
rqa 188,0,56320
mvaaz 104,128,80
v_exp_f32 v96, v96
mvaas 104,132,84
buffer_load_dwordx4 v2, s[72:75], s10 offen offset:0 sc1 lds
mvaas 104,136,88
v_exp_f32 v97, v97
mvaas 104,140,92
v_exp_f32 v98, v98
mvaaz 108,144,80
v_exp_f32 v99, v99
mvaas 108,148,84
buffer_load_dwordx4 v2, s[72:75], s10 offen offset:1024 sc1 lds
mvaas 108,152,88
v_cvt_pk_bf16_f32 v80, v96, v97
v_cvt_pk_bf16_f32 v81, v98, v99
mvaas 108,156,92
v_exp_f32 v100, v100
mvaaz 112,128,96
buffer_load_dwordx4 v2, s[72:75], s10 offen offset:2048 sc1 lds
mvaas 112,132,100
v_exp_f32 v101, v101
mvaas 112,136,104
v_exp_f32 v102, v102
mvaas 112,140,108
buffer_load_dwordx4 v2, s[72:75], s10 offen offset:3072 sc1 lds
mvaaz 116,144,96
v_exp_f32 v103, v103
mvaas 116,148,100
v_cvt_pk_bf16_f32 v82, v100, v101
v_cvt_pk_bf16_f32 v83, v102, v103
mvaas 116,152,104
v_exp_f32 v104, v104
mvaas 116,156,108
v_exp_f32 v105, v105
mvaaz 120,128,112
v_exp_f32 v106, v106
mvaas 120,132,116
v_exp_f32 v107, v107
mvaas 120,136,120
v_cvt_pk_bf16_f32 v84, v104, v105
v_cvt_pk_bf16_f32 v85, v106, v107
mvaas 120,140,124
v_exp_f32 v108, v108
mvaaz 124,144,112
v_exp_f32 v109, v109
mvaas 124,148,116
v_exp_f32 v110, v110
mvaas 124,152,120
rqa 128,0,32768
v_cvt_pk_bf16_f32 v86, v108, v109
mvaas 124,156,124
v_exp_f32 v111, v111
v_smfmac_f32_16x16x64_bf16 v[48:51], a[192:195], v[64:71], v15
s_waitcnt lgkmcnt(1)
v_cvt_pk_bf16_f32 v87, v110, v111
mvavs 128,160,64
v_exp_f32 v112, v112
mvavs 144,164,64
v_exp_f32 v113, v113
mvavs 160,168,64
rqa 132,0,33792
v_cvt_pk_bf16_f32 v88, v112, v113
mvavs 176,172,64
v_exp_f32 v114, v114
mvavs 192,176,64
v_exp_f32 v115, v115
mvavs 208,180,64
rqa 136,0,36864
v_cvt_pk_bf16_f32 v89, v114, v115
mvavs 224,184,64
v_exp_f32 v116, v116
mvavs 240,188,64
v_exp_f32 v117, v117
mvavs 132,160,68
rqa 140,0,37888
v_cvt_pk_bf16_f32 v90, v116, v117
mvavs 148,164,68
v_exp_f32 v118, v118
mvavs 164,168,68
v_exp_f32 v119, v119
mvavs 180,172,68
rqa 144,0,34816
v_cvt_pk_bf16_f32 v91, v118, v119
mvavs 196,176,68
v_exp_f32 v120, v120
mvavs 212,180,68
v_exp_f32 v121, v121
mvavs 228,184,68
rqa 148,0,35840
v_cvt_pk_bf16_f32 v92, v120, v121
mvavs 244,188,68
v_exp_f32 v122, v122
v_smfmac_f32_16x16x64_bf16 v[52:55], a[192:195], v[72:79], v15
rqa 152,0,38912
mvavs 136,160,72
v_exp_f32 v123, v123
mvavs 152,164,72
rqa 156,0,39936
v_cvt_pk_bf16_f32 v93, v122, v123
mvavs 168,168,72
v_exp_f32 v124, v124
mvavs 184,172,72
v_exp_f32 v125, v125
mvavs 200,176,72
v_exp_f32 v126, v126
mvavs 216,180,72
v_exp_f32 v127, v127
mvavs 232,184,72
v_cvt_pk_bf16_f32 v94, v124, v125
v_cvt_pk_bf16_f32 v95, v126, v127
mvavs 248,188,72
v_xor_b32 v0, 0x10000, v0
mvavs 140,160,76
mvavs 156,164,76
mvavs 172,168,76
mvavs 188,172,76
mvavs 204,176,76
mvavs 220,180,76
s_waitcnt vmcnt(9) lgkmcnt(0)
mvavs 236,184,76
mvavs 252,188,76
s_barrier
mvaaz 96,128,64
L_B_tail:
mvaas 96,132,68
s_lshl_b32 s5, s80, 4
rqa 160,0,16384
s_lshl_b32 s57, s80, 10
mvaas 96,136,72
rqa 164,0,17408
s_lshl_b32 s61, s80, 11
mvaas 96,140,76
rqa 168,0,18432
mvaaz 100,144,64
rqa 172,0,19456
mvaas 100,148,68
rqa 176,0,20480
v_and_b32 v2, 0x3ff, v0
mvaas 100,152,72
rqa 180,0,21504
v_lshrrev_b32 v1, 7, v2
mvaas 100,156,76
rqa 184,0,22528
v_lshrrev_b32 v28, 6, v2
mvaaz 104,128,80
rqa 188,0,23552
v_fmac_f32 v96, s22, v44
mvaas 104,132,84
s_and_b32 s6, s30, 3
v_fmac_f32 v97, s22, v45
v_fmac_f32 v98, s22, v46
mvaas 104,136,88
s_xor_b32 s62, s61, 8192
v_fmac_f32 v99, s22, v47
v_add_u32 v1, s5, v1
mvaas 104,140,92
v_add_u32 v28, s5, v28
v_mul_u32_u24 v1, 1280, v1
mvaaz 108,144,80
s_xor_b32 s5, s94, 7
v_exp_f32 v96, v96
mvaas 108,148,84
s_lshl_b32 s5, s5, 5
v_exp_f32 v97, v97
mvaas 108,152,88
s_and_b32 s52, s5, 128
v_mul_u32_u24 v28, 1280, v28
v_lshrrev_b32 v20, 3, v2
mvaas 108,156,92
s_add_u32 s53, s52, 10240
v_exp_f32 v98, v98
mvaaz 112,128,96
v_exp_f32 v99, v99
mvaas 112,132,100
v_and_b32 v20, 96, v20
v_xor_b32 v20, v20, v2
mvaas 112,136,104
s_xor_b32 s54, s52, 128
v_cvt_pk_bf16_f32 v64, v96, v97
v_cvt_pk_bf16_f32 v65, v98, v99
mvaas 112,140,108
s_add_u32 s55, s54, 10240
v_fmac_f32 v100, s23, v44
v_fmac_f32 v101, s23, v45
mvaaz 116,144,96
s_min_u32 s60, s94, 5
v_and_b32 v21, 48, v20
v_xor_b32 v20, s5, v20
mvaas 116,148,100
s_lshl_b32 s5, s6, 8
v_fmac_f32 v102, s23, v46
v_fmac_f32 v103, s23, v47
mvaas 116,152,104
s_mul_i32 s60, s60, 40960
v_exp_f32 v100, v100
mvaas 116,156,108
v_exp_f32 v101, v101
mvaaz 120,128,112
v_and_b32 v20, 112, v20
v_add3_u32 v1, v1, v20, s5
mvaas 120,132,116
s_lshl_b32 s5, s6, 6
v_exp_f32 v102, v102
mvaas 120,136,120
s_add_u32 s5, s5, 1024
v_exp_f32 v103, v103
mvaas 120,140,124
v_add3_u32 v28, v28, v21, s5
v_cvt_pk_bf16_f32 v66, v100, v101
mvaaz 124,144,112
s_mul_i32 s58, s94, 245760
v_cvt_pk_bf16_f32 v67, v102, v103
v_fmac_f32 v104, s24, v44
mvaas 124,148,116
s_add_u32 s58, s58, 81920
v_fmac_f32 v105, s24, v45
v_fmac_f32 v106, s24, v46
mvaas 124,152,120
s_add_u32 m0, s61, 102400
rqa 128,0,0
v_fmac_f32 v107, s24, v47
mvaas 124,156,124
s_add_u32 s87, s58, s52
v_exp_f32 v104, v104
v_smfmac_f32_16x16x64_bf16 v[48:51], a[192:195], v[80:87], v15
s_waitcnt lgkmcnt(1)
v_lshrrev_b32 v20, 2, v2
mvavs 128,160,80
v_exp_f32 v105, v105
mvavs 144,164,80
rqa 132,0,1024
v_and_b32 v20, 60, v20
mvavs 160,168,80
v_exp_f32 v106, v106
mvavs 176,172,80
v_exp_f32 v107, v107
mvavs 192,176,80
buffer_load_dwordx4 v1, s[48:51], s87 offen lds
mvavs 208,180,80
s_add_u32 m0, s61, 103424
rqa 136,0,4096
v_cvt_pk_bf16_f32 v68, v104, v105
mvavs 224,184,80
s_add_u32 s87, s58, s53
v_cvt_pk_bf16_f32 v69, v106, v107
v_fmac_f32 v108, s25, v44
mvavs 240,188,80
v_fmac_f32 v109, s25, v45
v_fmac_f32 v110, s25, v46
mvavs 132,160,84
rqa 140,0,5120
v_fmac_f32 v111, s25, v47
mvavs 148,164,84
v_exp_f32 v108, v108
mvavs 164,168,84
buffer_load_dwordx4 v1, s[48:51], s87 offen lds
mvavs 180,172,84
s_add_u32 m0, s62, 102400
v_exp_f32 v109, v109
mvavs 196,176,84
s_add_u32 s87, s58, s54
v_exp_f32 v110, v110
mvavs 212,180,84
rqa 144,0,2048
v_cvt_pk_bf16_f32 v70, v108, v109
mvavs 228,184,84
v_exp_f32 v111, v111
mvavs 244,188,84
rqa 148,0,3072
v_cvt_pk_bf16_f32 v71, v110, v111
v_smfmac_f32_16x16x64_bf16 v[52:55], a[192:195], v[88:95], v15
buffer_load_dwordx4 v1, s[48:51], s87 offen lds
mvavs 136,160,88
s_add_u32 m0, s62, 103424
v_exp_f32 v112, v112
mvavs 152,164,88
s_add_u32 s87, s58, s55
v_exp_f32 v113, v113
mvavs 168,168,88
v_exp_f32 v114, v114
mvavs 184,172,88
rqa 152,0,6144
v_cvt_pk_bf16_f32 v72, v112, v113
mvavs 200,176,88
v_exp_f32 v115, v115
mvavs 216,180,88
v_cvt_pk_bf16_f32 v73, v114, v115
v_exp_f32 v116, v116
mvavs 232,184,88
buffer_load_dwordx4 v1, s[48:51], s87 offen lds
rqa 156,0,7168
mvavs 248,188,88
s_add_u32 m0, s57, 118784
v_exp_f32 v117, v117
mvavs 140,160,92
v_exp_f32 v118, v118
mvavs 156,164,92
v_exp_f32 v119, v119
mvavs 172,168,92
v_cvt_pk_bf16_f32 v74, v116, v117
v_cvt_pk_bf16_f32 v75, v118, v119
mvavs 188,172,92
buffer_load_dwordx4 v28, s[48:51], s58 offen lds
mvavs 204,176,92
v_exp_f32 v120, v120
mvavs 220,180,92
s_waitcnt vmcnt(5) lgkmcnt(0)
v_exp_f32 v121, v121
mvavs 236,184,92
v_exp_f32 v122, v122
v_exp_f32 v123, v123
v_cvt_pk_bf16_f32 v76, v120, v121
v_cvt_pk_bf16_f32 v77, v122, v123
v_exp_f32 v124, v124
v_exp_f32 v125, v125
v_exp_f32 v126, v126
v_exp_f32 v127, v127
v_cvt_pk_bf16_f32 v78, v124, v125
v_cvt_pk_bf16_f32 v79, v126, v127
mvavs 252,188,92
s_barrier
mvaaz 112,128,96
rqa 176,0,53248
mvaas 112,132,100
rqa 180,0,54272
mvaas 112,136,104
rqa 184,0,55296
mvaas 112,140,108
rqa 188,0,56320
mvaaz 116,144,96
rqa 160,0,49152
mvaas 116,148,100
rqa 164,0,50176
v_mov_b32 v27, 3
mvaas 116,152,104
rqa 168,0,51200
v_fmac_f32 v112, s22, v44
mvaas 116,156,108
rqa 172,0,52224
v_fmac_f32 v113, s22, v45
mvaaz 120,128,112
buffer_store_dword v27, off, s[64:67], s19 sc1
mvaas 120,132,116
v_fmac_f32 v114, s22, v46
v_fmac_f32 v115, s22, v47
mvaas 120,136,120
v_exp_f32 v112, v112
mvaas 120,140,124
s_mul_i32 s58, s94, 245760
v_exp_f32 v113, v113
mvaaz 124,144,112
s_add_u32 s58, s58, 0
v_exp_f32 v114, v114
mvaas 124,148,116
s_add_u32 m0, s61, 0
v_exp_f32 v115, v115
mvaas 124,152,120
s_add_u32 s87, s58, s52
v_cvt_pk_bf16_f32 v88, v112, v113
v_cvt_pk_bf16_f32 v89, v114, v115
mvaas 124,156,124
s_waitcnt lgkmcnt(3)
v_fmac_f32 v116, s23, v44
v_fmac_f32 v117, s23, v45
mvavs 192,176,64
v_fmac_f32 v118, s23, v46
v_fmac_f32 v119, s23, v47
mvavs 208,180,64
v_exp_f32 v116, v116
mvavs 224,184,64
v_exp_f32 v117, v117
mvavs 240,188,64
v_exp_f32 v118, v118
mvavs 196,176,68
buffer_load_dwordx4 v1, s[48:51], s87 offen lds
mvavs 212,180,68
s_add_u32 m0, s61, 1024
v_exp_f32 v119, v119
mvavs 228,184,68
s_add_u32 s87, s58, s53
v_cvt_pk_bf16_f32 v90, v116, v117
v_cvt_pk_bf16_f32 v91, v118, v119
mvavs 244,188,68
buffer_load_dwordx4 v1, s[48:51], s87 offen lds
v_smfmac_f32_16x16x64_bf16 v[48:51], a[192:195], v[64:71], v15
s_add_u32 m0, s62, 0
s_add_u32 s87, s58, s54
v_fmac_f32 v120, s24, v44
mvavs 128,160,64
s_waitcnt lgkmcnt(0)
v_fmac_f32 v121, s24, v45
v_cvt_pk_bf16_f32 v192, v192, v193
mvavs 144,164,64
v_fmac_f32 v122, s24, v46
v_fmac_f32 v123, s24, v47
mvavs 160,168,64
v_cvt_pk_bf16_f32 v193, v194, v195
v_cvt_pk_bf16_f32 v194, v208, v209
mvavs 176,172,64
buffer_load_dwordx4 v1, s[48:51], s87 offen lds
mvavs 132,160,68
s_add_u32 m0, s62, 1024
v_exp_f32 v120, v120
mvavs 148,164,68
s_add_u32 s87, s58, s55
v_cvt_pk_bf16_f32 v195, v210, v211
v_cvt_pk_bf16_f32 v224, v224, v225
mvavs 164,168,68
s_sub_u32 s5, 15, s31
v_exp_f32 v121, v121
mvavs 180,172,68
s_lshl_b32 s5, s5, 2
v_cvt_pk_bf16_f32 v225, v226, v227
v_cvt_pk_bf16_f32 v226, v240, v241
v_smfmac_f32_16x16x64_bf16 v[52:55], a[192:195], v[72:79], v15
buffer_load_dwordx4 v1, s[48:51], s87 offen lds
mvavs 136,160,72
s_add_u32 m0, s57, 16384
v_exp_f32 v122, v122
mvavs 152,164,72
s_add_u32 s5, s5, s80
v_exp_f32 v123, v123
mvavs 168,168,72
s_lshl_b32 s5, s5, 7
v_cvt_pk_bf16_f32 v227, v242, v243
v_cvt_pk_bf16_f32 v92, v120, v121
mvavs 184,172,72
s_add_u32 s5, s5, 75497472
v_cvt_pk_bf16_f32 v93, v122, v123
v_cvt_pk_bf16_f32 v196, v196, v197
mvavs 200,176,72
ds_write_b128 v7, v[192:195] offset:0
mvavs 216,180,72
buffer_load_dwordx4 v28, s[48:51], s58 offen lds
v_fmac_f32 v124, s25, v44
v_fmac_f32 v125, s25, v45
v_cvt_pk_bf16_f32 v197, v198, v199
mvavs 232,184,72
v_fmac_f32 v126, s25, v46
v_fmac_f32 v127, s25, v47
v_cvt_pk_bf16_f32 v198, v212, v213
mvavs 248,188,72
v_cvt_pk_bf16_f32 v199, v214, v215
v_cvt_pk_bf16_f32 v228, v228, v229
mvavs 140,160,76
ds_write_b128 v7, v[224:227] offset:1024
mvavs 156,164,76
buffer_load_dword a204, v20, s[64:67], s5 offen offset:0 sc1
buffer_load_dword a205, v20, s[64:67], s5 offen offset:64 sc1
v_exp_f32 v124, v124
mvavs 172,168,76
s_lshl_b32 s5, s31, 2
v_exp_f32 v125, v125
v_cvt_pk_bf16_f32 v229, v230, v231
mvavs 188,172,76
s_add_u32 s5, s5, s80
s_lshl_b32 s5, s5, 7
s_add_u32 s5, s5, 75497472
v_cvt_pk_bf16_f32 v230, v244, v245
mvavs 204,176,76
buffer_load_dword a206, v20, s[64:67], s5 offen offset:0 sc1
buffer_load_dword a207, v20, s[64:67], s5 offen offset:64 sc1
v_exp_f32 v126, v126
v_cvt_pk_bf16_f32 v231, v246, v247
mvavs 220,180,76
v_exp_f32 v127, v127
mvavs 236,184,76
ds_write_b128 v7, v[196:199] offset:2048
ds_write_b128 v7, v[228:231] offset:3072
v_cvt_pk_bf16_f32 v94, v124, v125
v_cvt_pk_bf16_f32 v95, v126, v127
v_xor_b32 v0, 0x10000, v0
s_waitcnt lgkmcnt(0)
mvavs 252,188,76
s_barrier
s_branch L_B_fin
L_B_om1:
v_smfmac_f32_16x16x64_bf16 v[36:39], a[192:195], v[88:95], v15
s_mul_i32 s59, s94, 24576
s_add_u32 s59, s59, 540672
rqa 176,0,20480
mvaaz 96,128,64
s_add_u32 s59, s59, s84
rqa 180,0,21504
s_lshl_b32 s5, s80, 4
mvaas 96,132,68
s_mov_b32 s70, s16
rqa 184,0,22528
s_mov_b32 s74, s16
mvaas 96,136,72
buffer_load_dwordx4 a[208:211], v5, s[64:67], s59 offen offset:0 sc1
mvaas 96,140,76
s_lshl_b32 s57, s80, 10
v_and_b32 v2, 0x3ff, v0
v_lshrrev_b32 v1, 7, v2
v_lshrrev_b32 v28, 6, v2
mvaaz 100,144,64
s_lshl_b32 s61, s80, 11
rqa 188,0,23552
rqa 160,0,16384
mvaas 100,148,68
s_and_b32 s6, s30, 3
rqa 164,0,17408
v_add_u32 v1, s5, v1
mvaas 100,152,72
s_xor_b32 s62, s61, 8192
rqa 168,0,18432
v_add_u32 v28, s5, v28
mvaas 100,156,76
buffer_load_dwordx4 a[212:215], v5, s[64:67], s59 offen offset:1024 sc1
mvaaz 104,128,80
s_xor_b32 s5, s94, 7
rqa 172,0,19456
rqv 224,30,0
mvaas 104,132,84
s_lshl_b32 s5, s5, 5
v_mul_u32_u24 v1, 1280, v1
v_mul_u32_u24 v28, 1280, v28
v_fmac_f32 v96, s22, v44
v_fmac_f32 v97, s22, v45
mvaas 104,136,88
buffer_load_dwordx4 a[216:219], v6, s[64:67], s59 offen offset:0 sc1
rqv 240,30,1024
v_fmac_f32 v98, s22, v46
v_fmac_f32 v99, s22, v47
mvaas 104,140,92
s_and_b32 s52, s5, 128
rqv 228,30,2048
v_add_f32 v32, v32, v33
v_exp_f32 v96, v96
mvaaz 108,144,80
s_waitcnt lgkmcnt(8)
rqv 244,30,3072
v_add_f32 v33, v34, v35
v_lshrrev_b32 v20, 3, v2
v_and_b32 v20, 96, v20
v_xor_b32 v20, v20, v2
v_exp_f32 v97, v97
mvaas 108,148,84
buffer_load_dwordx4 a[220:223], v6, s[64:67], s59 offen offset:1024 sc1
v_add_f32 v34, v36, v37
v_exp_f32 v98, v98
mvaas 108,152,88
s_add_u32 s59, s59, 4096
v_add_f32 v35, v38, v39
v_exp_f32 v99, v99
mvaas 108,156,92
s_add_u32 s53, s52, 10240
v_and_b32 v21, 48, v20
v_xor_b32 v20, s5, v20
v_cvt_pk_bf16_f32 v64, v96, v97
v_cvt_pk_bf16_f32 v65, v98, v99
mvavs 200,176,88
buffer_load_dwordx4 a[224:227], v5, s[64:67], s59 offen offset:0 sc1
v_fmac_f32 v100, s23, v44
v_fmac_f32 v101, s23, v45
mvavs 216,180,88
s_lshl_b32 s5, s6, 8
v_fmac_f32 v102, s23, v46
v_fmac_f32 v103, s23, v47
mvavs 232,184,88
s_xor_b32 s54, s52, 128
v_and_b32 v20, 112, v20
v_add3_u32 v1, v1, v20, s5
v_exp_f32 v100, v100
s_waitcnt lgkmcnt(1)
mvavs 248,188,88
buffer_load_dwordx4 a[228:231], v5, s[64:67], s59 offen offset:1024 sc1
v_exp_f32 v101, v101
mvavs 204,176,92
s_lshl_b32 s5, s6, 6
v_exp_f32 v102, v102
mvavs 220,180,92
s_add_u32 s5, s5, 1024
ds_write_b128 v30, v[32:35]
v_add3_u32 v28, v28, v21, s5
v_exp_f32 v103, v103
mvavs 236,184,92
buffer_load_dwordx4 a[232:235], v6, s[64:67], s59 offen offset:0 sc1
v_cvt_pk_bf16_f32 v66, v100, v101
v_cvt_pk_bf16_f32 v67, v102, v103
mvavs 252,188,92
s_add_u32 s55, s54, 10240
v_fmac_f32 v104, s24, v44
v_fmac_f32 v105, s24, v45
mvaaz 112,128,96
s_min_u32 s60, s94, 5
v_fmac_f32 v106, s24, v46
v_fmac_f32 v107, s24, v47
mvaas 112,132,100
buffer_load_dwordx4 a[236:239], v6, s[64:67], s59 offen offset:1024 sc1
v_exp_f32 v104, v104
mvaas 112,136,104
s_lshl_b32 s59, s94, 12
v_exp_f32 v105, v105
mvaas 112,140,108
s_add_u32 s59, s59, 720896
s_cmp_ge_u32 s94, 6
s_cselect_b32 s59, 268435456, s59
s_add_u32 s59, s59, s84
v_lshrrev_b32 v20, 2, v2
v_and_b32 v20, 60, v20
v_exp_f32 v106, v106
mvaaz 116,144,96
buffer_load_dwordx4 a[240:243], v5, s[64:67], s59 offen offset:0 sc1
v_cvt_pk_bf16_f32 v200, v200, v201
v_exp_f32 v107, v107
mvaas 116,148,100
s_mul_i32 s60, s60, 40960
v_cvt_pk_bf16_f32 v201, v202, v203
v_cvt_pk_bf16_f32 v68, v104, v105
v_cvt_pk_bf16_f32 v69, v106, v107
mvaas 116,152,104
s_mul_i32 s58, s94, 245760
v_cvt_pk_bf16_f32 v202, v216, v217
v_fmac_f32 v108, s25, v44
v_fmac_f32 v109, s25, v45
mvaas 116,156,108
s_add_u32 s58, s58, 81920
v_fmac_f32 v110, s25, v46
v_fmac_f32 v111, s25, v47
mvaaz 120,128,112
buffer_load_dwordx4 a[244:247], v5, s[64:67], s59 offen offset:1024 sc1
v_cvt_pk_bf16_f32 v203, v218, v219
v_exp_f32 v108, v108
mvaas 120,132,116
s_add_u32 m0, s61, 102400
v_exp_f32 v109, v109
mvaas 120,136,120
s_add_u32 s87, s58, s52
v_cvt_pk_bf16_f32 v232, v232, v233
v_exp_f32 v110, v110
mvaas 120,140,124
buffer_load_dwordx4 a[248:251], v6, s[64:67], s59 offen offset:0 sc1
v_exp_f32 v111, v111
mvaaz 124,144,112
v_cvt_pk_bf16_f32 v233, v234, v235
v_cvt_pk_bf16_f32 v70, v108, v109
v_cvt_pk_bf16_f32 v71, v110, v111
mvaas 124,148,116
v_cvt_pk_bf16_f32 v234, v248, v249
v_exp_f32 v112, v112
mvaas 124,152,120
buffer_load_dwordx4 a[252:255], v6, s[64:67], s59 offen offset:1024 sc1
v_cvt_pk_bf16_f32 v235, v250, v251
v_exp_f32 v113, v113
mvaas 124,156,124
ds_write_b128 v7, v[200:203] offset:4096
v_exp_f32 v114, v114
mvavs 136,160,88
v_exp_f32 v115, v115
mvavs 152,164,88
buffer_load_dwordx4 v1, s[48:51], s87 offen lds
v_cvt_pk_bf16_f32 v204, v204, v205
v_cvt_pk_bf16_f32 v72, v112, v113
v_cvt_pk_bf16_f32 v73, v114, v115
mvavs 168,168,88
s_add_u32 m0, s61, 103424
ds_write_b128 v7, v[232:235] offset:5120
rqa 128,0,0
v_cvt_pk_bf16_f32 v205, v206, v207
v_exp_f32 v116, v116
mvavs 184,172,88
s_add_u32 s87, s58, s53
rqa 132,0,1024
v_exp_f32 v117, v117
mvavs 140,160,92
buffer_load_dwordx4 v1, s[48:51], s87 offen lds
rqa 136,0,4096
v_cvt_pk_bf16_f32 v206, v220, v221
v_exp_f32 v118, v118
mvavs 156,164,92
s_add_u32 m0, s62, 102400
rqa 140,0,5120
v_cvt_pk_bf16_f32 v207, v222, v223
v_exp_f32 v119, v119
mvavs 172,168,92
s_add_u32 s87, s58, s54
v_cvt_pk_bf16_f32 v74, v116, v117
v_cvt_pk_bf16_f32 v75, v118, v119
mvavs 188,172,92
buffer_load_dwordx4 v1, s[48:51], s87 offen lds
ds_write_b128 v7, v[204:207] offset:6144
rqa 144,0,2048
v_exp_f32 v120, v120
mvvvs 128,60,224
s_add_u32 m0, s62, 103424
rqa 148,0,3072
v_cvt_pk_bf16_f32 v236, v236, v237
v_exp_f32 v121, v121
mvvvs 144,56,224
s_add_u32 s87, s58, s55
rqa 152,0,6144
v_cvt_pk_bf16_f32 v237, v238, v239
v_exp_f32 v122, v122
mvvvs 160,60,240
buffer_load_dwordx4 v1, s[48:51], s87 offen lds
rqa 156,0,7168
v_cvt_pk_bf16_f32 v238, v252, v253
v_exp_f32 v123, v123
mvvvs 176,56,240
s_add_u32 m0, s57, 118784
v_cvt_pk_bf16_f32 v76, v120, v121
v_cvt_pk_bf16_f32 v77, v122, v123
mvvvs 132,60,228
s_waitcnt lgkmcnt(5)
v_cvt_pk_bf16_f32 v239, v254, v255
v_exp_f32 v124, v124
mvvvs 148,56,228
buffer_load_dwordx4 v28, s[48:51], s58 offen lds
v_exp_f32 v125, v125
mvvvs 164,60,244
ds_write_b128 v7, v[236:239] offset:7168
v_exp_f32 v126, v126
v_exp_f32 v127, v127
v_cvt_pk_bf16_f32 v78, v124, v125
v_cvt_pk_bf16_f32 v79, v126, v127
s_waitcnt vmcnt(34) lgkmcnt(0)
mvvvs 180,56,244
s_barrier
ds_read_b128 v[36:39], v7
mvaaz 112,128,96
s_mul_i32 s59, s94, 24576
rqv 232,30,4096
rqv 248,30,5120
mvaas 112,132,100
s_add_u32 s59, s59, 524288
rqv 236,30,6144
rqv 252,30,7168
mvaas 112,136,104
s_add_u32 s59, s59, s84
mvaas 112,140,108
mvaaz 116,144,96
mvaas 116,148,100
s_waitcnt lgkmcnt(4)
v_add_f32 v36, v36, v32
v_add_f32 v37, v37, v33
v_add_f32 v38, v38, v34
mvaas 116,152,104
v_add_f32 v39, v39, v35
v_max3_u32 v32, v36, v37, v38
mvaas 116,156,108
v_min3_u32 v33, v36, v37, v38
v_max_u32 v32, v32, v39
v_min_u32 v33, v33, v39
v_cmp_lt_u32 s[4:5], s15, v32
v_cmp_gt_u32 vcc, s14, v33
s_nop 0
s_or_b64 vcc, vcc, s[4:5]
s_cbranch_vccnz FBb_spin
FBb_ok:
s_waitcnt vmcnt(23) lgkmcnt(3)
mvvvs 136,60,232
s_add_u32 s87, s83, 0
v_accvgpr_read_b32 v32, a196
v_accvgpr_read_b32 v33, a197
mvvvs 152,56,232
s_waitcnt vmcnt(22) lgkmcnt(2)
rqa 176,0,53248
v_accvgpr_read_b32 v34, a198
mvvvs 168,60,248
buffer_load_dwordx4 a[0:3], v5, s[64:67], s59 offen offset:0 sc1
mvvvs 184,56,248
s_waitcnt vmcnt(22) lgkmcnt(1)
rqa 180,0,54272
v_accvgpr_read_b32 v35, a199
v_rcp_f32 v36, v36
v_rcp_f32 v37, v37
mvvvs 140,60,236
v_rcp_f32 v38, v38
v_rcp_f32 v39, v39
v_mul_f32 v36, v36, v32
rqa 184,0,55296
v_mul_f32 v37, v37, v33
v_pk_mul_f32 v[128:129], v[128:129], v[36:37] op_sel:[0,0] op_sel_hi:[1,0]
v_pk_mul_f32 v[130:131], v[130:131], v[36:37] op_sel:[0,0] op_sel_hi:[1,0]
v_pk_mul_f32 v[144:145], v[144:145], v[36:37] op_sel:[0,0] op_sel_hi:[1,0]
v_pk_mul_f32 v[146:147], v[146:147], v[36:37] op_sel:[0,0] op_sel_hi:[1,0]
v_pk_mul_f32 v[160:161], v[160:161], v[36:37] op_sel:[0,0] op_sel_hi:[1,0]
v_pk_mul_f32 v[162:163], v[162:163], v[36:37] op_sel:[0,0] op_sel_hi:[1,0]
v_pk_mul_f32 v[176:177], v[176:177], v[36:37] op_sel:[0,0] op_sel_hi:[1,0]
v_pk_mul_f32 v[178:179], v[178:179], v[36:37] op_sel:[0,0] op_sel_hi:[1,0]
mvvvs 156,56,236
buffer_load_dwordx4 a[4:7], v5, s[64:67], s59 offen offset:1024 sc1
rqa 188,0,56320
v_mul_f32 v38, v38, v34
v_mul_f32 v39, v39, v35
mvvvs 172,60,252
rqa 160,0,49152
v_cvt_pk_bf16_f32 v128, v128, v129
mvvvs 188,56,252
buffer_load_dwordx4 a[8:11], v6, s[64:67], s59 offen offset:0 sc1
rqa 164,0,50176
mvaaz 120,128,112
rqa 168,0,51200
v_cvt_pk_bf16_f32 v129, v130, v131
mvaas 120,132,116
buffer_load_dwordx4 a[12:15], v6, s[64:67], s59 offen offset:1024 sc1
v_cvt_pk_bf16_f32 v130, v144, v145
rqa 172,0,52224
v_fmac_f32 v112, s22, v44
v_fmac_f32 v113, s22, v45
v_fmac_f32 v114, s22, v46
v_fmac_f32 v115, s22, v47
mvaas 120,136,120
s_add_u32 s59, s59, 4096
v_cvt_pk_bf16_f32 v131, v146, v147
v_cvt_pk_bf16_f32 v160, v160, v161
mvaas 120,140,124
buffer_load_dwordx4 a[16:19], v5, s[64:67], s59 offen offset:0 sc1
v_exp_f32 v112, v112
mvaaz 124,144,112
buffer_store_dwordx4 v[128:131], v5, s[64:67], s87 offen offset:0 sc1
buffer_load_dwordx4 a[20:23], v5, s[64:67], s59 offen offset:1024 sc1
v_cvt_pk_bf16_f32 v161, v162, v163
mvaas 124,148,116
s_add_u32 s87, s83, 4096
v_exp_f32 v113, v113
mvaas 124,152,120
v_cvt_pk_bf16_f32 v162, v176, v177
s_waitcnt lgkmcnt(1)
v_pk_mul_f32 v[132:133], v[132:133], v[36:37] op_sel:[0,1] op_sel_hi:[1,1]
v_pk_mul_f32 v[134:135], v[134:135], v[36:37] op_sel:[0,1] op_sel_hi:[1,1]
v_pk_mul_f32 v[148:149], v[148:149], v[36:37] op_sel:[0,1] op_sel_hi:[1,1]
v_pk_mul_f32 v[150:151], v[150:151], v[36:37] op_sel:[0,1] op_sel_hi:[1,1]
v_pk_mul_f32 v[164:165], v[164:165], v[36:37] op_sel:[0,1] op_sel_hi:[1,1]
v_pk_mul_f32 v[166:167], v[166:167], v[36:37] op_sel:[0,1] op_sel_hi:[1,1]
v_pk_mul_f32 v[180:181], v[180:181], v[36:37] op_sel:[0,1] op_sel_hi:[1,1]
v_pk_mul_f32 v[182:183], v[182:183], v[36:37] op_sel:[0,1] op_sel_hi:[1,1]
mvaas 124,156,124
buffer_load_dwordx4 a[24:27], v6, s[64:67], s59 offen offset:0 sc1
v_cvt_pk_bf16_f32 v163, v178, v179
v_exp_f32 v114, v114
v_exp_f32 v115, v115
mvavz 192,176,64
v_cvt_pk_bf16_f32 v88, v112, v113
v_cvt_pk_bf16_f32 v89, v114, v115
mvavz 208,180,64
buffer_store_dwordx4 v[160:163], v5, s[64:67], s87 offen offset:0 sc1
buffer_load_dwordx4 a[28:31], v6, s[64:67], s59 offen offset:1024 sc1
v_cvt_pk_bf16_f32 v132, v132, v133
mvavz 224,184,64
s_add_u32 s59, s59, 4096
v_cvt_pk_bf16_f32 v133, v134, v135
v_cvt_pk_bf16_f32 v134, v148, v149
mvavz 240,188,64
buffer_load_dwordx4 a[32:35], v5, s[64:67], s59 offen offset:0 sc1
v_fmac_f32 v116, s23, v44
v_fmac_f32 v117, s23, v45
mvavz 196,176,68
s_add_u32 s87, s83, 0
v_cvt_pk_bf16_f32 v135, v150, v151
v_fmac_f32 v118, s23, v46
mvavz 212,180,68
buffer_load_dwordx4 a[36:39], v5, s[64:67], s59 offen offset:1024 sc1
v_fmac_f32 v119, s23, v47
mvavz 228,184,68
buffer_store_dwordx4 v[132:135], v5, s[64:67], s87 offen offset:2048 sc1
buffer_load_dwordx4 a[40:43], v6, s[64:67], s59 offen offset:0 sc1
v_cvt_pk_bf16_f32 v164, v164, v165
mvavz 244,188,68
s_add_u32 s87, s83, 4096
v_cvt_pk_bf16_f32 v165, v166, v167
v_exp_f32 v116, v116
v_exp_f32 v117, v117
v_smfmac_f32_16x16x64_bf16 v[48:51], a[192:195], v[64:71], v15
v_cvt_pk_bf16_f32 v166, v180, v181
s_waitcnt lgkmcnt(0)
v_pk_mul_f32 v[136:137], v[136:137], v[38:39] op_sel:[0,0] op_sel_hi:[1,0]
v_pk_mul_f32 v[138:139], v[138:139], v[38:39] op_sel:[0,0] op_sel_hi:[1,0]
v_pk_mul_f32 v[152:153], v[152:153], v[38:39] op_sel:[0,0] op_sel_hi:[1,0]
v_pk_mul_f32 v[154:155], v[154:155], v[38:39] op_sel:[0,0] op_sel_hi:[1,0]
v_pk_mul_f32 v[168:169], v[168:169], v[38:39] op_sel:[0,0] op_sel_hi:[1,0]
v_pk_mul_f32 v[170:171], v[170:171], v[38:39] op_sel:[0,0] op_sel_hi:[1,0]
v_pk_mul_f32 v[184:185], v[184:185], v[38:39] op_sel:[0,0] op_sel_hi:[1,0]
v_pk_mul_f32 v[186:187], v[186:187], v[38:39] op_sel:[0,0] op_sel_hi:[1,0]
mvavz 128,160,64
buffer_load_dwordx4 a[44:47], v6, s[64:67], s59 offen offset:1024 sc1
v_cvt_pk_bf16_f32 v167, v182, v183
v_exp_f32 v118, v118
mvavz 144,164,64
s_add_u32 s59, s59, 4096
v_cvt_pk_bf16_f32 v136, v136, v137
v_exp_f32 v119, v119
mvavz 160,168,64
buffer_store_dwordx4 v[164:167], v5, s[64:67], s87 offen offset:2048 sc1
buffer_load_dwordx4 a[48:51], v5, s[64:67], s59 offen offset:0 sc1
v_cvt_pk_bf16_f32 v137, v138, v139
mvavz 176,172,64
s_add_u32 s87, s83, 745472
v_cvt_pk_bf16_f32 v138, v152, v153
v_cvt_pk_bf16_f32 v192, v192, v193
mvavz 132,160,68
buffer_load_dwordx4 a[52:55], v5, s[64:67], s59 offen offset:1024 sc1
v_cvt_pk_bf16_f32 v139, v154, v155
v_cvt_pk_bf16_f32 v90, v116, v117
v_cvt_pk_bf16_f32 v91, v118, v119
v_cvt_pk_bf16_f32 v193, v194, v195
mvavz 148,164,68
v_fmac_f32 v120, s24, v44
v_fmac_f32 v121, s24, v45
v_fmac_f32 v122, s24, v46
v_fmac_f32 v123, s24, v47
v_cvt_pk_bf16_f32 v194, v208, v209
mvavz 164,168,68
buffer_store_dwordx4 v[136:139], v5, s[64:67], s87 offen offset:0 sc1
v_cvt_pk_bf16_f32 v168, v168, v169
v_cvt_pk_bf16_f32 v195, v210, v211
s_mul_i32 s58, s94, 245760
s_add_u32 s58, s58, 0
s_add_u32 m0, s61, 0
s_add_u32 s87, s58, s52
mvavz 180,172,68
buffer_load_dwordx4 a[56:59], v6, s[64:67], s59 offen offset:0 sc1
v_cvt_pk_bf16_f32 v169, v170, v171
buffer_load_dwordx4 a[60:63], v6, s[64:67], s59 offen offset:1024 sc1
v_cvt_pk_bf16_f32 v170, v184, v185
v_cvt_pk_bf16_f32 v171, v186, v187
buffer_load_dwordx4 v1, s[48:51], s87 offen lds
s_add_u32 s87, s83, 749568
v_smfmac_f32_16x16x64_bf16 v[52:55], a[192:195], v[72:79], v15
buffer_store_dwordx4 v[168:171], v5, s[64:67], s87 offen offset:0 sc1
v_exp_f32 v120, v120
v_cvt_pk_bf16_f32 v224, v224, v225
v_pk_mul_f32 v[140:141], v[140:141], v[38:39] op_sel:[0,1] op_sel_hi:[1,1]
v_pk_mul_f32 v[142:143], v[142:143], v[38:39] op_sel:[0,1] op_sel_hi:[1,1]
v_pk_mul_f32 v[156:157], v[156:157], v[38:39] op_sel:[0,1] op_sel_hi:[1,1]
v_pk_mul_f32 v[158:159], v[158:159], v[38:39] op_sel:[0,1] op_sel_hi:[1,1]
v_pk_mul_f32 v[172:173], v[172:173], v[38:39] op_sel:[0,1] op_sel_hi:[1,1]
v_pk_mul_f32 v[174:175], v[174:175], v[38:39] op_sel:[0,1] op_sel_hi:[1,1]
v_pk_mul_f32 v[188:189], v[188:189], v[38:39] op_sel:[0,1] op_sel_hi:[1,1]
v_pk_mul_f32 v[190:191], v[190:191], v[38:39] op_sel:[0,1] op_sel_hi:[1,1]
mvavz 136,160,72
s_add_u32 m0, s61, 1024
v_cvt_pk_bf16_f32 v225, v226, v227
v_cvt_pk_bf16_f32 v140, v140, v141
mvavz 152,164,72
s_add_u32 s87, s58, s53
v_exp_f32 v121, v121
v_cvt_pk_bf16_f32 v226, v240, v241
mvavz 168,168,72
s_sub_u32 s5, 15, s31
v_cvt_pk_bf16_f32 v141, v142, v143
v_exp_f32 v122, v122
v_exp_f32 v123, v123
v_cvt_pk_bf16_f32 v227, v242, v243
mvavz 184,172,72
buffer_load_dwordx4 v1, s[48:51], s87 offen lds
v_cvt_pk_bf16_f32 v142, v156, v157
s_add_u32 m0, s62, 0
s_add_u32 s87, s58, s54
mvavz 200,176,72
buffer_load_dwordx4 v1, s[48:51], s87 offen lds
ds_write_b128 v7, v[192:195] offset:0
v_cvt_pk_bf16_f32 v143, v158, v159
v_cvt_pk_bf16_f32 v196, v196, v197
s_add_u32 s87, s83, 745472
mvavz 216,180,72
buffer_store_dwordx4 v[140:143], v5, s[64:67], s87 offen offset:2048 sc1
v_cvt_pk_bf16_f32 v172, v172, v173
v_cvt_pk_bf16_f32 v92, v120, v121
v_cvt_pk_bf16_f32 v93, v122, v123
v_cvt_pk_bf16_f32 v197, v198, v199
s_add_u32 m0, s62, 1024
s_add_u32 s87, s58, s55
mvavz 232,184,72
buffer_load_dwordx4 v1, s[48:51], s87 offen lds
v_cvt_pk_bf16_f32 v173, v174, v175
v_fmac_f32 v124, s25, v44
v_fmac_f32 v125, s25, v45
v_cvt_pk_bf16_f32 v198, v212, v213
v_cvt_pk_bf16_f32 v174, v188, v189
v_cvt_pk_bf16_f32 v175, v190, v191
s_add_u32 m0, s57, 16384
s_add_u32 s87, s83, 749568
mvavz 248,188,72
buffer_load_dwordx4 v28, s[48:51], s58 offen lds
buffer_store_dwordx4 v[172:175], v5, s[64:67], s87 offen offset:2048 sc1
v_cvt_pk_bf16_f32 v199, v214, v215
v_fmac_f32 v126, s25, v46
v_fmac_f32 v127, s25, v47
mvavz 140,160,76
s_lshl_b32 s5, s5, 2
ds_write_b128 v7, v[224:227] offset:1024
mvavz 156,164,76
s_add_u32 s5, s5, s80
v_cvt_pk_bf16_f32 v228, v228, v229
v_cvt_pk_bf16_f32 v229, v230, v231
mvavz 172,168,76
s_lshl_b32 s5, s5, 7
v_exp_f32 v124, v124
v_exp_f32 v125, v125
mvavz 188,172,76
s_add_u32 s5, s5, 75497472
v_cvt_pk_bf16_f32 v230, v244, v245
v_cvt_pk_bf16_f32 v231, v246, v247
mvavz 204,176,76
buffer_load_dword a204, v20, s[64:67], s5 offen offset:0 sc1
buffer_load_dword a205, v20, s[64:67], s5 offen offset:64 sc1
v_exp_f32 v126, v126
mvavz 220,180,76
s_lshl_b32 s5, s31, 2
s_add_u32 s5, s5, s80
s_lshl_b32 s5, s5, 7
s_add_u32 s5, s5, 75497472
mvavz 236,184,76
buffer_load_dword a206, v20, s[64:67], s5 offen offset:0 sc1
ds_write_b128 v7, v[196:199] offset:2048
buffer_load_dword a207, v20, s[64:67], s5 offen offset:64 sc1
ds_write_b128 v7, v[228:231] offset:3072
v_exp_f32 v127, v127
v_cvt_pk_bf16_f32 v94, v124, v125
v_cvt_pk_bf16_f32 v95, v126, v127
v_xor_b32 v0, 0x10000, v0
s_waitcnt lgkmcnt(0)
mvavz 252,188,76
s_barrier
L_B_fin:
rqv 224,30,0
rqv 240,30,1024
rqv 228,30,2048
rqv 244,30,3072
v_smfmac_f32_16x16x64_bf16 v[52:55], a[192:195], v[88:95], v15
s_mul_i32 s58, s94, 245760
s_add_u32 s58, s58, 163840
rqa 176,0,20480
s_waitcnt lgkmcnt(4)
mvvvs 128,60,224
rqa 180,0,21504
rqa 184,0,22528
rqa 188,0,23552
rqa 160,0,16384
rqa 164,0,17408
rqa 168,0,18432
rqa 172,0,19456
mvvvs 144,56,224
s_add_u32 m0, s61, 20480
s_add_u32 s87, s58, s52
s_and_b32 s81, s100, -512
s_waitcnt lgkmcnt(10)
mvvvs 160,60,240
buffer_load_dwordx4 v1, s[48:51], s87 offen lds
v_and_b32 v9, 0x3c0, v2
mvvvs 176,56,240
s_add_u32 m0, s61, 21504
v_and_b32 v3, 0x1ff, v2
s_add_u32 s87, s58, s53
v_add_f32 v48, v48, v49
s_waitcnt lgkmcnt(8)
mvvvs 132,60,228
buffer_load_dword v24, v3, s[64:67], s81 offen sc1
mvvvs 148,56,228
buffer_load_dwordx4 v1, s[48:51], s87 offen lds
v_lshrrev_b32 v11, 1, v2
mvvvs 164,60,244
s_add_u32 m0, s62, 20480
v_add_f32 v49, v50, v51
v_and_b32 v11, 24, v11
mvvvs 180,56,244
s_add_u32 s87, s58, s54
v_add_f32 v50, v52, v53
v_add_f32 v51, v54, v55
s_waitcnt lgkmcnt(4)
mvavs 200,176,88
buffer_load_dwordx4 v1, s[48:51], s87 offen lds
v_lshl_add_u32 v32, v9, 1, v11
mvavs 216,180,88
s_add_u32 m0, s62, 21504
v_lshrrev_b32 v33, 2, v2
s_add_u32 s87, s58, s55
mvavs 232,184,88
buffer_load_dwordx4 v1, s[48:51], s87 offen lds
mvavs 248,188,88
s_add_u32 m0, s57, 36864
v_and_b32 v33, 96, v33
v_add_u32 v32, v32, v33
mvavs 204,176,92
buffer_load_dwordx4 v28, s[48:51], s58 offen lds
mvavs 220,180,92
s_add_u32 s58, s60, 1966080
v_xor_b32 v33, 32, v32
v_xor_b32 v34, 64, v32
mvavs 236,184,92
s_mul_i32 s87, s80, 10240
ds_write_b128 v30, v[48:51]
mvavs 252,188,92
s_sub_u32 s5, s58, s87
v_cvt_pk_bf16_f32 v200, v200, v201
s_add_u32 m0, s57, 40960
s_waitcnt lgkmcnt(1)
mvavs 136,160,88
s_add_u32 s87, s5, s52
v_cvt_pk_bf16_f32 v201, v202, v203
v_xor_b32 v35, 96, v32
mvavs 152,164,88
buffer_load_dwordx4 v1, s[48:51], s87 offen lds
v_cvt_pk_bf16_f32 v202, v216, v217
v_cvt_pk_bf16_f32 v203, v218, v219
mvavs 168,168,88
s_add_u32 m0, s57, 49152
v_add_u32 v36, 61440, v32
v_cvt_pk_bf16_f32 v232, v232, v233
mvavs 184,172,88
s_add_u32 s87, s5, s54
v_cvt_pk_bf16_f32 v233, v234, v235
v_cvt_pk_bf16_f32 v234, v248, v249
mvavs 140,160,92
buffer_load_dwordx4 v1, s[48:51], s87 offen lds
v_add_u32 v37, 61440, v33
v_cvt_pk_bf16_f32 v235, v250, v251
mvavs 156,164,92
s_add_u32 m0, s57, 57344
v_add_u32 v38, 61440, v34
v_cvt_pk_bf16_f32 v204, v204, v205
v_cvt_pk_bf16_f32 v205, v206, v207
s_cmp_lt_u32 s80, 2
s_cselect_b32 s87, s58, 0x7ff00000
mvavs 172,168,92
buffer_load_dwordx4 v28, s[48:51], s87 offen lds
ds_write_b128 v7, v[200:203] offset:4096
ds_write_b128 v7, v[232:235] offset:5120
v_cvt_pk_bf16_f32 v206, v220, v221
v_cvt_pk_bf16_f32 v207, v222, v223
v_add_u32 v39, 61440, v35
ds_write_b128 v7, v[204:207] offset:6144
v_cvt_pk_bf16_f32 v236, v236, v237
v_cvt_pk_bf16_f32 v237, v238, v239
v_cvt_pk_bf16_f32 v238, v252, v253
v_cvt_pk_bf16_f32 v239, v254, v255
ds_write_b128 v7, v[236:239] offset:7168
s_waitcnt vmcnt(9) lgkmcnt(0)
mvavs 188,172,92
s_barrier
ds_read_b128 v[52:55], v7
rqv 232,30,4096
rqv 248,30,5120
s_waitcnt lgkmcnt(1)
mvvvs 136,60,232
rqv 236,30,6144
rqv 252,30,7168
rtv 64,32,0
rtv 66,32,2048
mvvvs 152,56,232
s_waitcnt lgkmcnt(4)
rtv 68,32,4096
rtv 70,32,6144
rtv 72,33,0
rtv 74,33,2048
rtv 76,33,4096
rtv 78,33,6144
mvvvs 168,60,248
v_add_f32 v52, v52, v48
v_add_f32 v53, v53, v49
v_add_f32 v54, v54, v50
mvvvs 184,56,248
v_add_f32 v55, v55, v51
v_max3_u32 v48, v52, v53, v54
v_min3_u32 v49, v52, v53, v54
v_max_u32 v48, v48, v55
v_min_u32 v49, v49, v55
v_cmp_lt_u32 s[4:5], s15, v48
v_cmp_gt_u32 vcc, s14, v49
s_nop 0
s_or_b64 vcc, vcc, s[4:5]
s_cbranch_vccnz FBc_spin
FBc_ok:
s_waitcnt lgkmcnt(8)
mvvvs 140,60,236
s_cmp_le_u32 s31, 0
s_cselect_b32 s87, s19, 268435456
s_add_u32 s58, s30, 0
mvvvs 156,56,236
s_and_b32 s58, s58, 3
v_accvgpr_read_b32 v48, a200
v_accvgpr_read_b32 v49, a201
mvvvs 172,60,252
s_lshl2_add_u32 s58, s94, s58
v_accvgpr_read_b32 v50, a202
v_accvgpr_read_b32 v51, a203
mvvvs 188,56,252
s_mul_i32 s58, s58, 163840
v_rcp_f32 v52, v52
v_rcp_f32 v53, v53
v_mov_b32 v27, 3
s_waitcnt lgkmcnt(4)
mvvaz 96,64,0
buffer_store_dword v27, off, s[64:67], s87 sc1
v_rcp_f32 v54, v54
v_rcp_f32 v55, v55
v_mul_f32 v52, v52, v48
mvvas 96,68,16
s_add_u32 m0, s61, 61440
v_mul_f32 v53, v53, v49
v_mul_f32 v54, v54, v50
v_mul_f32 v55, v55, v51
mvvaz 100,68,20
s_add_u32 s87, s58, s52
v_mul_f32 v128, v128, v52
v_mul_f32 v129, v129, v52
mvvas 100,64,4
buffer_load_dwordx4 v1, s[44:47], s87 offen lds
mvvaz 208,64,8
s_add_u32 m0, s61, 62464
rtv 80,34,0
v_mul_f32 v130, v130, v52
mvvas 208,68,24
s_add_u32 s87, s58, s53
rtv 82,34,2048
v_mul_f32 v131, v131, v52
mvvaz 212,68,28
s_waitcnt lgkmcnt(2)
rtv 84,34,4096
v_mul_f32 v144, v144, v52
mvvas 212,64,12
buffer_load_dwordx4 v1, s[44:47], s87 offen lds
mvvaz 104,72,0
s_add_u32 m0, s62, 61440
rtv 86,34,6144
v_mul_f32 v145, v145, v52
mvvas 104,76,16
s_add_u32 s87, s58, s54
v_mul_f32 v146, v146, v52
v_mul_f32 v147, v147, v52
mvvaz 108,76,20
rtv 88,35,0
v_cvt_pk_bf16_f32 v128, v128, v129
mvvas 108,72,4
buffer_load_dwordx4 v1, s[44:47], s87 offen lds
mvvaz 216,72,8
s_add_u32 m0, s62, 62464
rtv 90,35,2048
v_cvt_pk_bf16_f32 v129, v130, v131
mvvas 216,76,24
s_add_u32 s87, s58, s55
rtv 92,35,4096
v_cvt_pk_bf16_f32 v130, v144, v145
mvvaz 220,76,28
rtv 94,35,6144
v_cvt_pk_bf16_f32 v131, v146, v147
mvvas 220,72,12
s_waitcnt lgkmcnt(4)
v_mul_f32 v132, v132, v53
v_mul_f32 v133, v133, v53
mvvaz 112,80,0
buffer_load_dwordx4 v1, s[44:47], s87 offen lds
mvvas 112,84,16
s_add_u32 m0, s57, 77824
rtv 64,32,8192
v_mul_f32 v134, v134, v53
mvvaz 116,84,20
s_add_u32 s87, s83, 0
rtv 66,32,10240
v_mul_f32 v135, v135, v53
mvvas 116,80,4
rtv 68,32,12288
v_mul_f32 v148, v148, v53
mvvaz 224,80,8
buffer_load_dwordx4 v28, s[44:47], s58 offen lds
mvvas 224,84,24
s_add_u32 s58, s58, 81920
rtv 70,32,14336
v_mul_f32 v149, v149, v53
mvvaz 228,84,28
s_add_u32 m0, s61, 81920
v_mul_f32 v150, v150, v53
v_mul_f32 v151, v151, v53
mvvas 228,80,12
s_waitcnt lgkmcnt(4)
rtv 72,33,8192
v_cvt_pk_bf16_f32 v132, v132, v133
mvvaz 120,88,0
buffer_store_dwordx4 v[128:131], v6, s[64:67], s87 offen offset:0 sc1
rtv 74,33,10240
v_cvt_pk_bf16_f32 v133, v134, v135
v_cvt_pk_bf16_f32 v134, v148, v149
mvvas 120,92,16
s_add_u32 s87, s58, s52
rtv 76,33,12288
v_cvt_pk_bf16_f32 v135, v150, v151
mvvaz 124,92,20
v_mul_f32 v136, v136, v54
v_mul_f32 v137, v137, v54
mvvas 124,88,4
rtv 78,33,14336
v_mul_f32 v138, v138, v54
mvvaz 240,88,8
v_mul_f32 v139, v139, v54
v_mul_f32 v152, v152, v54
mvvas 240,92,24
v_mul_f32 v153, v153, v54
v_mul_f32 v154, v154, v54
mvvaz 244,92,28
s_waitcnt vmcnt(14) lgkmcnt(4)
v_cmp_gt_u32 vcc, 2, v24
v_mul_f32 v155, v155, v54
mvvas 244,88,12
s_cbranch_vccnz PIB_spin
PIB_ok:
rtv 80,36,40960
mvvaz 192,64,0
buffer_load_dwordx4 v1, s[44:47], s87 offen lds
mvvas 192,68,16
s_add_u32 m0, s61, 82944
rtv 82,36,43008
v_cvt_pk_bf16_f32 v136, v136, v137
mvvaz 196,68,20
s_add_u32 s87, s58, s53
rtv 84,36,45056
v_cvt_pk_bf16_f32 v137, v138, v139
mvvas 196,64,4
buffer_load_dwordx4 v1, s[44:47], s87 offen lds
mvvaz 232,64,8
s_add_u32 m0, s62, 81920
rtv 86,36,47104
v_cvt_pk_bf16_f32 v138, v152, v153
mvvas 232,68,24
s_add_u32 s87, s58, s54
v_cvt_pk_bf16_f32 v139, v154, v155
v_mul_f32 v140, v140, v55
mvvaz 236,68,28
buffer_load_dwordx4 v1, s[44:47], s87 offen lds
mvvas 236,64,12
s_add_u32 m0, s62, 82944
rtv 88,37,40960
v_mul_f32 v141, v141, v55
s_waitcnt lgkmcnt(5)
mvvaz 200,72,0
s_add_u32 s87, s58, s55
rtv 90,37,43008
v_mul_f32 v142, v142, v55
mvvas 200,76,16
rtv 92,37,45056
v_mul_f32 v143, v143, v55
mvvaz 204,76,20
buffer_load_dwordx4 v1, s[44:47], s87 offen lds
mvvas 204,72,4
s_add_u32 m0, s57, 98304
rtv 94,37,47104
v_mul_f32 v156, v156, v55
mvvaz 248,72,8
v_mul_f32 v157, v157, v55
v_mul_f32 v158, v158, v55
mvvas 248,76,24
s_add_u32 s87, s83, 0
v_mul_f32 v159, v159, v55
v_cvt_pk_bf16_f32 v140, v140, v141
mvvaz 252,76,28
v_cvt_pk_bf16_f32 v141, v142, v143
v_cvt_pk_bf16_f32 v142, v156, v157
mvvas 252,72,12
s_waitcnt lgkmcnt(4)
rtv 64,38,40960
v_cvt_pk_bf16_f32 v143, v158, v159
mvvas 96,80,32
buffer_load_dwordx4 v28, s[44:47], s58 offen lds
mvvas 96,84,48
rtv 66,38,43008
v_mul_f32 v168, v168, v54
mvvas 100,84,52
rtv 68,38,45056
v_add_u32 v9, v9, v11
mvvas 100,80,36
rtv 70,38,47104
v_mul_f32 v169, v169, v54
mvvas 208,80,40
buffer_store_dwordx4 v[132:135], v6, s[64:67], s87 offen offset:2048 sc1
s_add_u32 s87, s83, 745472
v_lshrrev_b32 v10, 3, v2
v_mul_f32 v170, v170, v54
mvvas 208,84,56
v_mul_f32 v171, v171, v54
v_and_b32 v10, 32, v10
mvvas 212,84,60
s_and_b32 s81, s100, -64
v_and_b32 v26, 48, v2
v_mul_f32 v184, v184, v54
mvvas 212,80,44
s_waitcnt lgkmcnt(4)
rtv 72,39,40960
v_mul_f32 v185, v185, v54
mvvas 104,88,32
rtv 74,39,43008
v_add_u32 v9, v9, v10
mvvas 104,92,48
rtv 76,39,45056
v_mul_f32 v186, v186, v54
mvvas 108,92,52
buffer_store_dwordx4 v[136:139], v6, s[64:67], s87 offen offset:0 sc1
s_add_u32 s87, s83, 745472
v_mul_f32 v187, v187, v54
v_xor_b32 v10, 32, v9
mvvas 108,88,36
s_waitcnt lgkmcnt(4)
rtv 78,39,47104
v_cvt_pk_bf16_f32 v168, v168, v169
mvvas 216,88,40
s_add_u32 s59, s30, 0
v_cvt_pk_bf16_f32 v169, v170, v171
s_and_b32 s59, s59, 3
mvvas 216,92,56
buffer_load_dword v24, v26, s[64:67], s81 offen sc1
mvvas 220,92,60
buffer_store_dwordx4 v[140:143], v6, s[64:67], s87 offen offset:2048 sc1
s_lshl2_add_u32 s59, s94, s59
s_lshl_b32 s59, s59, 14
s_add_u32 s59, s59, 0
mvvas 220,88,44
s_add_u32 s59, s59, s84
rtv 80,36,49152
v_add_u32 v11, 61440, v9
mvvas 112,64,32
s_waitcnt lgkmcnt(4)
rtv 82,36,51200
v_cvt_pk_bf16_f32 v170, v184, v185
mvvas 112,68,48
rtv 84,36,53248
v_cvt_pk_bf16_f32 v171, v186, v187
mvvas 116,68,52
v_add_u32 v12, 61440, v10
v_mul_f32 v172, v172, v55
mvvas 116,64,36
rtv 86,36,55296
v_mul_f32 v173, v173, v55
mvvas 224,64,40
buffer_load_dwordx4 a[64:67], v5, s[64:67], s59 offen offset:0 sc1
mvvas 224,68,56
v_add_u32 v13, 122880, v9
v_mul_f32 v174, v174, v55
mvvas 228,68,60
s_add_u32 s87, s83, 749568
v_mul_f32 v175, v175, v55
v_add_u32 v14, 122880, v10
mvvas 228,64,44
s_waitcnt lgkmcnt(4)
rtv 88,37,49152
v_mul_f32 v188, v188, v55
mvvas 120,72,32
buffer_load_dwordx4 a[68:71], v5, s[64:67], s59 offen offset:1024 sc1
mvvas 120,76,48
rtv 90,37,51200
mvvas 124,76,52
rtv 92,37,53248
mvvas 124,72,36
rtv 94,37,55296
mvvas 240,72,40
mvvas 240,76,56
buffer_store_dwordx4 v[168:171], v6, s[64:67], s87 offen offset:0 sc1
mvvas 244,76,60
mvvas 244,72,44
s_waitcnt lgkmcnt(4)
mvvas 192,80,32
mvvas 192,84,48
s_waitcnt vmcnt(19) lgkmcnt(0)
s_barrier
mvvas 196,84,52
s_add_u32 s59, s30, 0
rtv 64,32,20480
s_and_b32 s59, s59, 3
mvvas 196,80,36
s_lshl2_add_u32 s59, s94, s59
rtv 66,32,22528
s_lshl_b32 s59, s59, 14
mvvas 232,80,40
s_add_u32 s59, s59, 4096
rtv 68,32,24576
s_add_u32 s59, s59, s84
mvvas 232,84,56
buffer_load_dwordx4 a[80:83], v5, s[64:67], s59 offen offset:0 sc1
mvvas 236,84,60
rtv 70,32,26624
s_add_u32 s87, s83, 749568
mvvas 236,80,44
v_mul_f32 v189, v189, v55
v_add_u32 v40, 122880, v32
mvvas 200,88,32
v_mul_f32 v190, v190, v55
v_add_u32 v41, 122880, v33
mvvas 200,92,48
rtv 72,33,20480
v_mul_f32 v191, v191, v55
mvvas 204,92,52
s_waitcnt lgkmcnt(3)
rtv 74,33,22528
v_cvt_pk_bf16_f32 v172, v172, v173
mvvas 204,88,36
buffer_load_dwordx4 a[84:87], v5, s[64:67], s59 offen offset:1024 sc1
mvvas 248,88,40
s_add_u32 s59, s30, 0
v_cvt_pk_bf16_f32 v173, v174, v175
v_add_u32 v42, 122880, v34
mvvas 248,92,56
s_and_b32 s59, s59, 3
rtv 76,33,24576
v_cvt_pk_bf16_f32 v174, v188, v189
mvvas 252,92,60
s_lshl2_add_u32 s59, s94, s59
rtv 78,33,26624
v_add_u32 v43, 122880, v35
mvvas 252,88,44
s_lshl_b32 s59, s59, 14
v_cvt_pk_bf16_f32 v175, v190, v191
v_mul_f32 v160, v160, v52
mvvas 96,64,208
buffer_store_dwordx4 v[172:175], v6, s[64:67], s87 offen offset:2048 sc1
rtv 80,34,20480
v_mul_f32 v161, v161, v52
v_mul_f32 v162, v162, v52
s_waitcnt lgkmcnt(5)
mvvas 96,68,224
s_add_u32 s59, s59, 8192
rtv 82,34,22528
v_mul_f32 v163, v163, v52
mvvas 100,68,228
s_add_u32 s59, s59, s84
rtv 84,34,24576
v_mul_f32 v176, v176, v52
mvvas 100,64,212
buffer_load_dwordx4 a[96:99], v5, s[64:67], s59 offen offset:0 sc1
mvvas 208,64,216
s_add_u32 s87, s83, 4096
rtv 86,34,26624
v_mul_f32 v177, v177, v52
mvvas 208,68,232
v_mul_f32 v178, v178, v52
v_mul_f32 v179, v179, v52
mvvas 212,68,236
s_waitcnt lgkmcnt(6)
v_cvt_pk_bf16_f32 v160, v160, v161
v_cvt_pk_bf16_f32 v161, v162, v163
mvvas 212,64,220
buffer_load_dwordx4 a[100:103], v5, s[64:67], s59 offen offset:1024 sc1
mvvas 104,72,208
s_waitcnt lgkmcnt(4)
rtv 88,35,20480
v_cvt_pk_bf16_f32 v162, v176, v177
mvvas 104,76,224
s_add_u32 s59, s30, 0
rtv 90,35,22528
v_cvt_pk_bf16_f32 v163, v178, v179
mvvas 108,76,228
s_and_b32 s59, s59, 3
rtv 92,35,24576
v_mul_f32 v164, v164, v53
mvvas 108,72,212
s_lshl2_add_u32 s59, s94, s59
rtv 94,35,26624
v_mul_f32 v165, v165, v53
mvvas 216,72,216
buffer_store_dwordx4 v[160:163], v6, s[64:67], s87 offen offset:0 sc1
v_mul_f32 v166, v166, v53
v_mul_f32 v167, v167, v53
s_lshl_b32 s59, s59, 14
mvvas 216,76,232
s_add_u32 s59, s59, 12288
v_mul_f32 v180, v180, v53
s_add_u32 s59, s59, s84
mvvas 220,76,236
v_mul_f32 v181, v181, v53
v_accvgpr_read_b32 v16, a204
mvvas 220,72,220
s_waitcnt lgkmcnt(4)
rtv 64,32,28672
v_mul_f32 v182, v182, v53
mvvas 112,80,208
rtv 66,32,30720
v_mul_f32 v183, v183, v53
mvvas 112,84,224
buffer_load_dwordx4 a[112:115], v5, s[64:67], s59 offen offset:0 sc1
mvvas 116,84,228
rtv 68,32,32768
v_accvgpr_read_b32 v17, a205
mvvas 116,80,212
s_add_u32 s87, s83, 4096
rtv 70,32,34816
v_cvt_pk_bf16_f32 v164, v164, v165
mvvas 224,80,216
v_accvgpr_read_b32 v18, a206
v_cvt_pk_bf16_f32 v165, v166, v167
mvvas 224,84,232
buffer_load_dwordx4 a[116:119], v5, s[64:67], s59 offen offset:1024 sc1
mvvas 228,84,236
v_cvt_pk_bf16_f32 v166, v180, v181
v_accvgpr_read_b32 v19, a207
mvvas 228,80,220
s_waitcnt lgkmcnt(4)
rtv 72,33,28672
v_cvt_pk_bf16_f32 v167, v182, v183
mvvas 120,88,208
s_add_u32 s58, s30, 1
rtv 74,33,30720
v_add_f32 v16, 1.0, v16
mvvas 120,92,224
s_and_b32 s58, s58, 3
rtv 76,33,32768
v_add_f32 v17, 1.0, v17
mvvas 124,92,228
buffer_store_dwordx4 v[164:167], v6, s[64:67], s87 offen offset:2048 sc1
v_add_f32 v18, 1.0, v18
s_lshl2_add_u32 s58, s94, s58
s_mul_i32 s58, s58, 163840
mvvas 124,88,212
s_add_u32 m0, s61, 122880
rtv 78,33,34816
v_add_f32 v19, 1.0, v19
mvvas 240,88,216
s_add_u32 s87, s58, s52
v_rcp_f32 v16, v16
mvvas 240,92,232
v_rcp_f32 v17, v17
mvvas 244,92,236
s_waitcnt lgkmcnt(4)
v_rcp_f32 v18, v18
mvvas 244,88,220
buffer_load_dwordx4 v1, s[44:47], s87 offen lds
mvvas 192,64,208
s_add_u32 m0, s61, 123904
v_rcp_f32 v19, v19
mvvas 192,68,224
s_add_u32 s87, s58, s53
rtv 80,32,40960
s_bitcmp1_b32 s94, 0
mvvas 196,68,228
s_cselect_b64 vcc, -1, 0
rtv 82,32,43008
v_cndmask_b32 v20, v16, v17, vcc
mvvas 196,64,212
s_bitcmp1_b32 s94, 1
rtv 84,33,40960
v_cndmask_b32 v21, v18, v19, vcc
mvvas 232,64,216
buffer_load_dwordx4 v1, s[44:47], s87 offen lds
mvvas 232,68,232
s_cselect_b64 vcc, -1, 0
rtv 86,33,43008
s_add_u32 m0, s62, 122880
mvvas 236,68,236
s_add_u32 s87, s58, s54
v_cndmask_b32 v20, v20, v21, vcc
v_lshrrev_b32 v4, 4, v2
mvvas 236,64,220
rtv 88,34,40960
s_waitcnt lgkmcnt(5)
mvvas 200,72,208
mvvas 200,76,224
rtv 90,34,43008
v_and_b32 v52, 15, v4
mvvas 204,76,228
mvvas 204,72,212
rtv 92,35,40960
mvvas 248,72,216
s_waitcnt vmcnt(15)
v_cmp_gt_u32 vcc, 3, v24
s_waitcnt lgkmcnt(5)
mvvas 248,76,232
s_cbranch_vccnz PA_spin
PA_ok:
rtv 94,35,43008
mvvas 252,76,236
buffer_load_dwordx4 v1, s[44:47], s87 offen lds
mvvas 252,72,220
s_add_u32 m0, s62, 123904
rtv 64,32,49152
s_add_u32 s87, s58, s55
mvvas 96,80,240
buffer_load_dwordx4 v1, s[44:47], s87 offen lds
mvvas 100,80,244
s_add_u32 m0, s57, 139264
rtv 66,32,51200
v_lshrrev_b32 v4, 4, v4
mvvas 208,80,248
v_lshlrev_b32 v53, 2, v4
s_waitcnt lgkmcnt(5)
mvvas 212,80,252
buffer_load_dwordx4 v28, s[44:47], s58 offen lds
mvvas 104,84,240
s_add_u32 s58, s58, 81920
rtv 68,33,49152
v_lshlrev_b32 v4, 3, v4
mvvas 108,84,244
s_add_u32 m0, s61, 143360
rtv 70,33,51200
s_add_u32 s87, s58, s52
mvvas 216,84,248
mvvas 220,84,252
rtv 72,34,8192
s_waitcnt lgkmcnt(6)
mvvas 112,88,240
rtv 74,34,10240
v_mul_u32_u24 v54, 1280, v52
mvvas 116,88,244
buffer_load_dwordx4 v1, s[44:47], s87 offen lds
mvvas 224,88,248
s_add_u32 m0, s61, 144384
rtv 76,34,12288
s_add_u32 s87, s58, s53
mvvas 228,88,252
rtv 78,34,14336
s_waitcnt lgkmcnt(7)
mvvas 120,92,240
v_add_u32 v4, v4, v54
mvvas 124,92,244
buffer_load_dwordx4 v1, s[44:47], s87 offen lds
mvvas 240,92,248
s_add_u32 m0, s62, 143360
s_add_u32 s87, s58, s54
mvvas 244,92,252
s_waitcnt lgkmcnt(5)
rtv 80,35,8192
v_and_b32 v53, 4, v53
mvvas 192,64,240
rtv 82,35,10240
mvvas 196,64,244
rtv 84,35,12288
s_waitcnt lgkmcnt(7)
mvvas 232,64,248
buffer_load_dwordx4 v1, s[44:47], s87 offen lds
mvvas 236,64,252
s_add_u32 m0, s62, 144384
rtv 86,35,14336
v_sub_u32 v52, v52, v53
mvvas 200,68,240
s_add_u32 s87, s58, s55
mvvas 204,68,244
mvvas 248,68,248
mvvas 252,68,252
s_waitcnt lgkmcnt(4)
rtv 88,9,16384
v_mov_b32 v54, 0x3f80
mvvaz 184,72,0
buffer_load_dwordx4 v1, s[44:47], s87 offen lds
mvvas 184,76,16
rtv 90,9,17408
s_add_u32 m0, s57, 159744
mvvaz 188,76,20
s_add_u32 s59, s30, 1
rtv 92,9,18432
s_and_b32 s59, s59, 3
mvvas 188,72,4
s_lshl2_add_u32 s59, s94, s59
rtv 94,9,19456
v_mov_b32 v55, 1.0
mvvaz 152,72,8
buffer_load_dwordx4 v28, s[44:47], s58 offen lds
mvvas 152,76,24
s_lshl_b32 s59, s59, 14
s_add_u32 s59, s59, 0
s_add_u32 s59, s59, s84
mvvaz 156,76,28
v_cmp_eq_u32 vcc, 0, v52
mvvas 156,72,12
s_waitcnt lgkmcnt(4)
rtv 64,10,16384
v_cndmask_b32 v44, 0, v54, vcc
mvvaz 144,80,0
rtv 66,10,17408
mvvas 144,84,16
buffer_load_dwordx4 a[128:131], v5, s[64:67], s59 offen offset:0 sc1
mvvaz 148,84,20
rtv 68,10,18432
v_cmp_eq_u32 vcc, 1, v52
mvvas 148,80,4
rtv 70,10,19456
v_cndmask_b32 v44, v44, v55, vcc
mvvaz 128,80,8
mvvas 128,84,24
s_waitcnt lgkmcnt(4)
mvvaz 132,84,28
buffer_load_dwordx4 a[132:135], v5, s[64:67], s59 offen offset:1024 sc1
mvvas 132,80,12
s_add_u32 s59, s30, 1
rtv 72,38,49152
v_cmp_eq_u32 vcc, 2, v52
mvvaz 176,88,0
s_and_b32 s59, s59, 3
rtv 74,38,51200
v_mov_b32 v27, 4
mvvas 176,92,16
s_lshl2_add_u32 s59, s94, s59
rtv 76,38,53248
v_cndmask_b32 v45, 0, v54, vcc
mvvaz 180,92,20
s_lshl_b32 s59, s59, 14
v_cmp_eq_u32 vcc, 3, v52
s_add_u32 s59, s59, 4096
mvvas 180,88,4
s_add_u32 s59, s59, s84
rtv 78,38,55296
v_cndmask_b32 v45, v45, v55, vcc
mvvaz 136,88,8
buffer_load_dwordx4 a[144:147], v5, s[64:67], s59 offen offset:0 sc1
mvvas 136,92,24
v_cmp_eq_u32 vcc, 8, v52
mvvaz 140,92,28
s_nop 0
v_cndmask_b32 v46, 0, v54, vcc
mvvas 140,88,12
rtv 80,39,49152
s_waitcnt lgkmcnt(5)
mvvaz 168,64,0
buffer_load_dwordx4 a[148:151], v5, s[64:67], s59 offen offset:1024 sc1
mvvas 168,68,16
s_add_u32 s59, s30, 1
rtv 82,39,51200
v_cmp_eq_u32 vcc, 9, v52
mvvaz 172,68,20
s_and_b32 s59, s59, 3
rtv 84,39,53248
v_cndmask_b32 v46, v46, v55, vcc
mvvas 172,64,4
s_lshl2_add_u32 s59, s94, s59
rtv 86,39,55296
s_lshl_b32 s59, s59, 14
mvvaz 160,64,8
s_add_u32 s59, s59, 8192
v_cmp_eq_u32 vcc, 10, v52
s_add_u32 s59, s59, s84
mvvas 160,68,24
v_cndmask_b32 v47, 0, v54, vcc
mvvaz 164,68,28
s_waitcnt vmcnt(14)
s_waitcnt lgkmcnt(4)
mvvas 164,64,12
buffer_store_dword v27, off, s[64:67], s100 sc1
mvvas 184,72,32
buffer_load_dwordx4 a[160:163], v5, s[64:67], s59 offen offset:0 sc1
mvvas 184,76,48
rtv 88,11,57344
v_cmp_eq_u32 vcc, 11, v52
mvvas 188,76,52
s_waitcnt lgkmcnt(3)
rtv 90,11,58368
v_cndmask_b32 v47, v47, v55, vcc
mvvas 188,72,36
buffer_load_dwordx4 a[164:167], v5, s[64:67], s59 offen offset:1024 sc1
mvvas 152,72,40
s_add_u32 s59, s30, 1
rtv 92,11,59392
s_and_b32 s59, s59, 3
mvvas 152,76,56
s_lshl2_add_u32 s59, s94, s59
rtv 94,11,60416
v_lshrrev_b32 v7, 9, v2
mvvas 156,76,60
s_lshl_b32 s59, s59, 14
s_add_u32 s59, s59, 12288
s_add_u32 s59, s59, s84
mvvas 156,72,44
buffer_load_dwordx4 a[176:179], v5, s[64:67], s59 offen offset:0 sc1
mvvas 144,80,32
s_waitcnt lgkmcnt(4)
rtv 64,12,57344
v_mul_u32_u24 v7, 73216, v7
mvvas 144,84,48
rtv 66,12,58368
mvvas 148,84,52
rtv 68,12,59392
mvvas 148,80,36
rtv 70,12,60416
v_add_u32 v7, v7, v2
mvvas 128,80,40
buffer_load_dwordx4 a[180:183], v5, s[64:67], s59 offen offset:1024 sc1
mvvas 128,84,56
s_add_u32 s59, s30, 2
s_and_b32 s59, s59, 3
s_lshl2_add_u32 s59, s94, s59
mvvas 132,84,60
s_lshl_b32 s59, s59, 14
s_add_u32 s59, s59, 0
s_add_u32 s59, s59, s84
mvvas 132,80,44
s_waitcnt lgkmcnt(5)
rtv 72,34,28672
v_min_u32 v8, 368, v2
mvvas 176,88,32
rtv 74,34,30720
s_waitcnt lgkmcnt(6)
mvvas 176,92,48
buffer_load_dwordx4 a[192:195], v5, s[64:67], s59 offen offset:0 sc1
mvvas 180,92,52
rtv 76,34,32768
mvvas 180,88,36
rtv 78,34,34816
v_lshlrev_b32 v54, 6, v8
mvvas 136,88,40
mvvas 136,92,56
s_waitcnt lgkmcnt(4)
mvvas 140,92,60
buffer_load_dwordx4 a[196:199], v5, s[64:67], s59 offen offset:1024 sc1
mvvas 140,88,44
s_add_u32 s59, s30, 2
rtv 80,35,28672
v_lshlrev_b32 v8, 5, v8
mvvas 168,64,32
s_and_b32 s59, s59, 3
rtv 82,35,30720
s_lshl2_add_u32 s59, s94, s59
mvvas 168,68,48
s_lshl_b32 s59, s59, 14
rtv 84,35,32768
s_add_u32 s59, s59, 4096
mvvas 172,68,52
v_add_u32 v8, 5632, v8
s_add_u32 s59, s59, s84
mvvas 172,64,36
buffer_load_dwordx4 a[0:3], v5, s[64:67], s59 offen offset:0 sc1
mvvas 160,64,40
rtv 86,35,34816
mvvas 160,68,56
mvvas 164,68,60
v_add_u32 v55, -1024, v54
mvvas 164,64,44
rtv 88,9,36864
s_waitcnt lgkmcnt(5)
mvvas 184,72,208
buffer_load_dwordx4 a[4:7], v5, s[64:67], s59 offen offset:1024 sc1
mvvas 184,76,224
s_add_u32 s59, s30, 2
rtv 90,9,37888
v_cmp_gt_u32 vcc, 256, v2
mvvas 188,76,228
s_and_b32 s59, s59, 3
rtv 92,9,38912
v_cndmask_b32 v8, v8, v55, vcc
mvvas 188,72,212
s_lshl2_add_u32 s59, s94, s59
rtv 94,9,39936
s_lshl_b32 s59, s59, 14
mvvas 152,72,216
s_add_u32 s59, s59, 8192
s_add_u32 s59, s59, s84
mvvas 152,76,232
buffer_load_dwordx4 a[16:19], v5, s[64:67], s59 offen offset:0 sc1
mvvas 156,76,236
v_cmp_gt_u32 vcc, 128, v2
mvvas 156,72,220
s_waitcnt lgkmcnt(4)
rtv 64,10,36864
v_cndmask_b32 v8, v8, v54, vcc
mvvas 144,80,208
rtv 66,10,37888
mvvas 144,84,224
rtv 68,10,38912
mvvas 148,84,228
buffer_load_dwordx4 a[20:23], v5, s[64:67], s59 offen offset:1024 sc1
mvvas 148,80,212
s_add_u32 s59, s30, 2
rtv 70,10,39936
s_and_b32 s59, s59, 3
mvvas 128,80,216
s_lshl2_add_u32 s59, s94, s59
s_lshl_b32 s59, s59, 14
s_add_u32 s59, s59, 12288
mvvas 128,84,232
s_add_u32 s59, s59, s84
mvvas 132,84,236
s_waitcnt lgkmcnt(4)
mvvas 132,80,220
buffer_load_dwordx4 a[32:35], v5, s[64:67], s59 offen offset:0 sc1
mvvas 176,88,208
s_and_b32 s5, s30, 3
rtv 72,34,49152
s_lshl2_add_u32 s5, s31, s5
mvvas 176,92,224
s_lshl_b32 s5, s5, 5
rtv 74,34,51200
s_add_u32 s5, s5, s80
mvvas 180,92,228
s_mul_i32 s5, s5, 18432
s_add_u32 s56, s5, 100663296
mvvas 180,88,212
rtv 76,35,49152
mvvas 136,88,216
buffer_load_dwordx4 a[36:39], v5, s[64:67], s59 offen offset:1024 sc1
mvvas 136,92,232
s_add_u32 s59, s30, 3
rtv 78,35,51200
s_and_b32 s59, s59, 3
mvvas 140,92,236
s_lshl2_add_u32 s59, s94, s59
s_lshl_b32 s59, s59, 14
s_add_u32 s59, s59, 0
mvvas 140,88,220
s_waitcnt lgkmcnt(4)
rtv 80,9,57344
s_add_u32 s59, s59, s84
mvvas 168,64,208
mvvas 168,68,224
buffer_load_dwordx4 a[48:51], v5, s[64:67], s59 offen offset:0 sc1
mvvas 172,68,228
rtv 82,9,58368
mvvas 172,64,212
rtv 84,10,57344
mvvas 160,64,216
mvvas 160,68,232
rtv 86,10,58368
mvvas 164,68,236
mvvas 164,64,220
s_waitcnt lgkmcnt(5)
mvvas 184,72,240
mvvas 188,72,244
s_waitcnt lgkmcnt(0)
s_barrier
mvvas 152,72,248
buffer_load_dwordx4 a[52:55], v5, s[64:67], s59 offen offset:1024 sc1
mvvas 156,72,252
s_add_u32 s58, s30, 2
rtv 88,11,16384
s_and_b32 s58, s58, 3
mvvas 144,76,240
s_lshl2_add_u32 s58, s94, s58
rtv 90,11,17408
s_mul_i32 s58, s58, 163840
mvvas 148,76,244
s_add_u32 m0, s61, 0
rtv 92,11,18432
s_add_u32 s87, s58, s52
mvvas 128,76,248
rtv 94,11,19456
mvvas 132,76,252
rtv 64,12,16384
mvvas 176,80,240
buffer_load_dwordx4 v1, s[44:47], s87 offen lds
mvvas 180,80,244
s_add_u32 m0, s61, 1024
rtv 66,12,17408
rtv 68,12,18432
mvvas 136,80,248
rtv 70,12,19456
s_add_u32 s87, s58, s53
mvvas 140,80,252
rtv 72,36,0
mvvas 168,84,240
rtv 74,36,2048
mvvas 172,84,244
buffer_load_dwordx4 v1, s[44:47], s87 offen lds
mvvas 160,84,248
s_add_u32 m0, s62, 0
rtv 76,36,4096
rtv 78,36,6144
mvvas 164,84,252
s_waitcnt lgkmcnt(10)
rtv 80,37,0
s_add_u32 s87, s58, s54
mvvas 176,88,64
rtv 82,37,2048
s_waitcnt lgkmcnt(10)
mvvas 176,92,80
rtv 84,37,4096
s_waitcnt lgkmcnt(9)
mvvas 180,92,84
buffer_load_dwordx4 v1, s[44:47], s87 offen lds
mvvas 180,88,68
s_add_u32 m0, s62, 1024
rtv 86,37,6144
s_add_u32 s87, s58, s55
mvvas 168,64,64
s_waitcnt lgkmcnt(8)
rtv 88,38,0
v_lshrrev_b32 v26, 2, v2
mvvas 168,68,80
rtv 90,38,2048
v_and_b32 v26, 60, v26
mvvas 172,68,84
buffer_load_dwordx4 v1, s[44:47], s87 offen lds
mvvas 172,64,68
s_waitcnt lgkmcnt(8)
rtv 92,38,4096
s_add_u32 m0, s57, 16384
mvvas 96,72,64
rtv 94,38,6144
s_waitcnt lgkmcnt(8)
mvvas 96,76,80
rtv 64,39,0
mvvas 100,76,84
rtv 66,39,2048
s_and_b32 s81, s100, -64
mvvas 100,72,68
rtv 68,39,4096
s_waitcnt lgkmcnt(7)
mvvas 104,80,64
buffer_load_dwordx4 v28, s[44:47], s58 offen lds
mvvas 104,84,80
s_add_u32 s58, s58, 81920
rtv 70,39,6144
rtv 72,36,8192
mvvas 108,84,84
s_add_u32 m0, s61, 102400
rtv 74,36,10240
s_add_u32 s87, s58, s52
mvvas 108,80,68
rtv 76,36,12288
s_waitcnt lgkmcnt(9)
mvvas 112,88,64
rtv 78,36,14336
s_waitcnt lgkmcnt(8)
mvvas 112,92,80
buffer_load_dwordx4 v1, s[44:47], s87 offen lds
mvvas 116,92,84
s_add_u32 m0, s61, 103424
rtv 80,37,8192
rtv 82,37,10240
mvvas 116,88,68
s_waitcnt lgkmcnt(8)
rtv 84,37,12288
s_add_u32 s87, s58, s53
mvvas 120,64,64
rtv 86,37,14336
s_waitcnt lgkmcnt(8)
mvvas 120,68,80
rtv 88,38,8192
s_waitcnt lgkmcnt(7)
mvvas 124,68,84
buffer_load_dword v24, v26, s[64:67], s81 offen sc1
mvvas 124,64,68
buffer_load_dwordx4 v1, s[44:47], s87 offen lds
rtv 90,38,10240
mvvas 192,72,64
s_add_u32 m0, s62, 102400
rtv 92,38,12288
rtv 94,38,14336
s_waitcnt lgkmcnt(8)
mvvas 192,76,80
rtv 64,11,36864
s_add_u32 s87, s58, s54
mvvas 196,76,84
rtv 66,11,37888
s_waitcnt lgkmcnt(6)
mvvas 196,72,68
buffer_load_dwordx4 v1, s[44:47], s87 offen lds
mvvas 200,80,64
s_add_u32 m0, s62, 103424
rtv 68,11,38912
rtv 70,11,39936
mvvas 200,84,80
rtv 72,12,36864
s_add_u32 s87, s58, s55
mvvas 204,84,84
rtv 74,12,37888
mvvas 204,80,68
rtv 76,12,38912
s_waitcnt lgkmcnt(7)
mvvas 184,88,64
buffer_load_dwordx4 v1, s[44:47], s87 offen lds
mvvas 184,92,80
s_add_u32 m0, s57, 118784
rtv 78,12,39936
rtv 80,36,20480
mvvas 188,92,84
rtv 82,36,22528
mvvas 188,88,68
rtv 84,36,24576
s_waitcnt lgkmcnt(9)
mvvas 176,64,96
rtv 86,36,26624
s_waitcnt lgkmcnt(8)
mvvas 176,68,112
buffer_load_dwordx4 v28, s[44:47], s58 offen lds
mvvas 180,68,116
s_add_u32 s58, s30, 3
rtv 88,37,20480
rtv 90,37,22528
mvvas 180,64,100
s_and_b32 s58, s58, 3
rtv 92,37,24576
s_lshl2_add_u32 s58, s94, s58
s_waitcnt lgkmcnt(9)
mvvas 168,72,96
s_mul_i32 s58, s58, 163840
rtv 94,37,26624
s_add_u32 m0, s61, 20480
s_waitcnt lgkmcnt(8)
mvvas 168,76,112
s_waitcnt lgkmcnt(6)
rtv 64,38,20480
s_add_u32 s87, s58, s52
mvvas 172,76,116
buffer_load_dwordx4 v1, s[44:47], s87 offen lds
mvvas 172,72,100
s_add_u32 m0, s61, 21504
rtv 66,38,22528
rtv 68,38,24576
mvvas 96,80,96
s_waitcnt lgkmcnt(7)
rtv 70,38,26624
s_add_u32 s87, s58, s53
mvvas 96,84,112
rtv 72,39,20480
mvvas 100,84,116
rtv 74,39,22528
s_waitcnt lgkmcnt(8)
mvvas 100,80,100
buffer_load_dwordx4 v1, s[44:47], s87 offen lds
mvvas 104,88,96
s_add_u32 m0, s62, 20480
rtv 76,39,24576
rtv 78,39,26624
s_waitcnt lgkmcnt(8)
mvvas 104,92,112
s_add_u32 s87, s58, s54
rtv 80,36,28672
s_mov_b32 s42, 2621440
mvvas 108,92,116
rtv 82,36,30720
s_mov_b32 s43, 0x20000
mvvas 108,88,100
rtv 84,36,32768
s_waitcnt lgkmcnt(7)
mvvas 112,64,96
buffer_load_dwordx4 v1, s[44:47], s87 offen lds
mvvas 112,68,112
s_add_u32 m0, s62, 21504
rtv 86,36,34816
rtv 88,37,28672
mvvas 116,68,116
rtv 90,37,30720
s_add_u32 s87, s58, s55
mvvas 116,64,100
rtv 92,37,32768
s_waitcnt lgkmcnt(9)
mvvas 120,72,96
rtv 94,37,34816
s_waitcnt lgkmcnt(8)
mvvas 120,76,112
buffer_load_dwordx4 v1, s[44:47], s87 offen lds
mvvas 124,76,116
rtv 64,38,28672
rtv 66,38,30720
rtv 68,38,32768
mvvas 124,72,100
s_load_dwordx2 s[40:41], s[0:1], 88
rtv 70,38,34816
s_waitcnt vmcnt(34) lgkmcnt(0)
s_barrier
mvvas 192,80,96
rtv 72,13,16384
s_add_u32 m0, s57, 36864
mvvas 192,84,112
buffer_load_dwordx4 v28, s[44:47], s58 offen lds
mvvas 196,84,116
s_add_u32 s58, s58, 81920
rtv 74,13,17408
s_add_u32 m0, s61, 40960
mvvas 196,80,100
rtv 76,13,18432
s_add_u32 s87, s58, s52
mvvas 200,88,96
rtv 78,13,19456
mvvas 200,92,112
rtv 80,14,16384
mvvas 204,92,116
rtv 82,14,17408
mvvas 204,88,100
buffer_load_dwordx4 v1, s[44:47], s87 offen lds
mvvas 184,64,96
s_add_u32 m0, s61, 41984
rtv 84,14,18432
rtv 86,14,19456
mvvas 184,68,112
rtv 88,40,0
s_add_u32 s87, s58, s53
mvvas 188,68,116
rtv 90,40,2048
mvvas 188,64,100
rtv 92,40,4096
s_waitcnt vmcnt(32) lgkmcnt(7)
mvvas 176,72,128
buffer_load_dwordx4 v1, s[44:47], s87 offen lds
mvvas 176,76,144
s_add_u32 m0, s62, 40960
rtv 94,40,6144
rtv 64,41,0
mvvas 180,76,148
rtv 66,41,2048
s_add_u32 s87, s58, s54
mvvas 180,72,132
rtv 68,41,4096
s_waitcnt lgkmcnt(9)
mvvas 168,80,128
rtv 70,41,6144
s_waitcnt lgkmcnt(8)
mvvas 168,84,144
buffer_load_dwordx4 v1, s[44:47], s87 offen lds
mvvas 172,84,148
s_add_u32 m0, s62, 41984
rtv 72,42,0
rtv 74,42,2048
mvvas 172,80,132
s_waitcnt lgkmcnt(8)
rtv 76,42,4096
s_add_u32 s87, s58, s55
mvvas 96,88,128
s_add_u32 s59, s30, 3
rtv 78,42,6144
s_and_b32 s59, s59, 3
s_waitcnt lgkmcnt(8)
mvvas 96,92,144
s_lshl2_add_u32 s59, s94, s59
rtv 80,43,0
s_lshl_b32 s59, s59, 14
mvvas 100,92,148
buffer_load_dwordx4 v1, s[44:47], s87 offen lds
mvvas 100,88,132
s_add_u32 m0, s57, 57344
rtv 82,43,2048
rtv 84,43,4096
s_waitcnt lgkmcnt(7)
mvvas 104,64,128
s_add_u32 s59, s59, 4096
rtv 86,43,6144
s_add_u32 s59, s59, s84
mvvas 104,68,144
rtv 88,40,8192
mvvas 108,68,148
rtv 90,40,10240
s_waitcnt lgkmcnt(8)
mvvas 108,64,132
buffer_load_dwordx4 v28, s[44:47], s58 offen lds
mvvas 112,72,128
s_waitcnt lgkmcnt(6)
rtv 92,40,12288
rtv 94,40,14336
mvvas 112,76,144
rtv 64,41,8192
mvvas 116,76,148
rtv 66,41,10240
mvvas 116,72,132
rtv 68,41,12288
s_waitcnt lgkmcnt(7)
mvvas 120,80,128
buffer_load_dwordx4 a[208:211], v5, s[64:67], s59 offen offset:0 sc1
mvvas 120,84,144
rtv 70,41,14336
rtv 72,42,8192
mvvas 124,84,148
rtv 74,42,10240
mvvas 124,80,132
rtv 76,42,12288
s_waitcnt lgkmcnt(9)
mvvas 192,88,128
rtv 78,42,14336
s_waitcnt lgkmcnt(8)
mvvas 192,92,144
buffer_load_dwordx4 a[212:215], v5, s[64:67], s59 offen offset:1024 sc1
mvvas 196,92,148
s_add_u32 s59, s30, 3
rtv 80,13,36864
rtv 82,13,37888
mvvas 196,88,132
s_and_b32 s59, s59, 3
rtv 84,13,38912
s_lshl2_add_u32 s59, s94, s59
s_waitcnt vmcnt(16) lgkmcnt(9)
mvvas 200,64,128
s_lshl_b32 s59, s59, 14
rtv 86,13,39936
v_cmp_gt_u32 vcc, 4, v24
s_waitcnt lgkmcnt(6)
mvvas 200,68,144
s_add_u32 s59, s59, 8192
rtv 88,14,36864
s_add_u32 s59, s59, s84
mvvas 204,68,148
s_cbranch_vccnz PCB_spin
PCB_ok:
rtv 90,14,37888
mvvas 204,64,132
buffer_load_dwordx4 a[224:227], v5, s[64:67], s59 offen offset:0 sc1
mvvas 184,72,128
s_waitcnt lgkmcnt(6)
rtv 92,14,38912
rtv 94,14,39936
mvvas 184,76,144
rtv 64,40,20480
mvvas 188,76,148
rtv 66,40,22528
s_waitcnt lgkmcnt(8)
mvvas 188,72,132
buffer_load_dwordx4 a[228:231], v5, s[64:67], s59 offen offset:1024 sc1
mvvas 176,80,160
s_add_u32 s59, s30, 3
rtv 68,40,24576
rtv 70,40,26624
s_waitcnt lgkmcnt(8)
mvvas 176,84,176
s_and_b32 s59, s59, 3
rtv 72,41,20480
s_lshl2_add_u32 s59, s94, s59
mvvas 180,84,180
s_lshl_b32 s59, s59, 14
rtv 74,41,22528
s_add_u32 s59, s59, 12288
mvvas 180,80,164
s_waitcnt lgkmcnt(6)
rtv 76,41,24576
s_add_u32 s59, s59, s84
mvvas 168,88,160
buffer_load_dwordx4 a[240:243], v5, s[64:67], s59 offen offset:0 sc1
mvvas 168,92,176
rtv 78,41,26624
rtv 80,42,20480
mvvas 172,92,180
rtv 82,42,22528
mvvas 172,88,164
rtv 84,42,24576
s_waitcnt lgkmcnt(9)
mvvas 96,64,160
rtv 86,42,26624
s_waitcnt lgkmcnt(8)
mvvas 96,68,176
buffer_load_dwordx4 a[244:247], v5, s[64:67], s59 offen offset:1024 sc1
mvvas 100,68,180
s_add_u32 s59, s30, 0
rtv 88,43,20480
rtv 90,43,22528
mvvas 100,64,164
s_and_b32 s59, s59, 3
rtv 92,43,24576
s_lshl2_add_u32 s59, s94, s59
s_waitcnt lgkmcnt(9)
mvvas 104,72,160
s_lshl_b32 s59, s59, 14
rtv 94,43,26624
s_add_u32 s59, s59, 0
s_waitcnt lgkmcnt(8)
mvvas 104,76,176
rtv 64,40,28672
s_add_u32 s59, s59, s84
mvvas 108,76,180
buffer_load_dwordx4 a[72:75], v6, s[64:67], s59 offen offset:0 sc1
mvvas 108,72,164
s_waitcnt lgkmcnt(7)
rtv 66,40,30720
rtv 68,40,32768
mvvas 112,80,160
rtv 70,40,34816
s_waitcnt lgkmcnt(8)
mvvas 112,84,176
rtv 72,41,28672
mvvas 116,84,180
rtv 74,41,30720
s_waitcnt lgkmcnt(8)
mvvas 116,80,164
buffer_load_dwordx4 a[76:79], v6, s[64:67], s59 offen offset:1024 sc1
mvvas 120,88,160
s_add_u32 s59, s30, 0
rtv 76,41,32768
rtv 78,41,34816
s_waitcnt lgkmcnt(8)
mvvas 120,92,176
s_and_b32 s59, s59, 3
s_lshl2_add_u32 s59, s94, s59
s_lshl_b32 s59, s59, 14
s_add_u32 s59, s59, 4096
s_add_u32 s59, s59, s84
mvvas 124,92,180
buffer_load_dwordx4 a[88:91], v6, s[64:67], s59 offen offset:0 sc1
rtv 80,42,28672
rtv 82,42,30720
rtv 84,42,32768
rtv 86,42,34816
mvvas 124,88,164
s_waitcnt vmcnt(9) lgkmcnt(0)
s_barrier
mvvas 192,64,160
rtv 88,9,16384
mvvas 192,68,176
rtv 90,9,17408
mvvas 196,68,180
buffer_load_dwordx4 a[92:95], v6, s[64:67], s59 offen offset:1024 sc1
mvvas 196,64,164
s_add_u32 s59, s30, 0
rtv 92,9,18432
s_and_b32 s59, s59, 3
mvvas 200,72,160
s_lshl2_add_u32 s59, s94, s59
rtv 94,9,19456
s_lshl_b32 s59, s59, 14
mvvas 200,76,176
s_add_u32 s59, s59, 8192
rtv 64,11,57344
s_add_u32 s59, s59, s84
mvvas 204,76,180
rtv 66,11,58368
mvvas 204,72,164
rtv 68,11,59392
mvvas 184,80,160
buffer_load_dwordx4 a[104:107], v6, s[64:67], s59 offen offset:0 sc1
mvvas 184,84,176
rtv 70,11,60416
rtv 72,9,36864
mvvas 188,84,180
rtv 74,9,37888
mvvas 188,80,164
rtv 76,9,38912
s_waitcnt lgkmcnt(9)
mvvas 176,88,192
rtv 78,9,39936
s_waitcnt lgkmcnt(8)
mvvas 176,92,0
buffer_load_dwordx4 a[108:111], v6, s[64:67], s59 offen offset:1024 sc1
mvvas 180,92,4
s_add_u32 s59, s30, 0
rtv 80,9,57344
rtv 82,9,58368
mvvas 180,88,196
s_and_b32 s59, s59, 3
rtv 84,9,59392
s_lshl2_add_u32 s59, s94, s59
s_waitcnt lgkmcnt(9)
mvvas 176,64,16
s_lshl_b32 s59, s59, 14
rtv 86,9,60416
s_add_u32 s59, s59, 12288
s_waitcnt lgkmcnt(8)
mvvas 176,68,32
s_add_u32 s59, s59, s84
rtv 88,10,16384
mvvas 180,68,36
buffer_load_dwordx4 a[120:123], v6, s[64:67], s59 offen offset:0 sc1
mvvas 180,64,20
s_waitcnt lgkmcnt(7)
rtv 90,10,17408
rtv 92,10,18432
mvvas 176,72,48
rtv 94,10,19456
s_waitcnt vmcnt(12) lgkmcnt(8)
mvvas 176,76,208
rtv 64,12,57344
s_waitcnt vmcnt(11)
mvvas 180,76,212
rtv 66,12,58368
s_waitcnt vmcnt(10) lgkmcnt(8)
mvvas 180,72,52
buffer_load_dwordx4 a[124:127], v6, s[64:67], s59 offen offset:1024 sc1
mvvas 176,80,224
s_add_u32 s59, s30, 1
rtv 68,12,59392
rtv 70,12,60416
s_waitcnt vmcnt(8) lgkmcnt(8)
mvvas 176,84,240
s_and_b32 s59, s59, 3
rtv 72,10,36864
s_lshl2_add_u32 s59, s94, s59
mvvas 180,84,244
s_lshl_b32 s59, s59, 14
rtv 74,10,37888
s_add_u32 s59, s59, 0
mvvas 180,80,228
s_add_u32 s59, s59, s84
rtv 76,10,38912
v_cvt_pk_bf16_f32 v176, v176, v177
s_waitcnt lgkmcnt(7)
mvvas 168,88,192
buffer_load_dwordx4 a[136:139], v6, s[64:67], s59 offen offset:0 sc1
mvvas 168,92,0
s_waitcnt lgkmcnt(5)
rtv 78,10,39936
rtv 80,10,57344
mvvas 172,92,4
s_lshl_b32 s87, s94, 9
rtv 82,10,58368
v_cvt_pk_bf16_f32 v177, v178, v179
mvvas 172,88,196
s_add_u32 s87, s87, s56
rtv 84,10,59392
v_cvt_pk_bf16_f32 v178, v180, v181
mvvas 168,64,16
s_add_u32 s87, s87, 14336
rtv 86,10,60416
v_cvt_pk_bf16_f32 v179, v182, v183
s_waitcnt lgkmcnt(6)
mvvas 168,68,32
buffer_load_dwordx4 a[140:143], v6, s[64:67], s59 offen offset:1024 sc1
mvvas 172,68,36
s_add_u32 s59, s30, 1
rtv 88,32,0
rtv 90,32,2048
mvvas 172,64,20
s_and_b32 s59, s59, 3
rtv 92,32,4096
v_min_u32 v176, -2, v176
mvvas 168,72,48
s_lshl2_add_u32 s59, s94, s59
rtv 94,32,6144
v_min_u32 v177, -2, v177
s_waitcnt lgkmcnt(8)
mvvas 168,76,208
s_lshl_b32 s59, s59, 14
s_add_u32 s59, s59, 4096
s_add_u32 s59, s59, s84
mvvas 172,76,212
buffer_load_dwordx4 a[152:155], v6, s[64:67], s59 offen offset:0 sc1
rtv 64,36,40960
v_min_u32 v178, -2, v178
mvvas 172,72,52
s_waitcnt lgkmcnt(7)
rtv 66,36,43008
v_min_u32 v179, -2, v179
mvvas 168,80,224
s_waitcnt lgkmcnt(6)
rtv 68,36,45056
v_permlane32_swap_b32 v176, v178
mvvas 168,84,240
rtv 70,36,47104
v_permlane32_swap_b32 v177, v179
mvvas 172,84,244
s_waitcnt lgkmcnt(4)
rtv 72,32,20480
rtv 74,32,22528
mvvas 172,80,228
buffer_store_dwordx4 v[176:179], v7, s[64:67], s87 offen offset:0 sc1
buffer_load_dwordx4 a[156:159], v6, s[64:67], s59 offen offset:1024 sc1
rtv 76,32,24576
mvvas 96,88,192
s_add_u32 s59, s30, 1
rtv 78,32,26624
s_and_b32 s59, s59, 3
mvvas 96,92,0
s_lshl2_add_u32 s59, s94, s59
rtv 80,32,40960
s_lshl_b32 s59, s59, 14
mvvas 100,92,4
s_add_u32 s59, s59, 8192
rtv 82,32,43008
s_add_u32 s59, s59, s84
mvvas 100,88,196
s_lshl_b32 s87, s94, 9
rtv 84,32,45056
v_cvt_pk_bf16_f32 v168, v168, v169
s_waitcnt lgkmcnt(7)
mvvas 96,64,16
buffer_load_dwordx4 a[168:171], v6, s[64:67], s59 offen offset:0 sc1
mvvas 96,68,32
s_add_u32 s87, s87, s56
rtv 86,32,47104
v_cvt_pk_bf16_f32 v169, v170, v171
mvvas 100,68,36
s_add_u32 s87, s87, 309248
rtv 88,33,0
v_cvt_pk_bf16_f32 v170, v172, v173
mvvas 100,64,20
s_waitcnt lgkmcnt(7)
rtv 90,33,2048
v_cvt_pk_bf16_f32 v171, v174, v175
mvvas 96,72,48
s_waitcnt lgkmcnt(6)
rtv 92,33,4096
v_min_u32 v168, -2, v168
mvvas 96,76,208
buffer_load_dwordx4 a[172:175], v6, s[64:67], s59 offen offset:1024 sc1
rtv 94,33,6144
v_min_u32 v169, -2, v169
mvvas 100,76,212
s_add_u32 s59, s30, 1
rtv 64,37,40960
v_min_u32 v170, -2, v170
mvvas 100,72,52
s_and_b32 s59, s59, 3
rtv 66,37,43008
v_min_u32 v171, -2, v171
s_waitcnt lgkmcnt(6)
mvvas 96,80,224
s_lshl2_add_u32 s59, s94, s59
rtv 68,37,45056
v_permlane32_swap_b32 v168, v170
mvvas 96,84,240
s_lshl_b32 s59, s59, 14
rtv 70,37,47104
v_permlane32_swap_b32 v169, v171
s_add_u32 s59, s59, 12288
s_add_u32 s59, s59, s84
mvvas 100,84,244
buffer_store_dwordx4 v[168:171], v7, s[64:67], s87 offen offset:0 sc1
buffer_load_dwordx4 a[184:187], v6, s[64:67], s59 offen offset:0 sc1
rtv 72,33,20480
mvvas 100,80,228
s_waitcnt lgkmcnt(7)
rtv 74,33,22528
rtv 76,33,24576
mvvas 104,88,192
s_waitcnt lgkmcnt(7)
rtv 78,33,26624
v_cvt_pk_bf16_f32 v96, v96, v97
mvvas 104,92,0
s_waitcnt lgkmcnt(6)
rtv 80,33,40960
v_cvt_pk_bf16_f32 v97, v98, v99
mvvas 108,92,4
s_xor_b32 s87, s94, 7
rtv 82,33,43008
v_cvt_pk_bf16_f32 v98, v100, v101
mvvas 108,88,196
buffer_load_dwordx4 a[188:191], v6, s[64:67], s59 offen offset:1024 sc1
mvvas 104,64,16
s_add_u32 s59, s30, 2
rtv 84,33,45056
rtv 86,33,47104
s_waitcnt lgkmcnt(8)
mvvas 104,68,32
s_and_b32 s59, s59, 3
rtv 88,34,0
s_lshl2_add_u32 s59, s94, s59
mvvas 108,68,36
s_lshl_b32 s59, s59, 14
rtv 90,34,2048
s_add_u32 s59, s59, 0
mvvas 108,64,20
s_add_u32 s59, s59, s84
rtv 92,34,4096
v_cvt_pk_bf16_f32 v99, v102, v103
s_waitcnt lgkmcnt(7)
mvvas 104,72,48
buffer_load_dwordx4 a[200:203], v6, s[64:67], s59 offen offset:0 sc1
mvvas 104,76,208
s_mul_i32 s87, s87, 73728
rtv 94,34,6144
v_min_u32 v96, -2, v96
mvvas 108,76,212
s_add_u32 s87, s87, s56
rtv 64,38,40960
v_min_u32 v97, -2, v97
mvvas 108,72,52
s_add_u32 s87, s87, 13312
rtv 66,38,43008
rtv 68,38,45056
s_waitcnt lgkmcnt(9)
mvvas 104,80,224
s_waitcnt lgkmcnt(7)
v_min_u32 v98, -2, v98
v_min_u32 v99, -2, v99
mvvas 104,84,240
buffer_store_dwordx4 v[96:99], v2, s[64:67], s87 offen offset:0 sc1
buffer_load_dwordx4 a[204:207], v6, s[64:67], s59 offen offset:1024 sc1
rtv 70,38,47104
mvvas 108,84,244
s_add_u32 s59, s30, 2
rtv 72,34,20480
rtv 74,34,22528
mvvas 108,80,228
s_and_b32 s59, s59, 3
rtv 76,34,24576
s_lshl2_add_u32 s59, s94, s59
s_waitcnt lgkmcnt(7)
mvvas 112,88,192
s_lshl_b32 s59, s59, 14
rtv 78,34,26624
s_add_u32 s59, s59, 4096
mvvas 112,92,0
s_add_u32 s59, s59, s84
rtv 80,34,40960
v_cvt_pk_bf16_f32 v108, v108, v109
mvvas 116,92,4
buffer_load_dwordx4 a[8:11], v6, s[64:67], s59 offen offset:0 sc1
mvvas 116,88,196
s_xor_b32 s87, s94, 6
rtv 82,34,43008
rtv 84,34,45056
s_waitcnt lgkmcnt(9)
mvvas 112,64,16
s_mul_i32 s87, s87, 73728
rtv 86,34,47104
v_cvt_pk_bf16_f32 v109, v110, v111
s_waitcnt lgkmcnt(6)
mvvas 112,68,32
s_add_u32 s87, s87, s56
rtv 88,35,0
v_cvt_pk_bf16_f32 v110, v104, v105
mvvas 116,68,36
s_add_u32 s87, s87, 12288
rtv 90,35,2048
v_cvt_pk_bf16_f32 v111, v106, v107
mvvas 116,64,20
buffer_load_dwordx4 a[12:15], v6, s[64:67], s59 offen offset:1024 sc1
mvvas 112,72,48
s_add_u32 s59, s30, 2
rtv 92,35,4096
rtv 94,35,6144
s_waitcnt lgkmcnt(8)
mvvas 112,76,208
s_and_b32 s59, s59, 3
rtv 64,39,40960
v_min_u32 v108, -2, v108
mvvas 116,76,212
s_lshl2_add_u32 s59, s94, s59
rtv 66,39,43008
v_min_u32 v109, -2, v109
mvvas 116,72,52
s_lshl_b32 s59, s59, 14
s_add_u32 s59, s59, 8192
s_add_u32 s59, s59, s84
s_waitcnt lgkmcnt(6)
mvvas 112,80,224
buffer_load_dwordx4 a[24:27], v6, s[64:67], s59 offen offset:0 sc1
rtv 68,39,45056
v_min_u32 v110, -2, v110
mvvas 112,84,240
rtv 70,39,47104
v_min_u32 v111, -2, v111
mvvas 116,84,244
s_waitcnt lgkmcnt(6)
rtv 72,35,20480
rtv 74,35,22528
mvvas 116,80,228
buffer_store_dwordx4 v[108:111], v2, s[64:67], s87 offen offset:0 sc1
buffer_load_dwordx4 a[28:31], v6, s[64:67], s59 offen offset:1024 sc1
rtv 76,35,24576
mvvas 120,88,192
s_add_u32 s59, s30, 2
rtv 78,35,26624
v_cvt_pk_bf16_f32 v112, v112, v113
s_waitcnt lgkmcnt(6)
mvvas 120,92,0
s_and_b32 s59, s59, 3
rtv 80,35,40960
v_cvt_pk_bf16_f32 v113, v114, v115
mvvas 124,92,4
s_lshl2_add_u32 s59, s94, s59
rtv 82,35,43008
s_lshl_b32 s59, s59, 14
mvvas 124,88,196
s_add_u32 s59, s59, 12288
rtv 84,35,45056
s_add_u32 s59, s59, s84
mvvas 120,64,16
s_xor_b32 s87, s94, 5
rtv 86,35,47104
v_cvt_pk_bf16_f32 v114, v116, v117
s_waitcnt lgkmcnt(6)
mvvas 120,68,32
s_mul_i32 s87, s87, 73728
rtv 88,32,8192
v_cvt_pk_bf16_f32 v115, v118, v119
mvvas 124,68,36
buffer_load_dwordx4 a[40:43], v6, s[64:67], s59 offen offset:0 sc1
mvvas 124,64,20
s_add_u32 s87, s87, s56
rtv 90,32,10240
rtv 92,32,12288
mvvas 120,72,48
s_add_u32 s87, s87, 11264
rtv 94,32,14336
v_min_u32 v112, -2, v112
s_waitcnt lgkmcnt(8)
mvvas 120,76,208
rtv 64,36,49152
v_min_u32 v113, -2, v113
mvvas 124,76,212
s_waitcnt lgkmcnt(7)
rtv 66,36,51200
v_min_u32 v114, -2, v114
mvvas 124,72,52
buffer_load_dwordx4 a[44:47], v6, s[64:67], s59 offen offset:1024 sc1
mvvas 120,80,224
s_add_u32 s59, s30, 3
rtv 68,36,53248
rtv 70,36,55296
s_waitcnt lgkmcnt(8)
mvvas 120,84,240
s_and_b32 s59, s59, 3
rtv 72,32,28672
v_min_u32 v115, -2, v115
mvvas 124,84,244
buffer_store_dwordx4 v[112:115], v2, s[64:67], s87 offen offset:0 sc1
rtv 74,32,30720
s_lshl2_add_u32 s59, s94, s59
s_lshl_b32 s59, s59, 14
mvvas 124,80,228
s_add_u32 s59, s59, 0
s_add_u32 s59, s59, s84
rtv 76,32,32768
s_waitcnt lgkmcnt(7)
mvvas 192,88,192
buffer_load_dwordx4 a[56:59], v6, s[64:67], s59 offen offset:0 sc1
mvvas 192,92,0
s_waitcnt lgkmcnt(5)
rtv 78,32,34816
rtv 80,32,49152
mvvas 196,92,4
s_xor_b32 s87, s94, 4
rtv 82,32,51200
v_cvt_pk_bf16_f32 v124, v124, v125
mvvas 196,88,196
s_mul_i32 s87, s87, 73728
rtv 84,32,53248
v_cvt_pk_bf16_f32 v125, v126, v127
mvvas 192,64,16
s_add_u32 s87, s87, s56
rtv 86,32,55296
v_cvt_pk_bf16_f32 v126, v120, v121
s_waitcnt lgkmcnt(6)
mvvas 192,68,32
buffer_load_dwordx4 a[60:63], v6, s[64:67], s59 offen offset:1024 sc1
mvvas 196,68,36
s_add_u32 s59, s30, 3
rtv 88,33,8192
rtv 90,33,10240
mvvas 196,64,20
s_and_b32 s59, s59, 3
rtv 92,33,12288
v_cvt_pk_bf16_f32 v127, v122, v123
mvvas 192,72,48
s_lshl2_add_u32 s59, s94, s59
rtv 94,33,14336
v_min_u32 v124, -2, v124
s_waitcnt lgkmcnt(6)
mvvas 192,76,208
s_lshl_b32 s59, s59, 14
s_add_u32 s59, s59, 4096
s_add_u32 s59, s59, s84
mvvas 196,76,212
buffer_load_dwordx4 a[216:219], v6, s[64:67], s59 offen offset:0 sc1
rtv 64,37,49152
v_min_u32 v125, -2, v125
mvvas 196,72,52
s_add_u32 s87, s87, 10240
rtv 66,37,51200
rtv 68,37,53248
mvvas 192,80,224
s_waitcnt lgkmcnt(7)
rtv 70,37,55296
v_min_u32 v126, -2, v126
mvvas 192,84,240
s_waitcnt lgkmcnt(6)
rtv 72,33,28672
v_min_u32 v127, -2, v127
mvvas 196,84,244
buffer_store_dwordx4 v[124:127], v2, s[64:67], s87 offen offset:0 sc1
buffer_load_dwordx4 a[220:223], v6, s[64:67], s59 offen offset:1024 sc1
rtv 74,33,30720
mvvas 196,80,228
s_add_u32 s59, s30, 3
rtv 76,33,32768
s_and_b32 s59, s59, 3
mvvas 200,88,192
s_lshl2_add_u32 s59, s94, s59
rtv 78,33,34816
s_lshl_b32 s59, s59, 14
s_waitcnt lgkmcnt(6)
mvvas 200,92,0
s_add_u32 s59, s59, 8192
rtv 80,33,49152
s_add_u32 s59, s59, s84
mvvas 204,92,4
s_xor_b32 s87, s94, 3
rtv 82,33,51200
v_cvt_pk_bf16_f32 v192, v192, v193
mvvas 204,88,196
s_mul_i32 s87, s87, 73728
rtv 84,33,53248
v_cvt_pk_bf16_f32 v193, v194, v195
mvvas 200,64,16
buffer_load_dwordx4 a[232:235], v6, s[64:67], s59 offen offset:0 sc1
s_waitcnt lgkmcnt(7)
mvvas 200,68,32
s_add_u32 s87, s87, s56
rtv 86,33,55296
rtv 88,34,8192
mvvas 204,68,36
s_add_u32 s87, s87, 9216
rtv 90,34,10240
v_cvt_pk_bf16_f32 v194, v196, v197
mvvas 204,64,20
s_waitcnt lgkmcnt(8)
rtv 92,34,12288
v_cvt_pk_bf16_f32 v195, v198, v199
mvvas 200,72,48
s_waitcnt lgkmcnt(7)
rtv 94,34,14336
v_min_u32 v192, -2, v192
mvvas 200,76,208
buffer_load_dwordx4 a[236:239], v6, s[64:67], s59 offen offset:1024 sc1
mvvas 204,76,212
s_add_u32 s59, s30, 3
rtv 64,38,49152
v_min_u32 v193, -2, v193
mvvas 204,72,52
s_and_b32 s59, s59, 3
rtv 66,38,51200
rtv 68,38,53248
s_waitcnt lgkmcnt(9)
mvvas 200,80,224
s_lshl2_add_u32 s59, s94, s59
rtv 70,38,55296
v_min_u32 v194, -2, v194
s_waitcnt lgkmcnt(8)
mvvas 200,84,240
s_lshl_b32 s59, s59, 14
v_min_u32 v195, -2, v195
s_add_u32 s59, s59, 12288
s_add_u32 s59, s59, s84
mvvas 204,84,244
buffer_store_dwordx4 v[192:195], v2, s[64:67], s87 offen offset:0 sc1
buffer_load_dwordx4 a[248:251], v6, s[64:67], s59 offen offset:0 sc1
rtv 72,34,28672
mvvas 204,80,228
s_waitcnt lgkmcnt(7)
rtv 74,34,30720
rtv 76,34,32768
mvvas 184,88,192
rtv 78,34,34816
s_waitcnt lgkmcnt(8)
mvvas 184,92,0
rtv 80,34,49152
s_waitcnt lgkmcnt(5)
mvvas 188,92,4
s_xor_b32 s87, s94, 2
rtv 82,34,51200
v_cvt_pk_bf16_f32 v204, v204, v205
mvvas 188,88,196
buffer_load_dwordx4 a[252:255], v6, s[64:67], s59 offen offset:1024 sc1
mvvas 184,64,16
s_mul_i32 s87, s87, 73728
rtv 84,34,53248
rtv 86,34,55296
mvvas 184,68,32
s_add_u32 s87, s87, s56
rtv 88,11,16384
v_cvt_pk_bf16_f32 v205, v206, v207
mvvas 188,68,36
s_add_u32 s87, s87, 8192
rtv 90,11,17408
v_cvt_pk_bf16_f32 v206, v200, v201
mvvas 188,64,20
s_waitcnt lgkmcnt(8)
rtv 92,11,18432
v_cvt_pk_bf16_f32 v207, v202, v203
mvvas 184,72,48
s_waitcnt lgkmcnt(7)
rtv 94,11,19456
v_min_u32 v204, -2, v204
mvvas 184,76,208
rtv 64,11,36864
v_min_u32 v205, -2, v205
mvvas 188,76,212
rtv 66,11,37888
v_min_u32 v206, -2, v206
mvvas 188,72,52
s_waitcnt lgkmcnt(8)
rtv 68,11,38912
v_min_u32 v207, -2, v207
mvvas 184,80,224
rtv 70,11,39936
s_waitcnt lgkmcnt(8)
mvvas 184,84,240
rtv 72,13,16384
mvvas 188,84,244
buffer_store_dwordx4 v[204:207], v2, s[64:67], s87 offen offset:0 sc1
rtv 74,13,17408
mvvas 188,80,228
rtv 76,13,18432
s_waitcnt vmcnt(39) lgkmcnt(9)
mvvas 136,88,72
s_waitcnt vmcnt(37) lgkmcnt(7)
rtv 78,13,19456
v_cvt_pk_bf16_f32 v184, v184, v185
mvvas 136,92,88
s_waitcnt vmcnt(35) lgkmcnt(6)
rtv 80,13,36864
v_cvt_pk_bf16_f32 v185, v186, v187
mvvas 140,92,92
s_xor_b32 s87, s94, 1
rtv 82,13,37888
v_cvt_pk_bf16_f32 v186, v188, v189
mvvas 140,88,76
s_mul_i32 s87, s87, 73728
rtv 84,13,38912
v_cvt_pk_bf16_f32 v187, v190, v191
mvvas 136,64,104
s_add_u32 s87, s87, s56
rtv 86,13,39936
v_min_u32 v184, -2, v184
s_waitcnt vmcnt(32) lgkmcnt(8)
mvvas 136,68,120
s_add_u32 s87, s87, 7168
rtv 88,9,16384
v_min_u32 v185, -2, v185
mvvas 140,68,124
rtv 90,9,17408
v_min_u32 v186, -2, v186
mvvas 140,64,108
s_waitcnt vmcnt(31) lgkmcnt(8)
rtv 92,9,18432
v_min_u32 v187, -2, v187
mvvas 136,72,136
rtv 94,9,19456
s_waitcnt vmcnt(29) lgkmcnt(8)
mvvas 136,76,152
rtv 64,11,57344
s_waitcnt vmcnt(27)
mvvas 140,76,156
rtv 66,11,58368
mvvas 140,72,140
rtv 68,11,59392
s_waitcnt vmcnt(26) lgkmcnt(9)
mvvas 136,80,168
rtv 70,11,60416
s_waitcnt vmcnt(23) lgkmcnt(8)
mvvas 136,84,184
rtv 72,9,36864
s_waitcnt vmcnt(22)
mvvas 140,84,188
buffer_store_dwordx4 v[184:187], v2, s[64:67], s87 offen offset:0 sc1
rtv 74,9,37888
mvvas 140,80,172
rtv 76,9,38912
s_waitcnt vmcnt(22) lgkmcnt(9)
mvvas 136,88,200
rtv 78,9,39936
s_waitcnt vmcnt(19) lgkmcnt(8)
mvvas 136,92,8
rtv 80,9,57344
s_waitcnt vmcnt(18)
mvvas 140,92,12
rtv 82,9,58368
mvvas 140,88,204
rtv 84,9,59392
s_waitcnt vmcnt(17) lgkmcnt(9)
mvvas 136,64,24
rtv 86,9,60416
s_waitcnt vmcnt(14) lgkmcnt(8)
mvvas 136,68,40
rtv 88,12,16384
s_waitcnt vmcnt(13)
mvvas 140,68,44
rtv 90,12,17408
s_mul_i32 s4, s80, 40960
mvvas 140,64,28
rtv 92,12,18432
s_waitcnt vmcnt(11) lgkmcnt(9)
mvvas 136,72,56
rtv 94,12,19456
s_waitcnt vmcnt(9) lgkmcnt(8)
mvvas 136,76,216
rtv 64,12,36864
s_waitcnt vmcnt(7)
mvvas 140,76,220
rtv 66,12,37888
mvvas 140,72,60
rtv 68,12,38912
s_waitcnt vmcnt(6) lgkmcnt(9)
mvvas 136,80,232
rtv 70,12,39936
s_waitcnt vmcnt(3) lgkmcnt(8)
mvvas 136,84,248
rtv 72,14,16384
s_waitcnt vmcnt(2) lgkmcnt(7)
mvvas 140,84,252
s_sub_u32 s5, 15, s31
rtv 74,14,17408
s_mul_i32 s5, s5, 163840
mvvas 140,80,236
s_add_u32 s5, s5, s4
rtv 76,14,18432
v_cvt_pk_bf16_f32 v136, v136, v137
mvvas 160,88,72
s_mul_i32 s6, s31, 163840
rtv 78,14,19456
v_cvt_pk_bf16_f32 v137, v138, v139
s_waitcnt lgkmcnt(8)
mvvas 160,92,88
s_add_u32 s6, s6, s4
rtv 80,14,36864
v_cvt_pk_bf16_f32 v138, v140, v141
mvvas 164,92,92
s_lshl_b32 s87, s94, 9
rtv 82,14,37888
v_cvt_pk_bf16_f32 v139, v142, v143
mvvas 164,88,76
s_add_u32 s87, s87, s56
rtv 84,14,38912
v_min_u32 v136, -2, v136
s_waitcnt lgkmcnt(7)
mvvas 160,64,104
s_add_u32 s87, s87, 161792
rtv 86,14,39936
v_min_u32 v137, -2, v137
mvvas 160,68,120
s_waitcnt lgkmcnt(6)
rtv 88,10,16384
v_min_u32 v138, -2, v138
mvvas 164,68,124
s_bitcmp1_b32 s94, 1
rtv 90,10,17408
v_min_u32 v139, -2, v139
mvvas 164,64,108
s_cselect_b32 s7, s6, s5
rtv 92,10,18432
s_and_b32 s4, s94, 1
mvvas 160,72,136
s_mul_i32 s4, s4, 20480
rtv 94,10,19456
s_add_u32 s7, s7, s4
s_waitcnt lgkmcnt(8)
mvvas 160,76,152
rtv 64,12,57344
mvvas 164,76,156
rtv 66,12,58368
mvvas 164,72,140
rtv 68,12,59392
s_waitcnt lgkmcnt(9)
mvvas 160,80,168
s_waitcnt lgkmcnt(7)
v_permlane32_swap_b32 v136, v138
mvvas 160,84,184
s_waitcnt lgkmcnt(5)
rtv 70,12,60416
v_permlane32_swap_b32 v137, v139
mvvas 164,84,188
s_and_b32 s3, s30, 3
rtv 72,10,36864
rtv 74,10,37888
mvvas 164,80,172
buffer_store_dwordx4 v[136:139], v7, s[64:67], s87 offen offset:0 sc1
rtv 76,10,38912
s_lshr_b32 s4, s94, 2
s_lshl1_add_u32 s4, s3, s4
mvvas 160,88,200
s_lshl_b32 s4, s4, 5
rtv 78,10,39936
s_add_u32 s7, s7, s4
s_waitcnt lgkmcnt(8)
mvvas 160,92,8
rtv 80,10,57344
mvvas 164,92,12
rtv 82,10,58368
mvvas 164,88,204
rtv 84,10,59392
s_waitcnt lgkmcnt(9)
mvvas 160,64,24
rtv 86,10,60416
s_waitcnt lgkmcnt(8)
mvvas 160,68,40
rtv 88,36,0
s_waitcnt lgkmcnt(7)
mvvas 164,68,44
s_lshl3_add_u32 s4, s3, s94
rtv 90,36,2048
v_add_u32 v5, 20480, v4
mvvas 164,64,28
s_lshl_b32 s4, s4, 5
rtv 92,36,4096
s_add_u32 s5, s5, s4
mvvas 160,72,56
s_waitcnt lgkmcnt(7)
rtv 94,36,6144
s_add_u32 s6, s6, s4
mvvas 160,76,216
rtv 64,36,20480
mvvas 164,76,220
rtv 66,36,22528
mvvas 164,72,60
rtv 68,36,24576
s_waitcnt lgkmcnt(7)
mvvas 160,80,232
s_mul_i32 s59, s94, 73728
rtv 70,36,26624
s_add_u32 s59, s59, s56
mvvas 160,84,248
s_mov_b32 s99, 0x10000
rtv 72,40,0
s_mov_b32 s52, 0
mvvas 164,84,252
s_add_u32 s57, s59, 13312
rtv 74,40,2048
s_mov_b32 s53, 0x7f80
mvvas 164,80,236
s_waitcnt lgkmcnt(8)
rtv 76,40,4096
v_cvt_pk_bf16_f32 v160, v160, v161
mvvas 208,88,72
s_waitcnt lgkmcnt(7)
rtv 78,40,6144
v_cvt_pk_bf16_f32 v161, v162, v163
mvvas 208,92,88
s_waitcnt lgkmcnt(6)
rtv 80,40,20480
v_min_u32 v160, -2, v160
mvvas 212,92,92
s_lshl_b32 s87, s94, 9
rtv 82,40,22528
v_cvt_pk_bf16_f32 v162, v164, v165
mvvas 212,88,76
s_add_u32 s87, s87, s56
rtv 84,40,24576
v_cvt_pk_bf16_f32 v163, v166, v167
mvvas 208,64,104
s_add_u32 s87, s87, 456704
rtv 86,40,26624
v_min_u32 v161, -2, v161
s_waitcnt lgkmcnt(8)
mvvas 208,68,120
rtv 88,32,0
v_min_u32 v162, -2, v162
mvvas 212,68,124
rtv 90,32,2048
v_min_u32 v163, -2, v163
mvvas 212,64,108
rtv 92,32,4096
s_waitcnt lgkmcnt(9)
mvvas 208,72,136
rtv 94,32,6144
s_waitcnt lgkmcnt(8)
mvvas 208,76,152
rtv 64,36,40960
mvvas 212,76,156
buffer_load_dwordx4 v[96:99], v2, s[64:67], s57 offen offset:0 sc1
mvvas 212,72,140
s_waitcnt lgkmcnt(5)
rtv 66,36,43008
rtv 68,36,45056
mvvas 208,80,168
s_add_u32 s57, s59, 12288
v_permlane32_swap_b32 v160, v162
mvvas 208,84,184
rtv 70,36,47104
v_permlane32_swap_b32 v161, v163
mvvas 212,84,188
rtv 72,32,20480
rtv 74,32,22528
mvvas 212,80,172
buffer_store_dwordx4 v[160:163], v7, s[64:67], s87 offen offset:0 sc1
rtv 76,32,24576
s_waitcnt lgkmcnt(9)
mvvas 208,88,200
rtv 78,32,26624
s_waitcnt lgkmcnt(8)
mvvas 208,92,8
rtv 80,32,40960
mvvas 212,92,12
rtv 82,32,43008
mvvas 212,88,204
rtv 84,32,45056
s_waitcnt lgkmcnt(9)
mvvas 208,64,24
rtv 86,32,47104
s_waitcnt lgkmcnt(8)
mvvas 208,68,40
rtv 88,37,0
mvvas 212,68,44
rtv 90,37,2048
mvvas 212,64,28
rtv 92,37,4096
s_waitcnt lgkmcnt(7)
mvvas 208,72,56
buffer_load_dwordx4 v[100:103], v2, s[64:67], s57 offen offset:0 sc1
mvvas 208,76,216
rtv 94,37,6144
rtv 64,37,20480
mvvas 212,76,220
rtv 66,37,22528
s_add_u32 s57, s59, 11264
mvvas 212,72,60
rtv 68,37,24576
s_waitcnt lgkmcnt(9)
mvvas 208,80,232
rtv 70,37,26624
s_waitcnt lgkmcnt(8)
mvvas 208,84,248
rtv 72,41,0
mvvas 212,84,252
rtv 74,41,2048
mvvas 212,80,236
rtv 76,41,4096
s_waitcnt lgkmcnt(9)
mvvas 216,88,72
rtv 78,41,6144
s_waitcnt lgkmcnt(8)
mvvas 216,92,88
s_waitcnt lgkmcnt(6)
rtv 80,41,20480
v_cvt_pk_bf16_f32 v208, v208, v209
mvvas 220,92,92
s_xor_b32 s87, s94, 7
rtv 82,41,22528
v_cvt_pk_bf16_f32 v209, v210, v211
mvvas 220,88,76
s_mul_i32 s87, s87, 73728
rtv 84,41,24576
v_cvt_pk_bf16_f32 v210, v212, v213
mvvas 216,64,104
s_add_u32 s87, s87, s56
rtv 86,41,26624
v_cvt_pk_bf16_f32 v211, v214, v215
s_waitcnt lgkmcnt(8)
mvvas 216,68,120
s_add_u32 s87, s87, 6144
rtv 88,33,0
v_min_u32 v208, -2, v208
mvvas 220,68,124
buffer_load_dwordx4 v[104:107], v2, s[64:67], s57 offen offset:0 sc1
mvvas 220,64,108
s_waitcnt lgkmcnt(7)
rtv 90,33,2048
rtv 92,33,4096
mvvas 216,72,136
s_waitcnt lgkmcnt(7)
rtv 94,33,6144
v_min_u32 v209, -2, v209
mvvas 216,76,152
s_add_u32 s57, s59, 10240
rtv 64,37,40960
v_min_u32 v210, -2, v210
mvvas 220,76,156
rtv 66,37,43008
v_min_u32 v211, -2, v211
mvvas 220,72,140
rtv 68,37,45056
s_waitcnt lgkmcnt(9)
mvvas 216,80,168
rtv 70,37,47104
s_waitcnt lgkmcnt(8)
mvvas 216,84,184
rtv 72,33,20480
mvvas 220,84,188
buffer_store_dwordx4 v[208:211], v2, s[64:67], s87 offen offset:0 sc1
rtv 74,33,22528
mvvas 220,80,172
rtv 76,33,24576
s_waitcnt lgkmcnt(9)
mvvas 216,88,200
rtv 78,33,26624
s_waitcnt lgkmcnt(8)
mvvas 216,92,8
rtv 80,33,40960
mvvas 220,92,12
rtv 82,33,43008
mvvas 220,88,204
rtv 84,33,45056
s_waitcnt lgkmcnt(9)
mvvas 216,64,24
rtv 86,33,47104
s_waitcnt lgkmcnt(8)
mvvas 216,68,40
buffer_load_dwordx4 v[108:111], v2, s[64:67], s57 offen offset:0 sc1
mvvas 220,68,44
rtv 88,38,0
rtv 90,38,2048
mvvas 220,64,28
s_waitcnt lgkmcnt(8)
rtv 92,38,4096
s_add_u32 s57, s59, 9216
mvvas 216,72,56
rtv 94,38,6144
s_waitcnt lgkmcnt(8)
mvvas 216,76,216
rtv 64,38,20480
mvvas 220,76,220
rtv 66,38,22528
mvvas 220,72,60
rtv 68,38,24576
s_waitcnt lgkmcnt(9)
mvvas 216,80,232
rtv 70,38,26624
s_waitcnt lgkmcnt(8)
mvvas 216,84,248
rtv 72,42,0
mvvas 220,84,252
rtv 74,42,2048
mvvas 220,80,236
rtv 76,42,4096
s_waitcnt lgkmcnt(9)
mvvas 224,88,72
rtv 78,42,6144
s_waitcnt lgkmcnt(8)
mvvas 224,92,88
rtv 80,42,20480
s_waitcnt lgkmcnt(7)
mvvas 228,92,92
s_xor_b32 s87, s94, 6
rtv 82,42,22528
v_cvt_pk_bf16_f32 v220, v220, v221
mvvas 228,88,76
buffer_load_dwordx4 v[112:115], v2, s[64:67], s57 offen offset:0 sc1
mvvas 224,64,104
s_mul_i32 s87, s87, 73728
rtv 84,42,24576
rtv 86,42,26624
s_waitcnt lgkmcnt(8)
mvvas 224,68,120
s_add_u32 s87, s87, s56
rtv 88,34,0
v_cvt_pk_bf16_f32 v221, v222, v223
mvvas 228,68,124
s_add_u32 s87, s87, 5120
rtv 90,34,2048
v_cvt_pk_bf16_f32 v222, v216, v217
mvvas 228,64,108
s_add_u32 s57, s59, 8192
rtv 92,34,4096
v_cvt_pk_bf16_f32 v223, v218, v219
s_waitcnt lgkmcnt(9)
mvvas 224,72,136
s_waitcnt lgkmcnt(7)
rtv 94,34,6144
v_min_u32 v220, -2, v220
mvvas 224,76,152
rtv 64,38,40960
v_min_u32 v221, -2, v221
mvvas 228,76,156
rtv 66,38,43008
v_min_u32 v222, -2, v222
mvvas 228,72,140
s_waitcnt lgkmcnt(8)
rtv 68,38,45056
v_min_u32 v223, -2, v223
mvvas 224,80,168
rtv 70,38,47104
s_waitcnt lgkmcnt(8)
mvvas 224,84,184
rtv 72,34,20480
mvvas 228,84,188
buffer_store_dwordx4 v[220:223], v2, s[64:67], s87 offen offset:0 sc1
buffer_load_dwordx4 v[116:119], v2, s[64:67], s57 offen offset:0 sc1
rtv 74,34,22528
mvvas 228,80,172
rtv 76,34,24576
s_waitcnt lgkmcnt(9)
mvvas 224,88,200
rtv 78,34,26624
s_waitcnt lgkmcnt(8)
mvvas 224,92,8
rtv 80,34,40960
mvvas 228,92,12
rtv 82,34,43008
mvvas 228,88,204
rtv 84,34,45056
s_waitcnt lgkmcnt(9)
mvvas 224,64,24
s_waitcnt lgkmcnt(7)
rtv 86,34,47104
s_add_u32 s57, s59, 7168
mvvas 224,68,40
rtv 88,39,0
mvvas 228,68,44
rtv 90,39,2048
mvvas 228,64,28
rtv 92,39,4096
s_waitcnt lgkmcnt(9)
mvvas 224,72,56
rtv 94,39,6144
s_waitcnt lgkmcnt(8)
mvvas 224,76,216
rtv 64,39,20480
mvvas 228,76,220
rtv 66,39,22528
mvvas 228,72,60
rtv 68,39,24576
s_waitcnt lgkmcnt(9)
mvvas 224,80,232
rtv 70,39,26624
s_waitcnt lgkmcnt(8)
mvvas 224,84,248
rtv 72,43,0
mvvas 228,84,252
rtv 74,43,2048
mvvas 228,80,236
rtv 76,43,4096
s_waitcnt lgkmcnt(7)
mvvas 240,88,72
buffer_load_dwordx4 v[120:123], v2, s[64:67], s57 offen offset:0 sc1
mvvas 240,92,88
s_waitcnt lgkmcnt(5)
rtv 78,43,6144
rtv 80,43,20480
mvvas 244,92,92
s_xor_b32 s87, s94, 5
rtv 82,43,22528
v_cvt_pk_bf16_f32 v224, v224, v225
mvvas 244,88,76
s_mul_i32 s87, s87, 73728
rtv 84,43,24576
v_cvt_pk_bf16_f32 v225, v226, v227
mvvas 240,64,104
s_add_u32 s87, s87, s56
rtv 86,43,26624
v_cvt_pk_bf16_f32 v226, v228, v229
s_waitcnt lgkmcnt(8)
mvvas 240,68,120
s_add_u32 s87, s87, 4096
rtv 88,35,0
v_cvt_pk_bf16_f32 v227, v230, v231
mvvas 244,68,124
rtv 90,35,2048
v_min_u32 v224, -2, v224
mvvas 244,64,108
s_waitcnt lgkmcnt(8)
rtv 92,35,4096
v_min_u32 v225, -2, v225
mvvas 240,72,136
s_waitcnt lgkmcnt(7)
rtv 94,35,6144
v_min_u32 v226, -2, v226
mvvas 240,76,152
rtv 64,39,40960
v_min_u32 v227, -2, v227
mvvas 244,76,156
rtv 66,39,43008
mvvas 244,72,140
rtv 68,39,45056
s_waitcnt lgkmcnt(9)
mvvas 240,80,168
rtv 70,39,47104
s_waitcnt lgkmcnt(8)
mvvas 240,84,184
rtv 72,35,20480
mvvas 244,84,188
buffer_store_dwordx4 v[224:227], v2, s[64:67], s87 offen offset:0 sc1
rtv 74,35,22528
mvvas 244,80,172
rtv 76,35,24576
s_waitcnt lgkmcnt(9)
mvvas 240,88,200
rtv 78,35,26624
s_waitcnt lgkmcnt(8)
mvvas 240,92,8
rtv 80,35,40960
s_add_u32 s57, s59, 14336
mvvas 244,92,12
rtv 82,35,43008
mvvas 244,88,204
rtv 84,35,45056
s_waitcnt lgkmcnt(9)
mvvas 240,64,24
rtv 86,35,47104
s_waitcnt lgkmcnt(8)
mvvas 240,68,40
rtv 88,36,8192
mvvas 244,68,44
rtv 90,36,10240
mvvas 244,64,28
rtv 92,36,12288
s_waitcnt lgkmcnt(9)
mvvas 240,72,56
rtv 94,36,14336
s_waitcnt lgkmcnt(8)
mvvas 240,76,216
rtv 64,36,28672
mvvas 244,76,220
rtv 66,36,30720
mvvas 244,72,60
rtv 68,36,32768
s_waitcnt lgkmcnt(9)
mvvas 240,80,232
rtv 70,36,34816
s_waitcnt lgkmcnt(8)
mvvas 240,84,248
buffer_load_dwordx4 v[124:127], v2, s[64:67], s57 offen offset:0 sc1
mvvas 244,84,252
s_add_u32 s57, s59, 14336
rtv 72,40,8192
rtv 74,40,10240
mvvas 244,80,236
rtv 76,40,12288
s_waitcnt lgkmcnt(9)
mvvas 232,88,72
rtv 78,40,14336
s_waitcnt lgkmcnt(8)
mvvas 232,92,88
rtv 80,40,28672
s_waitcnt lgkmcnt(7)
mvvas 236,92,92
s_xor_b32 s87, s94, 4
rtv 82,40,30720
v_cvt_pk_bf16_f32 v244, v244, v245
mvvas 236,88,76
s_mul_i32 s87, s87, 73728
rtv 84,40,32768
v_cvt_pk_bf16_f32 v245, v246, v247
mvvas 232,64,104
s_add_u32 s87, s87, s56
rtv 86,40,34816
v_cvt_pk_bf16_f32 v246, v240, v241
s_waitcnt lgkmcnt(8)
mvvas 232,68,120
s_add_u32 s87, s87, 3072
rtv 88,32,8192
v_cvt_pk_bf16_f32 v247, v242, v243
mvvas 236,68,124
rtv 90,32,10240
v_min_u32 v244, -2, v244
mvvas 236,64,108
s_waitcnt lgkmcnt(6)
rtv 92,32,12288
v_min_u32 v245, -2, v245
mvvas 232,72,136
buffer_load_dwordx4 v[196:199], v2, s[64:67], s57 offen offset:1024 sc1
mvvas 232,76,152
s_add_u32 s57, s59, 14336
rtv 94,32,14336
rtv 64,36,49152
mvvas 236,76,156
rtv 66,36,51200
v_min_u32 v246, -2, v246
mvvas 236,72,140
s_waitcnt lgkmcnt(8)
rtv 68,36,53248
v_min_u32 v247, -2, v247
mvvas 232,80,168
rtv 70,36,55296
s_waitcnt lgkmcnt(8)
mvvas 232,84,184
rtv 72,32,28672
mvvas 236,84,188
buffer_store_dwordx4 v[244:247], v2, s[64:67], s87 offen offset:0 sc1
rtv 74,32,30720
mvvas 236,80,172
rtv 76,32,32768
s_waitcnt lgkmcnt(9)
mvvas 232,88,200
rtv 78,32,34816
s_waitcnt lgkmcnt(8)
mvvas 232,92,8
rtv 80,32,49152
mvvas 236,92,12
rtv 82,32,51200
mvvas 236,88,204
rtv 84,32,53248
s_waitcnt lgkmcnt(7)
mvvas 232,64,24
buffer_load_dwordx4 v[200:203], v2, s[64:67], s57 offen offset:2048 sc1
mvvas 232,68,40
s_add_u32 s57, s59, 14336
rtv 86,32,55296
rtv 88,37,8192
mvvas 236,68,44
rtv 90,37,10240
mvvas 236,64,28
rtv 92,37,12288
s_waitcnt lgkmcnt(9)
mvvas 232,72,56
rtv 94,37,14336
s_waitcnt lgkmcnt(8)
mvvas 232,76,216
rtv 64,37,28672
mvvas 236,76,220
rtv 66,37,30720
mvvas 236,72,60
rtv 68,37,32768
s_waitcnt lgkmcnt(9)
mvvas 232,80,232
rtv 70,37,34816
s_waitcnt lgkmcnt(8)
mvvas 232,84,248
rtv 72,41,8192
mvvas 236,84,252
rtv 74,41,10240
mvvas 236,80,236
rtv 76,41,12288
s_waitcnt lgkmcnt(7)
mvvas 248,88,72
buffer_load_dwordx4 v[204:207], v2, s[64:67], s57 offen offset:3072 sc1
mvvas 248,92,88
s_add_u32 s57, s59, 6144
rtv 78,41,14336
rtv 80,41,28672
mvvas 252,92,92
s_xor_b32 s87, s94, 3
rtv 82,41,30720
v_cvt_pk_bf16_f32 v232, v232, v233
mvvas 252,88,76
s_mul_i32 s87, s87, 73728
rtv 84,41,32768
v_cvt_pk_bf16_f32 v233, v234, v235
s_waitcnt lgkmcnt(7)
mvvas 248,64,104
s_add_u32 s87, s87, s56
rtv 86,41,34816
v_cvt_pk_bf16_f32 v234, v236, v237
mvvas 248,68,120
s_add_u32 s87, s87, 2048
rtv 88,33,8192
v_cvt_pk_bf16_f32 v235, v238, v239
mvvas 252,68,124
rtv 90,33,10240
v_min_u32 v232, -2, v232
mvvas 252,64,108
s_waitcnt lgkmcnt(8)
rtv 92,33,12288
v_min_u32 v233, -2, v233
mvvas 248,72,136
s_waitcnt lgkmcnt(7)
rtv 94,33,14336
v_min_u32 v234, -2, v234
mvvas 248,76,152
rtv 64,37,49152
v_min_u32 v235, -2, v235
mvvas 252,76,156
rtv 66,37,51200
mvvas 252,72,140
rtv 68,37,53248
s_waitcnt lgkmcnt(7)
mvvas 248,80,168
buffer_load_dwordx4 v[168:171], v2, s[64:67], s57 offen offset:0 sc1
mvvas 248,84,184
s_add_u32 s57, s59, 5120
rtv 70,37,55296
rtv 72,33,28672
mvvas 252,84,188
buffer_store_dwordx4 v[232:235], v2, s[64:67], s87 offen offset:0 sc1
rtv 74,33,30720
mvvas 252,80,172
rtv 76,33,32768
s_waitcnt lgkmcnt(9)
mvvas 248,88,200
rtv 78,33,34816
s_waitcnt lgkmcnt(8)
mvvas 248,92,8
rtv 80,33,49152
mvvas 252,92,12
rtv 82,33,51200
mvvas 252,88,204
rtv 84,33,53248
s_waitcnt lgkmcnt(9)
mvvas 248,64,24
rtv 86,33,55296
s_waitcnt lgkmcnt(8)
mvvas 248,68,40
rtv 88,38,8192
mvvas 252,68,44
rtv 90,38,10240
mvvas 252,64,28
rtv 92,38,12288
s_waitcnt lgkmcnt(7)
mvvas 248,72,56
buffer_load_dwordx4 v[172:175], v2, s[64:67], s57 offen offset:0 sc1
mvvas 248,76,216
s_add_u32 s57, s59, 4096
rtv 94,38,14336
rtv 64,38,28672
mvvas 252,76,220
rtv 66,38,30720
mvvas 252,72,60
rtv 68,38,32768
s_waitcnt lgkmcnt(9)
mvvas 248,80,232
rtv 70,38,34816
s_waitcnt lgkmcnt(8)
mvvas 248,84,248
rtv 72,42,8192
mvvas 252,84,252
rtv 74,42,10240
mvvas 252,80,236
rtv 76,42,12288
s_waitcnt lgkmcnt(9)
mvvas 152,88,72
rtv 78,42,14336
s_waitcnt lgkmcnt(8)
mvvas 152,92,88
rtv 80,42,28672
s_waitcnt lgkmcnt(7)
mvvas 156,92,92
s_xor_b32 s87, s94, 2
rtv 82,42,30720
v_cvt_pk_bf16_f32 v252, v252, v253
mvvas 156,88,76
s_mul_i32 s87, s87, 73728
rtv 84,42,32768
v_cvt_pk_bf16_f32 v253, v254, v255
mvvas 152,64,104
buffer_load_dwordx4 v[176:179], v2, s[64:67], s57 offen offset:0 sc1
s_waitcnt lgkmcnt(7)
mvvas 152,68,120
s_add_u32 s87, s87, s56
rtv 86,42,34816
rtv 88,34,8192
mvvas 156,68,124
s_add_u32 s87, s87, 1024
rtv 90,34,10240
v_cvt_pk_bf16_f32 v254, v248, v249
mvvas 156,64,108
s_add_u32 s57, s59, 3072
rtv 92,34,12288
v_cvt_pk_bf16_f32 v255, v250, v251
s_waitcnt lgkmcnt(9)
mvvas 152,72,136
s_waitcnt lgkmcnt(7)
rtv 94,34,14336
v_min_u32 v252, -2, v252
mvvas 152,76,152
rtv 64,38,49152
v_min_u32 v253, -2, v253
mvvas 156,76,156
rtv 66,38,51200
v_min_u32 v254, -2, v254
mvvas 156,72,140
s_waitcnt lgkmcnt(8)
rtv 68,38,53248
v_min_u32 v255, -2, v255
mvvas 152,80,168
rtv 70,38,55296
s_waitcnt lgkmcnt(8)
mvvas 152,84,184
rtv 72,34,28672
mvvas 156,84,188
buffer_store_dwordx4 v[252:255], v2, s[64:67], s87 offen offset:0 sc1
buffer_load_dwordx4 v[180:183], v2, s[64:67], s57 offen offset:0 sc1
rtv 74,34,30720
mvvas 156,80,172
rtv 76,34,32768
s_waitcnt lgkmcnt(9)
mvvas 152,88,200
s_waitcnt lgkmcnt(7)
rtv 78,34,34816
s_add_u32 s57, s59, 2048
mvvas 152,92,8
rtv 80,34,49152
mvvas 156,92,12
rtv 82,34,51200
mvvas 156,88,204
rtv 84,34,53248
s_waitcnt lgkmcnt(9)
mvvas 152,64,24
rtv 86,34,55296
s_waitcnt lgkmcnt(8)
mvvas 152,68,40
rtv 88,39,8192
mvvas 156,68,44
rtv 90,39,10240
mvvas 156,64,28
rtv 92,39,12288
s_waitcnt lgkmcnt(9)
mvvas 152,72,56
rtv 94,39,14336
s_waitcnt lgkmcnt(8)
mvvas 152,76,216
buffer_load_dwordx4 v[184:187], v2, s[64:67], s57 offen offset:0 sc1
mvvas 156,76,220
rtv 64,39,28672
mvvas 156,72,60
rtv 66,39,30720
s_waitcnt lgkmcnt(8)
mvvas 152,80,232
s_waitcnt lgkmcnt(6)
rtv 68,39,32768
s_add_u32 s57, s59, 1024
mvvas 152,84,248
rtv 70,39,34816
s_waitcnt lgkmcnt(6)
mvvas 156,84,252
s_xor_b32 s87, s94, 1
s_mul_i32 s87, s87, 73728
s_add_u32 s87, s87, s56
mvvas 156,80,236
s_add_u32 s87, s87, 0
rtv 72,43,8192
v_cvt_pk_bf16_f32 v152, v152, v153
mvvas 144,88,64
s_waitcnt lgkmcnt(5)
rtv 74,43,10240
v_cvt_pk_bf16_f32 v153, v154, v155
mvvas 144,92,80
rtv 76,43,12288
v_cvt_pk_bf16_f32 v154, v156, v157
mvvas 148,92,84
v_cvt_pk_bf16_f32 v155, v158, v159
v_min_u32 v152, -2, v152
mvvas 148,88,68
rtv 78,43,14336
v_min_u32 v153, -2, v153
mvvas 128,88,72
v_min_u32 v154, -2, v154
v_min_u32 v155, -2, v155
mvvas 128,92,88
buffer_load_dwordx4 v[188:191], v2, s[64:67], s57 offen offset:0 sc1
mvvas 132,92,92
buffer_store_dwordx4 v[152:155], v2, s[64:67], s87 offen offset:0 sc1
mvvas 132,88,76
rtv 80,43,28672
s_waitcnt lgkmcnt(5)
mvvas 144,64,96
rtv 82,43,30720
s_add_u32 s57, s59, 0
mvvas 144,68,112
rtv 84,43,32768
mvvas 148,68,116
mvvas 148,64,100
rtv 86,43,34816
mvvas 128,64,104
mvvas 128,68,120
mvvas 132,68,124
s_waitcnt lgkmcnt(4)
mvvas 132,64,108
buffer_load_dwordx4 v[192:195], v2, s[64:67], s57 offen offset:0 sc1
mvvas 144,72,128
rtv 88,35,8192
mvvas 144,76,144
rtv 90,35,10240
mvvas 148,76,148
rtv 92,35,12288
mvvas 148,72,132
rtv 94,35,14336
mvvas 128,72,136
mvvas 128,76,152
mvvas 132,76,156
mvvas 132,72,140
rtv 64,39,49152
s_waitcnt lgkmcnt(5)
mvvas 144,80,160
s_waitcnt vmcnt(25)
v_max3_u32 v48, v96, v97, v98
v_max_u32 v48, v99, v48
mvvas 144,84,176
s_waitcnt vmcnt(23)
rtv 66,39,51200
v_cmp_eq_u32 vcc, -1, v48
mvvas 148,84,180
s_cmp_lg_u64 vcc, 0
v_max3_u32 v48, v100, v101, v102
v_max_u32 v48, v103, v48
mvvas 148,80,164
s_addc_u32 s52, s52, s52
rtv 68,39,53248
v_cmp_eq_u32 vcc, -1, v48
mvvas 128,80,168
s_cmp_lg_u64 vcc, 0
rtv 70,39,55296
s_addc_u32 s52, s52, s52
mvvas 128,84,184
s_waitcnt vmcnt(22)
v_max3_u32 v48, v104, v105, v106
v_max_u32 v48, v107, v48
mvvas 132,84,188
v_cmp_eq_u32 vcc, -1, v48
s_waitcnt vmcnt(20) lgkmcnt(4)
mvvas 132,80,172
s_cmp_lg_u64 vcc, 0
v_max3_u32 v48, v108, v109, v110
v_max_u32 v48, v111, v48
mvvas 144,88,192
s_addc_u32 s52, s52, s52
rtv 72,35,28672
v_cmp_eq_u32 vcc, -1, v48
mvvas 144,92,0
buffer_load_dword v49, v8, s[64:67], s59 offen offset:1020 sc1
mvvas 148,92,4
s_cmp_lg_u64 vcc, 0
s_waitcnt vmcnt(18)
v_max3_u32 v48, v112, v113, v114
v_max_u32 v48, v115, v48
mvvas 148,88,196
s_addc_u32 s52, s52, s52
rtv 74,35,30720
v_cmp_eq_u32 vcc, -1, v48
mvvas 128,88,200
s_cmp_lg_u64 vcc, 0
rtv 76,35,32768
v_max3_u32 v48, v116, v117, v118
mvvas 128,92,8
s_addc_u32 s52, s52, s52
v_max_u32 v48, v119, v48
v_cmp_eq_u32 vcc, -1, v48
mvvas 132,92,12
s_cmp_lg_u64 vcc, 0
rtv 78,35,34816
s_addc_u32 s52, s52, s52
mvvas 132,88,204
s_waitcnt vmcnt(17) lgkmcnt(4)
v_max3_u32 v48, v120, v121, v122
v_max_u32 v48, v123, v48
mvvas 144,64,16
s_waitcnt vmcnt(14)
rtv 80,35,49152
v_cmp_eq_u32 vcc, -1, v48
mvvas 144,68,32
s_cmp_lg_u64 vcc, 0
rtv 82,35,51200
v_max3_u32 v48, v124, v125, v126
mvvas 148,68,36
s_addc_u32 s52, s52, s52
v_max3_u32 v48, v127, v196, v48
v_max3_u32 v48, v197, v198, v48
mvvas 148,64,20
s_waitcnt vmcnt(12)
rtv 84,35,53248
v_max3_u32 v48, v199, v200, v48
mvvas 128,64,24
s_waitcnt vmcnt(11)
v_max3_u32 v48, v201, v202, v48
v_max3_u32 v48, v203, v204, v48
mvvas 128,68,40
rtv 86,35,55296
v_max3_u32 v48, v205, v206, v48
mvvas 132,68,44
v_max_u32 v48, v207, v48
v_cmp_eq_u32 vcc, -1, v48
mvvas 132,64,28
s_cmp_lg_u64 vcc, 0
s_addc_u32 s52, s52, s52
s_waitcnt lgkmcnt(5)
mvvas 144,72,48
s_waitcnt vmcnt(10) lgkmcnt(4)
v_max3_u32 v48, v168, v169, v170
v_max_u32 v48, v171, v48
mvvas 144,76,208
v_cmp_eq_u32 vcc, -1, v48
s_waitcnt vmcnt(8)
mvvas 148,76,212
s_cmp_lg_u64 vcc, 0
v_max3_u32 v48, v172, v173, v174
v_max_u32 v48, v175, v48
mvvas 148,72,52
s_waitcnt vmcnt(7)
v_cmp_eq_u32 vcc, -1, v48
s_addc_u32 s52, s52, s52
mvvas 128,72,56
s_cmp_lg_u64 vcc, 0
v_max3_u32 v48, v176, v177, v178
v_max_u32 v48, v179, v48
mvvas 128,76,216
s_waitcnt vmcnt(5)
v_cmp_eq_u32 vcc, -1, v48
s_addc_u32 s52, s52, s52
mvvas 132,76,220
s_cmp_lg_u64 vcc, 0
v_max3_u32 v48, v180, v181, v182
v_max_u32 v48, v183, v48
mvvas 132,72,60
s_waitcnt vmcnt(4) lgkmcnt(0)
v_cmp_eq_u32 vcc, -1, v48
s_addc_u32 s52, s52, s52
mvvas 144,80,224
s_cmp_lg_u64 vcc, 0
v_max3_u32 v48, v184, v185, v186
v_max_u32 v48, v187, v48
mvvas 144,84,240
s_waitcnt vmcnt(3)
v_cmp_eq_u32 vcc, -1, v48
s_addc_u32 s52, s52, s52
mvvas 148,84,244
s_cmp_lg_u64 vcc, 0
v_max3_u32 v48, v188, v189, v190
v_max_u32 v48, v191, v48
mvvas 148,80,228
s_waitcnt vmcnt(1)
v_cmp_eq_u32 vcc, -1, v48
s_addc_u32 s52, s52, s52
mvvas 128,80,232
s_cmp_lg_u64 vcc, 0
v_max3_u32 v48, v192, v193, v194
s_addc_u32 s52, s52, s52
mvvas 128,84,248
v_max_u32 v48, v195, v48
v_cmp_eq_u32 vcc, -1, v48
mvvas 132,84,252
s_cmp_lg_u64 vcc, 0
s_addc_u32 s52, s52, s52
s_cmp_lg_u32 s52, 0
mvvas 132,80,236
s_cbranch_scc1 P3_lp
P3_s1:
mvvvz 64,44,124
mvvvs 144,60,96
s_mov_b32 s53, -1
s_cmp_lg_u32 s52, 0
mvvvs 148,58,98
mvvvs 64,44,196
mvvvs 144,58,102
mvvvs 148,58,106
mvvvs 64,44,200
mvvvs 144,58,110
mvvvs 148,58,114
mvvvs 64,44,204
mvvvs 144,58,118
mvvvs 148,56,120
s_cbranch_scc1 P3_w2
mvvvs 128,60,168
s_nop 3
v_mul_f32 v64, v64, v20
v_mul_f32 v65, v65, v20
mvvvs 132,58,170
v_mul_f32 v66, v66, v20
v_mul_f32 v67, v67, v20
mvvvs 128,58,174
v_cvt_pk_bf16_f32 v64, v64, v65
v_cvt_pk_bf16_f32 v65, v66, v67
mvvvs 132,58,178
v_mul_f32 v144, v144, v16
v_mul_f32 v145, v145, v16
mvvvs 128,58,182
v_mul_f32 v146, v146, v16
v_mul_f32 v147, v147, v16
mvvvs 132,58,186
v_cvt_pk_bf16_f32 v144, v144, v145
v_cvt_pk_bf16_f32 v145, v146, v147
v_mul_f32 v148, v148, v17
v_mul_f32 v149, v149, v17
v_mul_f32 v150, v150, v17
v_mul_f32 v151, v151, v17
v_cvt_pk_bf16_f32 v148, v148, v149
v_cvt_pk_bf16_f32 v149, v150, v151
mvvvs 128,58,190
buffer_store_dwordx2 v[64:65], v4, s[40:43], s7 offen offset:1024 sc0 sc1
buffer_store_dwordx2 v[144:145], v4, s[40:43], s5 offen offset:0 sc0 sc1
buffer_store_dwordx2 v[148:149], v5, s[40:43], s5 offen offset:0 sc0 sc1
s_nop 4
v_mul_f32 v128, v128, v18
v_mul_f32 v129, v129, v18
v_mul_f32 v130, v130, v18
v_mul_f32 v131, v131, v18
v_cvt_pk_bf16_f32 v128, v128, v129
v_cvt_pk_bf16_f32 v129, v130, v131
buffer_store_dwordx2 v[128:129], v4, s[40:43], s6 offen offset:0 sc0 sc1
mvvvs 132,56,192
s_nop 7
v_mul_f32 v132, v132, v19
v_mul_f32 v133, v133, v19
v_mul_f32 v134, v134, v19
v_mul_f32 v135, v135, v19
v_cvt_pk_bf16_f32 v132, v132, v133
v_cvt_pk_bf16_f32 v133, v134, v135
buffer_store_dwordx2 v[132:133], v5, s[40:43], s6 offen offset:0 sc0 sc1
P3_end:
s_waitcnt vmcnt(0)
K_end:
s_endpgm
K_spare:
s_mov_b32 s56, s28
s_mov_b32 s57, s29
s_mov_b32 s58, 1280
s_mov_b32 s59, 0x20000
v_lshrrev_b32 v7, 4, v24
v_lshlrev_b32 v7, 4, v7
s_waitcnt lgkmcnt(0)
buffer_load_dwordx4 a[32:35], v7, s[56:59], 0 offen offset:0
buffer_load_dwordx4 a[36:39], v7, s[56:59], 0 offen offset:64
maaaz 128,0,96
s_add_u32 m0, s85, 114688
rta 30,23,9216
s_mov_b32 s82, 524288
maaas 128,4,100
buffer_load_dwordx4 a[40:43], v7, s[56:59], 0 offen offset:128
maaaz 132,8,96
buffer_load_dwordx4 a[44:47], v7, s[56:59], 0 offen offset:192
buffer_load_dwordx4 a[48:51], v7, s[56:59], 0 offen offset:256
buffer_load_dwordx4 a[52:55], v7, s[56:59], 0 offen offset:320
buffer_load_dwordx4 a[56:59], v7, s[56:59], 0 offen offset:384
buffer_load_dwordx4 a[60:63], v7, s[56:59], 0 offen offset:448
buffer_load_dwordx4 a[64:67], v7, s[56:59], 0 offen offset:512
buffer_load_dwordx4 a[68:71], v7, s[56:59], 0 offen offset:576
buffer_load_dwordx4 a[72:75], v7, s[56:59], 0 offen offset:640
buffer_load_dwordx4 a[76:79], v7, s[56:59], 0 offen offset:704
buffer_load_dwordx4 a[80:83], v7, s[56:59], 0 offen offset:768
buffer_load_dwordx4 a[84:87], v7, s[56:59], 0 offen offset:832
buffer_load_dwordx4 a[88:91], v7, s[56:59], 0 offen offset:896
buffer_load_dwordx4 a[92:95], v7, s[56:59], 0 offen offset:960
maaas 132,12,100
buffer_load_dwordx4 v12, s[52:55], s82 offen offset:0 lds
v_mul_f32 v64, s90, v64
v_mul_f32 v65, s90, v65
v_mul_f32 v66, s90, v66
v_mul_f32 v67, s90, v67
v_mul_f32 v224, s90, v224
maaaz 136,16,96
v_mul_f32 v225, s90, v225
v_mul_f32 v226, s90, v226
v_mul_f32 v227, s90, v227
v_cvt_pk_bf16_f32 v64, v64, v65
v_cvt_pk_bf16_f32 v65, v66, v67
maaas 136,20,100
s_waitcnt lgkmcnt(0)
rqa 112,18,4096
v_cvt_pk_bf16_f32 v66, v224, v225
v_cvt_pk_bf16_f32 v67, v226, v227
v_mul_f32 v68, s90, v68
v_mul_f32 v69, s90, v69
v_mul_f32 v70, s90, v70
maaaz 140,24,96
buffer_load_dwordx4 v13, s[52:55], s82 offen offset:1024 lds
v_mul_f32 v71, s90, v71
v_mul_f32 v228, s90, v228
v_mul_f32 v229, s90, v229
v_mul_f32 v230, s90, v230
v_mul_f32 v231, s90, v231
maaas 140,28,100
s_waitcnt vmcnt(17)
rqa 116,19,4096
v_cvt_pk_bf16_f32 v68, v68, v69
v_cvt_pk_bf16_f32 v69, v70, v71
v_cvt_pk_bf16_f32 v70, v228, v229
v_cvt_pk_bf16_f32 v71, v230, v231
mvaaz 160,32,96
s_waitcnt vmcnt(16)
v_mul_f32 v72, s90, v72
v_mul_f32 v73, s90, v73
v_mul_f32 v74, s90, v74
v_mul_f32 v75, s90, v75
v_mul_f32 v232, s90, v232
mvaas 160,36,100
buffer_load_dwordx4 v14, s[52:55], s82 offen offset:2048 lds
v_mul_f32 v233, s90, v233
v_mul_f32 v234, s90, v234
v_mul_f32 v235, s90, v235
v_cvt_pk_bf16_f32 v72, v72, v73
v_cvt_pk_bf16_f32 v73, v74, v75
maaaz 144,0,104
v_cvt_pk_bf16_f32 v74, v232, v233
v_cvt_pk_bf16_f32 v75, v234, v235
maaas 144,4,108
v_mul_f32 v76, s90, v76
v_mul_f32 v77, s90, v77
maaaz 148,8,104
s_mov_b32 s81, 256
rqa 120,18,6144
v_mul_f32 v78, s90, v78
maaas 148,12,108
v_mul_f32 v79, s90, v79
v_mul_f32 v236, s90, v236
v_mul_f32 v237, s90, v237
v_mul_f32 v238, s90, v238
v_mul_f32 v239, s90, v239
maaaz 152,16,104
buffer_load_dwordx4 v15, s[52:55], s82 offen offset:3072 lds
v_cvt_pk_bf16_f32 v76, v76, v77
v_cvt_pk_bf16_f32 v77, v78, v79
v_cvt_pk_bf16_f32 v78, v236, v237
v_cvt_pk_bf16_f32 v79, v238, v239
maaas 152,20,108
rqa 124,19,6144
v_mul_f32 v80, s90, v80
v_mul_f32 v81, s90, v81
v_mul_f32 v82, s90, v82
v_mul_f32 v83, s90, v83
v_mul_f32 v240, s90, v240
maaaz 156,24,104
s_add_u32 m0, s84, 32768
v_mul_f32 v241, s90, v241
v_mul_f32 v242, s90, v242
v_mul_f32 v243, s90, v243
v_cvt_pk_bf16_f32 v80, v80, v81
v_cvt_pk_bf16_f32 v81, v82, v83
maaas 156,28,108
buffer_load_dwordx4 v8, s[40:43], s81 offen offset:0 lds
s_mov_b32 s87, 524288
v_cvt_pk_bf16_f32 v82, v240, v241
v_cvt_pk_bf16_f32 v83, v242, v243
v_mul_f32 v84, s90, v84
v_mul_f32 v85, s90, v85
v_mul_f32 v86, s90, v86
mvaaz 164,32,104
buffer_store_dwordx4 v[144:147], v6, s[64:67], s87 offen offset:0 sc1
v_mul_f32 v87, s90, v87
v_mul_f32 v244, s90, v244
v_mul_f32 v245, s90, v245
v_mul_f32 v246, s90, v246
v_mul_f32 v247, s90, v247
mvaas 164,36,108
s_mov_b32 s87, 524288
v_cvt_pk_bf16_f32 v84, v84, v85
v_cvt_pk_bf16_f32 v85, v86, v87
v_cvt_pk_bf16_f32 v86, v244, v245
v_cvt_pk_bf16_f32 v87, v246, v247
s_waitcnt lgkmcnt(1)
maaaz 160,0,112
buffer_load_dwordx4 v9, s[40:43], s81 offen offset:1024 lds
maaas 160,4,116
v_mul_f32 v88, s90, v88
v_mul_f32 v89, s90, v89
maaaz 164,8,112
v_mul_f32 v90, s90, v90
v_mul_f32 v91, s90, v91
v_mul_f32 v248, s90, v248
maaas 164,12,116
rqa 96,18,8192
v_mul_f32 v249, s90, v249
v_mul_f32 v250, s90, v250
v_mul_f32 v251, s90, v251
v_cvt_pk_bf16_f32 v88, v88, v89
v_cvt_pk_bf16_f32 v89, v90, v91
maaaz 168,16,112
v_cvt_pk_bf16_f32 v90, v248, v249
v_cvt_pk_bf16_f32 v91, v250, v251
v_mul_f32 v92, s90, v92
v_mul_f32 v93, s90, v93
v_mul_f32 v94, s90, v94
maaas 168,20,116
buffer_load_dwordx4 v10, s[40:43], s81 offen offset:2048 lds
rqa 100,19,8192
v_mul_f32 v95, s90, v95
v_mul_f32 v252, s90, v252
v_mul_f32 v253, s90, v253
v_mul_f32 v254, s90, v254
v_mul_f32 v255, s90, v255
maaaz 172,24,112
buffer_store_dwordx4 v[148:151], v6, s[64:67], s87 offen offset:1024 sc1
v_cvt_pk_bf16_f32 v92, v92, v93
v_cvt_pk_bf16_f32 v93, v94, v95
v_cvt_pk_bf16_f32 v94, v252, v253
v_cvt_pk_bf16_f32 v95, v254, v255
maaas 172,28,116
v_accvgpr_read_b32 v0, a224
v_accvgpr_read_b32 v1, a225
v_accvgpr_read_b32 v2, a226
v_accvgpr_read_b32 v3, a227
v_mul_f32 v96, s90, v96
mvaaz 168,32,112
buffer_load_dwordx4 v11, s[40:43], s81 offen offset:3072 lds
v_mul_f32 v97, s90, v97
v_mul_f32 v98, s90, v98
v_mul_f32 v99, s90, v99
v_mul_f32 v0, s90, v0
v_mul_f32 v1, s90, v1
mvaas 168,36,116
s_waitcnt lgkmcnt(1)
v_mul_f32 v2, s90, v2
v_mul_f32 v3, s90, v3
v_cvt_pk_bf16_f32 v96, v96, v97
v_cvt_pk_bf16_f32 v97, v98, v99
v_cvt_pk_bf16_f32 v98, v0, v1
maaaz 176,0,120
s_add_u32 m0, s84, 36864
v_cvt_pk_bf16_f32 v99, v2, v3
s_mov_b32 s81, 41216
maaas 176,4,124
s_mov_b32 s87, 524288
v_accvgpr_read_b32 v24, a228
v_accvgpr_read_b32 v25, a229
maaaz 180,8,120
v_accvgpr_read_b32 v26, a230
v_accvgpr_read_b32 v27, a231
maaas 180,12,124
buffer_load_dwordx4 v8, s[40:43], s81 offen offset:0 lds
rqa 104,18,10240
v_mul_f32 v100, s90, v100
v_mul_f32 v101, s90, v101
v_mul_f32 v102, s90, v102
v_mul_f32 v103, s90, v103
v_mul_f32 v24, s90, v24
maaaz 184,16,120
buffer_store_dwordx4 v[152:155], v6, s[64:67], s87 offen offset:2048 sc1
v_mul_f32 v25, s90, v25
v_mul_f32 v26, s90, v26
v_mul_f32 v27, s90, v27
v_cvt_pk_bf16_f32 v100, v100, v101
v_cvt_pk_bf16_f32 v101, v102, v103
maaas 184,20,124
rqa 108,19,10240
v_cvt_pk_bf16_f32 v102, v24, v25
v_cvt_pk_bf16_f32 v103, v26, v27
v_accvgpr_read_b32 v0, a232
v_accvgpr_read_b32 v1, a233
v_accvgpr_read_b32 v2, a234
maaaz 188,24,120
buffer_load_dwordx4 v9, s[40:43], s81 offen offset:1024 lds
v_accvgpr_read_b32 v3, a235
v_mul_f32 v104, s90, v104
v_mul_f32 v105, s90, v105
v_mul_f32 v106, s90, v106
v_mul_f32 v107, s90, v107
maaas 188,28,124
v_mul_f32 v0, s90, v0
v_mul_f32 v1, s90, v1
v_mul_f32 v2, s90, v2
v_mul_f32 v3, s90, v3
v_cvt_pk_bf16_f32 v104, v104, v105
mvaaz 172,32,120
s_waitcnt lgkmcnt(1)
v_cvt_pk_bf16_f32 v105, v106, v107
v_cvt_pk_bf16_f32 v106, v0, v1
v_cvt_pk_bf16_f32 v107, v2, v3
v_accvgpr_read_b32 v24, a236
v_accvgpr_read_b32 v25, a237
mvaas 172,36,124
buffer_load_dwordx4 v10, s[40:43], s81 offen offset:2048 lds
s_mov_b32 s87, 524288
v_accvgpr_read_b32 v26, a238
v_accvgpr_read_b32 v27, a239
v_mul_f32 v108, s90, v108
v_mul_f32 v109, s90, v109
v_mul_f32 v110, s90, v110
maaaz 192,0,96
buffer_store_dwordx4 v[156:159], v6, s[64:67], s87 offen offset:3072 sc1
v_mul_f32 v111, s90, v111
v_mul_f32 v24, s90, v24
v_mul_f32 v25, s90, v25
maaas 192,4,100
v_mul_f32 v26, s90, v26
v_mul_f32 v27, s90, v27
maaaz 196,8,96
rqa 112,18,12288
v_cvt_pk_bf16_f32 v108, v108, v109
maaas 196,12,100
v_cvt_pk_bf16_f32 v109, v110, v111
v_cvt_pk_bf16_f32 v110, v24, v25
v_cvt_pk_bf16_f32 v111, v26, v27
maaaz 200,16,96
buffer_load_dwordx4 v11, s[40:43], s81 offen offset:3072 lds
v_accvgpr_read_b32 v0, a240
v_accvgpr_read_b32 v1, a241
v_accvgpr_read_b32 v2, a242
v_accvgpr_read_b32 v3, a243
v_mul_f32 v112, s90, v112
maaas 200,20,100
rqa 116,19,12288
v_mul_f32 v113, s90, v113
v_mul_f32 v114, s90, v114
v_mul_f32 v115, s90, v115
v_mul_f32 v0, s90, v0
v_mul_f32 v1, s90, v1
maaaz 204,24,96
v_mul_f32 v2, s90, v2
v_mul_f32 v3, s90, v3
v_cvt_pk_bf16_f32 v112, v112, v113
v_cvt_pk_bf16_f32 v113, v114, v115
v_cvt_pk_bf16_f32 v114, v0, v1
maaas 204,28,100
v_cvt_pk_bf16_f32 v115, v2, v3
v_accvgpr_read_b32 v24, a244
v_accvgpr_read_b32 v25, a245
v_accvgpr_read_b32 v26, a246
v_accvgpr_read_b32 v27, a247
mvaaz 176,32,96
v_mul_f32 v116, s90, v116
v_mul_f32 v117, s90, v117
v_mul_f32 v118, s90, v118
v_mul_f32 v119, s90, v119
v_mul_f32 v24, s90, v24
mvaas 176,36,100
v_mul_f32 v25, s90, v25
v_mul_f32 v26, s90, v26
v_mul_f32 v27, s90, v27
v_cvt_pk_bf16_f32 v116, v116, v117
v_cvt_pk_bf16_f32 v117, v118, v119
maaaz 208,0,104
s_waitcnt lgkmcnt(1)
v_cvt_pk_bf16_f32 v118, v24, v25
v_cvt_pk_bf16_f32 v119, v26, v27
maaas 208,4,108
v_accvgpr_read_b32 v0, a248
v_accvgpr_read_b32 v1, a249
maaaz 212,8,104
rqa 120,18,14336
v_accvgpr_read_b32 v2, a250
maaas 212,12,108
v_accvgpr_read_b32 v3, a251
v_mul_f32 v120, s90, v120
v_mul_f32 v121, s90, v121
v_mul_f32 v122, s90, v122
v_mul_f32 v123, s90, v123
rqa 124,19,14336
maaaz 216,16,104
v_mul_f32 v0, s90, v0
v_mul_f32 v1, s90, v1
v_mul_f32 v2, s90, v2
v_mul_f32 v3, s90, v3
v_cvt_pk_bf16_f32 v120, v120, v121
maaas 216,20,108
v_cvt_pk_bf16_f32 v121, v122, v123
v_cvt_pk_bf16_f32 v122, v0, v1
v_cvt_pk_bf16_f32 v123, v2, v3
v_accvgpr_read_b32 v24, a252
v_accvgpr_read_b32 v25, a253
maaaz 220,24,104
v_accvgpr_read_b32 v26, a254
v_accvgpr_read_b32 v27, a255
v_mul_f32 v124, s90, v124
v_mul_f32 v125, s90, v125
v_mul_f32 v126, s90, v126
v_mul_f32 v127, s90, v127
v_mul_f32 v24, s90, v24
v_mul_f32 v25, s90, v25
v_mul_f32 v26, s90, v26
v_mul_f32 v27, s90, v27
v_cvt_pk_bf16_f32 v124, v124, v125
v_cvt_pk_bf16_f32 v125, v126, v127
v_cvt_pk_bf16_f32 v126, v24, v25
v_cvt_pk_bf16_f32 v127, v26, v27
maaas 220,28,108
s_waitcnt vmcnt(12) lgkmcnt(0)
s_barrier
mvaaz 180,32,104
s_add_u32 m0, s85, 98304
rqa 96,16,0
s_mov_b32 s82, 1048576
mvaas 180,36,108
buffer_load_dwordx4 v12, s[52:55], s82 offen offset:0 lds
maaaz 224,0,112
s_mov_b32 s44, s18
rqa 100,17,0
s_mov_b32 s45, s19
maaas 224,4,116
s_mov_b32 s46, 5242880
s_mov_b32 s48, s26
s_mov_b32 s49, s27
maaaz 228,8,112
buffer_load_dwordx4 v13, s[52:55], s82 offen offset:1024 lds
maaas 228,12,116
s_mov_b32 s50, 2211840
rqa 104,16,2048
s_and_b32 s5, s30, 3
maaaz 232,16,112
s_lshl2_add_u32 s5, s31, s5
rqa 108,17,2048
s_lshl3_add_u32 s5, s5, s94
maaas 232,20,116
s_mul_i32 s5, s5, 73728
s_mul_i32 s6, s80, 14336
s_add_u32 s5, s5, s6
maaaz 236,24,112
s_add_u32 s5, s5, 100663296
s_add_u32 s36, s64, s5
s_addc_u32 s37, s65, 0
maaas 236,28,116
s_lshl_b32 s6, s80, 12
s_add_u32 s38, s6, 18432
mvaaz 184,32,112
mvaas 184,36,116
buffer_load_dwordx4 v14, s[52:55], s82 offen offset:2048 lds
maaaz 240,0,120
rta 0,20,16384
maaas 240,4,124
rta 2,20,17408
maaaz 244,8,120
rta 4,20,24576
rta 6,20,25600
maaas 244,12,124
rta 8,21,16384
rta 10,21,17408
maaaz 248,16,120
s_mov_b32 s81, 384
rta 12,21,24576
rta 14,21,25600
maaas 248,20,124
s_mov_b32 s14, 0x26800000
rta 16,22,16384
rta 18,22,17408
maaaz 252,24,120
s_mov_b32 s87, 8192
rta 20,22,24576
rta 22,22,25600
maaas 252,28,124
s_mov_b32 s15, 0x58800000
rta 24,23,16384
rta 26,23,17408
mvaaz 188,32,120
buffer_load_dwordx4 v15, s[52:55], s82 offen offset:3072 lds
mvaas 188,36,124
s_add_u32 m0, s84, 65536
rta 28,23,24576
rta 30,23,25600
s_waitcnt lgkmcnt(12)
maaas 128,0,96
s_sub_u32 s11, 16, s31
rqa 112,16,4096
v_mbcnt_lo_u32_b32 v26, -1, 0
maaas 128,4,100
buffer_load_dwordx4 v8, s[40:43], s81 offen offset:0 lds
s_waitcnt lgkmcnt(9)
maaas 132,8,96
s_lshl_b32 s11, s11, 15
rqa 116,17,4096
v_mbcnt_hi_u32_b32 v26, -1, v26
maaas 132,12,100
buffer_store_dwordx4 v[32:35], v6, s[64:67], s87 offen offset:0 sc1
s_add_u32 s12, s11, 16384
s_add_u32 s16, s31, 1
s_lshl_b32 s16, s16, 15
s_waitcnt lgkmcnt(4)
maaas 136,16,96
s_sub_u32 s13, 8, s31
v_lshlrev_b32 v27, 4, v26
s_mov_b32 s9, 65536
maaas 136,20,100
s_mov_b32 s10, 98304
s_lshl_b32 s8, s80, 12
v_add_u32 v1, s8, v27
maaas 140,24,96
s_mov_b32 s20, 0x20e624a1
s_mov_b32 s21, 0x22f6ace3
s_cmp_eq_u32 s80, 0
s_waitcnt lgkmcnt(2)
maaas 140,28,100
buffer_load_dwordx4 a[32:35], v7, s[56:59], 0 offen offset:1024
mvaas 160,40,96
s_cselect_b32 s34, 16, 0
rqa 120,16,6144
s_lshr_b32 s5, s80, 1
mvaas 160,44,100
buffer_load_dwordx4 v9, s[40:43], s81 offen offset:1024 lds
maaas 144,0,104
s_xor_b32 s5, s5, s80
rqa 124,17,6144
s_lshl_b32 s5, s5, 12
maaas 144,4,108
buffer_load_dwordx4 a[36:39], v7, s[56:59], 0 offen offset:1088
maaas 148,8,104
s_lshl_b32 s6, s33, 11
v_add_u32 v2, s5, v27
s_lshl_b32 s5, s33, 13
maaas 148,12,108
buffer_load_dwordx4 v10, s[40:43], s81 offen offset:2048 lds
maaas 152,16,104
s_waitcnt lgkmcnt(2)
v_add_u32 v0, s5, v27
s_lshl_b32 s5, s32, 12
maaas 152,20,108
s_add_u32 s5, s5, s6
s_add_u32 s5, s5, 98304
v_add_u32 v24, s5, v27
maaas 156,24,104
s_lshl_b32 s5, s32, 13
s_add_u32 s5, s5, 98304
v_add_u32 v25, s5, v27
maaas 156,28,108
s_mov_b32 s87, 8192
v_and_b32 v27, 15, v26
s_lshl1_add_u32 s5, s33, 0
mvaas 164,40,104
s_add_u32 s6, s32, 0
rqa 96,16,8192
v_lshlrev_b32 v26, 2, v27
mvaas 164,44,108
s_cmp_gt_u32 s5, s6
s_cselect_b32 s22, 0xff800000, 0
s_cmp_eq_u32 s5, s6
maaas 160,0,112
buffer_load_dwordx4 v11, s[40:43], s81 offen offset:3072 lds
maaas 160,4,116
s_cselect_b32 s22, -2.0, s22
rqa 100,17,8192
s_lshl1_add_u32 s5, s33, 1
maaas 164,8,112
buffer_store_dwordx4 v[36:39], v6, s[64:67], s87 offen offset:1024 sc1
s_add_u32 s6, s32, 0
s_cmp_gt_u32 s5, s6
s_cselect_b32 s23, 0xff800000, 0
maaas 164,12,116
s_cmp_eq_u32 s5, s6
s_cselect_b32 s23, -2.0, s23
s_lshl1_add_u32 s5, s33, 0
maaas 168,16,112
s_add_u32 s6, s32, 2
s_cmp_gt_u32 s5, s6
s_cselect_b32 s24, 0xff800000, 0
maaas 168,20,116
s_cmp_eq_u32 s5, s6
s_cselect_b32 s24, -2.0, s24
s_lshl1_add_u32 s5, s33, 1
maaas 172,24,112
s_add_u32 s6, s32, 2
s_cmp_gt_u32 s5, s6
s_cselect_b32 s25, 0xff800000, 0
maaas 172,28,116
s_cmp_eq_u32 s5, s6
s_cselect_b32 s25, -2.0, s25
s_add_u32 m0, s84, 69632
mvaas 168,40,112
s_waitcnt lgkmcnt(1)
rqa 104,16,10240
s_mov_b32 s81, 41344
mvaas 168,44,116
buffer_load_dwordx4 v8, s[40:43], s81 offen offset:0 lds
maaas 176,0,120
rqa 108,17,10240
maaas 176,4,124
maaas 180,8,120
buffer_load_dwordx4 v9, s[40:43], s81 offen offset:1024 lds
maaas 180,12,124
maaas 184,16,120
maaas 184,20,124
maaas 188,24,120
maaas 188,28,124
mvaas 172,40,120
rqa 112,16,12288
mvaas 172,44,124
buffer_load_dwordx4 v10, s[40:43], s81 offen offset:2048 lds
maaas 192,0,96
rqa 116,17,12288
s_waitcnt lgkmcnt(3)
maaas 192,4,100
maaas 196,8,96
maaas 196,12,100
maaas 200,16,96
buffer_load_dwordx4 v11, s[40:43], s81 offen offset:3072 lds
maaas 200,20,100
maaas 204,24,96
maaas 204,28,100
mvaas 176,40,96
rqa 120,16,14336
mvaas 176,44,100
maaas 208,0,104
rqa 124,17,14336
s_waitcnt lgkmcnt(3)
maaas 208,4,108
maaas 212,8,104
maaas 212,12,108
maaas 216,16,104
maaas 216,20,108
maaas 220,24,104
maaas 220,28,108
s_waitcnt vmcnt(12) lgkmcnt(0)
s_barrier
mvaas 180,40,104
s_add_u32 m0, s85, 114688
rqa 96,16,32768
s_mov_b32 s82, 1572864
mvaas 180,44,108
buffer_load_dwordx4 v12, s[52:55], s82 offen offset:0 lds
maaas 224,0,112
rqa 100,17,32768
maaas 224,4,116
maaas 228,8,112
buffer_load_dwordx4 v13, s[52:55], s82 offen offset:1024 lds
maaas 228,12,116
rqa 104,16,34816
maaas 232,16,112
rqa 108,17,34816
maaas 232,20,116
maaas 236,24,112
maaas 236,28,116
mvaas 184,40,112
mvaas 184,44,116
buffer_load_dwordx4 v14, s[52:55], s82 offen offset:2048 lds
maaas 240,0,120
rta 0,20,0
maaas 240,4,124
rta 2,20,1024
maaas 244,8,120
rta 4,20,8192
rta 6,20,9216
maaas 244,12,124
rta 8,21,0
rta 10,21,1024
maaas 248,16,120
s_mov_b32 s81, 512
rta 12,21,8192
rta 14,21,9216
maaas 248,20,124
rta 16,22,0
rta 18,22,1024
maaas 252,24,120
s_mov_b32 s87, 8192
rta 20,22,8192
rta 22,22,9216
maaas 252,28,124
rta 24,23,0
rta 26,23,1024
mvaas 188,40,120
buffer_load_dwordx4 v15, s[52:55], s82 offen offset:3072 lds
mvaas 188,44,124
s_add_u32 m0, s84, 0
rta 28,23,8192
rta 30,23,9216
s_waitcnt lgkmcnt(14)
maaas 128,0,96
rqa 112,16,36864
s_waitcnt lgkmcnt(11)
maaas 128,4,100
buffer_load_dwordx4 v8, s[40:43], s81 offen offset:0 lds
maaas 132,8,96
rqa 116,17,36864
s_waitcnt lgkmcnt(8)
maaas 132,12,100
buffer_load_dword v27, v26, s[76:79], s8 offen sc1
maaas 136,16,96
buffer_store_dwordx4 v[40:43], v6, s[64:67], s87 offen offset:2048 sc1
s_waitcnt lgkmcnt(6)
maaas 136,20,100
s_waitcnt lgkmcnt(4)
maaas 140,24,96
s_waitcnt lgkmcnt(2)
maaas 140,28,100
buffer_load_dwordx4 a[40:43], v7, s[56:59], 0 offen offset:1152
mvaas 160,48,96
rqa 120,16,38912
mvaas 160,52,100
buffer_load_dwordx4 v9, s[40:43], s81 offen offset:1024 lds
maaas 144,0,104
rqa 124,17,38912
s_mov_b32 s87, 8192
maaas 144,4,108
buffer_load_dwordx4 a[44:47], v7, s[56:59], 0 offen offset:1216
maaas 148,8,104
maaas 148,12,108
buffer_load_dwordx4 v10, s[40:43], s81 offen offset:2048 lds
maaas 152,16,104
maaas 152,20,108
maaas 156,24,104
maaas 156,28,108
buffer_store_dwordx4 v[44:47], v6, s[64:67], s87 offen offset:3072 sc1
mvaas 164,48,104
rqa 96,16,40960
mvaas 164,52,108
s_waitcnt lgkmcnt(1)
maaas 160,0,112
buffer_load_dwordx4 v11, s[40:43], s81 offen offset:3072 lds
maaas 160,4,116
s_add_u32 m0, s84, 4096
rqa 100,17,40960
s_mov_b32 s81, 41472
maaas 164,8,112
s_mov_b32 s87, 532480
maaas 164,12,116
maaas 168,16,112
maaas 168,20,116
maaas 172,24,112
maaas 172,28,116
buffer_load_dwordx4 v8, s[40:43], s81 offen offset:0 lds
mvaas 168,48,112
rqa 104,16,43008
mvaas 168,52,116
buffer_store_dwordx4 v[48:51], v6, s[64:67], s87 offen offset:0 sc1
maaas 176,0,120
rqa 108,17,43008
maaas 176,4,124
maaas 180,8,120
buffer_load_dwordx4 v9, s[40:43], s81 offen offset:1024 lds
maaas 180,12,124
maaas 184,16,120
maaas 184,20,124
maaas 188,24,120
maaas 188,28,124
mvaas 172,48,120
rqa 112,16,45056
s_waitcnt lgkmcnt(2)
mvaas 172,52,124
buffer_load_dwordx4 v10, s[40:43], s81 offen offset:2048 lds
maaas 192,0,96
rqa 116,17,45056
maaas 192,4,100
maaas 196,8,96
maaas 196,12,100
maaas 200,16,96
buffer_load_dwordx4 v11, s[40:43], s81 offen offset:3072 lds
maaas 200,20,100
maaas 204,24,96
maaas 204,28,100
mvaas 176,48,96
rqa 120,16,47104
mvaas 176,52,100
maaas 208,0,104
rqa 124,17,47104
s_waitcnt lgkmcnt(3)
maaas 208,4,108
maaas 212,8,104
maaas 212,12,108
maaas 216,16,104
maaas 216,20,108
maaas 220,24,104
maaas 220,28,108
s_waitcnt vmcnt(14) lgkmcnt(0)
s_barrier
mvaas 180,48,104
s_add_u32 m0, s85, 98304
rqa 96,18,0
s_mov_b32 s82, 2097152
mvaas 180,52,108
buffer_load_dwordx4 v12, s[52:55], s82 offen offset:0 lds
maaas 224,0,112
rqa 100,19,0
maaas 224,4,116
maaas 228,8,112
buffer_load_dwordx4 v13, s[52:55], s82 offen offset:1024 lds
maaas 228,12,116
rqa 104,18,2048
maaas 232,16,112
rqa 108,19,2048
maaas 232,20,116
maaas 236,24,112
maaas 236,28,116
mvaas 184,48,112
mvaas 184,52,116
buffer_load_dwordx4 v14, s[52:55], s82 offen offset:2048 lds
maaas 240,0,120
rta 0,20,16384
maaas 240,4,124
rta 2,20,17408
maaas 244,8,120
rta 4,20,24576
rta 6,20,25600
maaas 244,12,124
rta 8,21,16384
rta 10,21,17408
maaas 248,16,120
s_mov_b32 s81, 640
rta 12,21,24576
rta 14,21,25600
maaas 248,20,124
rta 16,22,16384
rta 18,22,17408
maaas 252,24,120
s_mov_b32 s87, 532480
rta 20,22,24576
rta 22,22,25600
maaas 252,28,124
rta 24,23,16384
rta 26,23,17408
mvaas 188,48,120
buffer_load_dwordx4 v15, s[52:55], s82 offen offset:3072 lds
mvaas 188,52,124
s_add_u32 m0, s84, 32768
rta 28,23,24576
rta 30,23,25600
s_waitcnt lgkmcnt(14)
maaas 128,0,96
rqa 112,18,4096
s_waitcnt lgkmcnt(11)
maaas 128,4,100
buffer_load_dwordx4 v8, s[40:43], s81 offen offset:0 lds
maaas 132,8,96
rqa 116,19,4096
s_waitcnt lgkmcnt(10)
maaas 132,12,100
buffer_store_dwordx4 v[52:55], v6, s[64:67], s87 offen offset:1024 sc1
s_waitcnt lgkmcnt(8)
maaas 136,16,96
s_waitcnt lgkmcnt(6)
maaas 136,20,100
v_accvgpr_read_b32 v32, a128
s_waitcnt lgkmcnt(4)
maaas 140,24,96
s_waitcnt lgkmcnt(2)
v_accvgpr_read_b32 v33, a129
v_accvgpr_read_b32 v34, a130
maaas 140,28,100
v_accvgpr_read_b32 v35, a131
v_accvgpr_read_b32 v36, a132
mvaas 160,56,96
rqa 120,18,6144
v_accvgpr_read_b32 v37, a133
mvaas 160,60,100
buffer_load_dwordx4 v9, s[40:43], s81 offen offset:1024 lds
maaas 144,0,104
s_mov_b32 s87, 532480
rqa 124,19,6144
v_accvgpr_read_b32 v38, a134
maaas 144,4,108
v_accvgpr_read_b32 v39, a135
v_accvgpr_read_b32 v40, a136
maaas 148,8,104
v_accvgpr_read_b32 v41, a137
v_accvgpr_read_b32 v42, a138
maaas 148,12,108
v_accvgpr_read_b32 v43, a139
v_accvgpr_read_b32 v44, a140
maaas 152,16,104
v_accvgpr_read_b32 v45, a141
v_accvgpr_read_b32 v46, a142
maaas 152,20,108
buffer_load_dwordx4 v10, s[40:43], s81 offen offset:2048 lds
maaas 156,24,104
v_accvgpr_read_b32 v47, a143
maaas 156,28,108
buffer_store_dwordx4 v[56:59], v6, s[64:67], s87 offen offset:2048 sc1
mvaas 164,56,104
rqa 96,18,8192
mvaas 164,60,108
s_waitcnt lgkmcnt(1)
maaas 160,0,112
buffer_load_dwordx4 v11, s[40:43], s81 offen offset:3072 lds
maaas 160,4,116
s_add_u32 m0, s84, 36864
rqa 100,19,8192
s_mov_b32 s81, 41600
maaas 164,8,112
s_mov_b32 s87, 532480
maaas 164,12,116
maaas 168,16,112
maaas 168,20,116
maaas 172,24,112
maaas 172,28,116
buffer_load_dwordx4 v8, s[40:43], s81 offen offset:0 lds
mvaas 168,56,112
rqa 104,18,10240
mvaas 168,60,116
buffer_store_dwordx4 v[60:63], v6, s[64:67], s87 offen offset:3072 sc1
maaas 176,0,120
rqa 108,19,10240
maaas 176,4,124
maaas 180,8,120
buffer_load_dwordx4 v9, s[40:43], s81 offen offset:1024 lds
maaas 180,12,124
maaas 184,16,120
maaas 184,20,124
maaas 188,24,120
maaas 188,28,124
mvaas 172,56,120
rqa 112,18,12288
s_waitcnt lgkmcnt(2)
mvaas 172,60,124
buffer_load_dwordx4 v10, s[40:43], s81 offen offset:2048 lds
maaas 192,0,96
rqa 116,19,12288
maaas 192,4,100
maaas 196,8,96
maaas 196,12,100
maaas 200,16,96
buffer_load_dwordx4 v11, s[40:43], s81 offen offset:3072 lds
maaas 200,20,100
maaas 204,24,96
maaas 204,28,100
mvaas 176,56,96
rqa 120,18,14336
mvaas 176,60,100
maaas 208,0,104
rqa 124,19,14336
s_waitcnt lgkmcnt(3)
maaas 208,4,108
maaas 212,8,104
maaas 212,12,108
maaas 216,16,104
maaas 216,20,108
maaas 220,24,104
maaas 220,28,108
s_waitcnt vmcnt(11) lgkmcnt(0)
s_barrier
mvaas 180,56,104
s_add_u32 m0, s85, 114688
rqa 96,16,0
s_mov_b32 s82, 2621440
mvaas 180,60,108
buffer_load_dwordx4 v12, s[52:55], s82 offen offset:0 lds
maaas 224,0,112
rqa 100,17,0
maaas 224,4,116
maaas 228,8,112
buffer_load_dwordx4 v13, s[52:55], s82 offen offset:1024 lds
maaas 228,12,116
rqa 104,16,2048
v_cmp_gt_u32 vcc, s34, v27
maaas 232,16,112
rqa 108,17,2048
maaas 232,20,116
maaas 236,24,112
maaas 236,28,116
mvaas 184,56,112
mvaas 184,60,116
maaas 240,0,120
s_cbranch_vccnz PCS_spin
PCS_ok:
rta 0,20,0
maaas 240,4,124
rta 2,20,1024
v_mbcnt_lo_u32_b32 v26, -1, 0
maaas 244,8,120
rta 4,20,8192
rta 6,20,9216
maaas 244,12,124
rta 8,21,0
rta 10,21,1024
maaas 248,16,120
buffer_load_dwordx4 v14, s[52:55], s82 offen offset:2048 lds
maaas 248,20,124
s_mov_b32 s81, 768
rta 12,21,8192
rta 14,21,9216
maaas 252,24,120
s_mov_b32 s87, 16384
rta 16,22,0
rta 18,22,1024
maaas 252,28,124
rta 20,22,8192
rta 22,22,9216
mvaas 188,56,120
s_waitcnt lgkmcnt(10)
rta 24,23,0
rta 26,23,1024
mvaas 188,60,124
buffer_load_dwordx4 v15, s[52:55], s82 offen offset:3072 lds
mvaas 32,0,96
s_add_u32 m0, s84, 65536
rta 28,23,8192
rta 30,23,9216
s_waitcnt lgkmcnt(12)
mvaas 32,4,100
s_waitcnt lgkmcnt(10)
rqa 112,16,4096
v_mbcnt_hi_u32_b32 v26, -1, v26
mvaas 36,8,96
buffer_load_dwordx4 v8, s[40:43], s81 offen offset:0 lds
s_waitcnt lgkmcnt(9)
mvaas 36,12,100
s_waitcnt lgkmcnt(7)
rqa 116,17,4096
v_lshlrev_b32 v26, 2, v26
mvaas 40,16,96
buffer_store_dwordx4 v[64:67], v6, s[64:67], s87 offen offset:0 sc1
s_waitcnt lgkmcnt(6)
mvaas 40,20,100
s_waitcnt lgkmcnt(4)
mvaas 44,24,96
s_waitcnt lgkmcnt(2)
mvaas 44,28,100
mvaas 160,64,96
buffer_load_dwordx4 v9, s[40:43], s81 offen offset:1024 lds
mvaas 160,68,100
rqa 120,16,6144
maaas 144,0,104
rqa 124,17,6144
s_mov_b32 s87, 16384
maaas 144,4,108
maaas 148,8,104
maaas 148,12,108
buffer_load_dwordx4 v10, s[40:43], s81 offen offset:2048 lds
maaas 152,16,104
maaas 152,20,108
maaas 156,24,104
maaas 156,28,108
buffer_store_dwordx4 v[68:71], v6, s[64:67], s87 offen offset:1024 sc1
v_accvgpr_read_b32 v48, a144
v_accvgpr_read_b32 v49, a145
v_accvgpr_read_b32 v50, a146
mvaas 164,64,104
rqa 96,16,8192
v_accvgpr_read_b32 v51, a147
mvaas 164,68,108
s_waitcnt lgkmcnt(2)
v_accvgpr_read_b32 v52, a148
v_accvgpr_read_b32 v53, a149
maaas 160,0,112
rqa 100,17,8192
v_accvgpr_read_b32 v54, a150
maaas 160,4,116
buffer_load_dwordx4 v11, s[40:43], s81 offen offset:3072 lds
maaas 164,8,112
s_add_u32 m0, s84, 69632
v_accvgpr_read_b32 v55, a151
v_accvgpr_read_b32 v56, a152
maaas 164,12,116
s_mov_b32 s81, 41728
v_accvgpr_read_b32 v57, a153
v_accvgpr_read_b32 v58, a154
maaas 168,16,112
s_mov_b32 s87, 16384
v_accvgpr_read_b32 v59, a155
v_accvgpr_read_b32 v60, a156
maaas 168,20,116
v_accvgpr_read_b32 v61, a157
v_accvgpr_read_b32 v62, a158
maaas 172,24,112
v_accvgpr_read_b32 v63, a159
maaas 172,28,116
buffer_load_dwordx4 v8, s[40:43], s81 offen offset:0 lds
mvaas 168,64,112
rqa 104,16,10240
mvaas 168,68,116
buffer_store_dwordx4 v[72:75], v6, s[64:67], s87 offen offset:2048 sc1
maaas 176,0,120
rqa 108,17,10240
s_waitcnt lgkmcnt(2)
maaas 176,4,124
maaas 180,8,120
buffer_load_dwordx4 v9, s[40:43], s81 offen offset:1024 lds
maaas 180,12,124
maaas 184,16,120
maaas 184,20,124
maaas 188,24,120
maaas 188,28,124
mvaas 172,64,120
rqa 112,16,12288
mvaas 172,68,124
buffer_load_dwordx4 v10, s[40:43], s81 offen offset:2048 lds
maaas 192,0,96
rqa 116,17,12288
maaas 192,4,100
maaas 196,8,96
maaas 196,12,100
maaas 200,16,96
buffer_load_dwordx4 v11, s[40:43], s81 offen offset:3072 lds
maaas 200,20,100
maaas 204,24,96
maaas 204,28,100
mvaas 176,64,96
rqa 120,16,14336
mvaas 176,68,100
s_waitcnt lgkmcnt(2)
maaas 208,0,104
rqa 124,17,14336
maaas 208,4,108
maaas 212,8,104
maaas 212,12,108
maaas 216,16,104
maaas 216,20,108
maaas 220,24,104
maaas 220,28,108
s_waitcnt vmcnt(11) lgkmcnt(0)
s_barrier
mvaas 180,64,104
s_cmp_eq_u32 s80, 0
rqa 96,16,32768
s_cselect_b32 s87, s100, 268435456
mvaas 180,68,108
s_add_u32 m0, s85, 98304
v_mov_b32 v27, 1
v_and_b32 v28, 12, v26
s_mov_b32 s82, 3145728
maaas 224,0,112
buffer_store_dword v27, v28, s[64:67], s87 offen sc1
maaas 224,4,116
buffer_load_dwordx4 v12, s[52:55], s82 offen offset:0 lds
maaas 228,8,112
rqa 100,17,32768
maaas 228,12,116
buffer_load_dwordx4 v13, s[52:55], s82 offen offset:1024 lds
maaas 232,16,112
rqa 104,16,34816
maaas 232,20,116
rqa 108,17,34816
maaas 236,24,112
maaas 236,28,116
mvaas 184,64,112
mvaas 184,68,116
buffer_load_dwordx4 v14, s[52:55], s82 offen offset:2048 lds
maaas 240,0,120
rta 0,20,16384
maaas 240,4,124
rta 2,20,17408
maaas 244,8,120
rta 4,20,24576
rta 6,20,25600
maaas 244,12,124
rta 8,21,16384
rta 10,21,17408
maaas 248,16,120
s_mov_b32 s81, 896
rta 12,21,24576
rta 14,21,25600
maaas 248,20,124
rta 16,22,16384
rta 18,22,17408
maaas 252,24,120
s_mov_b32 s87, 16384
rta 20,22,24576
rta 22,22,25600
maaas 252,28,124
rta 24,23,16384
rta 26,23,17408
mvaas 188,64,120
buffer_load_dwordx4 v15, s[52:55], s82 offen offset:3072 lds
mvaas 188,68,124
s_add_u32 m0, s84, 0
rta 28,23,24576
rta 30,23,25600
s_waitcnt lgkmcnt(14)
mvaas 32,0,96
rqa 112,16,36864
s_waitcnt lgkmcnt(11)
mvaas 32,4,100
buffer_load_dwordx4 v8, s[40:43], s81 offen offset:0 lds
mvaas 36,8,96
rqa 116,17,36864
s_waitcnt lgkmcnt(10)
mvaas 36,12,100
buffer_store_dwordx4 v[76:79], v6, s[64:67], s87 offen offset:3072 sc1
s_waitcnt lgkmcnt(8)
mvaas 40,16,96
s_waitcnt lgkmcnt(6)
mvaas 40,20,100
s_waitcnt lgkmcnt(4)
mvaas 44,24,96
s_waitcnt lgkmcnt(2)
mvaas 44,28,100
mvaas 160,72,96
buffer_load_dwordx4 v9, s[40:43], s81 offen offset:1024 lds
mvaas 160,76,100
rqa 120,16,38912
mvaas 48,0,104
rqa 124,17,38912
s_mov_b32 s87, 540672
mvaas 48,4,108
mvaas 52,8,104
mvaas 52,12,108
buffer_load_dwordx4 v10, s[40:43], s81 offen offset:2048 lds
mvaas 56,16,104
mvaas 56,20,108
mvaas 60,24,104
mvaas 60,28,108
buffer_store_dwordx4 v[80:83], v6, s[64:67], s87 offen offset:0 sc1
mvaas 164,72,104
rqa 96,16,40960
mvaas 164,76,108
s_waitcnt lgkmcnt(1)
maaas 160,0,112
buffer_load_dwordx4 v11, s[40:43], s81 offen offset:3072 lds
maaas 160,4,116
s_add_u32 m0, s84, 4096
rqa 100,17,40960
s_mov_b32 s81, 41856
maaas 164,8,112
s_mov_b32 s87, 540672
maaas 164,12,116
maaas 168,16,112
maaas 168,20,116
maaas 172,24,112
maaas 172,28,116
buffer_load_dwordx4 v8, s[40:43], s81 offen offset:0 lds
mvaas 168,72,112
rqa 104,16,43008
mvaas 168,76,116
buffer_store_dwordx4 v[84:87], v6, s[64:67], s87 offen offset:1024 sc1
maaas 176,0,120
rqa 108,17,43008
maaas 176,4,124
maaas 180,8,120
buffer_load_dwordx4 v9, s[40:43], s81 offen offset:1024 lds
maaas 180,12,124
maaas 184,16,120
maaas 184,20,124
maaas 188,24,120
maaas 188,28,124
mvaas 172,72,120
rqa 112,16,45056
s_waitcnt lgkmcnt(2)
mvaas 172,76,124
buffer_load_dwordx4 v10, s[40:43], s81 offen offset:2048 lds
maaas 192,0,96
rqa 116,17,45056
maaas 192,4,100
maaas 196,8,96
maaas 196,12,100
maaas 200,16,96
buffer_load_dwordx4 v11, s[40:43], s81 offen offset:3072 lds
maaas 200,20,100
maaas 204,24,96
maaas 204,28,100
mvaas 176,72,96
rqa 120,16,47104
mvaas 176,76,100
maaas 208,0,104
rqa 124,17,47104
s_waitcnt lgkmcnt(3)
maaas 208,4,108
maaas 212,8,104
maaas 212,12,108
maaas 216,16,104
maaas 216,20,108
maaas 220,24,104
maaas 220,28,108
s_waitcnt vmcnt(11) lgkmcnt(0)
s_barrier
mvaas 180,72,104
s_add_u32 m0, s85, 114688
rqa 96,18,0
s_mov_b32 s82, 3670016
mvaas 180,76,108
buffer_load_dwordx4 v12, s[52:55], s82 offen offset:0 lds
maaas 224,0,112
rqa 100,19,0
maaas 224,4,116
maaas 228,8,112
buffer_load_dwordx4 v13, s[52:55], s82 offen offset:1024 lds
maaas 228,12,116
rqa 104,18,2048
maaas 232,16,112
rqa 108,19,2048
maaas 232,20,116
maaas 236,24,112
maaas 236,28,116
mvaas 184,72,112
mvaas 184,76,116
buffer_load_dwordx4 v14, s[52:55], s82 offen offset:2048 lds
maaas 240,0,120
rta 0,20,0
maaas 240,4,124
rta 2,20,1024
maaas 244,8,120
rta 4,20,8192
rta 6,20,9216
maaas 244,12,124
rta 8,21,0
rta 10,21,1024
maaas 248,16,120
s_mov_b32 s81, 1024
rta 12,21,8192
rta 14,21,9216
maaas 248,20,124
rta 16,22,0
rta 18,22,1024
maaas 252,24,120
s_mov_b32 s87, 540672
rta 20,22,8192
rta 22,22,9216
maaas 252,28,124
rta 24,23,0
rta 26,23,1024
mvaas 188,72,120
buffer_load_dwordx4 v15, s[52:55], s82 offen offset:3072 lds
mvaas 188,76,124
s_add_u32 m0, s84, 32768
rta 28,23,8192
rta 30,23,9216
s_waitcnt lgkmcnt(14)
mvaas 32,0,96
rqa 112,18,4096
s_waitcnt lgkmcnt(11)
mvaas 32,4,100
buffer_load_dwordx4 v8, s[40:43], s81 offen offset:0 lds
mvaas 36,8,96
rqa 116,19,4096
s_waitcnt lgkmcnt(10)
mvaas 36,12,100
buffer_store_dwordx4 v[88:91], v6, s[64:67], s87 offen offset:2048 sc1
s_waitcnt lgkmcnt(8)
mvaas 40,16,96
s_waitcnt lgkmcnt(6)
mvaas 40,20,100
s_waitcnt lgkmcnt(4)
mvaas 44,24,96
s_waitcnt lgkmcnt(2)
mvaas 44,28,100
mvaas 160,80,96
buffer_load_dwordx4 v9, s[40:43], s81 offen offset:1024 lds
mvaas 160,84,100
rqa 120,18,6144
mvaas 48,0,104
rqa 124,19,6144
s_mov_b32 s87, 540672
mvaas 48,4,108
mvaas 52,8,104
mvaas 52,12,108
buffer_load_dwordx4 v10, s[40:43], s81 offen offset:2048 lds
mvaas 56,16,104
mvaas 56,20,108
mvaas 60,24,104
mvaas 60,28,108
buffer_store_dwordx4 v[92:95], v6, s[64:67], s87 offen offset:3072 sc1
mvaas 164,80,104
rqa 96,18,8192
mvaas 164,84,108
s_waitcnt lgkmcnt(1)
maaas 160,0,112
buffer_load_dwordx4 v11, s[40:43], s81 offen offset:3072 lds
maaas 160,4,116
s_add_u32 m0, s84, 36864
rqa 100,19,8192
s_mov_b32 s81, 41984
maaas 164,8,112
s_mov_b32 s87, 24576
maaas 164,12,116
maaas 168,16,112
s_nop 0
v_accvgpr_read_b32 v64, a160
maaas 168,20,116
v_accvgpr_read_b32 v65, a161
v_accvgpr_read_b32 v66, a162
maaas 172,24,112
v_accvgpr_read_b32 v67, a163
maaas 172,28,116
buffer_load_dwordx4 v8, s[40:43], s81 offen offset:0 lds
mvaas 168,80,112
rqa 104,18,10240
v_accvgpr_read_b32 v68, a164
mvaas 168,84,116
buffer_store_dwordx4 v[96:99], v6, s[64:67], s87 offen offset:0 sc1
v_accvgpr_read_b32 v69, a165
v_accvgpr_read_b32 v70, a166
v_accvgpr_read_b32 v71, a167
maaas 176,0,120
rqa 108,19,10240
v_accvgpr_read_b32 v72, a168
maaas 176,4,124
v_accvgpr_read_b32 v73, a169
v_accvgpr_read_b32 v74, a170
maaas 180,8,120
v_accvgpr_read_b32 v75, a171
v_accvgpr_read_b32 v76, a172
maaas 180,12,124
buffer_load_dwordx4 v9, s[40:43], s81 offen offset:1024 lds
maaas 184,16,120
v_accvgpr_read_b32 v77, a173
v_accvgpr_read_b32 v78, a174
maaas 184,20,124
v_accvgpr_read_b32 v79, a175
maaas 188,24,120
maaas 188,28,124
mvaas 172,80,120
rqa 112,18,12288
s_waitcnt lgkmcnt(2)
mvaas 172,84,124
buffer_load_dwordx4 v10, s[40:43], s81 offen offset:2048 lds
maaas 192,0,96
rqa 116,19,12288
maaas 192,4,100
maaas 196,8,96
maaas 196,12,100
maaas 200,16,96
buffer_load_dwordx4 v11, s[40:43], s81 offen offset:3072 lds
maaas 200,20,100
maaas 204,24,96
maaas 204,28,100
mvaas 176,80,96
rqa 120,18,14336
mvaas 176,84,100
maaas 208,0,104
rqa 124,19,14336
s_waitcnt lgkmcnt(3)
maaas 208,4,108
maaas 212,8,104
maaas 212,12,108
maaas 216,16,104
maaas 216,20,108
maaas 220,24,104
maaas 220,28,108
s_waitcnt vmcnt(11) lgkmcnt(0)
s_barrier
mvaas 180,80,104
s_add_u32 m0, s85, 98304
rqa 96,16,0
s_mov_b32 s82, 4194304
mvaas 180,84,108
buffer_load_dwordx4 v12, s[52:55], s82 offen offset:0 lds
maaas 224,0,112
rqa 100,17,0
maaas 224,4,116
maaas 228,8,112
buffer_load_dwordx4 v13, s[52:55], s82 offen offset:1024 lds
maaas 228,12,116
rqa 104,16,2048
maaas 232,16,112
rqa 108,17,2048
maaas 232,20,116
maaas 236,24,112
maaas 236,28,116
mvaas 184,80,112
mvaas 184,84,116
buffer_load_dwordx4 v14, s[52:55], s82 offen offset:2048 lds
maaas 240,0,120
rta 0,20,16384
maaas 240,4,124
rta 2,20,17408
maaas 244,8,120
rta 4,20,24576
rta 6,20,25600
maaas 244,12,124
rta 8,21,16384
rta 10,21,17408
maaas 248,16,120
s_mov_b32 s81, 1152
rta 12,21,24576
rta 14,21,25600
maaas 248,20,124
rta 16,22,16384
rta 18,22,17408
maaas 252,24,120
s_mov_b32 s87, 24576
rta 20,22,24576
rta 22,22,25600
maaas 252,28,124
rta 24,23,16384
rta 26,23,17408
mvaas 188,80,120
buffer_load_dwordx4 v15, s[52:55], s82 offen offset:3072 lds
mvaas 188,84,124
s_add_u32 m0, s84, 65536
rta 28,23,24576
rta 30,23,25600
s_waitcnt lgkmcnt(14)
mvaas 32,0,96
rqa 112,16,4096
s_waitcnt lgkmcnt(11)
mvaas 32,4,100
buffer_load_dwordx4 v8, s[40:43], s81 offen offset:0 lds
mvaas 36,8,96
rqa 116,17,4096
s_waitcnt lgkmcnt(10)
mvaas 36,12,100
buffer_store_dwordx4 v[100:103], v6, s[64:67], s87 offen offset:1024 sc1
s_waitcnt lgkmcnt(8)
mvaas 40,16,96
s_waitcnt lgkmcnt(6)
mvaas 40,20,100
s_waitcnt lgkmcnt(4)
mvaas 44,24,96
s_waitcnt lgkmcnt(2)
mvaas 44,28,100
mvaas 160,88,96
buffer_load_dwordx4 v9, s[40:43], s81 offen offset:1024 lds
mvaas 160,92,100
rqa 120,16,6144
mvaas 48,0,104
rqa 124,17,6144
s_mov_b32 s87, 24576
mvaas 48,4,108
mvaas 52,8,104
mvaas 52,12,108
buffer_load_dwordx4 v10, s[40:43], s81 offen offset:2048 lds
mvaas 56,16,104
mvaas 56,20,108
mvaas 60,24,104
mvaas 60,28,108
buffer_store_dwordx4 v[104:107], v6, s[64:67], s87 offen offset:2048 sc1
mvaas 164,88,104
rqa 96,16,8192
mvaas 164,92,108
s_waitcnt lgkmcnt(1)
mvaas 64,0,112
buffer_load_dwordx4 v11, s[40:43], s81 offen offset:3072 lds
mvaas 64,4,116
s_add_u32 m0, s84, 69632
rqa 100,17,8192
s_mov_b32 s81, 42112
mvaas 68,8,112
s_mov_b32 s87, 24576
mvaas 68,12,116
mvaas 72,16,112
mvaas 72,20,116
mvaas 76,24,112
mvaas 76,28,116
buffer_load_dwordx4 v8, s[40:43], s81 offen offset:0 lds
mvaas 168,88,112
rqa 104,16,10240
mvaas 168,92,116
buffer_store_dwordx4 v[108:111], v6, s[64:67], s87 offen offset:3072 sc1
maaas 176,0,120
rqa 108,17,10240
maaas 176,4,124
maaas 180,8,120
buffer_load_dwordx4 v9, s[40:43], s81 offen offset:1024 lds
maaas 180,12,124
maaas 184,16,120
maaas 184,20,124
maaas 188,24,120
maaas 188,28,124
s_nop 0
v_accvgpr_read_b32 v80, a176
mvaas 172,88,120
rqa 112,16,12288
v_accvgpr_read_b32 v81, a177
mvaas 172,92,124
s_waitcnt lgkmcnt(2)
v_accvgpr_read_b32 v82, a178
v_accvgpr_read_b32 v83, a179
maaas 192,0,96
rqa 116,17,12288
v_accvgpr_read_b32 v84, a180
maaas 192,4,100
buffer_load_dwordx4 v10, s[40:43], s81 offen offset:2048 lds
maaas 196,8,96
v_accvgpr_read_b32 v85, a181
v_accvgpr_read_b32 v86, a182
maaas 196,12,100
v_accvgpr_read_b32 v87, a183
v_accvgpr_read_b32 v88, a184
maaas 200,16,96
v_accvgpr_read_b32 v89, a185
v_accvgpr_read_b32 v90, a186
maaas 200,20,100
v_accvgpr_read_b32 v91, a187
v_accvgpr_read_b32 v92, a188
maaas 204,24,96
v_accvgpr_read_b32 v93, a189
v_accvgpr_read_b32 v94, a190
maaas 204,28,100
v_accvgpr_read_b32 v95, a191
mvaas 176,88,96
buffer_load_dwordx4 v11, s[40:43], s81 offen offset:3072 lds
mvaas 176,92,100
rqa 120,16,14336
maaas 208,0,104
rqa 124,17,14336
s_waitcnt lgkmcnt(3)
maaas 208,4,108
maaas 212,8,104
maaas 212,12,108
maaas 216,16,104
maaas 216,20,108
maaas 220,24,104
maaas 220,28,108
s_waitcnt vmcnt(11) lgkmcnt(0)
s_barrier
mvaas 180,88,104
s_add_u32 m0, s85, 114688
rqa 96,16,32768
s_mov_b32 s82, 4718592
mvaas 180,92,108
buffer_load_dwordx4 v12, s[52:55], s82 offen offset:0 lds
maaas 224,0,112
rqa 100,17,32768
maaas 224,4,116
maaas 228,8,112
rqa 104,16,34816
maaas 228,12,116
rqa 108,17,34816
maaas 232,16,112
maaas 232,20,116
maaas 236,24,112
v_min_u32 v28, 212, v26
v_lshlrev_b32 v28, 5, v28
maaas 236,28,116
buffer_load_dwordx4 v13, s[52:55], s82 offen offset:1024 lds
mvaas 184,88,112
mvaas 184,92,116
maaas 240,0,120
rta 0,20,0
maaas 240,4,124
rta 2,20,1024
maaas 244,8,120
s_lshl2_add_u32 s35, s101, s80
rta 4,20,8192
rta 6,20,9216
maaas 244,12,124
s_mul_i32 s35, s35, 13824
rta 8,21,0
rta 10,21,1024
maaas 248,16,120
s_add_u32 s35, s35, 0
rta 12,21,8192
rta 14,21,9216
maaas 248,20,124
rta 16,22,0
rta 18,22,1024
maaas 252,24,120
rta 20,22,8192
rta 22,22,9216
maaas 252,28,124
rta 24,23,0
rta 26,23,1024
mvaas 188,88,120
rta 28,23,8192
mvaas 188,92,124
rta 30,23,9216
s_waitcnt lgkmcnt(12)
mvaas 32,0,96
buffer_load_dwordx4 v14, s[52:55], s82 offen offset:2048 lds
mvaas 32,4,100
rqa 112,16,36864
s_waitcnt lgkmcnt(9)
mvaas 36,8,96
buffer_load_dword v31, v28, s[48:51], s35 offen
mvaas 36,12,100
s_lshl2_add_u32 s35, s101, s80
rqa 116,17,36864
v_min_u32 v28, 212, v26
s_waitcnt lgkmcnt(6)
mvaas 40,16,96
s_mul_i32 s35, s35, 13824
v_lshlrev_b32 v28, 5, v28
s_add_u32 s35, s35, 6912
mvaas 40,20,100
s_waitcnt lgkmcnt(4)
mvaas 44,24,96
s_waitcnt lgkmcnt(2)
mvaas 44,28,100
buffer_load_dwordx4 v15, s[52:55], s82 offen offset:3072 lds
mvaas 160,32,96
rqa 120,16,38912
mvaas 160,36,100
buffer_load_dword v31, v28, s[48:51], s35 offen
mvaas 48,0,104
rqa 124,17,38912
mvaas 48,4,108
mvaas 52,8,104
mvaas 52,12,108
mvaas 56,16,104
s_mov_b32 s87, 548864
mvaas 56,20,108
mvaas 60,24,104
mvaas 60,28,108
mvaas 164,32,104
rqa 96,16,40960
mvaas 164,36,108
s_waitcnt lgkmcnt(2)
mvaas 64,0,112
rqa 100,17,40960
mvaas 64,4,116
buffer_store_dwordx4 v[112:115], v6, s[64:67], s87 offen offset:0 sc1
mvaas 68,8,112
mvaas 68,12,116
mvaas 72,16,112
s_mov_b32 s87, 548864
mvaas 72,20,116
mvaas 76,24,112
mvaas 76,28,116
mvaas 168,32,112
rqa 104,16,43008
mvaas 168,36,116
mvaas 80,0,120
rqa 108,17,43008
s_waitcnt lgkmcnt(2)
mvaas 80,4,124
buffer_store_dwordx4 v[116:119], v6, s[64:67], s87 offen offset:1024 sc1
mvaas 84,8,120
mvaas 84,12,124
mvaas 88,16,120
s_mov_b32 s87, 548864
mvaas 88,20,124
mvaas 92,24,120
mvaas 92,28,124
mvaas 172,32,120
rqa 112,16,45056
mvaas 172,36,124
maaas 192,0,96
rqa 116,17,45056
maaas 192,4,100
buffer_store_dwordx4 v[120:123], v6, s[64:67], s87 offen offset:2048 sc1
maaas 196,8,96
maaas 196,12,100
maaas 200,16,96
s_mov_b32 s87, 548864
maaas 200,20,100
maaas 204,24,96
s_nop 0
v_accvgpr_read_b32 v96, a192
maaas 204,28,100
v_accvgpr_read_b32 v97, a193
v_accvgpr_read_b32 v98, a194
mvaas 176,32,96
rqa 120,16,47104
v_accvgpr_read_b32 v99, a195
mvaas 176,36,100
s_waitcnt lgkmcnt(2)
v_accvgpr_read_b32 v100, a196
v_accvgpr_read_b32 v101, a197
maaas 208,0,104
rqa 124,17,47104
v_accvgpr_read_b32 v102, a198
maaas 208,4,108
buffer_store_dwordx4 v[124:127], v6, s[64:67], s87 offen offset:3072 sc1
v_accvgpr_read_b32 v103, a199
v_accvgpr_read_b32 v104, a200
v_accvgpr_read_b32 v105, a201
maaas 212,8,104
v_accvgpr_read_b32 v106, a202
v_accvgpr_read_b32 v107, a203
maaas 212,12,108
v_accvgpr_read_b32 v108, a204
v_accvgpr_read_b32 v109, a205
maaas 216,16,104
maaas 216,20,108
maaas 220,24,104
maaas 220,28,108
s_waitcnt vmcnt(5) lgkmcnt(0)
s_barrier
mvaas 180,32,104
rqa 96,18,12288
mvaas 180,36,108
v_accvgpr_read_b32 v110, a206
v_accvgpr_read_b32 v111, a207
v_accvgpr_read_b32 v112, a208
maaas 224,0,112
rqa 100,19,12288
maaas 224,4,116
maaas 228,8,112
rqa 104,18,14336
maaas 228,12,116
v_accvgpr_read_b32 v113, a209
v_accvgpr_read_b32 v114, a210
maaas 232,16,112
s_lshr_b32 s81, s30, 1
v_accvgpr_read_b32 v115, a211
v_accvgpr_read_b32 v116, a212
maaas 232,20,116
s_lshl_b32 s81, s81, 8
v_accvgpr_read_b32 v117, a213
v_accvgpr_read_b32 v118, a214
maaas 236,24,112
s_add_u32 s81, s81, 79691776
v_accvgpr_read_b32 v119, a215
v_accvgpr_read_b32 v120, a216
v_accvgpr_read_b32 v121, a217
maaas 236,28,116
v_accvgpr_read_b32 v122, a218
v_accvgpr_read_b32 v123, a219
mvaas 184,32,112
rqa 108,19,14336
v_accvgpr_read_b32 v124, a220
v_accvgpr_read_b32 v125, a221
mvaas 184,36,116
v_accvgpr_read_b32 v126, a222
v_accvgpr_read_b32 v127, a223
maaas 240,0,120
rta 0,20,16384
maaas 240,4,124
rta 2,20,17408
maaas 244,8,120
buffer_load_dword v27, v26, s[64:67], s81 offen sc1
maaas 244,12,124
rta 4,20,24576
rta 6,20,25600
maaas 248,16,120
rta 8,21,16384
rta 10,21,17408
maaas 248,20,124
rta 12,21,24576
rta 14,21,25600
maaas 252,24,120
rta 16,22,16384
rta 18,22,17408
maaas 252,28,124
rta 20,22,24576
rta 22,22,25600
mvaas 188,32,120
rta 24,23,16384
rta 26,23,17408
mvaas 188,36,124
s_waitcnt lgkmcnt(12)
rta 28,23,24576
rta 30,23,25600
maaas 224,0,96
rqa 112,18,0
s_waitcnt lgkmcnt(13)
maaas 224,4,100
s_waitcnt lgkmcnt(11)
maaas 228,8,96
rqa 116,19,0
s_waitcnt lgkmcnt(10)
maaas 228,12,100
s_waitcnt lgkmcnt(8)
maaas 232,16,96
s_waitcnt lgkmcnt(6)
maaas 232,20,100
s_add_u32 m0, s8, 0
s_waitcnt lgkmcnt(4)
maaas 236,24,96
v_accvgpr_read_b32 v8, a224
s_waitcnt lgkmcnt(2)
maaas 236,28,100
v_accvgpr_read_b32 v9, a225
v_accvgpr_read_b32 v10, a226
mvaas 184,40,96
rqa 120,18,2048
v_accvgpr_read_b32 v11, a227
mvaas 184,44,100
v_accvgpr_read_b32 v12, a228
v_accvgpr_read_b32 v13, a229
maaas 240,0,104
v_accvgpr_read_b32 v14, a230
v_accvgpr_read_b32 v15, a231
maaas 240,4,108
rqa 124,19,2048
v_cvt_pk_bf16_f32 v8, v8, v9
maaas 244,8,104
v_cvt_pk_bf16_f32 v9, v10, v11
v_cvt_pk_bf16_f32 v10, v12, v13
maaas 244,12,108
v_cvt_pk_bf16_f32 v11, v14, v15
v_accvgpr_read_b32 v12, a236
maaas 248,16,104
s_waitcnt vmcnt(0)
v_cmp_gt_u32 vcc, 1, v27
v_accvgpr_read_b32 v13, a237
maaas 248,20,108
ds_write_b128 v24, v[8:11] offset:0
maaas 252,24,104
v_accvgpr_read_b32 v8, a232
v_accvgpr_read_b32 v9, a233
maaas 252,28,108
s_cbranch_vccnz PFS_spin
PFS_ok:
s_mov_b32 s81, 0
v_accvgpr_read_b32 v10, a234
v_accvgpr_read_b32 v11, a235
mvaas 188,40,104
buffer_load_dwordx4 v1, s[68:71], s81 offen offset:0 sc1 lds
v_accvgpr_read_b32 v14, a238
v_accvgpr_read_b32 v15, a239
v_cvt_pk_bf16_f32 v8, v8, v9
v_cvt_pk_bf16_f32 v9, v10, v11
mvaas 188,44,108
s_waitcnt lgkmcnt(2)
v_cvt_pk_bf16_f32 v10, v12, v13
v_cvt_pk_bf16_f32 v11, v14, v15
mvaas 32,0,112
buffer_load_dwordx4 v1, s[68:71], s81 offen offset:1024 sc1 lds
mvaas 32,4,116
ds_write_b128 v24, v[8:11] offset:1024
mvaas 36,8,112
rqa 96,18,4096
v_accvgpr_read_b32 v8, a240
mvaas 36,12,116
v_accvgpr_read_b32 v9, a241
v_accvgpr_read_b32 v10, a242
v_accvgpr_read_b32 v11, a243
mvaas 40,16,112
buffer_load_dwordx4 v1, s[68:71], s81 offen offset:2048 sc1 lds
v_accvgpr_read_b32 v12, a244
v_accvgpr_read_b32 v13, a245
v_accvgpr_read_b32 v14, a246
v_accvgpr_read_b32 v15, a247
mvaas 40,20,116
rqa 100,19,4096
v_cvt_pk_bf16_f32 v8, v8, v9
v_cvt_pk_bf16_f32 v9, v10, v11
v_cvt_pk_bf16_f32 v10, v12, v13
v_cvt_pk_bf16_f32 v11, v14, v15
mvaas 44,24,112
buffer_load_dwordx4 v1, s[68:71], s81 offen offset:3072 sc1 lds
ds_write_b128 v24, v[8:11] offset:8192
v_accvgpr_read_b32 v8, a248
v_accvgpr_read_b32 v9, a249
mvaas 44,28,116
s_add_u32 m0, s8, 16384
s_mov_b32 s81, 32768
v_accvgpr_read_b32 v10, a250
v_accvgpr_read_b32 v11, a251
v_accvgpr_read_b32 v12, a252
v_accvgpr_read_b32 v13, a253
mvaas 160,40,112
buffer_load_dwordx4 v1, s[68:71], s81 offen offset:0 sc1 lds
v_accvgpr_read_b32 v14, a254
v_accvgpr_read_b32 v15, a255
v_cvt_pk_bf16_f32 v8, v8, v9
v_cvt_pk_bf16_f32 v9, v10, v11
mvaas 160,44,116
s_waitcnt lgkmcnt(2)
v_cvt_pk_bf16_f32 v10, v12, v13
v_cvt_pk_bf16_f32 v11, v14, v15
mvaas 48,0,120
buffer_load_dwordx4 v1, s[68:71], s81 offen offset:1024 sc1 lds
mvaas 48,4,124
ds_write_b128 v24, v[8:11] offset:9216
mvaas 52,8,120
rqa 104,18,6144
v_cvt_pk_bf16_f32 v32, v32, v33
mvaas 52,12,124
v_cvt_pk_bf16_f32 v33, v34, v35
v_cvt_pk_bf16_f32 v34, v36, v37
mvaas 56,16,120
buffer_load_dwordx4 v1, s[68:71], s81 offen offset:2048 sc1 lds
mvaas 56,20,124
rqa 108,19,6144
v_cvt_pk_bf16_f32 v35, v38, v39
mvaas 60,24,120
buffer_load_dwordx4 v1, s[68:71], s81 offen offset:3072 sc1 lds
v_cvt_pk_bf16_f32 v40, v40, v41
mvaas 60,28,124
s_add_u32 m0, s8, 32768
s_mov_b32 s81, 65536
v_cvt_pk_bf16_f32 v41, v42, v43
v_cvt_pk_bf16_f32 v42, v44, v45
mvaas 164,40,120
buffer_load_dwordx4 v1, s[68:71], s81 offen offset:0 sc1 lds
v_cvt_pk_bf16_f32 v43, v46, v47
mvaas 164,44,124
s_waitcnt lgkmcnt(3)
ds_write_b128 v24, v[32:35] offset:49152
mvaas 64,0,96
buffer_load_dwordx4 v1, s[68:71], s81 offen offset:1024 sc1 lds
mvaas 64,4,100
ds_write_b128 v24, v[40:43] offset:50176
mvaas 68,8,96
rqa 112,18,8192
v_cvt_pk_bf16_f32 v48, v48, v49
mvaas 68,12,100
v_cvt_pk_bf16_f32 v49, v50, v51
v_cvt_pk_bf16_f32 v50, v52, v53
mvaas 72,16,96
buffer_load_dwordx4 v1, s[68:71], s81 offen offset:2048 sc1 lds
mvaas 72,20,100
rqa 116,19,8192
v_cvt_pk_bf16_f32 v51, v54, v55
mvaas 76,24,96
buffer_load_dwordx4 v1, s[68:71], s81 offen offset:3072 sc1 lds
v_cvt_pk_bf16_f32 v56, v56, v57
mvaas 76,28,100
s_add_u32 m0, s8, 49152
s_mov_b32 s81, 0
v_cvt_pk_bf16_f32 v57, v58, v59
v_cvt_pk_bf16_f32 v58, v60, v61
mvaas 168,40,96
buffer_load_dwordx4 v2, s[72:75], s81 offen offset:0 sc1 lds
v_cvt_pk_bf16_f32 v59, v62, v63
mvaas 168,44,100
s_waitcnt lgkmcnt(3)
ds_write_b128 v24, v[48:51] offset:57344
mvaas 80,0,104
buffer_load_dwordx4 v2, s[72:75], s81 offen offset:1024 sc1 lds
mvaas 80,4,108
ds_write_b128 v24, v[56:59] offset:58368
mvaas 84,8,104
rqa 120,18,10240
v_cvt_pk_bf16_f32 v64, v64, v65
mvaas 84,12,108
v_cvt_pk_bf16_f32 v65, v66, v67
v_cvt_pk_bf16_f32 v66, v68, v69
mvaas 88,16,104
buffer_load_dwordx4 v2, s[72:75], s81 offen offset:2048 sc1 lds
mvaas 88,20,108
rqa 124,19,10240
v_cvt_pk_bf16_f32 v67, v70, v71
mvaas 92,24,104
buffer_load_dwordx4 v2, s[72:75], s81 offen offset:3072 sc1 lds
ds_write_b128 v24, v[64:67] offset:32768
v_cvt_pk_bf16_f32 v72, v72, v73
v_cvt_pk_bf16_f32 v73, v74, v75
v_cvt_pk_bf16_f32 v74, v76, v77
v_cvt_pk_bf16_f32 v75, v78, v79
s_waitcnt lgkmcnt(0)
mvaas 92,28,108
s_barrier
mvaas 172,40,104
s_cmp_eq_u32 s80, 0
ds_write_b128 v24, v[72:75] offset:33792
mvaas 172,44,108
s_cselect_b32 s87, s100, 268435456
v_mov_b32 v27, 2
v_and_b32 v28, 12, v26
v_cvt_pk_bf16_f32 v80, v80, v81
mvaas 96,0,112
buffer_store_dword v27, v28, s[64:67], s87 offen sc1
mvaas 96,4,116
mvaas 100,8,112
mvaas 100,12,116
v_cvt_pk_bf16_f32 v81, v82, v83
v_cvt_pk_bf16_f32 v82, v84, v85
mvaas 104,16,112
v_cvt_pk_bf16_f32 v83, v86, v87
v_cvt_pk_bf16_f32 v88, v88, v89
mvaas 104,20,116
v_cvt_pk_bf16_f32 v89, v90, v91
v_cvt_pk_bf16_f32 v90, v92, v93
mvaas 108,24,112
v_cvt_pk_bf16_f32 v91, v94, v95
v_cvt_pk_bf16_f32 v96, v96, v97
mvaas 108,28,116
ds_write_b128 v24, v[80:83] offset:40960
mvaas 176,40,112
v_cvt_pk_bf16_f32 v97, v98, v99
v_cvt_pk_bf16_f32 v98, v100, v101
mvaas 176,44,116
ds_write_b128 v24, v[88:91] offset:41984
mvaas 112,0,120
v_cvt_pk_bf16_f32 v99, v102, v103
v_cvt_pk_bf16_f32 v104, v104, v105
mvaas 112,4,124
v_cvt_pk_bf16_f32 v105, v106, v107
v_cvt_pk_bf16_f32 v106, v108, v109
mvaas 116,8,120
ds_write_b128 v24, v[96:99] offset:16384
mvaas 116,12,124
v_cvt_pk_bf16_f32 v107, v110, v111
mvaas 120,16,120
ds_write_b128 v24, v[104:107] offset:17408
mvaas 120,20,124
v_cvt_pk_bf16_f32 v112, v112, v113
v_cvt_pk_bf16_f32 v113, v114, v115
mvaas 124,24,120
s_nop 0
v_cvt_pk_bf16_f32 v114, v116, v117
mvaas 124,28,124
v_cvt_pk_bf16_f32 v115, v118, v119
mvaas 180,40,120
ds_write_b128 v24, v[112:115] offset:24576
v_cvt_pk_bf16_f32 v120, v120, v121
v_cvt_pk_bf16_f32 v121, v122, v123
s_nop 2
v_cvt_pk_bf16_f32 v122, v124, v125
v_cvt_pk_bf16_f32 v123, v126, v127
ds_write_b128 v24, v[120:123] offset:25600
mvaas 180,44,124
s_nop 4
v_mbcnt_lo_u32_b32 v7, -1, 0
v_mbcnt_hi_u32_b32 v7, -1, v7
v_and_b32 v7, 15, v7
v_lshlrev_b32 v7, 2, v7
s_sub_u32 s4, 15, s31
s_cmp_ge_u32 s80, 2
s_cselect_b32 s4, s31, s4
s_lshl_b32 s4, s4, 9
s_add_u32 s4, s4, 75497472
v_mul_f32 v160, s88, v160
v_max_f32 v160, 0xc2300000, v160
v_exp_f32 v160, -v160
buffer_store_dword v160, v7, s[64:67], s4 offen offset:0 sc1
v_mul_f32 v164, s88, v164
v_max_f32 v164, 0xc2300000, v164
v_exp_f32 v164, -v164
buffer_store_dword v164, v7, s[64:67], s4 offen offset:64 sc1
v_mul_f32 v168, s88, v168
v_max_f32 v168, 0xc2300000, v168
v_exp_f32 v168, -v168
buffer_store_dword v168, v7, s[64:67], s4 offen offset:128 sc1
v_mul_f32 v172, s88, v172
v_max_f32 v172, 0xc2300000, v172
v_exp_f32 v172, -v172
buffer_store_dword v172, v7, s[64:67], s4 offen offset:192 sc1
v_mul_f32 v176, s88, v176
v_max_f32 v176, 0xc2300000, v176
v_exp_f32 v176, -v176
buffer_store_dword v176, v7, s[64:67], s4 offen offset:256 sc1
v_mul_f32 v180, s88, v180
v_max_f32 v180, 0xc2300000, v180
v_exp_f32 v180, -v180
buffer_store_dword v180, v7, s[64:67], s4 offen offset:320 sc1
v_mul_f32 v184, s88, v184
v_max_f32 v184, 0xc2300000, v184
v_exp_f32 v184, -v184
buffer_store_dword v184, v7, s[64:67], s4 offen offset:384 sc1
v_mul_f32 v188, s88, v188
v_max_f32 v188, 0xc2300000, v188
v_exp_f32 v188, -v188
buffer_store_dword v188, v7, s[64:67], s4 offen offset:448 sc1
s_waitcnt vmcnt(17) lgkmcnt(0)
s_barrier
rqa 128,0,0
rqa 132,0,1024
rqa 136,0,4096
rqa 140,0,5120
rqa 0,25,49152
rqa 4,25,50176
rqa 8,25,51200
rqa 12,25,52224
rqa 144,0,2048
rqa 148,0,3072
rqa 152,0,6144
rqa 156,0,7168
s_waitcnt lgkmcnt(7)
mvaaz 96,128,0
s_add_u32 m0, s8, 65536
rqa 16,25,32768
s_mov_b32 s81, 98304
s_waitcnt lgkmcnt(7)
mvaas 96,132,4
s_waitcnt lgkmcnt(6)
rqa 20,25,33792
rqa 24,25,34816
rqa 28,25,35840
rqa 32,25,16384
rqa 36,25,17408
rqa 40,25,18432
rqa 44,25,19456
rqa 48,25,0
rqa 52,25,1024
rqa 56,25,2048
rqa 60,25,3072
buffer_load_dwordx4 v1, s[68:71], s81 offen offset:0 sc1 lds
buffer_load_dwordx4 v1, s[68:71], s81 offen offset:1024 sc1 lds
buffer_load_dwordx4 v1, s[68:71], s81 offen offset:2048 sc1 lds
buffer_load_dwordx4 v1, s[68:71], s81 offen offset:3072 sc1 lds
s_add_u32 m0, s8, 81920
s_mov_b32 s81, 32768
mvaas 96,136,8
buffer_load_dwordx4 v2, s[72:75], s81 offen offset:0 sc1 lds
buffer_load_dwordx4 v2, s[72:75], s81 offen offset:1024 sc1 lds
buffer_load_dwordx4 v2, s[72:75], s81 offen offset:2048 sc1 lds
buffer_load_dwordx4 v2, s[72:75], s81 offen offset:3072 sc1 lds
rqa 64,25,53248
s_waitcnt lgkmcnt(11)
mvaas 96,140,12
s_xor_b32 s8, s8, 0x10000
rqa 68,25,54272
rqa 72,25,55296
mvaaz 100,144,0
rqa 76,25,56320
mvaas 100,148,4
v_lshrrev_b32 v8, 4, v0
v_xor_b32 v8, v8, v0
mvaas 100,152,8
v_and_b32 v8, 32, v8
v_mov_b32 v9, 0x3f803f80
mvaas 100,156,12
v_cmp_eq_u32 vcc, 0, v8
v_and_b32 v8, 16, v0
s_nop 0
v_cndmask_b32 v9, 0, v9, vcc
v_mov_b32 v15, 0x44444444
v_accvgpr_write_b32 a192, v9
v_accvgpr_write_b32 a193, v9
v_accvgpr_write_b32 a194, v9
v_accvgpr_write_b32 a195, v9
v_cmp_eq_u32 vcc, 0, v8
v_mov_b32 v10, 0xeeeeeeee
v_bfe_u32 v8, v0, 8, 2
v_cndmask_b32 v15, v10, v15, vcc
v_bfe_u32 v9, v0, 4, 4
v_lshlrev_b32 v8, 2, v8
v_sub_u32 v8, v9, v8
v_mov_b32 v9, 0x00800000
v_mov_b32 v10, 0x7f000000
v_cmp_gt_i32 vcc, 0, v8
v_mov_b32 v32, 0
v_mov_b32 v33, 0
v_cndmask_b32 v44, v9, v10, vcc
v_cmp_gt_i32 vcc, 1, v8
v_mov_b32 v34, 0
v_mov_b32 v35, 0
v_cndmask_b32 v45, v9, v10, vcc
v_cmp_gt_i32 vcc, 2, v8
v_mov_b32 v36, 0
v_mov_b32 v37, 0
v_cndmask_b32 v46, v9, v10, vcc
v_cmp_gt_i32 vcc, 3, v8
v_mov_b32 v38, 0
v_mov_b32 v39, 0
v_cndmask_b32 v47, v9, v10, vcc
rqa 80,25,36864
mvaaz 104,128,16
rqa 84,25,37888
rqa 88,25,38912
mvaas 104,132,20
rqa 92,25,39936
s_waitcnt lgkmcnt(4)
mvaas 104,136,24
rqa 96,25,20480
mvaas 104,140,28
rqa 100,25,21504
mvaaz 108,144,16
rqa 104,25,22528
mvaas 108,148,20
rqa 108,25,23552
mvaas 108,152,24
rqa 112,25,4096
mvaas 108,156,28
rqa 116,25,5120
mvaaz 112,128,32
rqa 120,25,6144
mvaas 112,132,36
rqa 124,25,7168
mvaas 112,136,40
mvaas 112,140,44
mvaaz 116,144,32
mvaas 116,148,36
mvaas 116,152,40
mvaas 116,156,44
mvaaz 120,128,48
mvaas 120,132,52
mvaas 120,136,56
mvaas 120,140,60
mvaaz 124,144,48
mvaas 124,148,52
s_waitcnt lgkmcnt(0)
mvaas 124,152,56
mvaas 124,156,60
s_barrier
rqa 128,0,16384
rqa 132,0,17408
rqa 136,0,20480
rqa 140,0,21504
rqa 144,0,18432
rqa 148,0,19456
rqa 152,0,22528
rqa 156,0,23552
s_add_u32 m0, s8, 49152
s_nop 0
buffer_load_dwordx4 v2, s[72:75], s9 offen offset:0 sc1 lds
buffer_load_dwordx4 v2, s[72:75], s9 offen offset:1024 sc1 lds
buffer_load_dwordx4 v2, s[72:75], s9 offen offset:2048 sc1 lds
buffer_load_dwordx4 v2, s[72:75], s9 offen offset:3072 sc1 lds
s_mov_b32 s9, 131072
s_add_u32 m0, s8, 32768
s_nop 0
buffer_load_dwordx4 v1, s[68:71], s9 offen offset:0 sc1 lds
buffer_load_dwordx4 v1, s[68:71], s9 offen offset:1024 sc1 lds
buffer_load_dwordx4 v1, s[68:71], s9 offen offset:2048 sc1 lds
buffer_load_dwordx4 v1, s[68:71], s9 offen offset:3072 sc1 lds
s_xor_b32 s8, s8, 0x10000
v_exp_f32 v96, v96
v_exp_f32 v97, v97
v_exp_f32 v98, v98
v_exp_f32 v99, v99
v_cvt_pk_bf16_f32 v64, v96, v97
v_cvt_pk_bf16_f32 v65, v98, v99
v_exp_f32 v100, v100
v_exp_f32 v101, v101
v_exp_f32 v102, v102
v_exp_f32 v103, v103
v_cvt_pk_bf16_f32 v66, v100, v101
v_cvt_pk_bf16_f32 v67, v102, v103
v_exp_f32 v104, v104
v_exp_f32 v105, v105
v_exp_f32 v106, v106
v_exp_f32 v107, v107
v_cvt_pk_bf16_f32 v68, v104, v105
v_cvt_pk_bf16_f32 v69, v106, v107
v_exp_f32 v108, v108
v_exp_f32 v109, v109
v_exp_f32 v110, v110
v_exp_f32 v111, v111
v_cvt_pk_bf16_f32 v70, v108, v109
v_cvt_pk_bf16_f32 v71, v110, v111
v_exp_f32 v112, v112
v_exp_f32 v113, v113
v_exp_f32 v114, v114
v_exp_f32 v115, v115
v_cvt_pk_bf16_f32 v72, v112, v113
v_cvt_pk_bf16_f32 v73, v114, v115
v_exp_f32 v116, v116
v_exp_f32 v117, v117
v_exp_f32 v118, v118
v_exp_f32 v119, v119
v_cvt_pk_bf16_f32 v74, v116, v117
v_cvt_pk_bf16_f32 v75, v118, v119
v_exp_f32 v120, v120
v_exp_f32 v121, v121
v_exp_f32 v122, v122
v_exp_f32 v123, v123
v_cvt_pk_bf16_f32 v76, v120, v121
v_cvt_pk_bf16_f32 v77, v122, v123
v_exp_f32 v124, v124
v_exp_f32 v125, v125
v_exp_f32 v126, v126
v_exp_f32 v127, v127
v_cvt_pk_bf16_f32 v78, v124, v125
v_cvt_pk_bf16_f32 v79, v126, v127
v_and_b32 v7, 0x3ff, v0
s_lshl_b32 s6, s30, 14
s_lshl_b32 s7, s33, 13
s_add_u32 s6, s6, s7
s_lshl_b32 s7, s32, 10
s_add_u32 s83, s6, s7
s_sub_u32 s3, 15, s31
s_lshl_b32 s84, s33, 11
s_mul_i32 s7, s32, 745472
s_add_u32 s84, s84, s7
s_mov_b32 s82, 0
s_mul_i32 s5, s3, 1490944
s_add_u32 s5, s5, 50331648
v_add_u32 v5, s5, v7
s_mul_i32 s5, s31, 1490944
s_add_u32 s5, s5, 50331648
v_add_u32 v6, s5, v7
s_lshl_b32 s5, s80, 13
s_add_u32 s5, s5, 131072
v_add_u32 v7, s5, v7
v_xor_b32 v30, 0x2000, v7
s_lshl_b32 s5, s31, 9
s_lshl_b32 s6, s30, 4
s_add_u32 s5, s5, s6
s_lshl2_add_u32 s5, s80, s5
s_add_u32 s100, s5, 79695872
s_cmp_eq_u32 s80, 0
s_cselect_b32 s19, s100, 268435456
v_accvgpr_write_b32 a204, -1
v_accvgpr_write_b32 a205, -1
v_accvgpr_write_b32 a206, -1
v_accvgpr_write_b32 a207, -1
s_waitcnt vmcnt(16) lgkmcnt(0)
s_barrier
s_branch K_att
FBa_spin:
FBb_spin:
s_waitcnt lgkmcnt(0)
s_nop 7
s_nop 7
s_mov_b32 s70, 0x80000
s_mov_b32 s74, 0x80000
v_and_b32 v252, 0x3ff, v0
v_add_u32 v253, 4096, v252
s_lshl_b32 s3, s33, 12
v_add_u32 v254, s3, v252
s_sub_u32 s4, 15, s31
v_bfe_u32 v255, v0, 8, 2
v_lshlrev_b32 v255, 2, v255
v_bfe_u32 v32, v0, 4, 4
v_sub_u32 v255, v255, v32
s_lshl3_add_u32 s3, s4, s32
s_lshl_b32 s3, s3, 4
v_subrev_u32 v255, s3, v255
s_add_u32 s4, s4, 1
s_lshl_b32 s4, s4, 15
s_mov_b32 s3, 0
v_mov_b32 v32, 0xff800000
v_mov_b32 v128, 0
v_mov_b32 v129, 0
v_mov_b32 v130, 0
v_mov_b32 v131, 0
v_mov_b32 v132, 0
v_mov_b32 v133, 0
v_mov_b32 v134, 0
v_mov_b32 v135, 0
v_mov_b32 v136, 0
v_mov_b32 v137, 0
v_mov_b32 v138, 0
v_mov_b32 v139, 0
v_mov_b32 v140, 0
v_mov_b32 v141, 0
v_mov_b32 v142, 0
v_mov_b32 v143, 0
v_mov_b32 v144, 0
v_mov_b32 v145, 0
v_mov_b32 v146, 0
v_mov_b32 v147, 0
v_mov_b32 v148, 0
v_mov_b32 v149, 0
v_mov_b32 v150, 0
v_mov_b32 v151, 0
v_mov_b32 v152, 0
v_mov_b32 v153, 0
v_mov_b32 v154, 0
v_mov_b32 v155, 0
v_mov_b32 v156, 0
v_mov_b32 v157, 0
v_mov_b32 v158, 0
v_mov_b32 v159, 0
v_mov_b32 v160, 0
v_mov_b32 v161, 0
v_mov_b32 v162, 0
v_mov_b32 v163, 0
v_mov_b32 v164, 0
v_mov_b32 v165, 0
v_mov_b32 v166, 0
v_mov_b32 v167, 0
v_mov_b32 v168, 0
v_mov_b32 v169, 0
v_mov_b32 v170, 0
v_mov_b32 v171, 0
v_mov_b32 v172, 0
v_mov_b32 v173, 0
v_mov_b32 v174, 0
v_mov_b32 v175, 0
v_mov_b32 v176, 0
v_mov_b32 v177, 0
v_mov_b32 v178, 0
v_mov_b32 v179, 0
v_mov_b32 v180, 0
v_mov_b32 v181, 0
v_mov_b32 v182, 0
v_mov_b32 v183, 0
v_mov_b32 v184, 0
v_mov_b32 v185, 0
v_mov_b32 v186, 0
v_mov_b32 v187, 0
v_mov_b32 v188, 0
v_mov_b32 v189, 0
v_mov_b32 v190, 0
v_mov_b32 v191, 0
v_mov_b32 v240, 0
v_mov_b32 v241, 0
v_mov_b32 v242, 0
v_mov_b32 v243, 0
v_mov_b32 v244, 0
v_mov_b32 v245, 0
v_mov_b32 v246, 0
v_mov_b32 v247, 0
v_mov_b32 v248, 0x7149f2ca
v_mov_b32 v249, 0x7149f2ca
v_mov_b32 v250, 0x7149f2ca
v_mov_b32 v251, 0x7149f2ca
FB0_lp:
buffer_load_dwordx4 a[160:163], v252, s[68:71], s3 offen offset:0 sc1
buffer_load_dwordx4 a[164:167], v252, s[68:71], s3 offen offset:1024 sc1
buffer_load_dwordx4 a[168:171], v253, s[68:71], s3 offen offset:0 sc1
buffer_load_dwordx4 a[172:175], v253, s[68:71], s3 offen offset:1024 sc1
buffer_load_dwordx4 a[176:179], v252, s[68:71], s3 offen offset:2048 sc1
buffer_load_dwordx4 a[180:183], v252, s[68:71], s3 offen offset:3072 sc1
buffer_load_dwordx4 a[184:187], v253, s[68:71], s3 offen offset:2048 sc1
buffer_load_dwordx4 a[188:191], v253, s[68:71], s3 offen offset:3072 sc1
s_waitcnt vmcnt(7)
mvaaz 192,160,0
s_waitcnt vmcnt(0)
mvaas 192,164,4
mvaas 192,168,8
mvaas 192,172,12
mvaaz 196,176,0
mvaas 196,180,4
mvaas 196,184,8
mvaas 196,188,12
mvaaz 200,160,16
mvaas 200,164,20
mvaas 200,168,24
mvaas 200,172,28
mvaaz 204,176,16
mvaas 204,180,20
mvaas 204,184,24
mvaas 204,188,28
mvaaz 208,160,32
mvaas 208,164,36
mvaas 208,168,40
mvaas 208,172,44
mvaaz 212,176,32
mvaas 212,180,36
mvaas 212,184,40
mvaas 212,188,44
mvaaz 216,160,48
mvaas 216,164,52
mvaas 216,168,56
mvaas 216,172,60
mvaaz 220,176,48
mvaas 220,180,52
mvaas 220,184,56
mvaas 220,188,60
s_nop 7
s_nop 7
buffer_load_dwordx4 a[160:163], v254, s[72:75], s3 offen offset:0 sc1
buffer_load_dwordx4 a[164:167], v254, s[72:75], s3 offen offset:1024 sc1
buffer_load_dwordx4 a[168:171], v254, s[72:75], s3 offen offset:2048 sc1
buffer_load_dwordx4 a[172:175], v254, s[72:75], s3 offen offset:3072 sc1
v_cmp_lt_i32 vcc, 0, v255
s_nop 1
v_cndmask_b32 v192, v192, v32, vcc
v_cmp_lt_i32 vcc, -1, v255
s_nop 1
v_cndmask_b32 v193, v193, v32, vcc
v_cmp_lt_i32 vcc, -2, v255
s_nop 1
v_cndmask_b32 v194, v194, v32, vcc
v_cmp_lt_i32 vcc, -3, v255
s_nop 1
v_cndmask_b32 v195, v195, v32, vcc
v_cmp_lt_i32 vcc, -16, v255
s_nop 1
v_cndmask_b32 v196, v196, v32, vcc
v_cmp_lt_i32 vcc, -17, v255
s_nop 1
v_cndmask_b32 v197, v197, v32, vcc
v_cmp_lt_i32 vcc, -18, v255
s_nop 1
v_cndmask_b32 v198, v198, v32, vcc
v_cmp_lt_i32 vcc, -19, v255
s_nop 1
v_cndmask_b32 v199, v199, v32, vcc
v_max3_f32 v33, v192, v193, v194
v_max3_f32 v34, v195, v196, v197
v_max3_f32 v33, v33, v198, v199
v_max_f32 v33, v33, v34
v_mov_b32 v34, v33
s_nop 1
v_permlane32_swap_b32 v33, v34
v_max_f32 v33, v33, v34
v_mov_b32 v34, v33
s_nop 1
v_permlane16_swap_b32 v33, v34
v_max_f32 v33, v33, v34
v_min_f32 v33, -v33, v248
v_sub_f32 v34, v33, v248
v_exp_f32 v34, v34
v_mov_b32 v248, v33
v_mul_f32 v240, v240, v34
v_mul_f32 v241, v241, v34
v_mul_f32 v128, v128, v34
v_mul_f32 v129, v129, v34
v_mul_f32 v130, v130, v34
v_mul_f32 v131, v131, v34
v_mul_f32 v144, v144, v34
v_mul_f32 v145, v145, v34
v_mul_f32 v146, v146, v34
v_mul_f32 v147, v147, v34
v_mul_f32 v160, v160, v34
v_mul_f32 v161, v161, v34
v_mul_f32 v162, v162, v34
v_mul_f32 v163, v163, v34
v_mul_f32 v176, v176, v34
v_mul_f32 v177, v177, v34
v_mul_f32 v178, v178, v34
v_mul_f32 v179, v179, v34
v_add_f32 v192, v192, v33
v_add_f32 v193, v193, v33
v_add_f32 v194, v194, v33
v_add_f32 v195, v195, v33
v_add_f32 v196, v196, v33
v_add_f32 v197, v197, v33
v_add_f32 v198, v198, v33
v_add_f32 v199, v199, v33
v_exp_f32 v192, v192
v_exp_f32 v193, v193
v_exp_f32 v194, v194
v_exp_f32 v195, v195
v_exp_f32 v196, v196
v_exp_f32 v197, v197
v_exp_f32 v198, v198
v_exp_f32 v199, v199
v_cvt_pk_bf16_f32 v224, v192, v193
v_cvt_pk_bf16_f32 v225, v194, v195
v_cvt_pk_bf16_f32 v226, v196, v197
v_cvt_pk_bf16_f32 v227, v198, v199
v_cmp_lt_i32 vcc, 32, v255
s_nop 1
v_cndmask_b32 v200, v200, v32, vcc
v_cmp_lt_i32 vcc, 31, v255
s_nop 1
v_cndmask_b32 v201, v201, v32, vcc
v_cmp_lt_i32 vcc, 30, v255
s_nop 1
v_cndmask_b32 v202, v202, v32, vcc
v_cmp_lt_i32 vcc, 29, v255
s_nop 1
v_cndmask_b32 v203, v203, v32, vcc
v_cmp_lt_i32 vcc, 16, v255
s_nop 1
v_cndmask_b32 v204, v204, v32, vcc
v_cmp_lt_i32 vcc, 15, v255
s_nop 1
v_cndmask_b32 v205, v205, v32, vcc
v_cmp_lt_i32 vcc, 14, v255
s_nop 1
v_cndmask_b32 v206, v206, v32, vcc
v_cmp_lt_i32 vcc, 13, v255
s_nop 1
v_cndmask_b32 v207, v207, v32, vcc
v_max3_f32 v33, v200, v201, v202
v_max3_f32 v34, v203, v204, v205
v_max3_f32 v33, v33, v206, v207
v_max_f32 v33, v33, v34
v_mov_b32 v34, v33
s_nop 1
v_permlane32_swap_b32 v33, v34
v_max_f32 v33, v33, v34
v_mov_b32 v34, v33
s_nop 1
v_permlane16_swap_b32 v33, v34
v_max_f32 v33, v33, v34
v_min_f32 v33, -v33, v249
v_sub_f32 v34, v33, v249
v_exp_f32 v34, v34
s_nop 0
v_mul_f32 v242, v242, v34
v_mul_f32 v243, v243, v34
v_add_f32 v200, v200, v33
v_add_f32 v201, v201, v33
v_add_f32 v202, v202, v33
v_add_f32 v203, v203, v33
v_add_f32 v204, v204, v33
v_add_f32 v205, v205, v33
v_add_f32 v206, v206, v33
v_add_f32 v207, v207, v33
v_exp_f32 v200, v200
v_exp_f32 v201, v201
v_exp_f32 v202, v202
v_exp_f32 v203, v203
v_exp_f32 v204, v204
v_exp_f32 v205, v205
v_exp_f32 v206, v206
v_exp_f32 v207, v207
v_cvt_pk_bf16_f32 v228, v200, v201
v_cvt_pk_bf16_f32 v229, v202, v203
v_cvt_pk_bf16_f32 v230, v204, v205
v_cvt_pk_bf16_f32 v231, v206, v207
s_nop 1
v_smfmac_f32_16x16x64_bf16 v[240:243], a[192:195], v[224:231], v15
s_waitcnt vmcnt(0)
v_mul_f32 v132, v132, v34
mvavs 128,160,224
v_mul_f32 v133, v133, v34
v_mul_f32 v134, v134, v34
mvavs 144,164,224
v_mul_f32 v135, v135, v34
v_mul_f32 v148, v148, v34
mvavs 160,168,224
v_mul_f32 v149, v149, v34
v_mul_f32 v150, v150, v34
v_mul_f32 v151, v151, v34
mvavs 176,172,224
v_mul_f32 v164, v164, v34
v_mul_f32 v165, v165, v34
v_mul_f32 v166, v166, v34
v_mul_f32 v167, v167, v34
mvavs 132,160,228
v_mul_f32 v180, v180, v34
v_mul_f32 v181, v181, v34
v_mul_f32 v182, v182, v34
v_mul_f32 v183, v183, v34
mvavs 148,164,228
v_mov_b32 v249, v33
v_cmp_lt_i32 vcc, 64, v255
s_nop 1
v_cndmask_b32 v208, v208, v32, vcc
v_cmp_lt_i32 vcc, 63, v255
s_nop 1
v_cndmask_b32 v209, v209, v32, vcc
v_cmp_lt_i32 vcc, 62, v255
s_nop 1
v_cndmask_b32 v210, v210, v32, vcc
v_cmp_lt_i32 vcc, 61, v255
s_nop 1
v_cndmask_b32 v211, v211, v32, vcc
v_cmp_lt_i32 vcc, 48, v255
s_nop 1
v_cndmask_b32 v212, v212, v32, vcc
v_cmp_lt_i32 vcc, 47, v255
s_nop 1
v_cndmask_b32 v213, v213, v32, vcc
v_cmp_lt_i32 vcc, 46, v255
s_nop 1
v_cndmask_b32 v214, v214, v32, vcc
v_cmp_lt_i32 vcc, 45, v255
s_nop 1
v_cndmask_b32 v215, v215, v32, vcc
v_max3_f32 v33, v208, v209, v210
v_max3_f32 v34, v211, v212, v213
v_max3_f32 v33, v33, v214, v215
v_max_f32 v33, v33, v34
v_mov_b32 v34, v33
s_nop 1
v_permlane32_swap_b32 v33, v34
v_max_f32 v33, v33, v34
v_mov_b32 v34, v33
s_nop 1
v_permlane16_swap_b32 v33, v34
v_max_f32 v33, v33, v34
v_min_f32 v33, -v33, v250
v_sub_f32 v34, v33, v250
v_exp_f32 v34, v34
v_mov_b32 v250, v33
v_mul_f32 v244, v244, v34
v_mul_f32 v245, v245, v34
v_mul_f32 v136, v136, v34
v_mul_f32 v137, v137, v34
v_mul_f32 v138, v138, v34
v_mul_f32 v139, v139, v34
v_mul_f32 v152, v152, v34
v_mul_f32 v153, v153, v34
v_mul_f32 v154, v154, v34
v_mul_f32 v155, v155, v34
v_mul_f32 v168, v168, v34
v_mul_f32 v169, v169, v34
v_mul_f32 v170, v170, v34
v_mul_f32 v171, v171, v34
v_mul_f32 v184, v184, v34
v_mul_f32 v185, v185, v34
v_mul_f32 v186, v186, v34
v_mul_f32 v187, v187, v34
v_add_f32 v208, v208, v33
v_add_f32 v209, v209, v33
v_add_f32 v210, v210, v33
v_add_f32 v211, v211, v33
v_add_f32 v212, v212, v33
v_add_f32 v213, v213, v33
v_add_f32 v214, v214, v33
v_add_f32 v215, v215, v33
v_exp_f32 v208, v208
v_exp_f32 v209, v209
v_exp_f32 v210, v210
v_exp_f32 v211, v211
v_exp_f32 v212, v212
v_exp_f32 v213, v213
v_exp_f32 v214, v214
v_exp_f32 v215, v215
v_cvt_pk_bf16_f32 v232, v208, v209
v_cvt_pk_bf16_f32 v233, v210, v211
v_cvt_pk_bf16_f32 v234, v212, v213
v_cvt_pk_bf16_f32 v235, v214, v215
v_cmp_lt_i32 vcc, 96, v255
s_nop 1
v_cndmask_b32 v216, v216, v32, vcc
v_cmp_lt_i32 vcc, 95, v255
s_nop 1
v_cndmask_b32 v217, v217, v32, vcc
v_cmp_lt_i32 vcc, 94, v255
s_nop 1
v_cndmask_b32 v218, v218, v32, vcc
v_cmp_lt_i32 vcc, 93, v255
s_nop 1
v_cndmask_b32 v219, v219, v32, vcc
v_cmp_lt_i32 vcc, 80, v255
s_nop 1
v_cndmask_b32 v220, v220, v32, vcc
v_cmp_lt_i32 vcc, 79, v255
s_nop 1
v_cndmask_b32 v221, v221, v32, vcc
v_cmp_lt_i32 vcc, 78, v255
s_nop 1
v_cndmask_b32 v222, v222, v32, vcc
v_cmp_lt_i32 vcc, 77, v255
s_nop 1
v_cndmask_b32 v223, v223, v32, vcc
v_max3_f32 v33, v216, v217, v218
v_max3_f32 v34, v219, v220, v221
v_max3_f32 v33, v33, v222, v223
v_max_f32 v33, v33, v34
v_mov_b32 v34, v33
s_nop 1
v_permlane32_swap_b32 v33, v34
v_max_f32 v33, v33, v34
v_mov_b32 v34, v33
s_nop 1
v_permlane16_swap_b32 v33, v34
v_max_f32 v33, v33, v34
v_min_f32 v33, -v33, v251
v_sub_f32 v34, v33, v251
v_exp_f32 v34, v34
s_nop 0
v_mul_f32 v246, v246, v34
v_mul_f32 v247, v247, v34
v_add_f32 v216, v216, v33
v_add_f32 v217, v217, v33
v_add_f32 v218, v218, v33
v_add_f32 v219, v219, v33
v_add_f32 v220, v220, v33
v_add_f32 v221, v221, v33
v_add_f32 v222, v222, v33
v_add_f32 v223, v223, v33
v_exp_f32 v216, v216
v_exp_f32 v217, v217
v_exp_f32 v218, v218
v_exp_f32 v219, v219
v_exp_f32 v220, v220
v_exp_f32 v221, v221
v_exp_f32 v222, v222
v_exp_f32 v223, v223
v_cvt_pk_bf16_f32 v236, v216, v217
v_cvt_pk_bf16_f32 v237, v218, v219
v_cvt_pk_bf16_f32 v238, v220, v221
v_cvt_pk_bf16_f32 v239, v222, v223
mvavs 164,168,228
v_mov_b32 v251, v33
v_mul_f32 v140, v140, v34
v_mul_f32 v141, v141, v34
v_mul_f32 v142, v142, v34
v_mul_f32 v143, v143, v34
v_mul_f32 v156, v156, v34
v_mul_f32 v157, v157, v34
v_mul_f32 v158, v158, v34
v_mul_f32 v159, v159, v34
v_mul_f32 v172, v172, v34
v_mul_f32 v173, v173, v34
v_mul_f32 v174, v174, v34
v_mul_f32 v175, v175, v34
v_mul_f32 v188, v188, v34
v_mul_f32 v189, v189, v34
v_mul_f32 v190, v190, v34
v_mul_f32 v191, v191, v34
mvavs 180,172,228
v_smfmac_f32_16x16x64_bf16 v[244:247], a[192:195], v[232:239], v15
mvavs 136,160,232
mvavs 152,164,232
mvavs 168,168,232
mvavs 184,172,232
mvavs 140,160,236
mvavs 156,164,236
mvavs 172,168,236
mvavs 188,172,236
s_nop 7
s_nop 7
v_add_u32 v255, 32, v255
s_add_u32 s3, s3, 8192
s_cmp_lt_u32 s3, s4
s_cbranch_scc1 FB0_lp
v_add_f32 v36, v240, v241
v_add_f32 v37, v242, v243
v_add_f32 v38, v244, v245
v_add_f32 v39, v246, v247
v_mov_b32 v232, 0
v_mov_b32 v233, 0
v_mov_b32 v234, 0
v_mov_b32 v235, 0
v_mov_b32 v236, 0
v_mov_b32 v237, 0
v_mov_b32 v238, 0
v_mov_b32 v239, 0
v_mov_b32 v248, 0
v_mov_b32 v249, 0
v_mov_b32 v250, 0
v_mov_b32 v251, 0
v_mov_b32 v252, 0
v_mov_b32 v253, 0
v_mov_b32 v254, 0
v_mov_b32 v255, 0
s_mov_b32 s70, s16
s_mov_b32 s74, s16
s_nop 3
s_cmp_eq_u32 s31, 0
s_cbranch_scc1 FBb_ok
s_branch FBa_ok
FBc_spin:
s_waitcnt lgkmcnt(0)
s_nop 7
s_nop 7
s_mov_b32 s70, 0x80000
s_mov_b32 s74, 0x80000
v_and_b32 v252, 0x3ff, v0
v_add_u32 v253, 4096, v252
s_lshl_b32 s3, s33, 12
v_add_u32 v254, s3, v252
s_mov_b32 s4, s31
v_bfe_u32 v255, v0, 8, 2
v_lshlrev_b32 v255, 2, v255
v_bfe_u32 v48, v0, 4, 4
v_sub_u32 v255, v255, v48
s_lshl3_add_u32 s3, s4, s32
s_lshl_b32 s3, s3, 4
v_subrev_u32 v255, s3, v255
s_add_u32 s4, s4, 1
s_lshl_b32 s4, s4, 15
s_mov_b32 s3, 0
v_mov_b32 v48, 0xff800000
v_mov_b32 v128, 0
v_mov_b32 v129, 0
v_mov_b32 v130, 0
v_mov_b32 v131, 0
v_mov_b32 v132, 0
v_mov_b32 v133, 0
v_mov_b32 v134, 0
v_mov_b32 v135, 0
v_mov_b32 v136, 0
v_mov_b32 v137, 0
v_mov_b32 v138, 0
v_mov_b32 v139, 0
v_mov_b32 v140, 0
v_mov_b32 v141, 0
v_mov_b32 v142, 0
v_mov_b32 v143, 0
v_mov_b32 v144, 0
v_mov_b32 v145, 0
v_mov_b32 v146, 0
v_mov_b32 v147, 0
v_mov_b32 v148, 0
v_mov_b32 v149, 0
v_mov_b32 v150, 0
v_mov_b32 v151, 0
v_mov_b32 v152, 0
v_mov_b32 v153, 0
v_mov_b32 v154, 0
v_mov_b32 v155, 0
v_mov_b32 v156, 0
v_mov_b32 v157, 0
v_mov_b32 v158, 0
v_mov_b32 v159, 0
v_mov_b32 v160, 0
v_mov_b32 v161, 0
v_mov_b32 v162, 0
v_mov_b32 v163, 0
v_mov_b32 v164, 0
v_mov_b32 v165, 0
v_mov_b32 v166, 0
v_mov_b32 v167, 0
v_mov_b32 v168, 0
v_mov_b32 v169, 0
v_mov_b32 v170, 0
v_mov_b32 v171, 0
v_mov_b32 v172, 0
v_mov_b32 v173, 0
v_mov_b32 v174, 0
v_mov_b32 v175, 0
v_mov_b32 v176, 0
v_mov_b32 v177, 0
v_mov_b32 v178, 0
v_mov_b32 v179, 0
v_mov_b32 v180, 0
v_mov_b32 v181, 0
v_mov_b32 v182, 0
v_mov_b32 v183, 0
v_mov_b32 v184, 0
v_mov_b32 v185, 0
v_mov_b32 v186, 0
v_mov_b32 v187, 0
v_mov_b32 v188, 0
v_mov_b32 v189, 0
v_mov_b32 v190, 0
v_mov_b32 v191, 0
v_mov_b32 v240, 0
v_mov_b32 v241, 0
v_mov_b32 v242, 0
v_mov_b32 v243, 0
v_mov_b32 v244, 0
v_mov_b32 v245, 0
v_mov_b32 v246, 0
v_mov_b32 v247, 0
v_mov_b32 v248, 0x7149f2ca
v_mov_b32 v249, 0x7149f2ca
v_mov_b32 v250, 0x7149f2ca
v_mov_b32 v251, 0x7149f2ca
FB1_lp:
buffer_load_dwordx4 a[160:163], v252, s[68:71], s3 offen offset:0 sc1
buffer_load_dwordx4 a[164:167], v252, s[68:71], s3 offen offset:1024 sc1
buffer_load_dwordx4 a[168:171], v253, s[68:71], s3 offen offset:0 sc1
buffer_load_dwordx4 a[172:175], v253, s[68:71], s3 offen offset:1024 sc1
buffer_load_dwordx4 a[176:179], v252, s[68:71], s3 offen offset:2048 sc1
buffer_load_dwordx4 a[180:183], v252, s[68:71], s3 offen offset:3072 sc1
buffer_load_dwordx4 a[184:187], v253, s[68:71], s3 offen offset:2048 sc1
buffer_load_dwordx4 a[188:191], v253, s[68:71], s3 offen offset:3072 sc1
s_waitcnt vmcnt(7)
mvaaz 192,160,64
s_waitcnt vmcnt(0)
mvaas 192,164,68
mvaas 192,168,72
mvaas 192,172,76
mvaaz 196,176,64
mvaas 196,180,68
mvaas 196,184,72
mvaas 196,188,76
mvaaz 200,160,80
mvaas 200,164,84
mvaas 200,168,88
mvaas 200,172,92
mvaaz 204,176,80
mvaas 204,180,84
mvaas 204,184,88
mvaas 204,188,92
mvaaz 208,160,96
mvaas 208,164,100
mvaas 208,168,104
mvaas 208,172,108
mvaaz 212,176,96
mvaas 212,180,100
mvaas 212,184,104
mvaas 212,188,108
mvaaz 216,160,112
mvaas 216,164,116
mvaas 216,168,120
mvaas 216,172,124
mvaaz 220,176,112
mvaas 220,180,116
mvaas 220,184,120
mvaas 220,188,124
s_nop 7
s_nop 7
buffer_load_dwordx4 a[160:163], v254, s[72:75], s3 offen offset:0 sc1
buffer_load_dwordx4 a[164:167], v254, s[72:75], s3 offen offset:1024 sc1
buffer_load_dwordx4 a[168:171], v254, s[72:75], s3 offen offset:2048 sc1
buffer_load_dwordx4 a[172:175], v254, s[72:75], s3 offen offset:3072 sc1
v_cmp_lt_i32 vcc, 0, v255
s_nop 1
v_cndmask_b32 v192, v192, v48, vcc
v_cmp_lt_i32 vcc, -1, v255
s_nop 1
v_cndmask_b32 v193, v193, v48, vcc
v_cmp_lt_i32 vcc, -2, v255
s_nop 1
v_cndmask_b32 v194, v194, v48, vcc
v_cmp_lt_i32 vcc, -3, v255
s_nop 1
v_cndmask_b32 v195, v195, v48, vcc
v_cmp_lt_i32 vcc, -16, v255
s_nop 1
v_cndmask_b32 v196, v196, v48, vcc
v_cmp_lt_i32 vcc, -17, v255
s_nop 1
v_cndmask_b32 v197, v197, v48, vcc
v_cmp_lt_i32 vcc, -18, v255
s_nop 1
v_cndmask_b32 v198, v198, v48, vcc
v_cmp_lt_i32 vcc, -19, v255
s_nop 1
v_cndmask_b32 v199, v199, v48, vcc
v_max3_f32 v49, v192, v193, v194
v_max3_f32 v50, v195, v196, v197
v_max3_f32 v49, v49, v198, v199
v_max_f32 v49, v49, v50
v_mov_b32 v50, v49
s_nop 1
v_permlane32_swap_b32 v49, v50
v_max_f32 v49, v49, v50
v_mov_b32 v50, v49
s_nop 1
v_permlane16_swap_b32 v49, v50
v_max_f32 v49, v49, v50
v_min_f32 v49, -v49, v248
v_sub_f32 v50, v49, v248
v_exp_f32 v50, v50
v_mov_b32 v248, v49
v_mul_f32 v240, v240, v50
v_mul_f32 v241, v241, v50
v_mul_f32 v128, v128, v50
v_mul_f32 v129, v129, v50
v_mul_f32 v130, v130, v50
v_mul_f32 v131, v131, v50
v_mul_f32 v144, v144, v50
v_mul_f32 v145, v145, v50
v_mul_f32 v146, v146, v50
v_mul_f32 v147, v147, v50
v_mul_f32 v160, v160, v50
v_mul_f32 v161, v161, v50
v_mul_f32 v162, v162, v50
v_mul_f32 v163, v163, v50
v_mul_f32 v176, v176, v50
v_mul_f32 v177, v177, v50
v_mul_f32 v178, v178, v50
v_mul_f32 v179, v179, v50
v_add_f32 v192, v192, v49
v_add_f32 v193, v193, v49
v_add_f32 v194, v194, v49
v_add_f32 v195, v195, v49
v_add_f32 v196, v196, v49
v_add_f32 v197, v197, v49
v_add_f32 v198, v198, v49
v_add_f32 v199, v199, v49
v_exp_f32 v192, v192
v_exp_f32 v193, v193
v_exp_f32 v194, v194
v_exp_f32 v195, v195
v_exp_f32 v196, v196
v_exp_f32 v197, v197
v_exp_f32 v198, v198
v_exp_f32 v199, v199
v_cvt_pk_bf16_f32 v224, v192, v193
v_cvt_pk_bf16_f32 v225, v194, v195
v_cvt_pk_bf16_f32 v226, v196, v197
v_cvt_pk_bf16_f32 v227, v198, v199
v_cmp_lt_i32 vcc, 32, v255
s_nop 1
v_cndmask_b32 v200, v200, v48, vcc
v_cmp_lt_i32 vcc, 31, v255
s_nop 1
v_cndmask_b32 v201, v201, v48, vcc
v_cmp_lt_i32 vcc, 30, v255
s_nop 1
v_cndmask_b32 v202, v202, v48, vcc
v_cmp_lt_i32 vcc, 29, v255
s_nop 1
v_cndmask_b32 v203, v203, v48, vcc
v_cmp_lt_i32 vcc, 16, v255
s_nop 1
v_cndmask_b32 v204, v204, v48, vcc
v_cmp_lt_i32 vcc, 15, v255
s_nop 1
v_cndmask_b32 v205, v205, v48, vcc
v_cmp_lt_i32 vcc, 14, v255
s_nop 1
v_cndmask_b32 v206, v206, v48, vcc
v_cmp_lt_i32 vcc, 13, v255
s_nop 1
v_cndmask_b32 v207, v207, v48, vcc
v_max3_f32 v49, v200, v201, v202
v_max3_f32 v50, v203, v204, v205
v_max3_f32 v49, v49, v206, v207
v_max_f32 v49, v49, v50
v_mov_b32 v50, v49
s_nop 1
v_permlane32_swap_b32 v49, v50
v_max_f32 v49, v49, v50
v_mov_b32 v50, v49
s_nop 1
v_permlane16_swap_b32 v49, v50
v_max_f32 v49, v49, v50
v_min_f32 v49, -v49, v249
v_sub_f32 v50, v49, v249
v_exp_f32 v50, v50
s_nop 0
v_mul_f32 v242, v242, v50
v_mul_f32 v243, v243, v50
v_add_f32 v200, v200, v49
v_add_f32 v201, v201, v49
v_add_f32 v202, v202, v49
v_add_f32 v203, v203, v49
v_add_f32 v204, v204, v49
v_add_f32 v205, v205, v49
v_add_f32 v206, v206, v49
v_add_f32 v207, v207, v49
v_exp_f32 v200, v200
v_exp_f32 v201, v201
v_exp_f32 v202, v202
v_exp_f32 v203, v203
v_exp_f32 v204, v204
v_exp_f32 v205, v205
v_exp_f32 v206, v206
v_exp_f32 v207, v207
v_cvt_pk_bf16_f32 v228, v200, v201
v_cvt_pk_bf16_f32 v229, v202, v203
v_cvt_pk_bf16_f32 v230, v204, v205
v_cvt_pk_bf16_f32 v231, v206, v207
s_nop 1
v_smfmac_f32_16x16x64_bf16 v[240:243], a[192:195], v[224:231], v15
s_waitcnt vmcnt(0)
v_mul_f32 v132, v132, v50
mvavs 128,160,224
v_mul_f32 v133, v133, v50
v_mul_f32 v134, v134, v50
mvavs 144,164,224
v_mul_f32 v135, v135, v50
v_mul_f32 v148, v148, v50
mvavs 160,168,224
v_mul_f32 v149, v149, v50
v_mul_f32 v150, v150, v50
v_mul_f32 v151, v151, v50
mvavs 176,172,224
v_mul_f32 v164, v164, v50
v_mul_f32 v165, v165, v50
v_mul_f32 v166, v166, v50
v_mul_f32 v167, v167, v50
mvavs 132,160,228
v_mul_f32 v180, v180, v50
v_mul_f32 v181, v181, v50
v_mul_f32 v182, v182, v50
v_mul_f32 v183, v183, v50
mvavs 148,164,228
v_mov_b32 v249, v49
v_cmp_lt_i32 vcc, 64, v255
s_nop 1
v_cndmask_b32 v208, v208, v48, vcc
v_cmp_lt_i32 vcc, 63, v255
s_nop 1
v_cndmask_b32 v209, v209, v48, vcc
v_cmp_lt_i32 vcc, 62, v255
s_nop 1
v_cndmask_b32 v210, v210, v48, vcc
v_cmp_lt_i32 vcc, 61, v255
s_nop 1
v_cndmask_b32 v211, v211, v48, vcc
v_cmp_lt_i32 vcc, 48, v255
s_nop 1
v_cndmask_b32 v212, v212, v48, vcc
v_cmp_lt_i32 vcc, 47, v255
s_nop 1
v_cndmask_b32 v213, v213, v48, vcc
v_cmp_lt_i32 vcc, 46, v255
s_nop 1
v_cndmask_b32 v214, v214, v48, vcc
v_cmp_lt_i32 vcc, 45, v255
s_nop 1
v_cndmask_b32 v215, v215, v48, vcc
v_max3_f32 v49, v208, v209, v210
v_max3_f32 v50, v211, v212, v213
v_max3_f32 v49, v49, v214, v215
v_max_f32 v49, v49, v50
v_mov_b32 v50, v49
s_nop 1
v_permlane32_swap_b32 v49, v50
v_max_f32 v49, v49, v50
v_mov_b32 v50, v49
s_nop 1
v_permlane16_swap_b32 v49, v50
v_max_f32 v49, v49, v50
v_min_f32 v49, -v49, v250
v_sub_f32 v50, v49, v250
v_exp_f32 v50, v50
v_mov_b32 v250, v49
v_mul_f32 v244, v244, v50
v_mul_f32 v245, v245, v50
v_mul_f32 v136, v136, v50
v_mul_f32 v137, v137, v50
v_mul_f32 v138, v138, v50
v_mul_f32 v139, v139, v50
v_mul_f32 v152, v152, v50
v_mul_f32 v153, v153, v50
v_mul_f32 v154, v154, v50
v_mul_f32 v155, v155, v50
v_mul_f32 v168, v168, v50
v_mul_f32 v169, v169, v50
v_mul_f32 v170, v170, v50
v_mul_f32 v171, v171, v50
v_mul_f32 v184, v184, v50
v_mul_f32 v185, v185, v50
v_mul_f32 v186, v186, v50
v_mul_f32 v187, v187, v50
v_add_f32 v208, v208, v49
v_add_f32 v209, v209, v49
v_add_f32 v210, v210, v49
v_add_f32 v211, v211, v49
v_add_f32 v212, v212, v49
v_add_f32 v213, v213, v49
v_add_f32 v214, v214, v49
v_add_f32 v215, v215, v49
v_exp_f32 v208, v208
v_exp_f32 v209, v209
v_exp_f32 v210, v210
v_exp_f32 v211, v211
v_exp_f32 v212, v212
v_exp_f32 v213, v213
v_exp_f32 v214, v214
v_exp_f32 v215, v215
v_cvt_pk_bf16_f32 v232, v208, v209
v_cvt_pk_bf16_f32 v233, v210, v211
v_cvt_pk_bf16_f32 v234, v212, v213
v_cvt_pk_bf16_f32 v235, v214, v215
v_cmp_lt_i32 vcc, 96, v255
s_nop 1
v_cndmask_b32 v216, v216, v48, vcc
v_cmp_lt_i32 vcc, 95, v255
s_nop 1
v_cndmask_b32 v217, v217, v48, vcc
v_cmp_lt_i32 vcc, 94, v255
s_nop 1
v_cndmask_b32 v218, v218, v48, vcc
v_cmp_lt_i32 vcc, 93, v255
s_nop 1
v_cndmask_b32 v219, v219, v48, vcc
v_cmp_lt_i32 vcc, 80, v255
s_nop 1
v_cndmask_b32 v220, v220, v48, vcc
v_cmp_lt_i32 vcc, 79, v255
s_nop 1
v_cndmask_b32 v221, v221, v48, vcc
v_cmp_lt_i32 vcc, 78, v255
s_nop 1
v_cndmask_b32 v222, v222, v48, vcc
v_cmp_lt_i32 vcc, 77, v255
s_nop 1
v_cndmask_b32 v223, v223, v48, vcc
v_max3_f32 v49, v216, v217, v218
v_max3_f32 v50, v219, v220, v221
v_max3_f32 v49, v49, v222, v223
v_max_f32 v49, v49, v50
v_mov_b32 v50, v49
s_nop 1
v_permlane32_swap_b32 v49, v50
v_max_f32 v49, v49, v50
v_mov_b32 v50, v49
s_nop 1
v_permlane16_swap_b32 v49, v50
v_max_f32 v49, v49, v50
v_min_f32 v49, -v49, v251
v_sub_f32 v50, v49, v251
v_exp_f32 v50, v50
s_nop 0
v_mul_f32 v246, v246, v50
v_mul_f32 v247, v247, v50
v_add_f32 v216, v216, v49
v_add_f32 v217, v217, v49
v_add_f32 v218, v218, v49
v_add_f32 v219, v219, v49
v_add_f32 v220, v220, v49
v_add_f32 v221, v221, v49
v_add_f32 v222, v222, v49
v_add_f32 v223, v223, v49
v_exp_f32 v216, v216
v_exp_f32 v217, v217
v_exp_f32 v218, v218
v_exp_f32 v219, v219
v_exp_f32 v220, v220
v_exp_f32 v221, v221
v_exp_f32 v222, v222
v_exp_f32 v223, v223
v_cvt_pk_bf16_f32 v236, v216, v217
v_cvt_pk_bf16_f32 v237, v218, v219
v_cvt_pk_bf16_f32 v238, v220, v221
v_cvt_pk_bf16_f32 v239, v222, v223
mvavs 164,168,228
v_mov_b32 v251, v49
v_mul_f32 v140, v140, v50
v_mul_f32 v141, v141, v50
v_mul_f32 v142, v142, v50
v_mul_f32 v143, v143, v50
v_mul_f32 v156, v156, v50
v_mul_f32 v157, v157, v50
v_mul_f32 v158, v158, v50
v_mul_f32 v159, v159, v50
v_mul_f32 v172, v172, v50
v_mul_f32 v173, v173, v50
v_mul_f32 v174, v174, v50
v_mul_f32 v175, v175, v50
v_mul_f32 v188, v188, v50
v_mul_f32 v189, v189, v50
v_mul_f32 v190, v190, v50
v_mul_f32 v191, v191, v50
mvavs 180,172,228
v_smfmac_f32_16x16x64_bf16 v[244:247], a[192:195], v[232:239], v15
mvavs 136,160,232
mvavs 152,164,232
mvavs 168,168,232
mvavs 184,172,232
mvavs 140,160,236
mvavs 156,164,236
mvavs 172,168,236
mvavs 188,172,236
s_nop 7
s_nop 7
v_add_u32 v255, 32, v255
s_add_u32 s3, s3, 8192
s_cmp_lt_u32 s3, s4
s_cbranch_scc1 FB1_lp
v_add_f32 v52, v240, v241
v_add_f32 v53, v242, v243
v_add_f32 v54, v244, v245
v_add_f32 v55, v246, v247
v_mov_b32 v232, 0
v_mov_b32 v233, 0
v_mov_b32 v234, 0
v_mov_b32 v235, 0
v_mov_b32 v236, 0
v_mov_b32 v237, 0
v_mov_b32 v238, 0
v_mov_b32 v239, 0
v_mov_b32 v248, 0
v_mov_b32 v249, 0
v_mov_b32 v250, 0
v_mov_b32 v251, 0
v_mov_b32 v252, 0
v_mov_b32 v253, 0
v_mov_b32 v254, 0
v_mov_b32 v255, 0
s_mov_b32 s70, s16
s_mov_b32 s74, s16
s_nop 3
s_branch FBc_ok
PCK_spin:
s_mov_b32 s99, 0x40000
PCK_lp:
s_sleep 2
buffer_load_dword v27, v26, s[76:79], s8 offen sc1
s_waitcnt vmcnt(0)
v_cmp_gt_u32 vcc, s34, v27
s_nop 1
s_cbranch_vccz PCK_ok
s_sub_u32 s99, s99, 1
s_cmp_lg_u32 s99, 0
s_cbranch_scc1 PCK_lp
s_branch PCK_ok
PFK_spin:
s_mov_b32 s99, 0x40000
PFK_lp:
s_sleep 2
buffer_load_dword v27, v26, s[64:67], s81 offen sc1
s_waitcnt vmcnt(0)
v_cmp_gt_u32 vcc, 1, v27
s_nop 1
s_cbranch_vccz PFK_ok
s_sub_u32 s99, s99, 1
s_cmp_lg_u32 s99, 0
s_cbranch_scc1 PFK_lp
s_branch PFK_ok
PCS_spin:
s_mov_b32 s99, 0x40000
PCS_lp:
s_sleep 2
buffer_load_dword v27, v26, s[76:79], s8 offen sc1
s_waitcnt vmcnt(0)
v_cmp_gt_u32 vcc, s34, v27
s_nop 1
s_cbranch_vccz PCS_ok
s_sub_u32 s99, s99, 1
s_cmp_lg_u32 s99, 0
s_cbranch_scc1 PCS_lp
s_branch PCS_ok
PFS_spin:
s_mov_b32 s99, 0x40000
PFS_lp:
s_sleep 2
buffer_load_dword v27, v26, s[64:67], s81 offen sc1
s_waitcnt vmcnt(0)
v_cmp_gt_u32 vcc, 1, v27
s_nop 1
s_cbranch_vccz PFS_ok
s_sub_u32 s99, s99, 1
s_cmp_lg_u32 s99, 0
s_cbranch_scc1 PFS_lp
s_branch PFS_ok
PF2_spin:
s_mov_b32 s99, 0x40000
PF2_lp:
s_sleep 2
buffer_load_dword v20, v22, s[64:67], s81 offen sc1
s_waitcnt vmcnt(0)
v_cmp_gt_u32 vcc, 2, v20
s_nop 1
s_cbranch_vccz PF2_ok
s_sub_u32 s99, s99, 1
s_cmp_lg_u32 s99, 0
s_cbranch_scc1 PF2_lp
s_branch PF2_ok
PH_spin:
s_mov_b32 s99, 0x40000
PH_lp:
s_sleep 2
buffer_load_dword v20, v22, s[64:67], s81 offen sc1
s_waitcnt vmcnt(0)
v_cmp_gt_u32 vcc, 1, v20
s_nop 1
s_cbranch_vccz PH_ok
s_sub_u32 s99, s99, 1
s_cmp_lg_u32 s99, 0
s_cbranch_scc1 PH_lp
s_branch PH_ok
PA_spin:
s_mov_b32 s99, 0x40000
PA_lp:
s_sleep 2
buffer_load_dword v24, v26, s[64:67], s81 offen sc1
s_waitcnt vmcnt(0)
v_cmp_gt_u32 vcc, 3, v24
s_nop 1
s_cbranch_vccz PA_ok
s_sub_u32 s99, s99, 1
s_cmp_lg_u32 s99, 0
s_cbranch_scc1 PA_lp
s_branch PA_ok
PIB_spin:
s_mov_b32 s99, 0x40000
PIB_lp:
s_sleep 2
buffer_load_dword v24, v3, s[64:67], s81 offen sc1
s_waitcnt vmcnt(0)
v_cmp_gt_u32 vcc, 2, v24
s_nop 1
s_cbranch_vccz PIB_ok
s_sub_u32 s99, s99, 1
s_cmp_lg_u32 s99, 0
s_cbranch_scc1 PIB_lp
s_branch PIB_ok
PCB_spin:
s_mov_b32 s99, 0x40000
PCB_lp:
s_sleep 2
buffer_load_dword v24, v26, s[64:67], s81 offen sc1
s_waitcnt vmcnt(0)
v_cmp_gt_u32 vcc, 4, v24
s_nop 1
s_cbranch_vccz PCB_ok
s_sub_u32 s99, s99, 1
s_cmp_lg_u32 s99, 0
s_cbranch_scc1 PCB_lp
s_branch PCB_ok
P3_lp:
s_sub_u32 s99, s99, 1
s_cmp_eq_u32 s99, 0
s_cselect_b32 s52, 0, s52
s_cbranch_scc1 P3_ret
s_mov_b32 s54, s52
s_bcnt1_i32_b32 s87, s52
s_cmp_le_u32 s87, 3
s_cbranch_scc1 P3_ld
s_waitcnt vmcnt(0)
v_cmp_ne_u32 vcc, -1, v49
s_nop 0
s_bfe_u32 s87, vcc_lo, 0x80010
s_cmp_eq_u32 s87, 0xff
s_cselect_b32 s87, 0x80, 0
s_and_b32 s54, vcc_lo, 0x7f7f
s_or_b32 s54, s54, s87
s_and_b32 s54, s54, s52
s_sleep 1
P3_ld:
s_bitcmp1_b32 s54, 6
s_cbranch_scc1 P3_ld6
P3_lr6:
s_bitcmp1_b32 s54, 5
s_cbranch_scc1 P3_ld5
P3_lr5:
s_bitcmp1_b32 s54, 4
s_cbranch_scc1 P3_ld4
P3_lr4:
s_bitcmp1_b32 s54, 3
s_cbranch_scc1 P3_ld3
P3_lr3:
s_bitcmp1_b32 s54, 2
s_cbranch_scc1 P3_ld2
P3_lr2:
s_bitcmp1_b32 s54, 1
s_cbranch_scc1 P3_ld1
P3_lr1:
s_bitcmp1_b32 s54, 0
s_cbranch_scc1 P3_ld0
P3_lr0:
s_cmp_lt_u32 s54, 0x80
s_cbranch_scc1 P3_lr7
s_bitcmp1_b32 s54, 14
s_cbranch_scc1 P3_ld14
P3_lr14:
s_bitcmp1_b32 s54, 13
s_cbranch_scc1 P3_ld13
P3_lr13:
s_bitcmp1_b32 s54, 12
s_cbranch_scc1 P3_ld12
P3_lr12:
s_bitcmp1_b32 s54, 11
s_cbranch_scc1 P3_ld11
P3_lr11:
s_bitcmp1_b32 s54, 10
s_cbranch_scc1 P3_ld10
P3_lr10:
s_bitcmp1_b32 s54, 9
s_cbranch_scc1 P3_ld9
P3_lr9:
s_bitcmp1_b32 s54, 8
s_cbranch_scc1 P3_ld8
P3_lr8:
s_bitcmp1_b32 s54, 7
s_cbranch_scc1 P3_ld7
P3_lr7:
buffer_load_dword v49, v8, s[64:67], s59 offen offset:1020 sc1
s_and_b32 s87, s52, s53
s_cbranch_scc0 P3_s1
s_waitcnt vmcnt(1)
P3_ck:
s_bitcmp1_b32 s54, 6
s_cbranch_scc1 P3_do6
P3_dr6:
s_bitcmp1_b32 s54, 5
s_cbranch_scc1 P3_do5
P3_dr5:
s_bitcmp1_b32 s54, 4
s_cbranch_scc1 P3_do4
P3_dr4:
s_bitcmp1_b32 s54, 3
s_cbranch_scc1 P3_do3
P3_dr3:
s_bitcmp1_b32 s54, 2
s_cbranch_scc1 P3_do2
P3_dr2:
s_bitcmp1_b32 s54, 1
s_cbranch_scc1 P3_do1
P3_dr1:
s_bitcmp1_b32 s54, 0
s_cbranch_scc1 P3_do0
P3_dr0:
s_cmp_lt_u32 s54, 0x80
s_cbranch_scc1 P3_dr7
s_bitcmp1_b32 s54, 14
s_cbranch_scc1 P3_do14
P3_dr14:
s_bitcmp1_b32 s54, 13
s_cbranch_scc1 P3_do13
P3_dr13:
s_bitcmp1_b32 s54, 12
s_cbranch_scc1 P3_do12
P3_dr12:
s_bitcmp1_b32 s54, 11
s_cbranch_scc1 P3_do11
P3_dr11:
s_bitcmp1_b32 s54, 10
s_cbranch_scc1 P3_do10
P3_dr10:
s_bitcmp1_b32 s54, 9
s_cbranch_scc1 P3_do9
P3_dr9:
s_bitcmp1_b32 s54, 8
s_cbranch_scc1 P3_do8
P3_dr8:
s_bitcmp1_b32 s54, 7
s_cbranch_scc1 P3_do7
P3_dr7:
s_cmp_lg_u32 s52, 0
s_cbranch_scc1 P3_lp
P3_ret:
s_cmp_lg_u32 s53, -1
s_cbranch_scc1 P3_s1
mvvvs 128,60,168
mvvvs 132,58,170
mvvvs 128,58,174
mvvvs 132,58,178
mvvvs 128,58,182
mvvvs 132,58,186
mvvvs 128,58,190
s_nop 7
v_mul_f32 v128, v128, v18
v_mul_f32 v129, v129, v18
v_mul_f32 v130, v130, v18
v_mul_f32 v131, v131, v18
v_cvt_pk_bf16_f32 v128, v128, v129
v_cvt_pk_bf16_f32 v129, v130, v131
buffer_store_dwordx2 v[128:129], v4, s[40:43], s6 offen offset:0 sc0 sc1
mvvvs 132,56,192
s_nop 7
v_mul_f32 v132, v132, v19
v_mul_f32 v133, v133, v19
v_mul_f32 v134, v134, v19
v_mul_f32 v135, v135, v19
v_cvt_pk_bf16_f32 v132, v132, v133
v_cvt_pk_bf16_f32 v133, v134, v135
buffer_store_dwordx2 v[132:133], v5, s[40:43], s6 offen offset:0 sc0 sc1
s_branch P3_end
P3_w2:
s_nop 4
v_mul_f32 v64, v64, v20
v_mul_f32 v65, v65, v20
v_mul_f32 v66, v66, v20
v_mul_f32 v67, v67, v20
v_cvt_pk_bf16_f32 v64, v64, v65
v_cvt_pk_bf16_f32 v65, v66, v67
buffer_store_dwordx2 v[64:65], v4, s[40:43], s7 offen offset:1024 sc0 sc1
v_mul_f32 v144, v144, v16
v_mul_f32 v145, v145, v16
v_mul_f32 v146, v146, v16
v_mul_f32 v147, v147, v16
v_cvt_pk_bf16_f32 v144, v144, v145
v_cvt_pk_bf16_f32 v145, v146, v147
buffer_store_dwordx2 v[144:145], v4, s[40:43], s5 offen offset:0 sc0 sc1
v_mul_f32 v148, v148, v17
v_mul_f32 v149, v149, v17
v_mul_f32 v150, v150, v17
v_mul_f32 v151, v151, v17
v_cvt_pk_bf16_f32 v148, v148, v149
v_cvt_pk_bf16_f32 v149, v150, v151
buffer_store_dwordx2 v[148:149], v5, s[40:43], s5 offen offset:0 sc0 sc1
s_waitcnt vmcnt(4)
s_branch P3_ck
P3_ld14:
s_add_u32 s57, s59, 13312
buffer_load_dwordx4 v[96:99], v2, s[64:67], s57 offen offset:0 sc1
s_branch P3_lr14
P3_ld13:
s_add_u32 s57, s59, 12288
buffer_load_dwordx4 v[100:103], v2, s[64:67], s57 offen offset:0 sc1
s_branch P3_lr13
P3_ld12:
s_add_u32 s57, s59, 11264
buffer_load_dwordx4 v[104:107], v2, s[64:67], s57 offen offset:0 sc1
s_branch P3_lr12
P3_ld11:
s_add_u32 s57, s59, 10240
buffer_load_dwordx4 v[108:111], v2, s[64:67], s57 offen offset:0 sc1
s_branch P3_lr11
P3_ld10:
s_add_u32 s57, s59, 9216
buffer_load_dwordx4 v[112:115], v2, s[64:67], s57 offen offset:0 sc1
s_branch P3_lr10
P3_ld9:
s_add_u32 s57, s59, 8192
buffer_load_dwordx4 v[116:119], v2, s[64:67], s57 offen offset:0 sc1
s_branch P3_lr9
P3_ld8:
s_add_u32 s57, s59, 7168
buffer_load_dwordx4 v[120:123], v2, s[64:67], s57 offen offset:0 sc1
s_branch P3_lr8
P3_ld7:
s_add_u32 s57, s59, 14336
buffer_load_dwordx4 v[124:127], v2, s[64:67], s57 offen offset:0 sc1
s_add_u32 s57, s59, 14336
buffer_load_dwordx4 v[196:199], v2, s[64:67], s57 offen offset:1024 sc1
s_add_u32 s57, s59, 14336
buffer_load_dwordx4 v[200:203], v2, s[64:67], s57 offen offset:2048 sc1
s_add_u32 s57, s59, 14336
buffer_load_dwordx4 v[204:207], v2, s[64:67], s57 offen offset:3072 sc1
s_branch P3_lr7
P3_ld6:
s_add_u32 s57, s59, 6144
buffer_load_dwordx4 v[168:171], v2, s[64:67], s57 offen offset:0 sc1
s_branch P3_lr6
P3_ld5:
s_add_u32 s57, s59, 5120
buffer_load_dwordx4 v[172:175], v2, s[64:67], s57 offen offset:0 sc1
s_branch P3_lr5
P3_ld4:
s_add_u32 s57, s59, 4096
buffer_load_dwordx4 v[176:179], v2, s[64:67], s57 offen offset:0 sc1
s_branch P3_lr4
P3_ld3:
s_add_u32 s57, s59, 3072
buffer_load_dwordx4 v[180:183], v2, s[64:67], s57 offen offset:0 sc1
s_branch P3_lr3
P3_ld2:
s_add_u32 s57, s59, 2048
buffer_load_dwordx4 v[184:187], v2, s[64:67], s57 offen offset:0 sc1
s_branch P3_lr2
P3_ld1:
s_add_u32 s57, s59, 1024
buffer_load_dwordx4 v[188:191], v2, s[64:67], s57 offen offset:0 sc1
s_branch P3_lr1
P3_ld0:
s_add_u32 s57, s59, 0
buffer_load_dwordx4 v[192:195], v2, s[64:67], s57 offen offset:0 sc1
s_branch P3_lr0
P3_do14:
v_max3_u32 v48, v96, v97, v98
v_max_u32 v48, v99, v48
v_cmp_eq_u32 vcc, -1, v48
s_nop 0
s_cbranch_vccnz P3_dr14
s_bitset0_b32 s52, 14
s_branch P3_dr14
P3_do13:
v_max3_u32 v48, v100, v101, v102
v_max_u32 v48, v103, v48
v_cmp_eq_u32 vcc, -1, v48
s_nop 0
s_cbranch_vccnz P3_dr13
s_bitset0_b32 s52, 13
s_branch P3_dr13
P3_do12:
v_max3_u32 v48, v104, v105, v106
v_max_u32 v48, v107, v48
v_cmp_eq_u32 vcc, -1, v48
s_nop 0
s_cbranch_vccnz P3_dr12
s_bitset0_b32 s52, 12
s_branch P3_dr12
P3_do11:
v_max3_u32 v48, v108, v109, v110
v_max_u32 v48, v111, v48
v_cmp_eq_u32 vcc, -1, v48
s_nop 0
s_cbranch_vccnz P3_dr11
s_bitset0_b32 s52, 11
s_branch P3_dr11
P3_do10:
v_max3_u32 v48, v112, v113, v114
v_max_u32 v48, v115, v48
v_cmp_eq_u32 vcc, -1, v48
s_nop 0
s_cbranch_vccnz P3_dr10
s_bitset0_b32 s52, 10
s_branch P3_dr10
P3_do9:
v_max3_u32 v48, v116, v117, v118
v_max_u32 v48, v119, v48
v_cmp_eq_u32 vcc, -1, v48
s_nop 0
s_cbranch_vccnz P3_dr9
s_bitset0_b32 s52, 9
s_branch P3_dr9
P3_do8:
v_max3_u32 v48, v120, v121, v122
v_max_u32 v48, v123, v48
v_cmp_eq_u32 vcc, -1, v48
s_nop 0
s_cbranch_vccnz P3_dr8
s_bitset0_b32 s52, 8
s_branch P3_dr8
P3_do7:
v_max3_u32 v48, v124, v125, v126
v_max3_u32 v48, v127, v196, v48
v_max3_u32 v48, v197, v198, v48
v_max3_u32 v48, v199, v200, v48
v_max3_u32 v48, v201, v202, v48
v_max3_u32 v48, v203, v204, v48
v_max3_u32 v48, v205, v206, v48
v_max_u32 v48, v207, v48
v_cmp_eq_u32 vcc, -1, v48
s_nop 0
s_cbranch_vccnz P3_dr7
s_bitset0_b32 s52, 7
s_branch P3_dr7
P3_do6:
v_max3_u32 v48, v168, v169, v170
v_max_u32 v48, v171, v48
v_cmp_eq_u32 vcc, -1, v48
s_nop 0
s_cbranch_vccnz P3_dr6
s_bitset0_b32 s52, 6
s_branch P3_dr6
P3_do5:
v_max3_u32 v48, v172, v173, v174
v_max_u32 v48, v175, v48
v_cmp_eq_u32 vcc, -1, v48
s_nop 0
s_cbranch_vccnz P3_dr5
s_bitset0_b32 s52, 5
s_branch P3_dr5
P3_do4:
v_max3_u32 v48, v176, v177, v178
v_max_u32 v48, v179, v48
v_cmp_eq_u32 vcc, -1, v48
s_nop 0
s_cbranch_vccnz P3_dr4
s_bitset0_b32 s52, 4
s_branch P3_dr4
P3_do3:
v_max3_u32 v48, v180, v181, v182
v_max_u32 v48, v183, v48
v_cmp_eq_u32 vcc, -1, v48
s_nop 0
s_cbranch_vccnz P3_dr3
s_bitset0_b32 s52, 3
s_branch P3_dr3
P3_do2:
v_max3_u32 v48, v184, v185, v186
v_max_u32 v48, v187, v48
v_cmp_eq_u32 vcc, -1, v48
s_nop 0
s_cbranch_vccnz P3_dr2
s_bitset0_b32 s52, 2
s_branch P3_dr2
P3_do1:
v_max3_u32 v48, v188, v189, v190
v_max_u32 v48, v191, v48
v_cmp_eq_u32 vcc, -1, v48
s_nop 0
s_cbranch_vccnz P3_dr1
s_bitset0_b32 s52, 1
s_branch P3_dr1
P3_do0:
v_max3_u32 v48, v192, v193, v194
v_max_u32 v48, v195, v48
v_cmp_eq_u32 vcc, -1, v48
s_nop 0
s_cbranch_vccnz P3_dr0
s_bitset0_b32 s52, 0
s_branch P3_dr0
K_last:
s_endpgm
s_endpgm
s_endpgm
s_endpgm
s_endpgm
s_endpgm
s_endpgm
s_endpgm
s_endpgm
s_endpgm
s_endpgm
s_endpgm
s_endpgm
s_endpgm
s_endpgm
s_endpgm
s_endpgm
s_endpgm
s_endpgm
s_endpgm
s_endpgm
s_endpgm
s_endpgm
s_endpgm
s_endpgm
s_endpgm
s_endpgm
s_endpgm
s_endpgm
s_endpgm
s_endpgm
s_endpgm
s_endpgm
s_endpgm
s_endpgm
s_endpgm
s_endpgm
s_endpgm
s_endpgm
s_endpgm
s_endpgm
s_endpgm
s_endpgm
s_endpgm
s_endpgm
s_endpgm
s_endpgm
s_endpgm
s_endpgm
s_endpgm
s_endpgm
s_endpgm
s_endpgm
s_endpgm
s_endpgm
s_endpgm
s_endpgm
s_endpgm
s_endpgm
s_endpgm
s_endpgm
s_endpgm
s_endpgm
s_endpgm
s_endpgm
s_endpgm
s_endpgm
s_endpgm
s_endpgm
s_endpgm
s_endpgm
s_endpgm
s_endpgm
s_endpgm
s_endpgm
s_endpgm
s_endpgm
s_endpgm
s_endpgm
s_endpgm
s_endpgm
s_endpgm
s_endpgm
s_endpgm
s_endpgm
s_endpgm
s_endpgm
s_endpgm
s_endpgm
s_endpgm
s_endpgm
s_endpgm
s_endpgm
s_endpgm
s_endpgm
s_endpgm
s_endpgm
s_endpgm
s_endpgm
s_endpgm
s_endpgm
s_endpgm
s_endpgm
s_endpgm
s_endpgm
s_endpgm
s_endpgm
s_endpgm
s_endpgm
s_endpgm
s_endpgm
s_endpgm
s_endpgm
s_endpgm
s_endpgm
s_endpgm
s_endpgm
s_endpgm
s_endpgm
s_endpgm
s_endpgm
s_endpgm
s_endpgm
s_endpgm
s_endpgm
s_endpgm
s_endpgm
s_endpgm
s_endpgm
s_endpgm
s_endpgm
s_endpgm
s_endpgm
s_endpgm
s_endpgm
s_endpgm
s_endpgm
s_endpgm
s_endpgm
s_endpgm
s_endpgm
s_endpgm
s_endpgm
s_endpgm
s_endpgm
s_endpgm
s_endpgm
s_endpgm
s_endpgm
s_endpgm
s_endpgm
s_endpgm
s_endpgm
s_endpgm
s_endpgm
s_endpgm
s_endpgm
s_endpgm
s_endpgm
s_endpgm
s_endpgm
s_endpgm
s_endpgm
s_endpgm
s_endpgm
s_endpgm
s_endpgm
s_endpgm
s_endpgm
s_endpgm
s_endpgm
s_endpgm
s_endpgm
s_endpgm
s_endpgm
s_endpgm
s_endpgm
s_endpgm
s_endpgm
s_endpgm
s_endpgm
s_endpgm
s_endpgm
s_endpgm
s_endpgm
s_endpgm
s_endpgm
s_endpgm
s_endpgm
s_endpgm
s_endpgm
s_endpgm
s_endpgm
s_endpgm
s_endpgm
s_endpgm
s_endpgm
s_endpgm
s_endpgm
s_endpgm
s_endpgm
s_endpgm
s_endpgm
s_endpgm
s_endpgm
s_endpgm
s_endpgm
s_endpgm
s_endpgm
s_endpgm
s_endpgm
s_endpgm
s_endpgm
s_endpgm
s_endpgm
s_endpgm
s_endpgm
s_endpgm
s_endpgm
s_endpgm
s_endpgm
s_endpgm
s_endpgm
s_endpgm
s_endpgm
s_endpgm
s_endpgm
s_endpgm
s_endpgm
s_endpgm
s_endpgm
s_endpgm
s_endpgm
s_endpgm
s_endpgm
s_endpgm
s_endpgm
s_endpgm
s_endpgm
s_endpgm
s_endpgm
s_endpgm
s_endpgm
s_endpgm
s_endpgm
s_endpgm
s_endpgm
s_endpgm
s_endpgm
s_endpgm
s_endpgm
s_endpgm
s_endpgm
s_endpgm
s_endpgm
s_endpgm
s_endpgm
s_endpgm
s_endpgm
s_endpgm
s_endpgm
s_endpgm
s_endpgm
s_endpgm
s_endpgm
s_endpgm
s_endpgm
s_endpgm
s_endpgm
s_endpgm
s_endpgm
s_endpgm
s_endpgm
s_endpgm
s_endpgm
s_endpgm
s_endpgm
s_endpgm
s_endpgm
s_endpgm
s_endpgm
s_endpgm
s_endpgm
s_endpgm
s_endpgm
s_endpgm
s_endpgm
s_endpgm
s_endpgm
s_endpgm
s_endpgm
s_endpgm
s_endpgm
s_endpgm
s_endpgm
s_endpgm
s_endpgm
s_endpgm
s_endpgm
s_endpgm
s_endpgm
.section .rodata,"a"
.p2align 6
.amdhsa_kernel gated_mix__compressed_kv_cla__swiglu_ffn__prompt_kernel
  .amdhsa_next_free_vgpr 512
  .amdhsa_next_free_sgpr 102
  .amdhsa_accum_offset 256
  .amdhsa_group_segment_fixed_size 0
  .amdhsa_kernarg_size 112
  .amdhsa_user_sgpr_count 2
  .amdhsa_user_sgpr_kernarg_segment_ptr 1
  .amdhsa_system_sgpr_workgroup_id_x 1
.end_amdhsa_kernel
```
